```python
import torch

def _softmax(x, axis=-1):
    return torch.softmax(x, dim=axis)
def _gelu(x):
    return torch.nn.functional.gelu(x, approximate="tanh")
def _silu(x):
    return torch.nn.functional.silu(x)
def _sigmoid(x):
    return torch.sigmoid(x)
def _layernorm(x, axis=-1, eps=1e-5):
    m = x.mean(dim=axis, keepdim=True)
    v = x.var(dim=axis, keepdim=True, unbiased=False)
    return (x - m) / torch.sqrt(v + eps)
def _scatter_add(tgt, idx, src, axis=0):
    return tgt.clone().index_add_(axis, idx, src)
def _segment_sum(src, seg, n):
    out = torch.zeros((n,) + src.shape[1:], dtype=src.dtype)
    return out.index_add_(0, seg, src)
def _pad(x, pw):
    flat = tuple(v for pair in reversed(pw) for v in pair)
    return torch.nn.functional.pad(x, flat)

kernel_name = 'concat_heads__gqa_block_cached__mha_block_cached__near_ridge'

def setup_inputs():

    _w = (lambda a: (lambda t: t.to(torch.bfloat16) if t.is_floating_point() else t)(torch.as_tensor(a)))
    def _A_setup():
        B, Sq, D = 8, 128, 448
        Hq, Hkv, Sk, Dh = 16, 8, 1024, 256
        assert Hq % Hkv == 0, (Hq, Hkv)
        return {
            "x": _w((lambda *s: torch.randn(*s, dtype=torch.bfloat16) * 0.8)(B, Sq, D)),
            "k_cache": _w((lambda *s: torch.randn(*s, dtype=torch.bfloat16) * 0.8)(B, Hkv, Sk, Dh)),
            "v_cache": _w((lambda *s: torch.randn(*s, dtype=torch.bfloat16) * 0.05)(B, Hkv, Sk, Dh)),
            "wq": _w((lambda *s: torch.randn(*s, dtype=torch.bfloat16) * 0.8)(D, Hq * Dh) * (D ** -0.5)),
            "wo": _w((lambda *s: torch.randn(*s, dtype=torch.bfloat16) * 0.05)(Hq * Dh, D) * ((Hq * Dh) ** -0.5)),
        }
    _A_in = _A_setup()

    def _B_setup():
        B, Sq, D = 8, 128, 448
        H, Sk, Dh = 16, 1024, 256
        return {
            "x": _w((lambda *s: torch.randn(*s, dtype=torch.bfloat16) * 0.8)(B, Sq, D)),
            "k_cache": _w((lambda *s: torch.randn(*s, dtype=torch.bfloat16) * 0.8)(B, H, Sk, Dh)),
            "v_cache": _w((lambda *s: torch.randn(*s, dtype=torch.bfloat16) * 0.05)(B, H, Sk, Dh)),
            "wq": _w((lambda *s: torch.randn(*s, dtype=torch.bfloat16) * 0.8)(D, H * Dh) * (D ** -0.5)),
            "wo": _w((lambda *s: torch.randn(*s, dtype=torch.bfloat16) * 0.05)(H * Dh, D) * ((H * Dh) ** -0.5)),
        }
    _B_in = _B_setup()

    return {
        "A_x": _A_in["x"],
        "A_k_cache": _A_in["k_cache"],
        "A_v_cache": _A_in["v_cache"],
        "A_wq": _A_in["wq"],
        "A_wo": _A_in["wo"],
        "B_x": _B_in["x"],
        "B_k_cache": _B_in["k_cache"],
        "B_v_cache": _B_in["v_cache"],
        "B_wq": _B_in["wq"],
        "B_wo": _B_in["wo"],
    }

def reference(A_x, A_k_cache, A_v_cache, A_wq, A_wo, B_x, B_k_cache, B_v_cache, B_wq, B_wo):
    def _A_ref(x, k_cache, v_cache, wq, wo):
        B, Sq, D = x.shape
        Hq, Dh = 16, 256
        Hkv = k_cache.shape[1]
        rep = Hq // Hkv
        q = (lambda x, *d: x.permute(*d))((x @ wq).reshape(B, Sq, Hq, Dh), 0, 2, 1, 3)
        k = (lambda x, n, axis: torch.repeat_interleave(x, n, dim=axis))(k_cache, rep, axis=1)
        v = (lambda x, n, axis: torch.repeat_interleave(x, n, dim=axis))(v_cache, rep, axis=1)
        scores = torch.einsum("bhqd,bhkd->bhqk", q, k) * (Dh ** -0.5)
        p = _softmax(scores, axis=-1)
        o = torch.einsum("bhqk,bhkd->bhqd", p, v)
        return (lambda x, *d: x.permute(*d))(o, 0, 2, 1, 3).reshape(B, Sq, Hq * Dh) @ wo

    def _B_ref(x, k_cache, v_cache, wq, wo):
        B, Sq, D = x.shape
        H, Dh = 16, 256
        q = (lambda x, *d: x.permute(*d))((x @ wq).reshape(B, Sq, H, Dh), 0, 2, 1, 3)
        scores = torch.einsum("bhqd,bhkd->bhqk", q, k_cache) * (Dh ** -0.5)
        p = _softmax(scores, axis=-1)
        o = torch.einsum("bhqk,bhkd->bhqd", p, v_cache)
        return (lambda x, *d: x.permute(*d))(o, 0, 2, 1, 3).reshape(B, Sq, H * Dh) @ wo

    a = _A_ref(A_x, A_k_cache, A_v_cache, A_wq, A_wo)
    b = _B_ref(B_x, B_k_cache, B_v_cache, B_wq, B_wo)
    return torch.concatenate([a, b], axis=-1)
```

```asm
; @launch grid=(256,1,1) block=(256,1,1) lds=163840
.amdgcn_target "amdgcn-amd-amdhsa--gfx950"
.text
.globl concat_heads__gqa_block_cached__mha_block_cached__near_ridge_kernel
.p2align 8
.type concat_heads__gqa_block_cached__mha_block_cached__near_ridge_kernel,@function
concat_heads__gqa_block_cached__mha_block_cached__near_ridge_kernel:
    s_cmp_ge_u32 s2, 256
    s_cbranch_scc1 L_end
    s_and_b32 s3, s2, 1
    s_mul_i32 s4, s3, 40
    s_add_u32 s4, s0, s4
    s_addc_u32 s5, s1, 0
    s_load_dwordx8 s[48:55], s[4:5], 0
    s_load_dwordx2 s[56:57], s[4:5], 32
    s_load_dwordx2 s[58:59], s[0:1], 96
    s_load_dwordx4 s[60:63], s[0:1], 80
    s_bfe_u32 s4, s2, 0x20001
    s_bfe_u32 s5, s2, 0x20003
    s_lshl_b32 s4, s4, 2
    s_add_u32 s4, s4, s5
    s_lshr_b32 s6, s2, 5
    v_lshrrev_b32 v113, 6, v0
    v_and_b32 v0, 63, v0
    v_lshrrev_b32 v114, 5, v0
    v_readfirstlane_b32 s33, v113
    v_and_b32 v115, 31, v0
    v_lshrrev_b32 v116, 3, v0
    v_lshrrev_b32 v117, 4, v0
    v_and_b32 v118, 7, v0
    s_lshl_b32 s32, s33, 12
    v_lshl_add_u32 v119, v113, 5, v116
    v_mul_u32_u24 v119, 896, v119
    v_xor_b32 v49, v118, v117
    v_lshl_add_u32 v20, v49, 4, v119
    v_xor_b32 v49, 4, v49
    v_lshl_add_u32 v21, v49, 4, v119
    v_add_u32 v21, 6144, v21
    v_add_u32 v22, 12288, v20
    v_add_u32 v23, 12288, v21
    v_lshlrev_b32 v12, 1, v114
    v_xor_b32 v12, v12, v115
    v_lshlrev_b32 v12, 4, v12
    s_and_b32 s7, s33, 1
    s_lshl_b32 s7, s7, 2
    s_lshr_b32 s47, s33, 1
    s_add_u32 s7, s7, s47
    s_lshl_b32 s7, s7, 15
    v_lshl_add_u32 v16, v114, 13, v12
    v_add_u32 v16, s7, v16
    v_xor_b32 v17, 64, v16
    v_xor_b32 v18, 128, v16
    v_xor_b32 v19, 192, v16
    v_add_u32 v17, 15360, v17
    v_add_u32 v18, 63488, v18
    v_add_u32 v19, 78848, v19
    s_mov_b32 s37, 0
    s_mov_b32 s36, 0
    s_mul_i32 s7, s6, 114688
    s_lshl_b32 s47, s4, 9
    s_mov_b32 s22, 114688
    s_mov_b32 s23, 0x20000
    s_sub_u32 s18, 3670016, s47
    s_mov_b32 s19, 0x20000
    s_waitcnt lgkmcnt(0)
    s_add_u32 s20, s48, s7
    s_addc_u32 s21, s49, 0
    s_add_u32 s16, s54, s47
    s_addc_u32 s17, s55, 0
    s_add_u32 m0, s32, 65536
    s_nop 0
    buffer_load_dwordx4 v20, s[20:23], s37 offen offset:0  lds
    buffer_load_dwordx4 v21, s[20:23], s37 offen offset:1024  lds
    buffer_load_dwordx4 v22, s[20:23], s37 offen offset:2048  lds
    buffer_load_dwordx4 v23, s[20:23], s37 offen offset:3072  lds
    s_add_u32 s37, s37, 128
    s_add_u32 m0, s32, 0
    s_nop 0
    buffer_load_dwordx4 v16, s[16:19], s36 offen offset:0  lds
    buffer_load_dwordx4 v17, s[16:19], s36 offen offset:1024  lds
    buffer_load_dwordx4 v18, s[16:19], s36 offen offset:2048  lds
    buffer_load_dwordx4 v19, s[16:19], s36 offen offset:3072  lds
    s_add_u32 s36, s36, 262144
    s_getpc_b64 s[42:43]
L_pc0:
    s_mul_i32 s7, s3, L_bodyB - L_bodyA
    s_add_u32 s7, s7, L_bodyA - L_pc0
    s_add_u32 s42, s42, s7
    s_addc_u32 s43, s43, 0
    s_lshr_b32 s7, s2, 3
    s_lshl_b32 s7, s7, 2
    s_add_u32 s7, s7, s33
    s_mul_i32 s7, s7, 320
    v_min_u32 v49, 4, v0
    v_lshl_add_u32 v49, v49, 6, s7
    v_min_u32 v49, L_bodyB - L_bodyA - 4, v49
    v_mov_b32 v65, s43
    v_add_co_u32 v64, vcc, s42, v49
    s_nop 1
    v_addc_co_u32 v65, vcc, 0, v65, vcc
    global_load_dword v66, v[64:65], off
    v_and_b32 v112, 15, v0
    v_lshrrev_b32 v49, 1, v112
    v_xor_b32 v49, v49, v117
    v_lshlrev_b32 v49, 4, v49
    v_lshl_add_u32 v49, v112, 7, v49
    v_lshl_add_u32 v49, v113, 12, v49
    v_add_u32 v40, 65536, v49
    v_xor_b32 v41, 64, v40
    v_and_b32 v120, 3, v0
    v_lshrrev_b32 v121, 2, v0
    v_and_b32 v49, 7, v121
    v_lshlrev_b32 v49, 5, v49
    v_lshl_add_u32 v49, v120, 3, v49
    v_lshl_add_u32 v32, v121, 9, v49
    v_xor_b32 v33, 32, v32
    v_xor_b32 v34, 64, v32
    v_xor_b32 v35, 96, v32
    v_xor_b32 v36, 128, v32
    v_xor_b32 v37, 160, v32
    v_xor_b32 v38, 192, v32
    v_xor_b32 v39, 224, v32
    s_add_u32 m0, s32, 16384
    s_nop 0
    buffer_load_dwordx4 v16, s[16:19], s36 offen offset:0  lds
    buffer_load_dwordx4 v17, s[16:19], s36 offen offset:1024  lds
    buffer_load_dwordx4 v18, s[16:19], s36 offen offset:2048  lds
    buffer_load_dwordx4 v19, s[16:19], s36 offen offset:3072  lds
    s_add_u32 s36, s36, 262144
    s_add_u32 m0, s32, 81920
    s_nop 0
    buffer_load_dwordx4 v20, s[20:23], s37 offen offset:0  lds
    buffer_load_dwordx4 v21, s[20:23], s37 offen offset:1024  lds
    buffer_load_dwordx4 v22, s[20:23], s37 offen offset:2048  lds
    buffer_load_dwordx4 v23, s[20:23], s37 offen offset:3072  lds
    s_add_u32 s37, s37, 128
    s_cmp_eq_u32 s3, 0
    s_cbranch_scc0 L_bodyB
.p2align 6
L_bodyA:
    s_waitcnt vmcnt(9) lgkmcnt(0)
    s_barrier
    s_add_u32 m0, s32, 32768
    s_nop 0
    buffer_load_dwordx4 v16, s[16:19], s36 offen offset:0  lds
    buffer_load_dwordx4 v17, s[16:19], s36 offen offset:1024  lds
    ds_read_b128 a[192:195], v40 offset:0
    ds_read_b128 a[196:199], v40 offset:2048
    ds_read_b128 a[200:203], v41 offset:0
    ds_read_b128 a[204:207], v41 offset:2048
    ds_read_b64_tr_b16 a[64:65], v32 offset:0
    ds_read_b64_tr_b16 a[66:67], v32 offset:8192
    ds_read_b64_tr_b16 a[68:69], v33 offset:0
    ds_read_b64_tr_b16 a[70:71], v33 offset:8192
    ds_read_b64_tr_b16 a[72:73], v34 offset:0
    ds_read_b64_tr_b16 a[74:75], v34 offset:8192
    ds_read_b64_tr_b16 a[76:77], v35 offset:0
    ds_read_b64_tr_b16 a[78:79], v35 offset:8192
    ds_read_b64_tr_b16 a[80:81], v36 offset:0
    ds_read_b64_tr_b16 a[82:83], v36 offset:8192
    ds_read_b64_tr_b16 a[84:85], v37 offset:0
    ds_read_b64_tr_b16 a[86:87], v37 offset:8192
    ds_read_b64_tr_b16 a[88:89], v38 offset:0
    ds_read_b64_tr_b16 a[90:91], v38 offset:8192
    ds_read_b64_tr_b16 a[92:93], v39 offset:0
    ds_read_b64_tr_b16 a[94:95], v39 offset:8192
    buffer_load_dwordx4 v18, s[16:19], s36 offen offset:2048  lds
    ds_read_b64_tr_b16 a[96:97], v32 offset:256
    ds_read_b64_tr_b16 a[98:99], v32 offset:8448
    ds_read_b64_tr_b16 a[100:101], v33 offset:256
    ds_read_b64_tr_b16 a[102:103], v33 offset:8448
    ds_read_b64_tr_b16 a[104:105], v34 offset:256
    ds_read_b64_tr_b16 a[106:107], v34 offset:8448
    ds_read_b64_tr_b16 a[108:109], v35 offset:256
    ds_read_b64_tr_b16 a[110:111], v35 offset:8448
    ds_read_b64_tr_b16 a[112:113], v36 offset:256
    ds_read_b64_tr_b16 a[114:115], v36 offset:8448
    ds_read_b64_tr_b16 a[116:117], v37 offset:256
    ds_read_b64_tr_b16 a[118:119], v37 offset:8448
    ds_read_b64_tr_b16 a[120:121], v38 offset:256
    ds_read_b64_tr_b16 a[122:123], v38 offset:8448
    ds_read_b64_tr_b16 a[124:125], v39 offset:256
    ds_read_b64_tr_b16 a[126:127], v39 offset:8448
    buffer_load_dwordx4 v19, s[16:19], s36 offen offset:3072  lds
    s_add_u32 s36, s36, 262144
    s_add_u32 m0, s32, 49152
    s_nop 0
    buffer_load_dwordx4 v16, s[16:19], s36 offen offset:0  lds
    buffer_load_dwordx4 v17, s[16:19], s36 offen offset:1024  lds
    buffer_load_dwordx4 v18, s[16:19], s36 offen offset:2048  lds
    buffer_load_dwordx4 v19, s[16:19], s36 offen offset:3072  lds
    s_add_u32 s36, s36, 262144
    s_waitcnt vmcnt(12) lgkmcnt(0)
    s_barrier
    v_mfma_f32_16x16x32_bf16 v[128:131], a[64:67], a[192:195], 0
    s_add_u32 m0, s32, 65536
    ds_read_b64_tr_b16 a[128:129], v32 offset:16384
    s_nop 0
    v_mfma_f32_16x16x32_bf16 v[136:139], a[64:67], a[196:199], 0
    ds_read_b64_tr_b16 a[130:131], v32 offset:24576
    v_mfma_f32_16x16x32_bf16 v[140:143], a[68:71], a[196:199], 0
    ds_read_b64_tr_b16 a[132:133], v33 offset:16384
    v_mfma_f32_16x16x32_bf16 v[132:135], a[68:71], a[192:195], 0
    buffer_load_dwordx4 v20, s[20:23], s37 offen offset:0  lds
    v_mfma_f32_16x16x32_bf16 v[144:147], a[72:75], a[192:195], 0
    ds_read_b64_tr_b16 a[134:135], v33 offset:24576
    v_mfma_f32_16x16x32_bf16 v[152:155], a[72:75], a[196:199], 0
    ds_read_b64_tr_b16 a[136:137], v34 offset:16384
    v_mfma_f32_16x16x32_bf16 v[156:159], a[76:79], a[196:199], 0
    ds_read_b64_tr_b16 a[138:139], v34 offset:24576
    ds_read_b64_tr_b16 a[140:141], v35 offset:16384
    v_mfma_f32_16x16x32_bf16 v[148:151], a[76:79], a[192:195], 0
    ds_read_b64_tr_b16 a[142:143], v35 offset:24576
    buffer_load_dwordx4 v21, s[20:23], s37 offen offset:1024  lds
    v_mfma_f32_16x16x32_bf16 v[160:163], a[80:83], a[192:195], 0
    ds_read_b64_tr_b16 a[144:145], v36 offset:16384
    v_mfma_f32_16x16x32_bf16 v[168:171], a[80:83], a[196:199], 0
    ds_read_b64_tr_b16 a[146:147], v36 offset:24576
    v_mfma_f32_16x16x32_bf16 v[172:175], a[84:87], a[196:199], 0
    ds_read_b64_tr_b16 a[148:149], v37 offset:16384
    buffer_load_dwordx4 v22, s[20:23], s37 offen offset:2048  lds
    v_mfma_f32_16x16x32_bf16 v[164:167], a[84:87], a[192:195], 0
    ds_read_b64_tr_b16 a[150:151], v37 offset:24576
    v_mfma_f32_16x16x32_bf16 v[176:179], a[88:91], a[192:195], 0
    ds_read_b64_tr_b16 a[152:153], v38 offset:16384
    v_mfma_f32_16x16x32_bf16 v[184:187], a[88:91], a[196:199], 0
    ds_read_b64_tr_b16 a[154:155], v38 offset:24576
    buffer_load_dwordx4 v23, s[20:23], s37 offen offset:3072  lds
    v_mfma_f32_16x16x32_bf16 v[188:191], a[92:95], a[196:199], 0
    s_add_u32 s37, s37, 128
    ds_read_b64_tr_b16 a[156:157], v39 offset:16384
    s_add_u32 m0, s32, 0
    v_mfma_f32_16x16x32_bf16 v[180:183], a[92:95], a[192:195], 0
    s_nop 0
    ds_read_b64_tr_b16 a[158:159], v39 offset:24576
    ds_read_b64_tr_b16 a[160:161], v32 offset:16640
    v_mfma_f32_16x16x32_bf16 v[192:195], a[96:99], a[192:195], 0
    ds_read_b64_tr_b16 a[162:163], v32 offset:24832
    v_mfma_f32_16x16x32_bf16 v[200:203], a[96:99], a[196:199], 0
    ds_read_b64_tr_b16 a[164:165], v33 offset:16640
    v_mfma_f32_16x16x32_bf16 v[204:207], a[100:103], a[196:199], 0
    ds_read_b64_tr_b16 a[166:167], v33 offset:24832
    buffer_load_dwordx4 v16, s[16:19], s36 offen offset:0  lds
    v_mfma_f32_16x16x32_bf16 v[196:199], a[100:103], a[192:195], 0
    ds_read_b64_tr_b16 a[168:169], v34 offset:16640
    v_mfma_f32_16x16x32_bf16 v[208:211], a[104:107], a[192:195], 0
    ds_read_b64_tr_b16 a[170:171], v34 offset:24832
    v_mfma_f32_16x16x32_bf16 v[216:219], a[104:107], a[196:199], 0
    ds_read_b64_tr_b16 a[172:173], v35 offset:16640
    v_mfma_f32_16x16x32_bf16 v[220:223], a[108:111], a[196:199], 0
    ds_read_b64_tr_b16 a[174:175], v35 offset:24832
    buffer_load_dwordx4 v17, s[16:19], s36 offen offset:1024  lds
    v_mfma_f32_16x16x32_bf16 v[212:215], a[108:111], a[192:195], 0
    ds_read_b64_tr_b16 a[176:177], v36 offset:16640
    v_mfma_f32_16x16x32_bf16 v[224:227], a[112:115], a[192:195], 0
    ds_read_b64_tr_b16 a[178:179], v36 offset:24832
    v_mfma_f32_16x16x32_bf16 v[232:235], a[112:115], a[196:199], 0
    ds_read_b64_tr_b16 a[180:181], v37 offset:16640
    buffer_load_dwordx4 v18, s[16:19], s36 offen offset:2048  lds
    v_mfma_f32_16x16x32_bf16 v[236:239], a[116:119], a[196:199], 0
    ds_read_b64_tr_b16 a[182:183], v37 offset:24832
    ds_read_b64_tr_b16 a[184:185], v38 offset:16640
    v_mfma_f32_16x16x32_bf16 v[228:231], a[116:119], a[192:195], 0
    ds_read_b64_tr_b16 a[186:187], v38 offset:24832
    v_mfma_f32_16x16x32_bf16 v[240:243], a[120:123], a[192:195], 0
    ds_read_b64_tr_b16 a[188:189], v39 offset:16640
    buffer_load_dwordx4 v19, s[16:19], s36 offen offset:3072  lds
    ds_read_b64_tr_b16 a[190:191], v39 offset:24832
    v_mfma_f32_16x16x32_bf16 v[248:251], a[120:123], a[196:199], 0
    s_add_u32 s36, s36, 262144
    v_mfma_f32_16x16x32_bf16 v[252:255], a[124:127], a[196:199], 0
    v_mfma_f32_16x16x32_bf16 v[244:247], a[124:127], a[192:195], 0
    s_lshl_b32 s5, s3, 3
    s_add_u32 s5, s5, s6
    s_lshl_b32 s7, s5, 21
    s_add_u32 s28, s58, s7
    s_addc_u32 s29, s59, 0
    s_mov_b32 s30, 0x200000
    s_mov_b32 s31, 0x20000
    s_and_b32 s7, s4, 7
    s_lshl_b32 s7, s7, 18
    s_lshr_b32 s47, s4, 3
    s_lshl_b32 s47, s47, 9
    s_add_u32 s7, s7, s47
    s_add_u32 s7, s7, 229376
    v_lshlrev_b32 v49, 4, v115
    v_lshl_add_u32 v49, v114, 13, v49
    v_lshl_add_u32 v49, v113, 21, v49
    v_add_u32 v49, s7, v49
    v_mov_b32 v96, 1
    v_mov_b32 v97, 1
    v_mov_b32 v98, 1
    v_mov_b32 v99, 1
    s_mov_b32 s95, 0
    buffer_store_dwordx4 v[96:99], v49, s[28:31], 0 offen sc1
    s_add_u32 s92, s28, s7
    s_addc_u32 s93, s29, 0
    s_lshl_b32 s7, s5, 2
    s_add_u32 s7, s7, s33
    s_mul_i32 s7, s7, 4352
    s_add_u32 s7, s7, 33554432
    s_add_u32 s64, s58, s7
    s_addc_u32 s65, s59, 0
    s_waitcnt vmcnt(13) lgkmcnt(0)
    s_barrier
    v_mfma_f32_16x16x32_bf16 v[128:131], a[128:131], a[200:203], v[128:131]
    s_add_u32 m0, s32, 16384
    ds_read_b128 a[208:211], v40 offset:16384
    s_nop 0
    v_mfma_f32_16x16x32_bf16 v[136:139], a[128:131], a[204:207], v[136:139]
    ds_read_b128 a[212:215], v40 offset:18432
    v_mfma_f32_16x16x32_bf16 v[140:143], a[132:135], a[204:207], v[140:143]
    ds_read_b128 a[216:219], v41 offset:16384
    v_mfma_f32_16x16x32_bf16 v[132:135], a[132:135], a[200:203], v[132:135]
    ds_read_b128 a[220:223], v41 offset:18432
    v_mfma_f32_16x16x32_bf16 v[144:147], a[136:139], a[200:203], v[144:147]
    ds_read_b64_tr_b16 a[64:65], v32 offset:32768
    v_mfma_f32_16x16x32_bf16 v[152:155], a[136:139], a[204:207], v[152:155]
    ds_read_b64_tr_b16 a[66:67], v32 offset:40960
    v_mfma_f32_16x16x32_bf16 v[156:159], a[140:143], a[204:207], v[156:159]
    ds_read_b64_tr_b16 a[68:69], v33 offset:32768
    buffer_load_dwordx4 v16, s[16:19], s36 offen offset:0  lds
    v_mfma_f32_16x16x32_bf16 v[148:151], a[140:143], a[200:203], v[148:151]
    ds_read_b64_tr_b16 a[70:71], v33 offset:40960
    ds_read_b64_tr_b16 a[72:73], v34 offset:32768
    v_mfma_f32_16x16x32_bf16 v[160:163], a[144:147], a[200:203], v[160:163]
    ds_read_b64_tr_b16 a[74:75], v34 offset:40960
    v_mfma_f32_16x16x32_bf16 v[168:171], a[144:147], a[204:207], v[168:171]
    ds_read_b64_tr_b16 a[76:77], v35 offset:32768
    v_mfma_f32_16x16x32_bf16 v[172:175], a[148:151], a[204:207], v[172:175]
    ds_read_b64_tr_b16 a[78:79], v35 offset:40960
    v_mfma_f32_16x16x32_bf16 v[164:167], a[148:151], a[200:203], v[164:167]
    ds_read_b64_tr_b16 a[80:81], v36 offset:32768
    ds_read_b64_tr_b16 a[82:83], v36 offset:40960
    v_mfma_f32_16x16x32_bf16 v[176:179], a[152:155], a[200:203], v[176:179]
    ds_read_b64_tr_b16 a[84:85], v37 offset:32768
    buffer_load_dwordx4 v17, s[16:19], s36 offen offset:1024  lds
    v_mfma_f32_16x16x32_bf16 v[184:187], a[152:155], a[204:207], v[184:187]
    ds_read_b64_tr_b16 a[86:87], v37 offset:40960
    v_mfma_f32_16x16x32_bf16 v[188:191], a[156:159], a[204:207], v[188:191]
    ds_read_b64_tr_b16 a[88:89], v38 offset:32768
    v_mfma_f32_16x16x32_bf16 v[180:183], a[156:159], a[200:203], v[180:183]
    ds_read_b64_tr_b16 a[90:91], v38 offset:40960
    ds_read_b64_tr_b16 a[92:93], v39 offset:32768
    v_mfma_f32_16x16x32_bf16 v[192:195], a[160:163], a[200:203], v[192:195]
    ds_read_b64_tr_b16 a[94:95], v39 offset:40960
    v_mfma_f32_16x16x32_bf16 v[200:203], a[160:163], a[204:207], v[200:203]
    ds_read_b64_tr_b16 a[96:97], v32 offset:33024
    v_mfma_f32_16x16x32_bf16 v[204:207], a[164:167], a[204:207], v[204:207]
    ds_read_b64_tr_b16 a[98:99], v32 offset:41216
    buffer_load_dwordx4 v18, s[16:19], s36 offen offset:2048  lds
    v_mfma_f32_16x16x32_bf16 v[196:199], a[164:167], a[200:203], v[196:199]
    ds_read_b64_tr_b16 a[100:101], v33 offset:33024
    v_mfma_f32_16x16x32_bf16 v[208:211], a[168:171], a[200:203], v[208:211]
    ds_read_b64_tr_b16 a[102:103], v33 offset:41216
    ds_read_b64_tr_b16 a[104:105], v34 offset:33024
    v_mfma_f32_16x16x32_bf16 v[216:219], a[168:171], a[204:207], v[216:219]
    ds_read_b64_tr_b16 a[106:107], v34 offset:41216
    v_mfma_f32_16x16x32_bf16 v[220:223], a[172:175], a[204:207], v[220:223]
    ds_read_b64_tr_b16 a[108:109], v35 offset:33024
    v_mfma_f32_16x16x32_bf16 v[212:215], a[172:175], a[200:203], v[212:215]
    ds_read_b64_tr_b16 a[110:111], v35 offset:41216
    v_mfma_f32_16x16x32_bf16 v[224:227], a[176:179], a[200:203], v[224:227]
    ds_read_b64_tr_b16 a[112:113], v36 offset:33024
    ds_read_b64_tr_b16 a[114:115], v36 offset:41216
    v_mfma_f32_16x16x32_bf16 v[232:235], a[176:179], a[204:207], v[232:235]
    ds_read_b64_tr_b16 a[116:117], v37 offset:33024
    buffer_load_dwordx4 v19, s[16:19], s36 offen offset:3072  lds
    v_mfma_f32_16x16x32_bf16 v[236:239], a[180:183], a[204:207], v[236:239]
    s_add_u32 s36, s36, 262144
    ds_read_b64_tr_b16 a[118:119], v37 offset:41216
    v_mfma_f32_16x16x32_bf16 v[228:231], a[180:183], a[200:203], v[228:231]
    ds_read_b64_tr_b16 a[120:121], v38 offset:33024
    v_mfma_f32_16x16x32_bf16 v[240:243], a[184:187], a[200:203], v[240:243]
    ds_read_b64_tr_b16 a[122:123], v38 offset:41216
    ds_read_b64_tr_b16 a[124:125], v39 offset:33024
    ds_read_b64_tr_b16 a[126:127], v39 offset:41216
    v_mfma_f32_16x16x32_bf16 v[248:251], a[184:187], a[204:207], v[248:251]
    v_mfma_f32_16x16x32_bf16 v[252:255], a[188:191], a[204:207], v[252:255]
    v_mfma_f32_16x16x32_bf16 v[244:247], a[188:191], a[200:203], v[244:247]
    s_mov_b32 s66, 128
    s_mov_b32 s67, 0x20000
    s_lshl_b32 s7, s4, 7
    v_lshl_add_u32 v1, v0, 2, s7
    v_mov_b32 v7, 0
    buffer_store_dword v7, v1, s[64:67], 0 offen sc1
    v_lshlrev_b32 v2, 7, v0
    v_add_u32 v55, v113, v0
    v_lshlrev_b32 v55, 2, v55
    s_lshl_b32 s7, s6, 4
    s_add_u32 s7, s7, s4
    s_xor_b32 s47, s3, 1
    s_lshr_b32 s7, s7, s47
    s_mul_i32 s34, s7, 16
    s_add_u32 s34, s34, -1
    s_lshl_b32 s34, s34, 14
    s_mov_b32 s35, s34
    s_lshl_b32 s7, s7, 19
    s_add_u32 s8, s50, s7
    s_addc_u32 s9, s51, 0
    s_mov_b32 s10, 0x80000
    s_mov_b32 s11, 0x20000
    s_add_u32 s12, s52, s7
    s_addc_u32 s13, s53, 0
    s_mov_b32 s14, 0x80000
    s_mov_b32 s15, 0x20000
    s_mul_i32 s7, s4, 229376
    s_add_u32 s24, s56, s7
    s_addc_u32 s25, s57, 0
    s_mov_b32 s26, 229376
    s_mov_b32 s27, 0x20000
    s_waitcnt vmcnt(14) lgkmcnt(0)
    s_barrier
    v_mfma_f32_16x16x32_bf16 v[128:131], a[64:67], a[208:211], v[128:131]
    s_add_u32 m0, s32, 81920
    ds_read_b64_tr_b16 a[128:129], v32 offset:49152
    s_nop 0
    v_mfma_f32_16x16x32_bf16 v[136:139], a[64:67], a[212:215], v[136:139]
    ds_read_b64_tr_b16 a[130:131], v32 offset:57344
    v_mfma_f32_16x16x32_bf16 v[140:143], a[68:71], a[212:215], v[140:143]
    ds_read_b64_tr_b16 a[132:133], v33 offset:49152
    v_mfma_f32_16x16x32_bf16 v[132:135], a[68:71], a[208:211], v[132:135]
    buffer_load_dwordx4 v20, s[20:23], s37 offen offset:0  lds
    v_mfma_f32_16x16x32_bf16 v[144:147], a[72:75], a[208:211], v[144:147]
    ds_read_b64_tr_b16 a[134:135], v33 offset:57344
    v_mfma_f32_16x16x32_bf16 v[152:155], a[72:75], a[212:215], v[152:155]
    ds_read_b64_tr_b16 a[136:137], v34 offset:49152
    v_mfma_f32_16x16x32_bf16 v[156:159], a[76:79], a[212:215], v[156:159]
    ds_read_b64_tr_b16 a[138:139], v34 offset:57344
    ds_read_b64_tr_b16 a[140:141], v35 offset:49152
    v_mfma_f32_16x16x32_bf16 v[148:151], a[76:79], a[208:211], v[148:151]
    ds_read_b64_tr_b16 a[142:143], v35 offset:57344
    buffer_load_dwordx4 v21, s[20:23], s37 offen offset:1024  lds
    v_mfma_f32_16x16x32_bf16 v[160:163], a[80:83], a[208:211], v[160:163]
    ds_read_b64_tr_b16 a[144:145], v36 offset:49152
    v_mfma_f32_16x16x32_bf16 v[168:171], a[80:83], a[212:215], v[168:171]
    ds_read_b64_tr_b16 a[146:147], v36 offset:57344
    v_mfma_f32_16x16x32_bf16 v[172:175], a[84:87], a[212:215], v[172:175]
    ds_read_b64_tr_b16 a[148:149], v37 offset:49152
    buffer_load_dwordx4 v22, s[20:23], s37 offen offset:2048  lds
    v_mfma_f32_16x16x32_bf16 v[164:167], a[84:87], a[208:211], v[164:167]
    ds_read_b64_tr_b16 a[150:151], v37 offset:57344
    v_mfma_f32_16x16x32_bf16 v[176:179], a[88:91], a[208:211], v[176:179]
    ds_read_b64_tr_b16 a[152:153], v38 offset:49152
    v_mfma_f32_16x16x32_bf16 v[184:187], a[88:91], a[212:215], v[184:187]
    ds_read_b64_tr_b16 a[154:155], v38 offset:57344
    buffer_load_dwordx4 v23, s[20:23], s37 offen offset:3072  lds
    v_mfma_f32_16x16x32_bf16 v[188:191], a[92:95], a[212:215], v[188:191]
    s_add_u32 s37, s37, 128
    ds_read_b64_tr_b16 a[156:157], v39 offset:49152
    s_add_u32 m0, s32, 32768
    v_mfma_f32_16x16x32_bf16 v[180:183], a[92:95], a[208:211], v[180:183]
    s_nop 0
    ds_read_b64_tr_b16 a[158:159], v39 offset:57344
    ds_read_b64_tr_b16 a[160:161], v32 offset:49408
    v_mfma_f32_16x16x32_bf16 v[192:195], a[96:99], a[208:211], v[192:195]
    ds_read_b64_tr_b16 a[162:163], v32 offset:57600
    v_mfma_f32_16x16x32_bf16 v[200:203], a[96:99], a[212:215], v[200:203]
    ds_read_b64_tr_b16 a[164:165], v33 offset:49408
    v_mfma_f32_16x16x32_bf16 v[204:207], a[100:103], a[212:215], v[204:207]
    ds_read_b64_tr_b16 a[166:167], v33 offset:57600
    buffer_load_dwordx4 v16, s[16:19], s36 offen offset:0  lds
    v_mfma_f32_16x16x32_bf16 v[196:199], a[100:103], a[208:211], v[196:199]
    ds_read_b64_tr_b16 a[168:169], v34 offset:49408
    v_mfma_f32_16x16x32_bf16 v[208:211], a[104:107], a[208:211], v[208:211]
    ds_read_b64_tr_b16 a[170:171], v34 offset:57600
    v_mfma_f32_16x16x32_bf16 v[216:219], a[104:107], a[212:215], v[216:219]
    ds_read_b64_tr_b16 a[172:173], v35 offset:49408
    v_mfma_f32_16x16x32_bf16 v[220:223], a[108:111], a[212:215], v[220:223]
    ds_read_b64_tr_b16 a[174:175], v35 offset:57600
    buffer_load_dwordx4 v17, s[16:19], s36 offen offset:1024  lds
    v_mfma_f32_16x16x32_bf16 v[212:215], a[108:111], a[208:211], v[212:215]
    ds_read_b64_tr_b16 a[176:177], v36 offset:49408
    v_mfma_f32_16x16x32_bf16 v[224:227], a[112:115], a[208:211], v[224:227]
    ds_read_b64_tr_b16 a[178:179], v36 offset:57600
    v_mfma_f32_16x16x32_bf16 v[232:235], a[112:115], a[212:215], v[232:235]
    ds_read_b64_tr_b16 a[180:181], v37 offset:49408
    buffer_load_dwordx4 v18, s[16:19], s36 offen offset:2048  lds
    v_mfma_f32_16x16x32_bf16 v[236:239], a[116:119], a[212:215], v[236:239]
    ds_read_b64_tr_b16 a[182:183], v37 offset:57600
    ds_read_b64_tr_b16 a[184:185], v38 offset:49408
    v_mfma_f32_16x16x32_bf16 v[228:231], a[116:119], a[208:211], v[228:231]
    ds_read_b64_tr_b16 a[186:187], v38 offset:57600
    v_mfma_f32_16x16x32_bf16 v[240:243], a[120:123], a[208:211], v[240:243]
    ds_read_b64_tr_b16 a[188:189], v39 offset:49408
    buffer_load_dwordx4 v19, s[16:19], s36 offen offset:3072  lds
    ds_read_b64_tr_b16 a[190:191], v39 offset:57600
    v_mfma_f32_16x16x32_bf16 v[248:251], a[120:123], a[212:215], v[248:251]
    s_add_u32 s36, s36, 262144
    v_mfma_f32_16x16x32_bf16 v[252:255], a[124:127], a[212:215], v[252:255]
    v_mfma_f32_16x16x32_bf16 v[244:247], a[124:127], a[208:211], v[244:247]
    s_lshl_b32 s7, s5, 4
    s_add_u32 s68, s62, s7
    s_addc_u32 s69, s63, 0
    s_mov_b32 s70, 4
    s_mov_b32 s71, 0x20000
    s_mov_b32 s72, s60
    s_mov_b32 s73, s61
    s_mov_b32 s74, 1835008
    s_mov_b32 s75, 0x20000
    s_mov_b32 s48, s28
    s_mov_b32 s49, s29
    s_mov_b32 s50, 0
    s_mov_b32 s51, 0x20000
    s_mov_b32 s52, 0
    s_mov_b32 s46, 0
    s_mov_b32 s87, 0x40000
    s_mov_b32 s86, 0x40000
    s_mov_b32 s88, 0
    s_mov_b32 s89, -1
    s_mov_b32 s40, 0x41000000
    s_mov_b32 s41, 0x3db8aa3b
    s_lshl_b32 s7, s6, 7
    s_cmp_ge_u32 s7, 896
    s_cselect_b32 s76, 0, s7
    s_add_u32 s7, s76, 128
    s_cmp_ge_u32 s7, 896
    s_cselect_b32 s77, 0, s7
    s_add_u32 s7, s77, 128
    s_cmp_ge_u32 s7, 896
    s_cselect_b32 s78, 0, s7
    s_add_u32 s7, s78, 128
    s_cmp_ge_u32 s7, 896
    s_cselect_b32 s79, 0, s7
    s_waitcnt vmcnt(14) lgkmcnt(0)
    s_barrier
    v_mfma_f32_16x16x32_bf16 v[128:131], a[128:131], a[216:219], v[128:131]
    s_add_u32 m0, s32, 49152
    ds_read_b128 a[192:195], v40 offset:0
    s_nop 0
    v_mfma_f32_16x16x32_bf16 v[136:139], a[128:131], a[220:223], v[136:139]
    ds_read_b128 a[196:199], v40 offset:2048
    v_mfma_f32_16x16x32_bf16 v[140:143], a[132:135], a[220:223], v[140:143]
    ds_read_b128 a[200:203], v41 offset:0
    v_mfma_f32_16x16x32_bf16 v[132:135], a[132:135], a[216:219], v[132:135]
    ds_read_b128 a[204:207], v41 offset:2048
    v_mfma_f32_16x16x32_bf16 v[144:147], a[136:139], a[216:219], v[144:147]
    ds_read_b64_tr_b16 a[64:65], v32 offset:0
    v_mfma_f32_16x16x32_bf16 v[152:155], a[136:139], a[220:223], v[152:155]
    ds_read_b64_tr_b16 a[66:67], v32 offset:8192
    v_mfma_f32_16x16x32_bf16 v[156:159], a[140:143], a[220:223], v[156:159]
    ds_read_b64_tr_b16 a[68:69], v33 offset:0
    buffer_load_dwordx4 v16, s[16:19], s36 offen offset:0  lds
    v_mfma_f32_16x16x32_bf16 v[148:151], a[140:143], a[216:219], v[148:151]
    ds_read_b64_tr_b16 a[70:71], v33 offset:8192
    ds_read_b64_tr_b16 a[72:73], v34 offset:0
    v_mfma_f32_16x16x32_bf16 v[160:163], a[144:147], a[216:219], v[160:163]
    ds_read_b64_tr_b16 a[74:75], v34 offset:8192
    v_mfma_f32_16x16x32_bf16 v[168:171], a[144:147], a[220:223], v[168:171]
    ds_read_b64_tr_b16 a[76:77], v35 offset:0
    v_mfma_f32_16x16x32_bf16 v[172:175], a[148:151], a[220:223], v[172:175]
    ds_read_b64_tr_b16 a[78:79], v35 offset:8192
    v_mfma_f32_16x16x32_bf16 v[164:167], a[148:151], a[216:219], v[164:167]
    ds_read_b64_tr_b16 a[80:81], v36 offset:0
    ds_read_b64_tr_b16 a[82:83], v36 offset:8192
    v_mfma_f32_16x16x32_bf16 v[176:179], a[152:155], a[216:219], v[176:179]
    ds_read_b64_tr_b16 a[84:85], v37 offset:0
    buffer_load_dwordx4 v17, s[16:19], s36 offen offset:1024  lds
    v_mfma_f32_16x16x32_bf16 v[184:187], a[152:155], a[220:223], v[184:187]
    ds_read_b64_tr_b16 a[86:87], v37 offset:8192
    v_mfma_f32_16x16x32_bf16 v[188:191], a[156:159], a[220:223], v[188:191]
    ds_read_b64_tr_b16 a[88:89], v38 offset:0
    v_mfma_f32_16x16x32_bf16 v[180:183], a[156:159], a[216:219], v[180:183]
    ds_read_b64_tr_b16 a[90:91], v38 offset:8192
    ds_read_b64_tr_b16 a[92:93], v39 offset:0
    v_mfma_f32_16x16x32_bf16 v[192:195], a[160:163], a[216:219], v[192:195]
    ds_read_b64_tr_b16 a[94:95], v39 offset:8192
    v_mfma_f32_16x16x32_bf16 v[200:203], a[160:163], a[220:223], v[200:203]
    ds_read_b64_tr_b16 a[96:97], v32 offset:256
    v_mfma_f32_16x16x32_bf16 v[204:207], a[164:167], a[220:223], v[204:207]
    ds_read_b64_tr_b16 a[98:99], v32 offset:8448
    buffer_load_dwordx4 v18, s[16:19], s36 offen offset:2048  lds
    v_mfma_f32_16x16x32_bf16 v[196:199], a[164:167], a[216:219], v[196:199]
    ds_read_b64_tr_b16 a[100:101], v33 offset:256
    v_mfma_f32_16x16x32_bf16 v[208:211], a[168:171], a[216:219], v[208:211]
    ds_read_b64_tr_b16 a[102:103], v33 offset:8448
    ds_read_b64_tr_b16 a[104:105], v34 offset:256
    v_mfma_f32_16x16x32_bf16 v[216:219], a[168:171], a[220:223], v[216:219]
    ds_read_b64_tr_b16 a[106:107], v34 offset:8448
    v_mfma_f32_16x16x32_bf16 v[220:223], a[172:175], a[220:223], v[220:223]
    ds_read_b64_tr_b16 a[108:109], v35 offset:256
    v_mfma_f32_16x16x32_bf16 v[212:215], a[172:175], a[216:219], v[212:215]
    ds_read_b64_tr_b16 a[110:111], v35 offset:8448
    v_mfma_f32_16x16x32_bf16 v[224:227], a[176:179], a[216:219], v[224:227]
    ds_read_b64_tr_b16 a[112:113], v36 offset:256
    ds_read_b64_tr_b16 a[114:115], v36 offset:8448
    v_mfma_f32_16x16x32_bf16 v[232:235], a[176:179], a[220:223], v[232:235]
    ds_read_b64_tr_b16 a[116:117], v37 offset:256
    buffer_load_dwordx4 v19, s[16:19], s36 offen offset:3072  lds
    v_mfma_f32_16x16x32_bf16 v[236:239], a[180:183], a[220:223], v[236:239]
    s_add_u32 s36, s36, 262144
    ds_read_b64_tr_b16 a[118:119], v37 offset:8448
    v_mfma_f32_16x16x32_bf16 v[228:231], a[180:183], a[216:219], v[228:231]
    ds_read_b64_tr_b16 a[120:121], v38 offset:256
    v_mfma_f32_16x16x32_bf16 v[240:243], a[184:187], a[216:219], v[240:243]
    ds_read_b64_tr_b16 a[122:123], v38 offset:8448
    ds_read_b64_tr_b16 a[124:125], v39 offset:256
    ds_read_b64_tr_b16 a[126:127], v39 offset:8448
    v_mfma_f32_16x16x32_bf16 v[248:251], a[184:187], a[220:223], v[248:251]
    v_mfma_f32_16x16x32_bf16 v[252:255], a[188:191], a[220:223], v[252:255]
    v_mfma_f32_16x16x32_bf16 v[244:247], a[188:191], a[216:219], v[244:247]
    s_add_u32 s7, s79, 128
    s_cmp_ge_u32 s7, 896
    s_cselect_b32 s80, 0, s7
    s_add_u32 s7, s80, 128
    s_cmp_ge_u32 s7, 896
    s_cselect_b32 s81, 0, s7
    s_add_u32 s7, s81, 128
    s_cmp_ge_u32 s7, 896
    s_cselect_b32 s82, 0, s7
    s_add_u32 s7, s82, 128
    s_lshl_b32 s83, s33, 11
    s_add_u32 s83, s83, 65536
    s_mov_b32 s84, s76
    s_mov_b32 s85, s77
    v_lshl_add_u32 v50, v113, 3, v114
    v_lshl_add_u32 v12, v50, 9, v12
    v_and_b32 v49, 15, v50
    v_xor_b32 v49, v49, v115
    v_lshlrev_b32 v49, 4, v49
    v_lshl_add_u32 v8, v50, 9, v49
    v_xor_b32 v9, 32, v8
    v_xor_b32 v10, 64, v8
    v_xor_b32 v11, 96, v8
    v_xor_b32 v13, 64, v12
    v_xor_b32 v14, 128, v12
    v_xor_b32 v15, 192, v12
    v_lshlrev_b32 v49, 1, v117
    v_xor_b32 v49, v49, v118
    v_lshl_add_u32 v24, v49, 4, v119
    v_add_u32 v25, 6144, v24
    v_add_u32 v26, 12288, v24
    s_waitcnt vmcnt(13) lgkmcnt(0)
    s_barrier
    s_mov_b64 s[90:91], 0
    s_mov_b32 s98, 0
    s_cmp_lg_u32 s33, 0
    s_cbranch_scc1 L_noprobe0A
    s_load_dword s90, s[92:93], 0 glc
    s_load_dword s91, s[92:93], 8192 glc
L_noprobe0A:
    v_mfma_f32_16x16x32_bf16 v[128:131], a[64:67], a[192:195], v[128:131]
    s_add_u32 m0, s32, 65536
    ds_read_b64_tr_b16 a[128:129], v32 offset:16384
    s_nop 0
    v_mfma_f32_16x16x32_bf16 v[136:139], a[64:67], a[196:199], v[136:139]
    ds_read_b64_tr_b16 a[130:131], v32 offset:24576
    v_mfma_f32_16x16x32_bf16 v[140:143], a[68:71], a[196:199], v[140:143]
    ds_read_b64_tr_b16 a[132:133], v33 offset:16384
    v_mfma_f32_16x16x32_bf16 v[132:135], a[68:71], a[192:195], v[132:135]
    buffer_load_dwordx4 v20, s[20:23], s37 offen offset:0  lds
    v_mfma_f32_16x16x32_bf16 v[144:147], a[72:75], a[192:195], v[144:147]
    ds_read_b64_tr_b16 a[134:135], v33 offset:24576
    v_mfma_f32_16x16x32_bf16 v[152:155], a[72:75], a[196:199], v[152:155]
    ds_read_b64_tr_b16 a[136:137], v34 offset:16384
    v_mfma_f32_16x16x32_bf16 v[156:159], a[76:79], a[196:199], v[156:159]
    ds_read_b64_tr_b16 a[138:139], v34 offset:24576
    ds_read_b64_tr_b16 a[140:141], v35 offset:16384
    v_mfma_f32_16x16x32_bf16 v[148:151], a[76:79], a[192:195], v[148:151]
    ds_read_b64_tr_b16 a[142:143], v35 offset:24576
    buffer_load_dwordx4 v21, s[20:23], s37 offen offset:1024  lds
    v_mfma_f32_16x16x32_bf16 v[160:163], a[80:83], a[192:195], v[160:163]
    ds_read_b64_tr_b16 a[144:145], v36 offset:16384
    v_mfma_f32_16x16x32_bf16 v[168:171], a[80:83], a[196:199], v[168:171]
    ds_read_b64_tr_b16 a[146:147], v36 offset:24576
    v_mfma_f32_16x16x32_bf16 v[172:175], a[84:87], a[196:199], v[172:175]
    ds_read_b64_tr_b16 a[148:149], v37 offset:16384
    buffer_load_dwordx4 v22, s[20:23], s37 offen offset:2048  lds
    v_mfma_f32_16x16x32_bf16 v[164:167], a[84:87], a[192:195], v[164:167]
    ds_read_b64_tr_b16 a[150:151], v37 offset:24576
    v_mfma_f32_16x16x32_bf16 v[176:179], a[88:91], a[192:195], v[176:179]
    ds_read_b64_tr_b16 a[152:153], v38 offset:16384
    v_mfma_f32_16x16x32_bf16 v[184:187], a[88:91], a[196:199], v[184:187]
    ds_read_b64_tr_b16 a[154:155], v38 offset:24576
    buffer_load_dwordx4 v23, s[20:23], s37 offen offset:3072  lds
    v_mfma_f32_16x16x32_bf16 v[188:191], a[92:95], a[196:199], v[188:191]
    s_add_u32 s37, s37, 128
    ds_read_b64_tr_b16 a[156:157], v39 offset:16384
    s_add_u32 m0, s32, 0
    v_mfma_f32_16x16x32_bf16 v[180:183], a[92:95], a[192:195], v[180:183]
    s_nop 0
    ds_read_b64_tr_b16 a[158:159], v39 offset:24576
    ds_read_b64_tr_b16 a[160:161], v32 offset:16640
    v_mfma_f32_16x16x32_bf16 v[192:195], a[96:99], a[192:195], v[192:195]
    s_andn2_b32 s94, s90, s91
    ds_read_b64_tr_b16 a[162:163], v32 offset:24832
    s_or_b32 s98, s98, s94
    v_mfma_f32_16x16x32_bf16 v[200:203], a[96:99], a[196:199], v[200:203]
    s_andn2_b32 s94, s90, s91
    ds_read_b64_tr_b16 a[164:165], v33 offset:16640
    s_or_b32 s98, s98, s94
    v_mfma_f32_16x16x32_bf16 v[204:207], a[100:103], a[196:199], v[204:207]
    s_andn2_b32 s94, s90, s91
    ds_read_b64_tr_b16 a[166:167], v33 offset:24832
    buffer_load_dwordx4 v16, s[16:19], s36 offen offset:0  lds
    v_mfma_f32_16x16x32_bf16 v[196:199], a[100:103], a[192:195], v[196:199]
    s_or_b32 s98, s98, s94
    ds_read_b64_tr_b16 a[168:169], v34 offset:16640
    s_andn2_b32 s94, s90, s91
    v_mfma_f32_16x16x32_bf16 v[208:211], a[104:107], a[192:195], v[208:211]
    s_or_b32 s98, s98, s94
    ds_read_b64_tr_b16 a[170:171], v34 offset:24832
    v_mfma_f32_16x16x32_bf16 v[216:219], a[104:107], a[196:199], v[216:219]
    s_andn2_b32 s94, s90, s91
    ds_read_b64_tr_b16 a[172:173], v35 offset:16640
    v_mfma_f32_16x16x32_bf16 v[220:223], a[108:111], a[196:199], v[220:223]
    s_or_b32 s98, s98, s94
    ds_read_b64_tr_b16 a[174:175], v35 offset:24832
    buffer_load_dwordx4 v17, s[16:19], s36 offen offset:1024  lds
    v_mfma_f32_16x16x32_bf16 v[212:215], a[108:111], a[192:195], v[212:215]
    s_andn2_b32 s94, s90, s91
    ds_read_b64_tr_b16 a[176:177], v36 offset:16640
    v_mfma_f32_16x16x32_bf16 v[224:227], a[112:115], a[192:195], v[224:227]
    s_or_b32 s98, s98, s94
    ds_read_b64_tr_b16 a[178:179], v36 offset:24832
    v_mfma_f32_16x16x32_bf16 v[232:235], a[112:115], a[196:199], v[232:235]
    s_andn2_b32 s94, s90, s91
    ds_read_b64_tr_b16 a[180:181], v37 offset:16640
    buffer_load_dwordx4 v18, s[16:19], s36 offen offset:2048  lds
    v_mfma_f32_16x16x32_bf16 v[236:239], a[116:119], a[196:199], v[236:239]
    s_or_b32 s98, s98, s94
    ds_read_b64_tr_b16 a[182:183], v37 offset:24832
    ds_read_b64_tr_b16 a[184:185], v38 offset:16640
    v_mfma_f32_16x16x32_bf16 v[228:231], a[116:119], a[192:195], v[228:231]
    s_andn2_b32 s94, s90, s91
    ds_read_b64_tr_b16 a[186:187], v38 offset:24832
    s_or_b32 s98, s98, s94
    v_mfma_f32_16x16x32_bf16 v[240:243], a[120:123], a[192:195], v[240:243]
    s_andn2_b32 s94, s90, s91
    ds_read_b64_tr_b16 a[188:189], v39 offset:16640
    buffer_load_dwordx4 v19, s[16:19], s36 offen offset:3072  lds
    ds_read_b64_tr_b16 a[190:191], v39 offset:24832
    v_mfma_f32_16x16x32_bf16 v[248:251], a[120:123], a[196:199], v[248:251]
    s_add_u32 s36, s36, 262144
    s_or_b32 s98, s98, s94
    v_mfma_f32_16x16x32_bf16 v[252:255], a[124:127], a[196:199], v[252:255]
    v_mfma_f32_16x16x32_bf16 v[244:247], a[124:127], a[192:195], v[244:247]
    s_andn2_b32 s94, s90, s91
    s_or_b32 s98, s98, s94
    v_add_u32 v27, 18432, v24
    v_xor_b32 v49, v112, v117
    v_lshlrev_b32 v49, 4, v49
    v_lshl_add_u32 v28, v112, 9, v49
    v_xor_b32 v29, 64, v28
    v_xor_b32 v30, 128, v28
    v_xor_b32 v31, 192, v28
    s_and_b32 s7, s33, 1
    s_andn2_b32 s94, s90, s91
    s_or_b32 s98, s98, s94
    s_lshl_b32 s7, s7, 12
    s_lshr_b32 s47, s33, 1
    s_lshl_b32 s47, s47, 14
    s_or_b32 s7, s7, s47
    v_and_b32 v49, 12, v112
    v_xor_b32 v53, s4, v49
    v_lshlrev_b32 v53, 8, v53
    v_lshl_add_u32 v53, v49, 17, v53
    s_andn2_b32 s94, s90, s91
    s_or_b32 s98, s98, s94
    v_lshl_add_u32 v53, v117, 6, v53
    v_lshl_add_u32 v53, v120, 4, v53
    s_lshl_b32 s47, s7, 1
    s_and_b32 s47, s47, 0x2000
    s_or_b32 s47, s47, s7
    v_add_u32 v53, s47, v53
    s_and_b32 s47, s4, 7
    s_lshl_b32 s47, s47, 18
    s_andn2_b32 s94, s90, s91
    s_or_b32 s98, s98, s94
    s_or_b32 s7, s7, s47
    s_lshr_b32 s47, s4, 3
    s_lshl_b32 s47, s47, 13
    s_or_b32 s7, s7, s47
    s_andn2_b32 s94, s90, s91
    s_or_b32 s98, s98, s94
    s_add_u32 s95, s95, s98
    s_waitcnt vmcnt(12) lgkmcnt(0)
    s_barrier
    v_mfma_f32_16x16x32_bf16 v[128:131], a[128:131], a[200:203], v[128:131]
    s_add_u32 m0, s32, 16384
    ds_read_b128 a[208:211], v40 offset:16384
    s_nop 0
    v_mfma_f32_16x16x32_bf16 v[136:139], a[128:131], a[204:207], v[136:139]
    ds_read_b128 a[212:215], v40 offset:18432
    v_mfma_f32_16x16x32_bf16 v[140:143], a[132:135], a[204:207], v[140:143]
    ds_read_b128 a[216:219], v41 offset:16384
    v_mfma_f32_16x16x32_bf16 v[132:135], a[132:135], a[200:203], v[132:135]
    ds_read_b128 a[220:223], v41 offset:18432
    v_mfma_f32_16x16x32_bf16 v[144:147], a[136:139], a[200:203], v[144:147]
    ds_read_b64_tr_b16 a[64:65], v32 offset:32768
    v_mfma_f32_16x16x32_bf16 v[152:155], a[136:139], a[204:207], v[152:155]
    ds_read_b64_tr_b16 a[66:67], v32 offset:40960
    v_mfma_f32_16x16x32_bf16 v[156:159], a[140:143], a[204:207], v[156:159]
    ds_read_b64_tr_b16 a[68:69], v33 offset:32768
    buffer_load_dwordx4 v16, s[16:19], s36 offen offset:0  lds
    v_mfma_f32_16x16x32_bf16 v[148:151], a[140:143], a[200:203], v[148:151]
    ds_read_b64_tr_b16 a[70:71], v33 offset:40960
    ds_read_b64_tr_b16 a[72:73], v34 offset:32768
    v_mfma_f32_16x16x32_bf16 v[160:163], a[144:147], a[200:203], v[160:163]
    ds_read_b64_tr_b16 a[74:75], v34 offset:40960
    v_mfma_f32_16x16x32_bf16 v[168:171], a[144:147], a[204:207], v[168:171]
    ds_read_b64_tr_b16 a[76:77], v35 offset:32768
    v_mfma_f32_16x16x32_bf16 v[172:175], a[148:151], a[204:207], v[172:175]
    ds_read_b64_tr_b16 a[78:79], v35 offset:40960
    v_mfma_f32_16x16x32_bf16 v[164:167], a[148:151], a[200:203], v[164:167]
    ds_read_b64_tr_b16 a[80:81], v36 offset:32768
    ds_read_b64_tr_b16 a[82:83], v36 offset:40960
    v_mfma_f32_16x16x32_bf16 v[176:179], a[152:155], a[200:203], v[176:179]
    ds_read_b64_tr_b16 a[84:85], v37 offset:32768
    buffer_load_dwordx4 v17, s[16:19], s36 offen offset:1024  lds
    v_mfma_f32_16x16x32_bf16 v[184:187], a[152:155], a[204:207], v[184:187]
    ds_read_b64_tr_b16 a[86:87], v37 offset:40960
    v_mfma_f32_16x16x32_bf16 v[188:191], a[156:159], a[204:207], v[188:191]
    ds_read_b64_tr_b16 a[88:89], v38 offset:32768
    v_mfma_f32_16x16x32_bf16 v[180:183], a[156:159], a[200:203], v[180:183]
    ds_read_b64_tr_b16 a[90:91], v38 offset:40960
    ds_read_b64_tr_b16 a[92:93], v39 offset:32768
    v_mfma_f32_16x16x32_bf16 v[192:195], a[160:163], a[200:203], v[192:195]
    ds_read_b64_tr_b16 a[94:95], v39 offset:40960
    v_mfma_f32_16x16x32_bf16 v[200:203], a[160:163], a[204:207], v[200:203]
    ds_read_b64_tr_b16 a[96:97], v32 offset:33024
    v_mfma_f32_16x16x32_bf16 v[204:207], a[164:167], a[204:207], v[204:207]
    ds_read_b64_tr_b16 a[98:99], v32 offset:41216
    buffer_load_dwordx4 v18, s[16:19], s36 offen offset:2048  lds
    v_mfma_f32_16x16x32_bf16 v[196:199], a[164:167], a[200:203], v[196:199]
    ds_read_b64_tr_b16 a[100:101], v33 offset:33024
    v_mfma_f32_16x16x32_bf16 v[208:211], a[168:171], a[200:203], v[208:211]
    ds_read_b64_tr_b16 a[102:103], v33 offset:41216
    ds_read_b64_tr_b16 a[104:105], v34 offset:33024
    v_mfma_f32_16x16x32_bf16 v[216:219], a[168:171], a[204:207], v[216:219]
    ds_read_b64_tr_b16 a[106:107], v34 offset:41216
    v_mfma_f32_16x16x32_bf16 v[220:223], a[172:175], a[204:207], v[220:223]
    ds_read_b64_tr_b16 a[108:109], v35 offset:33024
    v_mfma_f32_16x16x32_bf16 v[212:215], a[172:175], a[200:203], v[212:215]
    ds_read_b64_tr_b16 a[110:111], v35 offset:41216
    v_mfma_f32_16x16x32_bf16 v[224:227], a[176:179], a[200:203], v[224:227]
    ds_read_b64_tr_b16 a[112:113], v36 offset:33024
    ds_read_b64_tr_b16 a[114:115], v36 offset:41216
    v_mfma_f32_16x16x32_bf16 v[232:235], a[176:179], a[204:207], v[232:235]
    ds_read_b64_tr_b16 a[116:117], v37 offset:33024
    buffer_load_dwordx4 v19, s[16:19], s36 offen offset:3072  lds
    v_mfma_f32_16x16x32_bf16 v[236:239], a[180:183], a[204:207], v[236:239]
    s_add_u32 s36, s36, 262144
    ds_read_b64_tr_b16 a[118:119], v37 offset:41216
    v_mfma_f32_16x16x32_bf16 v[228:231], a[180:183], a[200:203], v[228:231]
    ds_read_b64_tr_b16 a[120:121], v38 offset:33024
    v_mfma_f32_16x16x32_bf16 v[240:243], a[184:187], a[200:203], v[240:243]
    ds_read_b64_tr_b16 a[122:123], v38 offset:41216
    ds_read_b64_tr_b16 a[124:125], v39 offset:33024
    ds_read_b64_tr_b16 a[126:127], v39 offset:41216
    v_mfma_f32_16x16x32_bf16 v[248:251], a[184:187], a[204:207], v[248:251]
    v_mfma_f32_16x16x32_bf16 v[252:255], a[188:191], a[204:207], v[252:255]
    v_mfma_f32_16x16x32_bf16 v[244:247], a[188:191], a[200:203], v[244:247]
    v_lshl_add_u32 v3, v0, 4, s7
    s_lshl_b32 s7, s6, 6
    s_lshl_b32 s47, s33, 3
    s_xor_b32 s47, s47, s4
    s_and_b32 s47, s47, 14
    s_add_u32 s7, s7, s47
    s_mul_i32 s7, s7, 3584
    s_mul_i32 s47, s3, 896
    s_add_u32 s7, s7, s47
    s_and_b32 s47, s4, 1
    s_lshl_b32 s47, s47, 6
    s_add_u32 s7, s7, s47
    v_and_b32 v4, 3, v121
    v_lshl_add_u32 v4, v113, 5, v4
    v_mul_u32_u24 v4, 1792, v4
    v_and_b32 v49, 1, v117
    v_lshl_add_u32 v4, v49, 5, v4
    v_lshl_add_u32 v4, v120, 3, v4
    v_add_u32 v4, s7, v4
    v_bfe_u32 v49, v121, 1, 2
    v_lshlrev_b32 v49, 5, v49
    v_lshl_add_u32 v49, v120, 3, v49
    v_lshl_add_u32 v42, v121, 7, v49
    v_xor_b32 v43, 32, v42
    v_xor_b32 v44, 64, v42
    v_xor_b32 v45, 96, v42
    v_mov_b32 v46, 0
    v_mov_b32 v47, 0
    s_waitcnt vmcnt(12) lgkmcnt(0)
    s_barrier
    s_mov_b64 s[90:91], 0
    s_mov_b32 s98, 0
    s_cmp_lg_u32 s33, 0
    s_cbranch_scc1 L_noprobe1A
    s_load_dword s90, s[92:93], 128 glc
    s_load_dword s91, s[92:93], 8320 glc
L_noprobe1A:
    v_mfma_f32_16x16x32_bf16 v[128:131], a[64:67], a[208:211], v[128:131]
    s_add_u32 m0, s32, 81920
    ds_read_b64_tr_b16 a[128:129], v32 offset:49152
    s_nop 0
    v_mfma_f32_16x16x32_bf16 v[136:139], a[64:67], a[212:215], v[136:139]
    ds_read_b64_tr_b16 a[130:131], v32 offset:57344
    v_mfma_f32_16x16x32_bf16 v[140:143], a[68:71], a[212:215], v[140:143]
    ds_read_b64_tr_b16 a[132:133], v33 offset:49152
    v_mfma_f32_16x16x32_bf16 v[132:135], a[68:71], a[208:211], v[132:135]
    buffer_load_dwordx4 v20, s[20:23], s37 offen offset:0  lds
    v_mfma_f32_16x16x32_bf16 v[144:147], a[72:75], a[208:211], v[144:147]
    ds_read_b64_tr_b16 a[134:135], v33 offset:57344
    v_mfma_f32_16x16x32_bf16 v[152:155], a[72:75], a[212:215], v[152:155]
    ds_read_b64_tr_b16 a[136:137], v34 offset:49152
    v_mfma_f32_16x16x32_bf16 v[156:159], a[76:79], a[212:215], v[156:159]
    ds_read_b64_tr_b16 a[138:139], v34 offset:57344
    ds_read_b64_tr_b16 a[140:141], v35 offset:49152
    v_mfma_f32_16x16x32_bf16 v[148:151], a[76:79], a[208:211], v[148:151]
    ds_read_b64_tr_b16 a[142:143], v35 offset:57344
    buffer_load_dwordx4 v21, s[20:23], s37 offen offset:1024  lds
    v_mfma_f32_16x16x32_bf16 v[160:163], a[80:83], a[208:211], v[160:163]
    ds_read_b64_tr_b16 a[144:145], v36 offset:49152
    v_mfma_f32_16x16x32_bf16 v[168:171], a[80:83], a[212:215], v[168:171]
    ds_read_b64_tr_b16 a[146:147], v36 offset:57344
    v_mfma_f32_16x16x32_bf16 v[172:175], a[84:87], a[212:215], v[172:175]
    ds_read_b64_tr_b16 a[148:149], v37 offset:49152
    buffer_load_dwordx4 v22, s[20:23], s37 offen offset:2048  lds
    v_mfma_f32_16x16x32_bf16 v[164:167], a[84:87], a[208:211], v[164:167]
    ds_read_b64_tr_b16 a[150:151], v37 offset:57344
    v_mfma_f32_16x16x32_bf16 v[176:179], a[88:91], a[208:211], v[176:179]
    ds_read_b64_tr_b16 a[152:153], v38 offset:49152
    v_mfma_f32_16x16x32_bf16 v[184:187], a[88:91], a[212:215], v[184:187]
    ds_read_b64_tr_b16 a[154:155], v38 offset:57344
    buffer_load_dwordx4 v23, s[20:23], s37 offen offset:3072  lds
    v_mfma_f32_16x16x32_bf16 v[188:191], a[92:95], a[212:215], v[188:191]
    s_add_u32 s37, s37, 128
    ds_read_b64_tr_b16 a[156:157], v39 offset:49152
    s_add_u32 m0, s32, 32768
    v_mfma_f32_16x16x32_bf16 v[180:183], a[92:95], a[208:211], v[180:183]
    s_nop 0
    ds_read_b64_tr_b16 a[158:159], v39 offset:57344
    ds_read_b64_tr_b16 a[160:161], v32 offset:49408
    v_mfma_f32_16x16x32_bf16 v[192:195], a[96:99], a[208:211], v[192:195]
    s_andn2_b32 s94, s90, s91
    ds_read_b64_tr_b16 a[162:163], v32 offset:57600
    s_or_b32 s98, s98, s94
    v_mfma_f32_16x16x32_bf16 v[200:203], a[96:99], a[212:215], v[200:203]
    s_andn2_b32 s94, s90, s91
    ds_read_b64_tr_b16 a[164:165], v33 offset:49408
    s_or_b32 s98, s98, s94
    v_mfma_f32_16x16x32_bf16 v[204:207], a[100:103], a[212:215], v[204:207]
    s_andn2_b32 s94, s90, s91
    ds_read_b64_tr_b16 a[166:167], v33 offset:57600
    buffer_load_dwordx4 v16, s[16:19], s36 offen offset:0  lds
    v_mfma_f32_16x16x32_bf16 v[196:199], a[100:103], a[208:211], v[196:199]
    s_or_b32 s98, s98, s94
    ds_read_b64_tr_b16 a[168:169], v34 offset:49408
    s_andn2_b32 s94, s90, s91
    v_mfma_f32_16x16x32_bf16 v[208:211], a[104:107], a[208:211], v[208:211]
    s_or_b32 s98, s98, s94
    ds_read_b64_tr_b16 a[170:171], v34 offset:57600
    v_mfma_f32_16x16x32_bf16 v[216:219], a[104:107], a[212:215], v[216:219]
    s_andn2_b32 s94, s90, s91
    ds_read_b64_tr_b16 a[172:173], v35 offset:49408
    v_mfma_f32_16x16x32_bf16 v[220:223], a[108:111], a[212:215], v[220:223]
    s_or_b32 s98, s98, s94
    ds_read_b64_tr_b16 a[174:175], v35 offset:57600
    buffer_load_dwordx4 v17, s[16:19], s36 offen offset:1024  lds
    v_mfma_f32_16x16x32_bf16 v[212:215], a[108:111], a[208:211], v[212:215]
    s_andn2_b32 s94, s90, s91
    ds_read_b64_tr_b16 a[176:177], v36 offset:49408
    v_mfma_f32_16x16x32_bf16 v[224:227], a[112:115], a[208:211], v[224:227]
    s_or_b32 s98, s98, s94
    ds_read_b64_tr_b16 a[178:179], v36 offset:57600
    v_mfma_f32_16x16x32_bf16 v[232:235], a[112:115], a[212:215], v[232:235]
    s_andn2_b32 s94, s90, s91
    ds_read_b64_tr_b16 a[180:181], v37 offset:49408
    buffer_load_dwordx4 v18, s[16:19], s36 offen offset:2048  lds
    v_mfma_f32_16x16x32_bf16 v[236:239], a[116:119], a[212:215], v[236:239]
    s_or_b32 s98, s98, s94
    ds_read_b64_tr_b16 a[182:183], v37 offset:57600
    ds_read_b64_tr_b16 a[184:185], v38 offset:49408
    v_mfma_f32_16x16x32_bf16 v[228:231], a[116:119], a[208:211], v[228:231]
    s_andn2_b32 s94, s90, s91
    ds_read_b64_tr_b16 a[186:187], v38 offset:57600
    s_or_b32 s98, s98, s94
    v_mfma_f32_16x16x32_bf16 v[240:243], a[120:123], a[208:211], v[240:243]
    s_andn2_b32 s94, s90, s91
    ds_read_b64_tr_b16 a[188:189], v39 offset:49408
    buffer_load_dwordx4 v19, s[16:19], s36 offen offset:3072  lds
    ds_read_b64_tr_b16 a[190:191], v39 offset:57600
    v_mfma_f32_16x16x32_bf16 v[248:251], a[120:123], a[212:215], v[248:251]
    s_add_u32 s36, s36, 262144
    s_or_b32 s98, s98, s94
    v_mfma_f32_16x16x32_bf16 v[252:255], a[124:127], a[212:215], v[252:255]
    v_mfma_f32_16x16x32_bf16 v[244:247], a[124:127], a[208:211], v[244:247]
    s_andn2_b32 s94, s90, s91
    s_or_b32 s98, s98, s94
    v_and_b32 v49, 1, v0
    v_lshlrev_b32 v49, 4, v49
    v_mov_b32 v50, 0x3f80
    v_lshlrev_b32 v50, v49, v50
    v_bfe_u32 v49, v0, 1, 3
    v_cmp_eq_u32 vcc, 0, v49
    s_nop 1
    v_cndmask_b32 v56, 0, v50, vcc
    s_andn2_b32 s94, s90, s91
    s_or_b32 s98, s98, s94
    v_cmp_eq_u32 vcc, 1, v49
    s_nop 1
    v_cndmask_b32 v57, 0, v50, vcc
    v_cmp_eq_u32 vcc, 2, v49
    s_nop 1
    v_cndmask_b32 v58, 0, v50, vcc
    v_cmp_eq_u32 vcc, 3, v49
    s_nop 1
    s_andn2_b32 s94, s90, s91
    s_or_b32 s98, s98, s94
    v_cndmask_b32 v59, 0, v50, vcc
    v_cmp_eq_u32 vcc, 4, v49
    s_nop 1
    v_cndmask_b32 v60, 0, v50, vcc
    v_cmp_eq_u32 vcc, 5, v49
    s_nop 1
    v_cndmask_b32 v61, 0, v50, vcc
    v_cmp_eq_u32 vcc, 6, v49
    s_andn2_b32 s94, s90, s91
    s_or_b32 s98, s98, s94
    s_nop 1
    v_cndmask_b32 v62, 0, v50, vcc
    v_cmp_eq_u32 vcc, 7, v49
    s_nop 1
    v_cndmask_b32 v63, 0, v50, vcc
    s_andn2_b32 s94, s90, s91
    s_or_b32 s98, s98, s94
    s_add_u32 s95, s95, s98
    s_waitcnt vmcnt(12) lgkmcnt(0)
    s_barrier
    v_mfma_f32_16x16x32_bf16 v[128:131], a[128:131], a[216:219], v[128:131]
    s_add_u32 m0, s32, 49152
    ds_read_b128 a[192:195], v40 offset:0
    s_nop 0
    v_mfma_f32_16x16x32_bf16 v[136:139], a[128:131], a[220:223], v[136:139]
    ds_read_b128 a[196:199], v40 offset:2048
    v_mfma_f32_16x16x32_bf16 v[140:143], a[132:135], a[220:223], v[140:143]
    ds_read_b128 a[200:203], v41 offset:0
    v_mfma_f32_16x16x32_bf16 v[132:135], a[132:135], a[216:219], v[132:135]
    ds_read_b128 a[204:207], v41 offset:2048
    v_mfma_f32_16x16x32_bf16 v[144:147], a[136:139], a[216:219], v[144:147]
    ds_read_b64_tr_b16 a[64:65], v32 offset:0
    v_mfma_f32_16x16x32_bf16 v[152:155], a[136:139], a[220:223], v[152:155]
    ds_read_b64_tr_b16 a[66:67], v32 offset:8192
    v_mfma_f32_16x16x32_bf16 v[156:159], a[140:143], a[220:223], v[156:159]
    ds_read_b64_tr_b16 a[68:69], v33 offset:0
    buffer_load_dwordx4 v16, s[16:19], s36 offen offset:0  lds
    v_mfma_f32_16x16x32_bf16 v[148:151], a[140:143], a[216:219], v[148:151]
    ds_read_b64_tr_b16 a[70:71], v33 offset:8192
    ds_read_b64_tr_b16 a[72:73], v34 offset:0
    v_mfma_f32_16x16x32_bf16 v[160:163], a[144:147], a[216:219], v[160:163]
    ds_read_b64_tr_b16 a[74:75], v34 offset:8192
    v_mfma_f32_16x16x32_bf16 v[168:171], a[144:147], a[220:223], v[168:171]
    ds_read_b64_tr_b16 a[76:77], v35 offset:0
    v_mfma_f32_16x16x32_bf16 v[172:175], a[148:151], a[220:223], v[172:175]
    ds_read_b64_tr_b16 a[78:79], v35 offset:8192
    v_mfma_f32_16x16x32_bf16 v[164:167], a[148:151], a[216:219], v[164:167]
    ds_read_b64_tr_b16 a[80:81], v36 offset:0
    ds_read_b64_tr_b16 a[82:83], v36 offset:8192
    v_mfma_f32_16x16x32_bf16 v[176:179], a[152:155], a[216:219], v[176:179]
    ds_read_b64_tr_b16 a[84:85], v37 offset:0
    buffer_load_dwordx4 v17, s[16:19], s36 offen offset:1024  lds
    v_mfma_f32_16x16x32_bf16 v[184:187], a[152:155], a[220:223], v[184:187]
    ds_read_b64_tr_b16 a[86:87], v37 offset:8192
    v_mfma_f32_16x16x32_bf16 v[188:191], a[156:159], a[220:223], v[188:191]
    ds_read_b64_tr_b16 a[88:89], v38 offset:0
    v_mfma_f32_16x16x32_bf16 v[180:183], a[156:159], a[216:219], v[180:183]
    ds_read_b64_tr_b16 a[90:91], v38 offset:8192
    ds_read_b64_tr_b16 a[92:93], v39 offset:0
    v_mfma_f32_16x16x32_bf16 v[192:195], a[160:163], a[216:219], v[192:195]
    ds_read_b64_tr_b16 a[94:95], v39 offset:8192
    v_mfma_f32_16x16x32_bf16 v[200:203], a[160:163], a[220:223], v[200:203]
    ds_read_b64_tr_b16 a[96:97], v32 offset:256
    v_mfma_f32_16x16x32_bf16 v[204:207], a[164:167], a[220:223], v[204:207]
    ds_read_b64_tr_b16 a[98:99], v32 offset:8448
    buffer_load_dwordx4 v18, s[16:19], s36 offen offset:2048  lds
    v_mfma_f32_16x16x32_bf16 v[196:199], a[164:167], a[216:219], v[196:199]
    ds_read_b64_tr_b16 a[100:101], v33 offset:256
    v_mfma_f32_16x16x32_bf16 v[208:211], a[168:171], a[216:219], v[208:211]
    ds_read_b64_tr_b16 a[102:103], v33 offset:8448
    ds_read_b64_tr_b16 a[104:105], v34 offset:256
    v_mfma_f32_16x16x32_bf16 v[216:219], a[168:171], a[220:223], v[216:219]
    ds_read_b64_tr_b16 a[106:107], v34 offset:8448
    v_mfma_f32_16x16x32_bf16 v[220:223], a[172:175], a[220:223], v[220:223]
    ds_read_b64_tr_b16 a[108:109], v35 offset:256
    v_mfma_f32_16x16x32_bf16 v[212:215], a[172:175], a[216:219], v[212:215]
    ds_read_b64_tr_b16 a[110:111], v35 offset:8448
    v_mfma_f32_16x16x32_bf16 v[224:227], a[176:179], a[216:219], v[224:227]
    ds_read_b64_tr_b16 a[112:113], v36 offset:256
    ds_read_b64_tr_b16 a[114:115], v36 offset:8448
    v_mfma_f32_16x16x32_bf16 v[232:235], a[176:179], a[220:223], v[232:235]
    ds_read_b64_tr_b16 a[116:117], v37 offset:256
    buffer_load_dwordx4 v19, s[16:19], s36 offen offset:3072  lds
    v_mfma_f32_16x16x32_bf16 v[236:239], a[180:183], a[220:223], v[236:239]
    s_add_u32 s36, s36, 262144
    ds_read_b64_tr_b16 a[118:119], v37 offset:8448
    v_mfma_f32_16x16x32_bf16 v[228:231], a[180:183], a[216:219], v[228:231]
    ds_read_b64_tr_b16 a[120:121], v38 offset:256
    v_mfma_f32_16x16x32_bf16 v[240:243], a[184:187], a[216:219], v[240:243]
    ds_read_b64_tr_b16 a[122:123], v38 offset:8448
    ds_read_b64_tr_b16 a[124:125], v39 offset:256
    ds_read_b64_tr_b16 a[126:127], v39 offset:8448
    v_mfma_f32_16x16x32_bf16 v[248:251], a[184:187], a[220:223], v[248:251]
    v_mfma_f32_16x16x32_bf16 v[252:255], a[188:191], a[220:223], v[252:255]
    v_mfma_f32_16x16x32_bf16 v[244:247], a[188:191], a[216:219], v[244:247]
    s_waitcnt vmcnt(12) lgkmcnt(0)
    s_barrier
    v_mfma_f32_16x16x32_bf16 v[128:131], a[64:67], a[192:195], v[128:131]
    s_add_u32 m0, s32, 65536
    ds_read_b64_tr_b16 a[128:129], v32 offset:16384
    s_nop 0
    v_mfma_f32_16x16x32_bf16 v[136:139], a[64:67], a[196:199], v[136:139]
    ds_read_b64_tr_b16 a[130:131], v32 offset:24576
    v_mfma_f32_16x16x32_bf16 v[140:143], a[68:71], a[196:199], v[140:143]
    ds_read_b64_tr_b16 a[132:133], v33 offset:16384
    v_mfma_f32_16x16x32_bf16 v[132:135], a[68:71], a[192:195], v[132:135]
    buffer_load_dwordx4 v20, s[20:23], s37 offen offset:0  lds
    v_mfma_f32_16x16x32_bf16 v[144:147], a[72:75], a[192:195], v[144:147]
    ds_read_b64_tr_b16 a[134:135], v33 offset:24576
    v_mfma_f32_16x16x32_bf16 v[152:155], a[72:75], a[196:199], v[152:155]
    ds_read_b64_tr_b16 a[136:137], v34 offset:16384
    v_mfma_f32_16x16x32_bf16 v[156:159], a[76:79], a[196:199], v[156:159]
    ds_read_b64_tr_b16 a[138:139], v34 offset:24576
    ds_read_b64_tr_b16 a[140:141], v35 offset:16384
    v_mfma_f32_16x16x32_bf16 v[148:151], a[76:79], a[192:195], v[148:151]
    ds_read_b64_tr_b16 a[142:143], v35 offset:24576
    buffer_load_dwordx4 v21, s[20:23], s37 offen offset:1024  lds
    v_mfma_f32_16x16x32_bf16 v[160:163], a[80:83], a[192:195], v[160:163]
    ds_read_b64_tr_b16 a[144:145], v36 offset:16384
    v_mfma_f32_16x16x32_bf16 v[168:171], a[80:83], a[196:199], v[168:171]
    ds_read_b64_tr_b16 a[146:147], v36 offset:24576
    v_mfma_f32_16x16x32_bf16 v[172:175], a[84:87], a[196:199], v[172:175]
    ds_read_b64_tr_b16 a[148:149], v37 offset:16384
    buffer_load_dwordx4 v22, s[20:23], s37 offen offset:2048  lds
    v_mfma_f32_16x16x32_bf16 v[164:167], a[84:87], a[192:195], v[164:167]
    ds_read_b64_tr_b16 a[150:151], v37 offset:24576
    v_mfma_f32_16x16x32_bf16 v[176:179], a[88:91], a[192:195], v[176:179]
    ds_read_b64_tr_b16 a[152:153], v38 offset:16384
    v_mfma_f32_16x16x32_bf16 v[184:187], a[88:91], a[196:199], v[184:187]
    ds_read_b64_tr_b16 a[154:155], v38 offset:24576
    buffer_load_dwordx4 v23, s[20:23], s37 offen offset:3072  lds
    v_mfma_f32_16x16x32_bf16 v[188:191], a[92:95], a[196:199], v[188:191]
    s_add_u32 s37, s37, 128
    ds_read_b64_tr_b16 a[156:157], v39 offset:16384
    s_add_u32 m0, s32, 0
    v_mfma_f32_16x16x32_bf16 v[180:183], a[92:95], a[192:195], v[180:183]
    s_nop 0
    ds_read_b64_tr_b16 a[158:159], v39 offset:24576
    ds_read_b64_tr_b16 a[160:161], v32 offset:16640
    v_mfma_f32_16x16x32_bf16 v[192:195], a[96:99], a[192:195], v[192:195]
    ds_read_b64_tr_b16 a[162:163], v32 offset:24832
    v_mfma_f32_16x16x32_bf16 v[200:203], a[96:99], a[196:199], v[200:203]
    ds_read_b64_tr_b16 a[164:165], v33 offset:16640
    v_mfma_f32_16x16x32_bf16 v[204:207], a[100:103], a[196:199], v[204:207]
    ds_read_b64_tr_b16 a[166:167], v33 offset:24832
    buffer_load_dwordx4 v16, s[16:19], s36 offen offset:0  lds
    v_mfma_f32_16x16x32_bf16 v[196:199], a[100:103], a[192:195], v[196:199]
    ds_read_b64_tr_b16 a[168:169], v34 offset:16640
    v_mfma_f32_16x16x32_bf16 v[208:211], a[104:107], a[192:195], v[208:211]
    ds_read_b64_tr_b16 a[170:171], v34 offset:24832
    v_mfma_f32_16x16x32_bf16 v[216:219], a[104:107], a[196:199], v[216:219]
    ds_read_b64_tr_b16 a[172:173], v35 offset:16640
    v_mfma_f32_16x16x32_bf16 v[220:223], a[108:111], a[196:199], v[220:223]
    ds_read_b64_tr_b16 a[174:175], v35 offset:24832
    buffer_load_dwordx4 v17, s[16:19], s36 offen offset:1024  lds
    v_mfma_f32_16x16x32_bf16 v[212:215], a[108:111], a[192:195], v[212:215]
    ds_read_b64_tr_b16 a[176:177], v36 offset:16640
    v_mfma_f32_16x16x32_bf16 v[224:227], a[112:115], a[192:195], v[224:227]
    ds_read_b64_tr_b16 a[178:179], v36 offset:24832
    v_mfma_f32_16x16x32_bf16 v[232:235], a[112:115], a[196:199], v[232:235]
    ds_read_b64_tr_b16 a[180:181], v37 offset:16640
    buffer_load_dwordx4 v18, s[16:19], s36 offen offset:2048  lds
    v_mfma_f32_16x16x32_bf16 v[236:239], a[116:119], a[196:199], v[236:239]
    ds_read_b64_tr_b16 a[182:183], v37 offset:24832
    ds_read_b64_tr_b16 a[184:185], v38 offset:16640
    v_mfma_f32_16x16x32_bf16 v[228:231], a[116:119], a[192:195], v[228:231]
    ds_read_b64_tr_b16 a[186:187], v38 offset:24832
    v_mfma_f32_16x16x32_bf16 v[240:243], a[120:123], a[192:195], v[240:243]
    ds_read_b64_tr_b16 a[188:189], v39 offset:16640
    buffer_load_dwordx4 v19, s[16:19], s36 offen offset:3072  lds
    ds_read_b64_tr_b16 a[190:191], v39 offset:24832
    v_mfma_f32_16x16x32_bf16 v[248:251], a[120:123], a[196:199], v[248:251]
    s_add_u32 s36, s36, 262144
    v_mfma_f32_16x16x32_bf16 v[252:255], a[124:127], a[196:199], v[252:255]
    v_mfma_f32_16x16x32_bf16 v[244:247], a[124:127], a[192:195], v[244:247]
    s_waitcnt vmcnt(12) lgkmcnt(0)
    s_barrier
    v_mfma_f32_16x16x32_bf16 v[128:131], a[128:131], a[200:203], v[128:131]
    s_add_u32 m0, s32, 16384
    ds_read_b128 a[208:211], v40 offset:16384
    s_nop 0
    v_mfma_f32_16x16x32_bf16 v[136:139], a[128:131], a[204:207], v[136:139]
    ds_read_b128 a[212:215], v40 offset:18432
    v_mfma_f32_16x16x32_bf16 v[140:143], a[132:135], a[204:207], v[140:143]
    ds_read_b128 a[216:219], v41 offset:16384
    v_mfma_f32_16x16x32_bf16 v[132:135], a[132:135], a[200:203], v[132:135]
    ds_read_b128 a[220:223], v41 offset:18432
    v_mfma_f32_16x16x32_bf16 v[144:147], a[136:139], a[200:203], v[144:147]
    ds_read_b64_tr_b16 a[64:65], v32 offset:32768
    v_mfma_f32_16x16x32_bf16 v[152:155], a[136:139], a[204:207], v[152:155]
    ds_read_b64_tr_b16 a[66:67], v32 offset:40960
    v_mfma_f32_16x16x32_bf16 v[156:159], a[140:143], a[204:207], v[156:159]
    ds_read_b64_tr_b16 a[68:69], v33 offset:32768
    buffer_load_dwordx4 v16, s[16:19], s36 offen offset:0  lds
    v_mfma_f32_16x16x32_bf16 v[148:151], a[140:143], a[200:203], v[148:151]
    ds_read_b64_tr_b16 a[70:71], v33 offset:40960
    ds_read_b64_tr_b16 a[72:73], v34 offset:32768
    v_mfma_f32_16x16x32_bf16 v[160:163], a[144:147], a[200:203], v[160:163]
    ds_read_b64_tr_b16 a[74:75], v34 offset:40960
    v_mfma_f32_16x16x32_bf16 v[168:171], a[144:147], a[204:207], v[168:171]
    ds_read_b64_tr_b16 a[76:77], v35 offset:32768
    v_mfma_f32_16x16x32_bf16 v[172:175], a[148:151], a[204:207], v[172:175]
    ds_read_b64_tr_b16 a[78:79], v35 offset:40960
    v_mfma_f32_16x16x32_bf16 v[164:167], a[148:151], a[200:203], v[164:167]
    ds_read_b64_tr_b16 a[80:81], v36 offset:32768
    ds_read_b64_tr_b16 a[82:83], v36 offset:40960
    v_mfma_f32_16x16x32_bf16 v[176:179], a[152:155], a[200:203], v[176:179]
    ds_read_b64_tr_b16 a[84:85], v37 offset:32768
    buffer_load_dwordx4 v17, s[16:19], s36 offen offset:1024  lds
    v_mfma_f32_16x16x32_bf16 v[184:187], a[152:155], a[204:207], v[184:187]
    ds_read_b64_tr_b16 a[86:87], v37 offset:40960
    v_mfma_f32_16x16x32_bf16 v[188:191], a[156:159], a[204:207], v[188:191]
    ds_read_b64_tr_b16 a[88:89], v38 offset:32768
    v_mfma_f32_16x16x32_bf16 v[180:183], a[156:159], a[200:203], v[180:183]
    ds_read_b64_tr_b16 a[90:91], v38 offset:40960
    ds_read_b64_tr_b16 a[92:93], v39 offset:32768
    v_mfma_f32_16x16x32_bf16 v[192:195], a[160:163], a[200:203], v[192:195]
    ds_read_b64_tr_b16 a[94:95], v39 offset:40960
    v_mfma_f32_16x16x32_bf16 v[200:203], a[160:163], a[204:207], v[200:203]
    ds_read_b64_tr_b16 a[96:97], v32 offset:33024
    v_mfma_f32_16x16x32_bf16 v[204:207], a[164:167], a[204:207], v[204:207]
    ds_read_b64_tr_b16 a[98:99], v32 offset:41216
    buffer_load_dwordx4 v18, s[16:19], s36 offen offset:2048  lds
    v_mfma_f32_16x16x32_bf16 v[196:199], a[164:167], a[200:203], v[196:199]
    ds_read_b64_tr_b16 a[100:101], v33 offset:33024
    v_mfma_f32_16x16x32_bf16 v[208:211], a[168:171], a[200:203], v[208:211]
    ds_read_b64_tr_b16 a[102:103], v33 offset:41216
    ds_read_b64_tr_b16 a[104:105], v34 offset:33024
    v_mfma_f32_16x16x32_bf16 v[216:219], a[168:171], a[204:207], v[216:219]
    ds_read_b64_tr_b16 a[106:107], v34 offset:41216
    v_mfma_f32_16x16x32_bf16 v[220:223], a[172:175], a[204:207], v[220:223]
    ds_read_b64_tr_b16 a[108:109], v35 offset:33024
    v_mfma_f32_16x16x32_bf16 v[212:215], a[172:175], a[200:203], v[212:215]
    ds_read_b64_tr_b16 a[110:111], v35 offset:41216
    v_mfma_f32_16x16x32_bf16 v[224:227], a[176:179], a[200:203], v[224:227]
    ds_read_b64_tr_b16 a[112:113], v36 offset:33024
    ds_read_b64_tr_b16 a[114:115], v36 offset:41216
    v_mfma_f32_16x16x32_bf16 v[232:235], a[176:179], a[204:207], v[232:235]
    ds_read_b64_tr_b16 a[116:117], v37 offset:33024
    buffer_load_dwordx4 v19, s[16:19], s36 offen offset:3072  lds
    v_mfma_f32_16x16x32_bf16 v[236:239], a[180:183], a[204:207], v[236:239]
    s_add_u32 s36, s36, 262144
    ds_read_b64_tr_b16 a[118:119], v37 offset:41216
    v_mfma_f32_16x16x32_bf16 v[228:231], a[180:183], a[200:203], v[228:231]
    ds_read_b64_tr_b16 a[120:121], v38 offset:33024
    v_mfma_f32_16x16x32_bf16 v[240:243], a[184:187], a[200:203], v[240:243]
    ds_read_b64_tr_b16 a[122:123], v38 offset:41216
    ds_read_b64_tr_b16 a[124:125], v39 offset:33024
    ds_read_b64_tr_b16 a[126:127], v39 offset:41216
    v_mfma_f32_16x16x32_bf16 v[248:251], a[184:187], a[204:207], v[248:251]
    v_mfma_f32_16x16x32_bf16 v[252:255], a[188:191], a[204:207], v[252:255]
    v_mfma_f32_16x16x32_bf16 v[244:247], a[188:191], a[200:203], v[244:247]
    s_waitcnt vmcnt(12) lgkmcnt(0)
    s_barrier
    v_mfma_f32_16x16x32_bf16 v[128:131], a[64:67], a[208:211], v[128:131]
    s_add_u32 m0, s32, 32768
    ds_read_b64_tr_b16 a[128:129], v32 offset:49152
    s_add_u32 s34, s34, 16384
    v_mfma_f32_16x16x32_bf16 v[136:139], a[64:67], a[212:215], v[136:139]
    s_and_b32 s34, s34, 0x7ffff
    ds_read_b64_tr_b16 a[130:131], v32 offset:57344
    v_mfma_f32_16x16x32_bf16 v[140:143], a[68:71], a[212:215], v[140:143]
    ds_read_b64_tr_b16 a[132:133], v33 offset:49152
    v_mfma_f32_16x16x32_bf16 v[132:135], a[68:71], a[208:211], v[132:135]
    ds_read_b64_tr_b16 a[134:135], v33 offset:57344
    v_mfma_f32_16x16x32_bf16 v[144:147], a[72:75], a[208:211], v[144:147]
    buffer_load_dwordx4 v8, s[8:11], s34 offen offset:0 nt lds
    v_mfma_f32_16x16x32_bf16 v[152:155], a[72:75], a[212:215], v[152:155]
    ds_read_b64_tr_b16 a[136:137], v34 offset:49152
    v_mfma_f32_16x16x32_bf16 v[156:159], a[76:79], a[212:215], v[156:159]
    ds_read_b64_tr_b16 a[138:139], v34 offset:57344
    ds_read_b64_tr_b16 a[140:141], v35 offset:49152
    v_mfma_f32_16x16x32_bf16 v[148:151], a[76:79], a[208:211], v[148:151]
    ds_read_b64_tr_b16 a[142:143], v35 offset:57344
    v_mfma_f32_16x16x32_bf16 v[160:163], a[80:83], a[208:211], v[160:163]
    ds_read_b64_tr_b16 a[144:145], v36 offset:49152
    v_mfma_f32_16x16x32_bf16 v[168:171], a[80:83], a[212:215], v[168:171]
    ds_read_b64_tr_b16 a[146:147], v36 offset:57344
    v_mfma_f32_16x16x32_bf16 v[172:175], a[84:87], a[212:215], v[172:175]
    ds_read_b64_tr_b16 a[148:149], v37 offset:49152
    v_mfma_f32_16x16x32_bf16 v[164:167], a[84:87], a[208:211], v[164:167]
    ds_read_b64_tr_b16 a[150:151], v37 offset:57344
    buffer_load_dwordx4 v9, s[8:11], s34 offen offset:1024 nt lds
    v_mfma_f32_16x16x32_bf16 v[176:179], a[88:91], a[208:211], v[176:179]
    ds_read_b64_tr_b16 a[152:153], v38 offset:49152
    v_mfma_f32_16x16x32_bf16 v[184:187], a[88:91], a[212:215], v[184:187]
    ds_read_b64_tr_b16 a[154:155], v38 offset:57344
    v_mfma_f32_16x16x32_bf16 v[188:191], a[92:95], a[212:215], v[188:191]
    ds_read_b64_tr_b16 a[156:157], v39 offset:49152
    v_mfma_f32_16x16x32_bf16 v[180:183], a[92:95], a[208:211], v[180:183]
    ds_read_b64_tr_b16 a[158:159], v39 offset:57344
    ds_read_b64_tr_b16 a[160:161], v32 offset:49408
    v_mfma_f32_16x16x32_bf16 v[192:195], a[96:99], a[208:211], v[192:195]
    ds_read_b64_tr_b16 a[162:163], v32 offset:57600
    v_mfma_f32_16x16x32_bf16 v[200:203], a[96:99], a[212:215], v[200:203]
    ds_read_b64_tr_b16 a[164:165], v33 offset:49408
    v_mfma_f32_16x16x32_bf16 v[204:207], a[100:103], a[212:215], v[204:207]
    ds_read_b64_tr_b16 a[166:167], v33 offset:57600
    buffer_load_dwordx4 v10, s[8:11], s34 offen offset:2048 nt lds
    v_mfma_f32_16x16x32_bf16 v[196:199], a[100:103], a[208:211], v[196:199]
    ds_read_b64_tr_b16 a[168:169], v34 offset:49408
    v_mfma_f32_16x16x32_bf16 v[208:211], a[104:107], a[208:211], v[208:211]
    ds_read_b64_tr_b16 a[170:171], v34 offset:57600
    v_mfma_f32_16x16x32_bf16 v[216:219], a[104:107], a[212:215], v[216:219]
    ds_read_b64_tr_b16 a[172:173], v35 offset:49408
    v_mfma_f32_16x16x32_bf16 v[220:223], a[108:111], a[212:215], v[220:223]
    ds_read_b64_tr_b16 a[174:175], v35 offset:57600
    v_mfma_f32_16x16x32_bf16 v[212:215], a[108:111], a[208:211], v[212:215]
    ds_read_b64_tr_b16 a[176:177], v36 offset:49408
    v_mfma_f32_16x16x32_bf16 v[224:227], a[112:115], a[208:211], v[224:227]
    ds_read_b64_tr_b16 a[178:179], v36 offset:57600
    v_mfma_f32_16x16x32_bf16 v[232:235], a[112:115], a[212:215], v[232:235]
    ds_read_b64_tr_b16 a[180:181], v37 offset:49408
    buffer_load_dwordx4 v11, s[8:11], s34 offen offset:3072 nt lds
    v_mfma_f32_16x16x32_bf16 v[236:239], a[116:119], a[212:215], v[236:239]
    ds_read_b64_tr_b16 a[182:183], v37 offset:57600
    ds_read_b64_tr_b16 a[184:185], v38 offset:49408
    v_mfma_f32_16x16x32_bf16 v[228:231], a[116:119], a[208:211], v[228:231]
    ds_read_b64_tr_b16 a[186:187], v38 offset:57600
    v_mfma_f32_16x16x32_bf16 v[240:243], a[120:123], a[208:211], v[240:243]
    ds_read_b64_tr_b16 a[188:189], v39 offset:49408
    ds_read_b64_tr_b16 a[190:191], v39 offset:57600
    v_mfma_f32_16x16x32_bf16 v[248:251], a[120:123], a[212:215], v[248:251]
    v_mfma_f32_16x16x32_bf16 v[252:255], a[124:127], a[212:215], v[252:255]
    v_mfma_f32_16x16x32_bf16 v[244:247], a[124:127], a[208:211], v[244:247]
    s_waitcnt vmcnt(8) lgkmcnt(0)
    s_barrier
    v_mfma_f32_16x16x32_bf16 v[128:131], a[128:131], a[216:219], v[128:131]
    s_add_u32 m0, s32, 49152
    ds_read_b128 a[192:195], v40 offset:0
    s_add_u32 s34, s34, 16384
    v_mfma_f32_16x16x32_bf16 v[136:139], a[128:131], a[220:223], v[136:139]
    s_and_b32 s34, s34, 0x7ffff
    ds_read_b128 a[196:199], v40 offset:2048
    v_mfma_f32_16x16x32_bf16 v[140:143], a[132:135], a[220:223], v[140:143]
    ds_read_b128 a[200:203], v41 offset:0
    v_mfma_f32_16x16x32_bf16 v[132:135], a[132:135], a[216:219], v[132:135]
    ds_read_b128 a[204:207], v41 offset:2048
    v_mfma_f32_16x16x32_bf16 v[144:147], a[136:139], a[216:219], v[144:147]
    ds_read_b64_tr_b16 a[64:65], v32 offset:0
    buffer_load_dwordx4 v8, s[8:11], s34 offen offset:0 nt lds
    v_mfma_f32_16x16x32_bf16 v[152:155], a[136:139], a[220:223], v[152:155]
    ds_read_b64_tr_b16 a[66:67], v32 offset:8192
    v_mfma_f32_16x16x32_bf16 v[156:159], a[140:143], a[220:223], v[156:159]
    ds_read_b64_tr_b16 a[68:69], v33 offset:0
    v_mfma_f32_16x16x32_bf16 v[148:151], a[140:143], a[216:219], v[148:151]
    ds_read_b64_tr_b16 a[70:71], v33 offset:8192
    ds_read_b64_tr_b16 a[72:73], v34 offset:0
    v_mfma_f32_16x16x32_bf16 v[160:163], a[144:147], a[216:219], v[160:163]
    ds_read_b64_tr_b16 a[74:75], v34 offset:8192
    v_mfma_f32_16x16x32_bf16 v[168:171], a[144:147], a[220:223], v[168:171]
    ds_read_b64_tr_b16 a[76:77], v35 offset:0
    v_mfma_f32_16x16x32_bf16 v[172:175], a[148:151], a[220:223], v[172:175]
    ds_read_b64_tr_b16 a[78:79], v35 offset:8192
    v_mfma_f32_16x16x32_bf16 v[164:167], a[148:151], a[216:219], v[164:167]
    ds_read_b64_tr_b16 a[80:81], v36 offset:0
    ds_read_b64_tr_b16 a[82:83], v36 offset:8192
    v_mfma_f32_16x16x32_bf16 v[176:179], a[152:155], a[216:219], v[176:179]
    ds_read_b64_tr_b16 a[84:85], v37 offset:0
    buffer_load_dwordx4 v9, s[8:11], s34 offen offset:1024 nt lds
    v_mfma_f32_16x16x32_bf16 v[184:187], a[152:155], a[220:223], v[184:187]
    ds_read_b64_tr_b16 a[86:87], v37 offset:8192
    v_mfma_f32_16x16x32_bf16 v[188:191], a[156:159], a[220:223], v[188:191]
    ds_read_b64_tr_b16 a[88:89], v38 offset:0
    v_mfma_f32_16x16x32_bf16 v[180:183], a[156:159], a[216:219], v[180:183]
    ds_read_b64_tr_b16 a[90:91], v38 offset:8192
    ds_read_b64_tr_b16 a[92:93], v39 offset:0
    v_mfma_f32_16x16x32_bf16 v[192:195], a[160:163], a[216:219], v[192:195]
    ds_read_b64_tr_b16 a[94:95], v39 offset:8192
    v_mfma_f32_16x16x32_bf16 v[200:203], a[160:163], a[220:223], v[200:203]
    ds_read_b64_tr_b16 a[96:97], v32 offset:256
    v_mfma_f32_16x16x32_bf16 v[204:207], a[164:167], a[220:223], v[204:207]
    ds_read_b64_tr_b16 a[98:99], v32 offset:8448
    buffer_load_dwordx4 v10, s[8:11], s34 offen offset:2048 nt lds
    v_mfma_f32_16x16x32_bf16 v[196:199], a[164:167], a[216:219], v[196:199]
    ds_read_b64_tr_b16 a[100:101], v33 offset:256
    v_mfma_f32_16x16x32_bf16 v[208:211], a[168:171], a[216:219], v[208:211]
    ds_read_b64_tr_b16 a[102:103], v33 offset:8448
    ds_read_b64_tr_b16 a[104:105], v34 offset:256
    v_mfma_f32_16x16x32_bf16 v[216:219], a[168:171], a[220:223], v[216:219]
    ds_read_b64_tr_b16 a[106:107], v34 offset:8448
    v_mfma_f32_16x16x32_bf16 v[220:223], a[172:175], a[220:223], v[220:223]
    ds_read_b64_tr_b16 a[108:109], v35 offset:256
    v_mfma_f32_16x16x32_bf16 v[212:215], a[172:175], a[216:219], v[212:215]
    ds_read_b64_tr_b16 a[110:111], v35 offset:8448
    v_mfma_f32_16x16x32_bf16 v[224:227], a[176:179], a[216:219], v[224:227]
    ds_read_b64_tr_b16 a[112:113], v36 offset:256
    ds_read_b64_tr_b16 a[114:115], v36 offset:8448
    v_mfma_f32_16x16x32_bf16 v[232:235], a[176:179], a[220:223], v[232:235]
    ds_read_b64_tr_b16 a[116:117], v37 offset:256
    buffer_load_dwordx4 v11, s[8:11], s34 offen offset:3072 nt lds
    v_mfma_f32_16x16x32_bf16 v[236:239], a[180:183], a[220:223], v[236:239]
    ds_read_b64_tr_b16 a[118:119], v37 offset:8448
    v_mfma_f32_16x16x32_bf16 v[228:231], a[180:183], a[216:219], v[228:231]
    ds_read_b64_tr_b16 a[120:121], v38 offset:256
    v_mfma_f32_16x16x32_bf16 v[240:243], a[184:187], a[216:219], v[240:243]
    ds_read_b64_tr_b16 a[122:123], v38 offset:8448
    ds_read_b64_tr_b16 a[124:125], v39 offset:256
    ds_read_b64_tr_b16 a[126:127], v39 offset:8448
    v_mfma_f32_16x16x32_bf16 v[248:251], a[184:187], a[220:223], v[248:251]
    s_mul_i32 s47, s33, 14336
    v_subrev_u32 v16, s47, v24
    v_subrev_u32 v17, s47, v25
    v_mfma_f32_16x16x32_bf16 v[252:255], a[188:191], a[220:223], v[252:255]
    v_mfma_f32_16x16x32_bf16 v[244:247], a[188:191], a[216:219], v[244:247]
    s_waitcnt vmcnt(8) lgkmcnt(0)
    s_barrier
    v_mfma_f32_16x16x32_bf16 v[128:131], a[64:67], a[192:195], v[128:131]
    s_add_u32 m0, s32, 0
    ds_read_b64_tr_b16 a[128:129], v32 offset:16384
    s_add_u32 s35, s35, 16384
    v_mfma_f32_16x16x32_bf16 v[136:139], a[64:67], a[196:199], v[136:139]
    s_and_b32 s35, s35, 0x7ffff
    ds_read_b64_tr_b16 a[130:131], v32 offset:24576
    v_mfma_f32_16x16x32_bf16 v[140:143], a[68:71], a[196:199], v[140:143]
    ds_read_b64_tr_b16 a[132:133], v33 offset:16384
    v_mfma_f32_16x16x32_bf16 v[132:135], a[68:71], a[192:195], v[132:135]
    ds_read_b64_tr_b16 a[134:135], v33 offset:24576
    v_mfma_f32_16x16x32_bf16 v[144:147], a[72:75], a[192:195], v[144:147]
    buffer_load_dwordx4 v12, s[12:15], s35 offen offset:0 nt lds
    v_mfma_f32_16x16x32_bf16 v[152:155], a[72:75], a[196:199], v[152:155]
    ds_read_b64_tr_b16 a[136:137], v34 offset:16384
    v_mfma_f32_16x16x32_bf16 v[156:159], a[76:79], a[196:199], v[156:159]
    ds_read_b64_tr_b16 a[138:139], v34 offset:24576
    ds_read_b64_tr_b16 a[140:141], v35 offset:16384
    v_mfma_f32_16x16x32_bf16 v[148:151], a[76:79], a[192:195], v[148:151]
    ds_read_b64_tr_b16 a[142:143], v35 offset:24576
    v_mfma_f32_16x16x32_bf16 v[160:163], a[80:83], a[192:195], v[160:163]
    ds_read_b64_tr_b16 a[144:145], v36 offset:16384
    v_mfma_f32_16x16x32_bf16 v[168:171], a[80:83], a[196:199], v[168:171]
    ds_read_b64_tr_b16 a[146:147], v36 offset:24576
    v_mfma_f32_16x16x32_bf16 v[172:175], a[84:87], a[196:199], v[172:175]
    ds_read_b64_tr_b16 a[148:149], v37 offset:16384
    v_mfma_f32_16x16x32_bf16 v[164:167], a[84:87], a[192:195], v[164:167]
    ds_read_b64_tr_b16 a[150:151], v37 offset:24576
    buffer_load_dwordx4 v13, s[12:15], s35 offen offset:1024 nt lds
    v_mfma_f32_16x16x32_bf16 v[176:179], a[88:91], a[192:195], v[176:179]
    ds_read_b64_tr_b16 a[152:153], v38 offset:16384
    v_mfma_f32_16x16x32_bf16 v[184:187], a[88:91], a[196:199], v[184:187]
    ds_read_b64_tr_b16 a[154:155], v38 offset:24576
    v_mfma_f32_16x16x32_bf16 v[188:191], a[92:95], a[196:199], v[188:191]
    ds_read_b64_tr_b16 a[156:157], v39 offset:16384
    v_mfma_f32_16x16x32_bf16 v[180:183], a[92:95], a[192:195], v[180:183]
    ds_read_b64_tr_b16 a[158:159], v39 offset:24576
    ds_read_b64_tr_b16 a[160:161], v32 offset:16640
    v_mfma_f32_16x16x32_bf16 v[192:195], a[96:99], a[192:195], v[192:195]
    ds_read_b64_tr_b16 a[162:163], v32 offset:24832
    v_mfma_f32_16x16x32_bf16 v[200:203], a[96:99], a[196:199], v[200:203]
    ds_read_b64_tr_b16 a[164:165], v33 offset:16640
    v_mfma_f32_16x16x32_bf16 v[204:207], a[100:103], a[196:199], v[204:207]
    ds_read_b64_tr_b16 a[166:167], v33 offset:24832
    buffer_load_dwordx4 v14, s[12:15], s35 offen offset:2048 nt lds
    v_mfma_f32_16x16x32_bf16 v[196:199], a[100:103], a[192:195], v[196:199]
    ds_read_b64_tr_b16 a[168:169], v34 offset:16640
    v_mfma_f32_16x16x32_bf16 v[208:211], a[104:107], a[192:195], v[208:211]
    ds_read_b64_tr_b16 a[170:171], v34 offset:24832
    v_mfma_f32_16x16x32_bf16 v[216:219], a[104:107], a[196:199], v[216:219]
    ds_read_b64_tr_b16 a[172:173], v35 offset:16640
    v_mfma_f32_16x16x32_bf16 v[220:223], a[108:111], a[196:199], v[220:223]
    ds_read_b64_tr_b16 a[174:175], v35 offset:24832
    v_mfma_f32_16x16x32_bf16 v[212:215], a[108:111], a[192:195], v[212:215]
    ds_read_b64_tr_b16 a[176:177], v36 offset:16640
    v_mfma_f32_16x16x32_bf16 v[224:227], a[112:115], a[192:195], v[224:227]
    ds_read_b64_tr_b16 a[178:179], v36 offset:24832
    v_mfma_f32_16x16x32_bf16 v[232:235], a[112:115], a[196:199], v[232:235]
    ds_read_b64_tr_b16 a[180:181], v37 offset:16640
    buffer_load_dwordx4 v15, s[12:15], s35 offen offset:3072 nt lds
    v_mfma_f32_16x16x32_bf16 v[236:239], a[116:119], a[196:199], v[236:239]
    ds_read_b64_tr_b16 a[182:183], v37 offset:24832
    ds_read_b64_tr_b16 a[184:185], v38 offset:16640
    v_mfma_f32_16x16x32_bf16 v[228:231], a[116:119], a[192:195], v[228:231]
    ds_read_b64_tr_b16 a[186:187], v38 offset:24832
    v_mfma_f32_16x16x32_bf16 v[240:243], a[120:123], a[192:195], v[240:243]
    ds_read_b64_tr_b16 a[188:189], v39 offset:16640
    ds_read_b64_tr_b16 a[190:191], v39 offset:24832
    v_mfma_f32_16x16x32_bf16 v[248:251], a[120:123], a[196:199], v[248:251]
    v_mfma_f32_16x16x32_bf16 v[252:255], a[124:127], a[196:199], v[252:255]
    v_mfma_f32_16x16x32_bf16 v[244:247], a[124:127], a[192:195], v[244:247]
    s_waitcnt vmcnt(8) lgkmcnt(0)
    s_barrier
    v_mfma_f32_16x16x32_bf16 v[128:131], a[128:131], a[200:203], v[128:131]
    s_add_u32 m0, s32, 16384
    ds_read_b128 a[64:67], v28 offset:32768
    s_add_u32 s34, s34, 16384
    v_mfma_f32_16x16x32_bf16 v[136:139], a[128:131], a[204:207], v[136:139]
    s_and_b32 s34, s34, 0x7ffff
    ds_read_b128 a[68:71], v28 offset:40960
    v_mfma_f32_16x16x32_bf16 v[140:143], a[132:135], a[204:207], v[140:143]
    buffer_load_dwordx4 v8, s[8:11], s34 offen offset:0 nt lds
    v_mfma_f32_16x16x32_bf16 v[132:135], a[132:135], a[200:203], v[132:135]
    ds_read_b128 a[72:75], v29 offset:32768
    v_mfma_f32_16x16x32_bf16 v[144:147], a[136:139], a[200:203], v[144:147]
    ds_read_b128 a[76:79], v29 offset:40960
    v_mfma_f32_16x16x32_bf16 v[152:155], a[136:139], a[204:207], v[152:155]
    ds_read_b128 a[80:83], v30 offset:32768
    v_mfma_f32_16x16x32_bf16 v[156:159], a[140:143], a[204:207], v[156:159]
    v_mfma_f32_16x16x32_bf16 v[148:151], a[140:143], a[200:203], v[148:151]
    ds_read_b128 a[84:87], v30 offset:40960
    v_mfma_f32_16x16x32_bf16 v[160:163], a[144:147], a[200:203], v[160:163]
    v_mul_f32 v128, s41, v128
    v_mul_f32 v129, s41, v129
    v_mfma_f32_16x16x32_bf16 v[168:171], a[144:147], a[204:207], v[168:171]
    ds_read_b128 a[88:91], v31 offset:32768
    v_mul_f32 v130, s41, v130
    v_mfma_f32_16x16x32_bf16 v[172:175], a[148:151], a[204:207], v[172:175]
    v_mul_f32 v131, s41, v131
    v_mul_f32 v132, s41, v132
    v_mfma_f32_16x16x32_bf16 v[164:167], a[148:151], a[200:203], v[164:167]
    ds_read_b128 a[92:95], v31 offset:40960
    v_mul_f32 v133, s41, v133
    v_mfma_f32_16x16x32_bf16 v[176:179], a[152:155], a[200:203], v[176:179]
    buffer_load_dwordx4 v9, s[8:11], s34 offen offset:1024 nt lds
    v_mul_f32 v134, s41, v134
    v_mul_f32 v135, s41, v135
    v_cvt_pk_bf16_f32 v112, v128, v129
    v_mfma_f32_16x16x32_bf16 v[184:187], a[152:155], a[204:207], v[184:187]
    ds_read_b128 a[96:99], v28 offset:33024
    v_cvt_pk_bf16_f32 v114, v132, v133
    v_cvt_pk_bf16_f32 v113, v130, v131
    v_cvt_pk_bf16_f32 v115, v134, v135
    v_mfma_f32_16x16x32_bf16 v[188:191], a[156:159], a[204:207], v[188:191]
    ds_read_b128 a[100:103], v28 offset:41216
    v_mul_f32 v136, s41, v136
    v_mul_f32 v137, s41, v137
    v_mul_f32 v138, s41, v138
    v_mul_f32 v139, s41, v139
    v_mfma_f32_16x16x32_bf16 v[180:183], a[156:159], a[200:203], v[180:183]
    v_mul_f32 v140, s41, v140
    v_mul_f32 v141, s41, v141
    v_mul_f32 v142, s41, v142
    v_mfma_f32_16x16x32_bf16 v[192:195], a[160:163], a[200:203], v[192:195]
    ds_read_b128 a[104:107], v29 offset:33024
    v_mul_f32 v143, s41, v143
    v_cvt_pk_bf16_f32 v116, v136, v137
    v_cvt_pk_bf16_f32 v118, v140, v141
    v_mfma_f32_16x16x32_bf16 v[200:203], a[160:163], a[204:207], v[200:203]
    v_cvt_pk_bf16_f32 v117, v138, v139
    v_cvt_pk_bf16_f32 v119, v142, v143
    v_permlane32_swap_b32 v112, v114
    v_permlane32_swap_b32 v113, v115
    v_mfma_f32_16x16x32_bf16 v[204:207], a[164:167], a[204:207], v[204:207]
    ds_read_b128 a[108:111], v29 offset:41216
    v_permlane32_swap_b32 v116, v118
    v_permlane32_swap_b32 v117, v119
    v_permlane16_swap_b32 v112, v114
    v_mfma_f32_16x16x32_bf16 v[196:199], a[164:167], a[200:203], v[196:199]
    buffer_load_dwordx4 v10, s[8:11], s34 offen offset:2048 nt lds
    v_permlane16_swap_b32 v113, v115
    v_permlane16_swap_b32 v116, v118
    v_permlane16_swap_b32 v117, v119
    v_mfma_f32_16x16x32_bf16 v[208:211], a[168:171], a[200:203], v[208:211]
    ds_read_b128 a[112:115], v30 offset:33024
    v_accvgpr_write_b32 a0, v112
    v_accvgpr_write_b32 a2, v114
    v_accvgpr_write_b32 a1, v113
    v_accvgpr_write_b32 a3, v115
    v_mfma_f32_16x16x32_bf16 v[216:219], a[168:171], a[204:207], v[216:219]
    v_accvgpr_write_b32 a4, v116
    v_accvgpr_write_b32 a6, v118
    v_accvgpr_write_b32 a5, v117
    v_mfma_f32_16x16x32_bf16 v[220:223], a[172:175], a[204:207], v[220:223]
    ds_read_b128 a[116:119], v30 offset:41216
    v_accvgpr_write_b32 a7, v119
    v_mul_f32 v144, s41, v144
    v_mul_f32 v145, s41, v145
    v_mfma_f32_16x16x32_bf16 v[212:215], a[172:175], a[200:203], v[212:215]
    ds_read_b128 a[120:123], v31 offset:33024
    v_mul_f32 v146, s41, v146
    v_mul_f32 v147, s41, v147
    v_mul_f32 v148, s41, v148
    v_mul_f32 v149, s41, v149
    v_mfma_f32_16x16x32_bf16 v[224:227], a[176:179], a[200:203], v[224:227]
    v_mul_f32 v150, s41, v150
    v_mul_f32 v151, s41, v151
    v_cvt_pk_bf16_f32 v112, v144, v145
    v_mfma_f32_16x16x32_bf16 v[232:235], a[176:179], a[204:207], v[232:235]
    ds_read_b128 a[124:127], v31 offset:41216
    v_cvt_pk_bf16_f32 v114, v148, v149
    v_cvt_pk_bf16_f32 v113, v146, v147
    v_cvt_pk_bf16_f32 v115, v150, v151
    v_mfma_f32_16x16x32_bf16 v[236:239], a[180:183], a[204:207], v[236:239]
    buffer_load_dwordx4 v11, s[8:11], s34 offen offset:3072 nt lds
    v_mul_f32 v152, s41, v152
    v_mul_f32 v153, s41, v153
    v_mul_f32 v154, s41, v154
    v_mul_f32 v155, s41, v155
    v_mfma_f32_16x16x32_bf16 v[228:231], a[180:183], a[200:203], v[228:231]
    v_mul_f32 v156, s41, v156
    v_mul_f32 v157, s41, v157
    v_mul_f32 v158, s41, v158
    v_mfma_f32_16x16x32_bf16 v[240:243], a[184:187], a[200:203], v[240:243]
    v_mul_f32 v159, s41, v159
    v_cvt_pk_bf16_f32 v116, v152, v153
    v_cvt_pk_bf16_f32 v118, v156, v157
    v_mfma_f32_16x16x32_bf16 v[248:251], a[184:187], a[204:207], v[248:251]
    v_cvt_pk_bf16_f32 v117, v154, v155
    v_cvt_pk_bf16_f32 v119, v158, v159
    v_permlane32_swap_b32 v112, v114
    v_permlane32_swap_b32 v113, v115
    v_mfma_f32_16x16x32_bf16 v[252:255], a[188:191], a[204:207], v[252:255]
    v_permlane32_swap_b32 v116, v118
    v_permlane32_swap_b32 v117, v119
    v_permlane16_swap_b32 v112, v114
    v_mfma_f32_16x16x32_bf16 v[244:247], a[188:191], a[200:203], v[244:247]
    v_permlane16_swap_b32 v113, v115
    v_permlane16_swap_b32 v116, v118
    v_permlane16_swap_b32 v117, v119
    v_accvgpr_write_b32 a8, v112
    v_accvgpr_write_b32 a10, v114
    v_accvgpr_write_b32 a9, v113
    v_accvgpr_write_b32 a11, v115
    v_accvgpr_write_b32 a12, v116
    v_accvgpr_write_b32 a14, v118
    v_accvgpr_write_b32 a13, v117
    v_accvgpr_write_b32 a15, v119
    s_nop 3
    s_waitcnt vmcnt(8) lgkmcnt(0)
    s_barrier
    v_mfma_f32_16x16x32_bf16 v[64:67], a[64:67], a[0:3], 0
    s_add_u32 m0, s32, 32768
    ds_read_b128 a[128:131], v28 offset:49152
    v_mul_f32 v160, s41, v160
    v_mfma_f32_16x16x32_bf16 v[68:71], a[68:71], a[0:3], 0
    s_add_u32 s35, s35, 16384
    ds_read_b128 a[132:135], v28 offset:57344
    v_mul_f32 v161, s41, v161
    v_mfma_f32_16x16x32_bf16 v[76:79], a[68:71], a[4:7], 0
    s_and_b32 s35, s35, 0x7ffff
    ds_read_b128 a[136:139], v29 offset:49152
    v_mul_f32 v162, s41, v162
    v_mul_f32 v163, s41, v163
    v_mul_f32 v164, s41, v164
    v_mul_f32 v165, s41, v165
    v_mfma_f32_16x16x32_bf16 v[72:75], a[64:67], a[4:7], 0
    ds_read_b128 a[140:143], v29 offset:57344
    v_mul_f32 v166, s41, v166
    v_mul_f32 v167, s41, v167
    v_cvt_pk_bf16_f32 v112, v160, v161
    v_cvt_pk_bf16_f32 v114, v164, v165
    v_cvt_pk_bf16_f32 v113, v162, v163
    v_cvt_pk_bf16_f32 v115, v166, v167
    v_mul_f32 v168, s41, v168
    v_mul_f32 v169, s41, v169
    v_mul_f32 v170, s41, v170
    v_mul_f32 v171, s41, v171
    v_mfma_f32_16x16x32_bf16 v[64:67], a[72:75], a[8:11], v[64:67]
    buffer_load_dwordx4 v12, s[12:15], s35 offen offset:0 nt lds
    v_mul_f32 v172, s41, v172
    v_mul_f32 v173, s41, v173
    v_mul_f32 v174, s41, v174
    v_mul_f32 v175, s41, v175
    v_cvt_pk_bf16_f32 v116, v168, v169
    v_cvt_pk_bf16_f32 v118, v172, v173
    v_cvt_pk_bf16_f32 v117, v170, v171
    v_cvt_pk_bf16_f32 v119, v174, v175
    v_permlane32_swap_b32 v112, v114
    v_permlane32_swap_b32 v113, v115
    v_permlane32_swap_b32 v116, v118
    v_mfma_f32_16x16x32_bf16 v[68:71], a[76:79], a[8:11], v[68:71]
    ds_read_b128 a[144:147], v30 offset:49152
    v_permlane32_swap_b32 v117, v119
    v_permlane16_swap_b32 v112, v114
    v_permlane16_swap_b32 v113, v115
    v_permlane16_swap_b32 v116, v118
    v_permlane16_swap_b32 v117, v119
    v_accvgpr_write_b32 a16, v112
    v_accvgpr_write_b32 a18, v114
    v_accvgpr_write_b32 a17, v113
    v_accvgpr_write_b32 a19, v115
    v_accvgpr_write_b32 a20, v116
    v_mfma_f32_16x16x32_bf16 v[76:79], a[76:79], a[12:15], v[76:79]
    buffer_load_dwordx4 v13, s[12:15], s35 offen offset:1024 nt lds
    v_accvgpr_write_b32 a22, v118
    v_accvgpr_write_b32 a21, v117
    v_accvgpr_write_b32 a23, v119
    v_mul_f32 v176, s41, v176
    v_mul_f32 v177, s41, v177
    v_mul_f32 v178, s41, v178
    v_mul_f32 v179, s41, v179
    v_mul_f32 v180, s41, v180
    v_mul_f32 v181, s41, v181
    v_mul_f32 v182, s41, v182
    v_mfma_f32_16x16x32_bf16 v[72:75], a[72:75], a[12:15], v[72:75]
    ds_read_b128 a[148:151], v30 offset:57344
    v_mul_f32 v183, s41, v183
    v_cvt_pk_bf16_f32 v112, v176, v177
    v_cvt_pk_bf16_f32 v114, v180, v181
    v_cvt_pk_bf16_f32 v113, v178, v179
    v_cvt_pk_bf16_f32 v115, v182, v183
    v_mul_f32 v184, s41, v184
    v_mul_f32 v185, s41, v185
    v_mul_f32 v186, s41, v186
    v_mul_f32 v187, s41, v187
    v_mul_f32 v188, s41, v188
    v_mul_f32 v189, s41, v189
    v_mfma_f32_16x16x32_bf16 v[64:67], a[80:83], a[16:19], v[64:67]
    v_mul_f32 v190, s41, v190
    v_mul_f32 v191, s41, v191
    v_cvt_pk_bf16_f32 v116, v184, v185
    v_cvt_pk_bf16_f32 v118, v188, v189
    v_cvt_pk_bf16_f32 v117, v186, v187
    v_cvt_pk_bf16_f32 v119, v190, v191
    v_permlane32_swap_b32 v112, v114
    v_permlane32_swap_b32 v113, v115
    v_permlane32_swap_b32 v116, v118
    v_permlane32_swap_b32 v117, v119
    v_mfma_f32_16x16x32_bf16 v[68:71], a[84:87], a[16:19], v[68:71]
    buffer_load_dwordx4 v14, s[12:15], s35 offen offset:2048 nt lds
    v_permlane16_swap_b32 v112, v114
    v_permlane16_swap_b32 v113, v115
    v_permlane16_swap_b32 v116, v118
    v_permlane16_swap_b32 v117, v119
    v_accvgpr_write_b32 a24, v112
    v_accvgpr_write_b32 a26, v114
    v_accvgpr_write_b32 a25, v113
    v_accvgpr_write_b32 a27, v115
    v_accvgpr_write_b32 a28, v116
    v_accvgpr_write_b32 a30, v118
    v_accvgpr_write_b32 a29, v117
    v_mfma_f32_16x16x32_bf16 v[76:79], a[84:87], a[20:23], v[76:79]
    ds_read_b128 a[152:155], v31 offset:49152
    v_accvgpr_write_b32 a31, v119
    v_mul_f32 v192, s41, v192
    v_mul_f32 v193, s41, v193
    v_mul_f32 v194, s41, v194
    v_mul_f32 v195, s41, v195
    v_mul_f32 v196, s41, v196
    v_mul_f32 v197, s41, v197
    v_mul_f32 v198, s41, v198
    v_mul_f32 v199, s41, v199
    v_cvt_pk_bf16_f32 v112, v192, v193
    v_mfma_f32_16x16x32_bf16 v[72:75], a[80:83], a[20:23], v[72:75]
    buffer_load_dwordx4 v15, s[12:15], s35 offen offset:3072 nt lds
    v_cvt_pk_bf16_f32 v114, v196, v197
    v_cvt_pk_bf16_f32 v113, v194, v195
    v_cvt_pk_bf16_f32 v115, v198, v199
    v_mul_f32 v200, s41, v200
    v_mul_f32 v201, s41, v201
    v_mul_f32 v202, s41, v202
    v_mul_f32 v203, s41, v203
    v_mul_f32 v204, s41, v204
    v_mul_f32 v205, s41, v205
    v_mul_f32 v206, s41, v206
    v_mul_f32 v207, s41, v207
    v_mfma_f32_16x16x32_bf16 v[64:67], a[88:91], a[24:27], v[64:67]
    s_mov_b32 m0, s83
    ds_read_b128 a[156:159], v31 offset:57344
    v_cvt_pk_bf16_f32 v116, v200, v201
    v_cvt_pk_bf16_f32 v118, v204, v205
    v_cvt_pk_bf16_f32 v117, v202, v203
    v_cvt_pk_bf16_f32 v119, v206, v207
    v_permlane32_swap_b32 v112, v114
    v_permlane32_swap_b32 v113, v115
    v_permlane32_swap_b32 v116, v118
    v_permlane32_swap_b32 v117, v119
    v_permlane16_swap_b32 v112, v114
    v_permlane16_swap_b32 v113, v115
    v_mfma_f32_16x16x32_bf16 v[68:71], a[92:95], a[24:27], v[68:71]
    s_add_u32 s83, s83, 8192
    ds_read_b128 a[160:163], v28 offset:49408
    v_permlane16_swap_b32 v116, v118
    v_permlane16_swap_b32 v117, v119
    v_accvgpr_write_b32 a32, v112
    v_accvgpr_write_b32 a34, v114
    v_accvgpr_write_b32 a33, v113
    v_accvgpr_write_b32 a35, v115
    v_accvgpr_write_b32 a36, v116
    v_accvgpr_write_b32 a38, v118
    v_accvgpr_write_b32 a37, v117
    v_accvgpr_write_b32 a39, v119
    v_mul_f32 v208, s41, v208
    v_mfma_f32_16x16x32_bf16 v[76:79], a[92:95], a[28:31], v[76:79]
    buffer_load_dwordx4 v16, s[24:27], s84 offen offset:0  lds
    v_mul_f32 v209, s41, v209
    v_mul_f32 v210, s41, v210
    v_mul_f32 v211, s41, v211
    v_mul_f32 v212, s41, v212
    v_mul_f32 v213, s41, v213
    v_mul_f32 v214, s41, v214
    v_mul_f32 v215, s41, v215
    v_cvt_pk_bf16_f32 v112, v208, v209
    v_cvt_pk_bf16_f32 v114, v212, v213
    v_cvt_pk_bf16_f32 v113, v210, v211
    v_mfma_f32_16x16x32_bf16 v[72:75], a[88:91], a[28:31], v[72:75]
    ds_read_b128 a[164:167], v28 offset:57600
    v_cvt_pk_bf16_f32 v115, v214, v215
    v_mul_f32 v216, s41, v216
    v_mul_f32 v217, s41, v217
    v_mul_f32 v218, s41, v218
    v_mul_f32 v219, s41, v219
    v_mul_f32 v220, s41, v220
    v_mul_f32 v221, s41, v221
    v_mul_f32 v222, s41, v222
    v_mul_f32 v223, s41, v223
    v_cvt_pk_bf16_f32 v116, v216, v217
    v_mfma_f32_16x16x32_bf16 v[64:67], a[96:99], a[32:35], v[64:67]
    ds_read_b128 a[168:171], v29 offset:49408
    v_cvt_pk_bf16_f32 v118, v220, v221
    v_cvt_pk_bf16_f32 v117, v218, v219
    v_cvt_pk_bf16_f32 v119, v222, v223
    v_permlane32_swap_b32 v112, v114
    v_permlane32_swap_b32 v113, v115
    v_permlane32_swap_b32 v116, v118
    v_permlane32_swap_b32 v117, v119
    v_permlane16_swap_b32 v112, v114
    v_permlane16_swap_b32 v113, v115
    v_permlane16_swap_b32 v116, v118
    v_permlane16_swap_b32 v117, v119
    v_mfma_f32_16x16x32_bf16 v[68:71], a[100:103], a[32:35], v[68:71]
    buffer_load_dwordx4 v17, s[24:27], s84 offen offset:1024  lds
    v_accvgpr_write_b32 a40, v112
    v_accvgpr_write_b32 a42, v114
    v_accvgpr_write_b32 a41, v113
    v_accvgpr_write_b32 a43, v115
    v_accvgpr_write_b32 a44, v116
    v_accvgpr_write_b32 a46, v118
    v_accvgpr_write_b32 a45, v117
    v_accvgpr_write_b32 a47, v119
    v_mul_f32 v224, s41, v224
    v_mul_f32 v225, s41, v225
    v_mfma_f32_16x16x32_bf16 v[76:79], a[100:103], a[36:39], v[76:79]
    s_add_u32 s84, s84, 57344
    ds_read_b128 a[172:175], v29 offset:57600
    v_mul_f32 v226, s41, v226
    v_mul_f32 v227, s41, v227
    v_mul_f32 v228, s41, v228
    v_mul_f32 v229, s41, v229
    v_mul_f32 v230, s41, v230
    v_mul_f32 v231, s41, v231
    v_cvt_pk_bf16_f32 v112, v224, v225
    v_cvt_pk_bf16_f32 v114, v228, v229
    v_cvt_pk_bf16_f32 v113, v226, v227
    v_cvt_pk_bf16_f32 v115, v230, v231
    v_mul_f32 v232, s41, v232
    v_mfma_f32_16x16x32_bf16 v[72:75], a[96:99], a[36:39], v[72:75]
    s_cmp_ge_u32 s84, 229376
    s_cselect_b32 s84, s85, s84
    s_cselect_b32 s85, s78, s85
    v_mul_f32 v233, s41, v233
    v_mul_f32 v234, s41, v234
    v_mul_f32 v235, s41, v235
    v_mul_f32 v236, s41, v236
    v_mul_f32 v237, s41, v237
    v_mul_f32 v238, s41, v238
    v_mul_f32 v239, s41, v239
    v_cvt_pk_bf16_f32 v116, v232, v233
    v_cvt_pk_bf16_f32 v118, v236, v237
    v_cvt_pk_bf16_f32 v117, v234, v235
    v_mfma_f32_16x16x32_bf16 v[64:67], a[104:107], a[40:43], v[64:67]
    s_mov_b32 m0, s83
    ds_read_b128 a[176:179], v30 offset:49408
    v_cvt_pk_bf16_f32 v119, v238, v239
    v_permlane32_swap_b32 v112, v114
    v_permlane32_swap_b32 v113, v115
    v_permlane32_swap_b32 v116, v118
    v_permlane32_swap_b32 v117, v119
    v_permlane16_swap_b32 v112, v114
    v_permlane16_swap_b32 v113, v115
    v_permlane16_swap_b32 v116, v118
    v_permlane16_swap_b32 v117, v119
    v_accvgpr_write_b32 a48, v112
    v_accvgpr_write_b32 a50, v114
    v_mfma_f32_16x16x32_bf16 v[68:71], a[108:111], a[40:43], v[68:71]
    s_add_u32 s83, s83, 8192
    v_accvgpr_write_b32 a49, v113
    v_accvgpr_write_b32 a51, v115
    v_accvgpr_write_b32 a52, v116
    v_accvgpr_write_b32 a54, v118
    v_accvgpr_write_b32 a53, v117
    v_accvgpr_write_b32 a55, v119
    v_mul_f32 v240, s41, v240
    v_mul_f32 v241, s41, v241
    v_mul_f32 v242, s41, v242
    v_mul_f32 v243, s41, v243
    v_mfma_f32_16x16x32_bf16 v[76:79], a[108:111], a[44:47], v[76:79]
    ds_read_b128 a[180:183], v30 offset:57600
    v_mul_f32 v244, s41, v244
    v_mul_f32 v245, s41, v245
    v_mul_f32 v246, s41, v246
    v_mul_f32 v247, s41, v247
    v_cvt_pk_bf16_f32 v112, v240, v241
    v_cvt_pk_bf16_f32 v114, v244, v245
    v_cvt_pk_bf16_f32 v113, v242, v243
    v_cvt_pk_bf16_f32 v115, v246, v247
    v_mul_f32 v248, s41, v248
    v_mul_f32 v249, s41, v249
    v_mul_f32 v250, s41, v250
    v_mul_f32 v251, s41, v251
    v_mul_f32 v252, s41, v252
    v_mul_f32 v253, s41, v253
    v_mul_f32 v254, s41, v254
    v_mul_f32 v255, s41, v255
    v_cvt_pk_bf16_f32 v116, v248, v249
    v_cvt_pk_bf16_f32 v118, v252, v253
    v_cvt_pk_bf16_f32 v117, v250, v251
    v_cvt_pk_bf16_f32 v119, v254, v255
    v_permlane32_swap_b32 v112, v114
    v_permlane32_swap_b32 v113, v115
    v_permlane32_swap_b32 v116, v118
    v_permlane32_swap_b32 v117, v119
    v_permlane16_swap_b32 v112, v114
    v_permlane16_swap_b32 v113, v115
    v_permlane16_swap_b32 v116, v118
    v_permlane16_swap_b32 v117, v119
    v_accvgpr_write_b32 a56, v112
    v_accvgpr_write_b32 a58, v114
    v_accvgpr_write_b32 a57, v113
    v_accvgpr_write_b32 a59, v115
    v_accvgpr_write_b32 a60, v116
    v_accvgpr_write_b32 a62, v118
    v_accvgpr_write_b32 a61, v117
    v_accvgpr_write_b32 a63, v119
    v_mfma_f32_16x16x32_bf16 v[72:75], a[104:107], a[44:47], v[72:75]
    buffer_load_dwordx4 v16, s[24:27], s84 offen offset:0  lds
    v_mfma_f32_16x16x32_bf16 v[64:67], a[112:115], a[48:51], v[64:67]
    buffer_load_dwordx4 v17, s[24:27], s84 offen offset:1024  lds
    v_mfma_f32_16x16x32_bf16 v[68:71], a[116:119], a[48:51], v[68:71]
    s_add_u32 s84, s84, 57344
    ds_read_b128 a[184:187], v31 offset:49408
    s_cmp_ge_u32 s84, 229376
    s_cselect_b32 s84, s85, s84
    s_cselect_b32 s85, s78, s85
    v_mfma_f32_16x16x32_bf16 v[76:79], a[116:119], a[52:55], v[76:79]
    ds_read_b128 a[188:191], v31 offset:57600
    v_mfma_f32_16x16x32_bf16 v[72:75], a[112:115], a[52:55], v[72:75]
    v_mfma_f32_16x16x32_bf16 v[64:67], a[120:123], a[56:59], v[64:67]
    v_mfma_f32_16x16x32_bf16 v[68:71], a[124:127], a[56:59], v[68:71]
    v_mfma_f32_16x16x32_bf16 v[76:79], a[124:127], a[60:63], v[76:79]
    v_mfma_f32_16x16x32_bf16 v[72:75], a[120:123], a[60:63], v[72:75]
    v_add_u32 v20, 0x10000, v42
    v_add_u32 v21, 0x10000, v43
    v_add_u32 v22, 0x10000, v44
    v_add_u32 v23, 0x10000, v45
    s_nop 3
    v_max3_f32 v48, v64, v65, v66
    v_max3_f32 v48, v48, v67, v68
    v_max3_f32 v48, v48, v69, v70
    v_max_f32 v48, v48, v71
    v_mov_b32 v49, v48
    s_nop 1
    v_permlane32_swap_b32 v49, v48
    v_max_f32 v48, v49, v48
    v_mov_b32 v49, v48
    s_nop 1
    v_permlane16_swap_b32 v49, v48
    v_max_f32 v48, v49, v48
    v_sub_f32 v104, 0, v48
    v_sub_f32 v105, 0, v48
    v_sub_f32 v106, 0, v48
    v_sub_f32 v107, 0, v48
    v_sub_f32 v64, v64, v48
    v_sub_f32 v65, v65, v48
    v_sub_f32 v66, v66, v48
    v_sub_f32 v67, v67, v48
    v_sub_f32 v68, v68, v48
    v_sub_f32 v69, v69, v48
    v_sub_f32 v70, v70, v48
    v_sub_f32 v71, v71, v48
    v_max3_f32 v48, v72, v73, v74
    v_max3_f32 v48, v48, v75, v76
    v_max3_f32 v48, v48, v77, v78
    v_max_f32 v48, v48, v79
    v_mov_b32 v49, v48
    s_nop 1
    v_permlane32_swap_b32 v49, v48
    v_max_f32 v48, v49, v48
    v_mov_b32 v49, v48
    s_nop 1
    v_permlane16_swap_b32 v49, v48
    v_max_f32 v48, v49, v48
    v_sub_f32 v108, 0, v48
    v_sub_f32 v109, 0, v48
    v_sub_f32 v110, 0, v48
    v_sub_f32 v111, 0, v48
    v_sub_f32 v72, v72, v48
    v_sub_f32 v73, v73, v48
    v_sub_f32 v74, v74, v48
    v_sub_f32 v75, v75, v48
    v_sub_f32 v76, v76, v48
    v_sub_f32 v77, v77, v48
    v_sub_f32 v78, v78, v48
    v_sub_f32 v79, v79, v48
    s_waitcnt vmcnt(12) lgkmcnt(0)
    s_barrier
    v_mfma_f32_16x16x32_bf16 v[80:83], a[128:131], a[0:3], v[104:107]
    s_add_u32 m0, s32, 49152
    ds_read_b64_tr_b16 a[64:65], v32 offset:0
    s_add_u32 s34, s34, 16384
    v_mfma_f32_16x16x32_bf16 v[84:87], a[132:135], a[0:3], v[104:107]
    s_and_b32 s34, s34, 0x7ffff
    v_exp_f32 v64, v64
    v_mfma_f32_16x16x32_bf16 v[92:95], a[132:135], a[4:7], v[108:111]
    ds_read_b64_tr_b16 a[66:67], v32 offset:8192
    ds_read_b64_tr_b16 a[68:69], v33 offset:0
    v_mfma_f32_16x16x32_bf16 v[88:91], a[128:131], a[4:7], v[108:111]
    v_exp_f32 v65, v65
    v_mfma_f32_16x16x32_bf16 v[80:83], a[136:139], a[8:11], v[80:83]
    ds_read_b64_tr_b16 a[70:71], v33 offset:8192
    buffer_load_dwordx4 v8, s[8:11], s34 offen offset:0 nt lds
    v_mfma_f32_16x16x32_bf16 v[84:87], a[140:143], a[8:11], v[84:87]
    s_mov_b32 m0, s83
    ds_read_b64_tr_b16 a[72:73], v34 offset:0
    v_exp_f32 v66, v66
    v_mfma_f32_16x16x32_bf16 v[92:95], a[140:143], a[12:15], v[92:95]
    s_add_u32 s83, s83, 8192
    ds_read_b64_tr_b16 a[74:75], v34 offset:8192
    ds_read_b64_tr_b16 a[76:77], v35 offset:0
    v_mfma_f32_16x16x32_bf16 v[88:91], a[136:139], a[12:15], v[88:91]
    ds_read_b64_tr_b16 a[78:79], v35 offset:8192
    v_cvt_pk_bf16_f32 v96, v64, v65
    v_exp_f32 v67, v67
    v_mfma_f32_16x16x32_bf16 v[80:83], a[144:147], a[16:19], v[80:83]
    ds_read_b64_tr_b16 a[80:81], v36 offset:0
    v_exp_f32 v68, v68
    v_mfma_f32_16x16x32_bf16 v[84:87], a[148:151], a[16:19], v[84:87]
    ds_read_b64_tr_b16 a[82:83], v36 offset:8192
    v_cvt_pk_bf16_f32 v97, v66, v67
    v_mfma_f32_16x16x32_bf16 v[92:95], a[148:151], a[20:23], v[92:95]
    ds_read_b64_tr_b16 a[84:85], v37 offset:0
    v_exp_f32 v69, v69
    v_mfma_f32_16x16x32_bf16 v[88:91], a[144:147], a[20:23], v[88:91]
    ds_read_b64_tr_b16 a[86:87], v37 offset:8192
    buffer_load_dwordx4 v16, s[24:27], s84 offen offset:0  lds
    v_mfma_f32_16x16x32_bf16 v[80:83], a[152:155], a[24:27], v[80:83]
    ds_read_b64_tr_b16 a[88:89], v38 offset:0
    v_exp_f32 v70, v70
    v_mfma_f32_16x16x32_bf16 v[84:87], a[156:159], a[24:27], v[84:87]
    ds_read_b64_tr_b16 a[90:91], v38 offset:8192
    v_cvt_pk_bf16_f32 v98, v68, v69
    v_mfma_f32_16x16x32_bf16 v[92:95], a[156:159], a[28:31], v[92:95]
    ds_read_b64_tr_b16 a[92:93], v39 offset:0
    v_exp_f32 v71, v71
    v_mfma_f32_16x16x32_bf16 v[88:91], a[152:155], a[28:31], v[88:91]
    ds_read_b64_tr_b16 a[94:95], v39 offset:8192
    ds_read_b64_tr_b16 a[96:97], v32 offset:256
    v_mfma_f32_16x16x32_bf16 v[80:83], a[160:163], a[32:35], v[80:83]
    ds_read_b64_tr_b16 a[98:99], v32 offset:8448
    v_exp_f32 v72, v72
    v_mfma_f32_16x16x32_bf16 v[84:87], a[164:167], a[32:35], v[84:87]
    ds_read_b64_tr_b16 a[100:101], v33 offset:256
    buffer_load_dwordx4 v17, s[24:27], s84 offen offset:1024  lds
    v_mfma_f32_16x16x32_bf16 v[92:95], a[164:167], a[36:39], v[92:95]
    s_add_u32 s84, s84, 57344
    ds_read_b64_tr_b16 a[102:103], v33 offset:8448
    v_cvt_pk_bf16_f32 v99, v70, v71
    v_mfma_f32_16x16x32_bf16 v[88:91], a[160:163], a[36:39], v[88:91]
    s_cmp_ge_u32 s84, 229376
    s_cselect_b32 s84, s85, s84
    s_cselect_b32 s85, s78, s85
    ds_read_b64_tr_b16 a[104:105], v34 offset:256
    v_exp_f32 v73, v73
    v_mfma_f32_16x16x32_bf16 v[80:83], a[168:171], a[40:43], v[80:83]
    ds_read_b64_tr_b16 a[106:107], v34 offset:8448
    v_exp_f32 v74, v74
    v_mfma_f32_16x16x32_bf16 v[84:87], a[172:175], a[40:43], v[84:87]
    ds_read_b64_tr_b16 a[108:109], v35 offset:256
    v_cvt_pk_bf16_f32 v100, v72, v73
    v_mfma_f32_16x16x32_bf16 v[92:95], a[172:175], a[44:47], v[92:95]
    ds_read_b64_tr_b16 a[110:111], v35 offset:8448
    v_exp_f32 v75, v75
    v_mfma_f32_16x16x32_bf16 v[88:91], a[168:171], a[44:47], v[88:91]
    ds_read_b64_tr_b16 a[112:113], v36 offset:256
    v_exp_f32 v76, v76
    v_mfma_f32_16x16x32_bf16 v[80:83], a[176:179], a[48:51], v[80:83]
    ds_read_b64_tr_b16 a[114:115], v36 offset:8448
    v_cvt_pk_bf16_f32 v101, v74, v75
    v_mfma_f32_16x16x32_bf16 v[84:87], a[180:183], a[48:51], v[84:87]
    ds_read_b64_tr_b16 a[116:117], v37 offset:256
    ds_read_b64_tr_b16 a[118:119], v37 offset:8448
    v_mfma_f32_16x16x32_bf16 v[92:95], a[180:183], a[52:55], v[92:95]
    ds_read_b64_tr_b16 a[120:121], v38 offset:256
    v_exp_f32 v77, v77
    v_mfma_f32_16x16x32_bf16 v[88:91], a[176:179], a[52:55], v[88:91]
    ds_read_b64_tr_b16 a[122:123], v38 offset:8448
    v_exp_f32 v78, v78
    v_mfma_f32_16x16x32_bf16 v[80:83], a[184:187], a[56:59], v[80:83]
    ds_read_b64_tr_b16 a[124:125], v39 offset:256
    ds_read_b64_tr_b16 a[126:127], v39 offset:8448
    v_mfma_f32_16x16x32_bf16 v[84:87], a[188:191], a[56:59], v[84:87]
    v_cvt_pk_bf16_f32 v102, v76, v77
    v_exp_f32 v79, v79
    v_mfma_f32_16x16x32_bf16 v[92:95], a[188:191], a[60:63], v[92:95]
    v_cvt_pk_bf16_f32 v103, v78, v79
    v_mfma_f32_16x16x32_bf16 v[88:91], a[184:187], a[60:63], v[88:91]
    s_waitcnt vmcnt(11) lgkmcnt(0)
    s_barrier
    v_mfma_f32_16x16x32_bf16 v[128:131], a[64:67], v[96:99], 0
    s_add_u32 m0, s32, 49152
    ds_read_b128 a[128:131], v28 offset:16384
    v_add_f32 v46, v46, v64
    v_mfma_f32_16x16x32_bf16 v[136:139], a[64:67], v[100:103], 0
    s_nop 0
    ds_read_b128 a[132:135], v28 offset:24576
    v_add_f32 v47, v47, v72
    v_mfma_f32_16x16x32_bf16 v[140:143], a[68:71], v[100:103], 0
    buffer_load_dwordx4 v9, s[8:11], s34 offen offset:1024 nt lds
    v_mfma_f32_16x16x32_bf16 v[132:135], a[68:71], v[96:99], 0
    ds_read_b128 a[136:139], v29 offset:16384
    v_add_f32 v46, v46, v65
    v_mfma_f32_16x16x32_bf16 v[144:147], a[72:75], v[96:99], 0
    ds_read_b128 a[140:143], v29 offset:24576
    v_add_f32 v47, v47, v73
    v_mfma_f32_16x16x32_bf16 v[152:155], a[72:75], v[100:103], 0
    ds_read_b128 a[144:147], v30 offset:16384
    v_add_f32 v46, v46, v66
    v_mfma_f32_16x16x32_bf16 v[156:159], a[76:79], v[100:103], 0
    buffer_load_dwordx4 v10, s[8:11], s34 offen offset:2048 nt lds
    v_mfma_f32_16x16x32_bf16 v[148:151], a[76:79], v[96:99], 0
    ds_read_b128 a[148:151], v30 offset:24576
    v_add_f32 v47, v47, v74
    v_mfma_f32_16x16x32_bf16 v[160:163], a[80:83], v[96:99], 0
    v_add_f32 v46, v46, v67
    v_add_f32 v47, v47, v75
    v_mfma_f32_16x16x32_bf16 v[168:171], a[80:83], v[100:103], 0
    buffer_load_dwordx4 v11, s[8:11], s34 offen offset:3072 nt lds
    v_mfma_f32_16x16x32_bf16 v[172:175], a[84:87], v[100:103], 0
    s_add_u32 m0, s32, 0
    ds_read_b128 a[152:155], v31 offset:16384
    v_add_f32 v46, v46, v68
    v_mfma_f32_16x16x32_bf16 v[164:167], a[84:87], v[96:99], 0
    s_add_u32 s35, s35, 16384
    ds_read_b128 a[156:159], v31 offset:24576
    v_add_f32 v47, v47, v76
    v_mfma_f32_16x16x32_bf16 v[176:179], a[88:91], v[96:99], 0
    s_and_b32 s35, s35, 0x7ffff
    ds_read_b128 a[160:163], v28 offset:16640
    v_add_f32 v46, v46, v69
    v_mfma_f32_16x16x32_bf16 v[184:187], a[88:91], v[100:103], 0
    buffer_load_dwordx4 v12, s[12:15], s35 offen offset:0 nt lds
    v_add_f32 v47, v47, v77
    v_mfma_f32_16x16x32_bf16 v[188:191], a[92:95], v[100:103], 0
    ds_read_b128 a[164:167], v28 offset:24832
    v_add_f32 v46, v46, v70
    v_mfma_f32_16x16x32_bf16 v[180:183], a[92:95], v[96:99], 0
    buffer_load_dwordx4 v13, s[12:15], s35 offen offset:1024 nt lds
    v_add_f32 v47, v47, v78
    v_add_f32 v46, v46, v71
    v_add_f32 v47, v47, v79
    v_mfma_f32_16x16x32_bf16 v[192:195], a[96:99], v[96:99], 0
    s_mov_b32 m0, s83
    ds_read_b128 a[168:171], v29 offset:16640
    s_add_u32 s83, s83, 8192
    v_mfma_f32_16x16x32_bf16 v[200:203], a[96:99], v[100:103], 0
    buffer_load_dwordx4 v16, s[24:27], s84 offen offset:0  lds
    v_mfma_f32_16x16x32_bf16 v[204:207], a[100:103], v[100:103], 0
    ds_read_b128 a[172:175], v29 offset:24832
    v_max3_f32 v48, v80, v81, v82
    v_mfma_f32_16x16x32_bf16 v[196:199], a[100:103], v[96:99], 0
    v_max3_f32 v48, v48, v83, v84
    v_max3_f32 v48, v48, v85, v86
    v_mfma_f32_16x16x32_bf16 v[208:211], a[104:107], v[96:99], 0
    buffer_load_dwordx4 v17, s[24:27], s84 offen offset:1024  lds
    v_mfma_f32_16x16x32_bf16 v[216:219], a[104:107], v[100:103], 0
    s_add_u32 s84, s84, 57344
    ds_read_b128 a[176:179], v30 offset:16640
    v_max3_f32 v48, v48, v87, v88
    v_mfma_f32_16x16x32_bf16 v[220:223], a[108:111], v[100:103], 0
    s_cmp_ge_u32 s84, 229376
    s_cselect_b32 s84, s85, s84
    s_cselect_b32 s85, s78, s85
    ds_read_b128 a[180:183], v30 offset:24832
    v_mfma_f32_16x16x32_bf16 v[212:215], a[108:111], v[96:99], 0
    s_and_b32 s7, s4, 12
    ds_read_b128 a[184:187], v31 offset:16640
    v_max3_f32 v48, v48, v89, v90
    v_mfma_f32_16x16x32_bf16 v[224:227], a[112:115], v[96:99], 0
    s_add_u32 s7, s7, 8
    v_max3_f32 v48, v48, v91, v92
    v_max3_f32 v48, v48, v93, v94
    v_mfma_f32_16x16x32_bf16 v[232:235], a[112:115], v[100:103], 0
    s_lshl_b32 s95, s95, s7
    ds_read_b128 a[188:191], v31 offset:24832
    s_add_u32 s95, s95, 1
    v_mfma_f32_16x16x32_bf16 v[236:239], a[116:119], v[100:103], 0
    v_mov_b32 v7, s95
    v_max_f32 v48, v48, v95
    v_mfma_f32_16x16x32_bf16 v[228:231], a[116:119], v[96:99], 0
    buffer_atomic_add v7, v55, s[68:71], 0 offen
    v_mfma_f32_16x16x32_bf16 v[240:243], a[120:123], v[96:99], 0
    v_cmp_lt_f32 vcc, s40, v48
    v_mfma_f32_16x16x32_bf16 v[248:251], a[120:123], v[100:103], 0
    v_mfma_f32_16x16x32_bf16 v[252:255], a[124:127], v[100:103], 0
    v_mfma_f32_16x16x32_bf16 v[244:247], a[124:127], v[96:99], 0
    s_cbranch_vccnz L_rs0
L_rb0:
    s_mov_b32 s39, 6
L_loopaA:
    s_waitcnt vmcnt(6) lgkmcnt(0)
    s_barrier
    v_mfma_f32_16x16x32_bf16 v[64:67], a[128:131], a[0:3], v[104:107]
    s_add_u32 m0, s32, 0
    ds_read_b64_tr_b16 a[64:65], v32 offset:32768
    s_nop 0
    v_mfma_f32_16x16x32_bf16 v[68:71], a[132:135], a[0:3], v[104:107]
    v_exp_f32 v80, v80
    v_mfma_f32_16x16x32_bf16 v[76:79], a[132:135], a[4:7], v[108:111]
    ds_read_b64_tr_b16 a[66:67], v32 offset:40960
    ds_read_b64_tr_b16 a[68:69], v33 offset:32768
    v_mfma_f32_16x16x32_bf16 v[72:75], a[128:131], a[4:7], v[108:111]
    v_exp_f32 v81, v81
    v_mfma_f32_16x16x32_bf16 v[64:67], a[136:139], a[8:11], v[64:67]
    ds_read_b64_tr_b16 a[70:71], v33 offset:40960
    ds_read_b64_tr_b16 a[72:73], v34 offset:32768
    v_mfma_f32_16x16x32_bf16 v[68:71], a[140:143], a[8:11], v[68:71]
    v_exp_f32 v82, v82
    v_mfma_f32_16x16x32_bf16 v[76:79], a[140:143], a[12:15], v[76:79]
    ds_read_b64_tr_b16 a[74:75], v34 offset:40960
    ds_read_b64_tr_b16 a[76:77], v35 offset:32768
    v_mfma_f32_16x16x32_bf16 v[72:75], a[136:139], a[12:15], v[72:75]
    ds_read_b64_tr_b16 a[78:79], v35 offset:40960
    v_cvt_pk_bf16_f32 v96, v80, v81
    v_exp_f32 v83, v83
    v_mfma_f32_16x16x32_bf16 v[64:67], a[144:147], a[16:19], v[64:67]
    ds_read_b64_tr_b16 a[80:81], v36 offset:32768
    buffer_load_dwordx4 v14, s[12:15], s35 offen offset:2048 nt lds
    v_mfma_f32_16x16x32_bf16 v[68:71], a[148:151], a[16:19], v[68:71]
    ds_read_b64_tr_b16 a[82:83], v36 offset:40960
    v_exp_f32 v84, v84
    v_mfma_f32_16x16x32_bf16 v[76:79], a[148:151], a[20:23], v[76:79]
    ds_read_b64_tr_b16 a[84:85], v37 offset:32768
    v_cvt_pk_bf16_f32 v97, v82, v83
    v_mfma_f32_16x16x32_bf16 v[72:75], a[144:147], a[20:23], v[72:75]
    ds_read_b64_tr_b16 a[86:87], v37 offset:40960
    v_exp_f32 v85, v85
    v_mfma_f32_16x16x32_bf16 v[64:67], a[152:155], a[24:27], v[64:67]
    ds_read_b64_tr_b16 a[88:89], v38 offset:32768
    v_exp_f32 v86, v86
    v_mfma_f32_16x16x32_bf16 v[68:71], a[156:159], a[24:27], v[68:71]
    ds_read_b64_tr_b16 a[90:91], v38 offset:40960
    v_cvt_pk_bf16_f32 v98, v84, v85
    v_mfma_f32_16x16x32_bf16 v[76:79], a[156:159], a[28:31], v[76:79]
    ds_read_b64_tr_b16 a[92:93], v39 offset:32768
    buffer_load_dwordx4 v15, s[12:15], s35 offen offset:3072 nt lds
    v_mfma_f32_16x16x32_bf16 v[72:75], a[152:155], a[28:31], v[72:75]
    s_add_u32 m0, s32, 16384
    ds_read_b64_tr_b16 a[94:95], v39 offset:40960
    v_exp_f32 v87, v87
    v_mfma_f32_16x16x32_bf16 v[64:67], a[160:163], a[32:35], v[64:67]
    s_add_u32 s34, s34, 16384
    ds_read_b64_tr_b16 a[96:97], v32 offset:33024
    ds_read_b64_tr_b16 a[98:99], v32 offset:41216
    v_mfma_f32_16x16x32_bf16 v[68:71], a[164:167], a[32:35], v[68:71]
    ds_read_b64_tr_b16 a[100:101], v33 offset:33024
    v_exp_f32 v88, v88
    v_mfma_f32_16x16x32_bf16 v[76:79], a[164:167], a[36:39], v[76:79]
    s_and_b32 s34, s34, 0x7ffff
    ds_read_b64_tr_b16 a[102:103], v33 offset:41216
    v_cvt_pk_bf16_f32 v99, v86, v87
    v_mfma_f32_16x16x32_bf16 v[72:75], a[160:163], a[36:39], v[72:75]
    ds_read_b64_tr_b16 a[104:105], v34 offset:33024
    v_exp_f32 v89, v89
    v_mfma_f32_16x16x32_bf16 v[64:67], a[168:171], a[40:43], v[64:67]
    ds_read_b64_tr_b16 a[106:107], v34 offset:41216
    v_exp_f32 v90, v90
    v_mfma_f32_16x16x32_bf16 v[68:71], a[172:175], a[40:43], v[68:71]
    ds_read_b64_tr_b16 a[108:109], v35 offset:33024
    v_cvt_pk_bf16_f32 v100, v88, v89
    v_mfma_f32_16x16x32_bf16 v[76:79], a[172:175], a[44:47], v[76:79]
    ds_read_b64_tr_b16 a[110:111], v35 offset:41216
    v_exp_f32 v91, v91
    v_mfma_f32_16x16x32_bf16 v[72:75], a[168:171], a[44:47], v[72:75]
    ds_read_b64_tr_b16 a[112:113], v36 offset:33024
    v_exp_f32 v92, v92
    v_mfma_f32_16x16x32_bf16 v[64:67], a[176:179], a[48:51], v[64:67]
    ds_read_b64_tr_b16 a[114:115], v36 offset:41216
    v_cvt_pk_bf16_f32 v101, v90, v91
    v_mfma_f32_16x16x32_bf16 v[68:71], a[180:183], a[48:51], v[68:71]
    ds_read_b64_tr_b16 a[116:117], v37 offset:33024
    buffer_load_dwordx4 v8, s[8:11], s34 offen offset:0 nt lds
    v_mfma_f32_16x16x32_bf16 v[76:79], a[180:183], a[52:55], v[76:79]
    ds_read_b64_tr_b16 a[118:119], v37 offset:41216
    ds_read_b64_tr_b16 a[120:121], v38 offset:33024
    v_mfma_f32_16x16x32_bf16 v[72:75], a[176:179], a[52:55], v[72:75]
    ds_read_b64_tr_b16 a[122:123], v38 offset:41216
    v_exp_f32 v93, v93
    v_mfma_f32_16x16x32_bf16 v[64:67], a[184:187], a[56:59], v[64:67]
    ds_read_b64_tr_b16 a[124:125], v39 offset:33024
    v_exp_f32 v94, v94
    ds_read_b64_tr_b16 a[126:127], v39 offset:41216
    v_mfma_f32_16x16x32_bf16 v[68:71], a[188:191], a[56:59], v[68:71]
    v_cvt_pk_bf16_f32 v102, v92, v93
    v_exp_f32 v95, v95
    v_mfma_f32_16x16x32_bf16 v[76:79], a[188:191], a[60:63], v[76:79]
    v_cvt_pk_bf16_f32 v103, v94, v95
    v_mfma_f32_16x16x32_bf16 v[72:75], a[184:187], a[60:63], v[72:75]
    s_waitcnt vmcnt(5) lgkmcnt(0)
    s_barrier
    v_mfma_f32_16x16x32_bf16 v[128:131], a[64:67], v[96:99], v[128:131]
    s_add_u32 m0, s32, 16384
    ds_read_b128 a[128:131], v28 offset:49152
    v_add_f32 v46, v46, v80
    v_mfma_f32_16x16x32_bf16 v[136:139], a[64:67], v[100:103], v[136:139]
    s_nop 0
    ds_read_b128 a[132:135], v28 offset:57344
    v_add_f32 v47, v47, v88
    v_mfma_f32_16x16x32_bf16 v[140:143], a[68:71], v[100:103], v[140:143]
    ds_read_b128 a[136:139], v29 offset:49152
    v_add_f32 v46, v46, v81
    v_mfma_f32_16x16x32_bf16 v[132:135], a[68:71], v[96:99], v[132:135]
    ds_read_b128 a[140:143], v29 offset:57344
    v_add_f32 v47, v47, v89
    v_mfma_f32_16x16x32_bf16 v[144:147], a[72:75], v[96:99], v[144:147]
    buffer_load_dwordx4 v9, s[8:11], s34 offen offset:1024 nt lds
    v_mfma_f32_16x16x32_bf16 v[152:155], a[72:75], v[100:103], v[152:155]
    ds_read_b128 a[144:147], v30 offset:49152
    v_add_f32 v46, v46, v82
    v_mfma_f32_16x16x32_bf16 v[156:159], a[76:79], v[100:103], v[156:159]
    v_add_f32 v47, v47, v90
    v_add_f32 v46, v46, v83
    v_mfma_f32_16x16x32_bf16 v[148:151], a[76:79], v[96:99], v[148:151]
    ds_read_b128 a[148:151], v30 offset:57344
    v_add_f32 v47, v47, v91
    v_mfma_f32_16x16x32_bf16 v[160:163], a[80:83], v[96:99], v[160:163]
    v_add_f32 v46, v46, v84
    v_add_f32 v47, v47, v92
    v_mfma_f32_16x16x32_bf16 v[168:171], a[80:83], v[100:103], v[168:171]
    buffer_load_dwordx4 v10, s[8:11], s34 offen offset:2048 nt lds
    v_mfma_f32_16x16x32_bf16 v[172:175], a[84:87], v[100:103], v[172:175]
    ds_read_b128 a[152:155], v31 offset:49152
    v_add_f32 v46, v46, v85
    v_mfma_f32_16x16x32_bf16 v[164:167], a[84:87], v[96:99], v[164:167]
    ds_read_b128 a[156:159], v31 offset:57344
    v_add_f32 v47, v47, v93
    v_mfma_f32_16x16x32_bf16 v[176:179], a[88:91], v[96:99], v[176:179]
    ds_read_b128 a[160:163], v28 offset:49408
    v_add_f32 v46, v46, v86
    v_mfma_f32_16x16x32_bf16 v[184:187], a[88:91], v[100:103], v[184:187]
    v_add_f32 v47, v47, v94
    v_add_f32 v46, v46, v87
    v_mfma_f32_16x16x32_bf16 v[188:191], a[92:95], v[100:103], v[188:191]
    buffer_load_dwordx4 v11, s[8:11], s34 offen offset:3072 nt lds
    v_mfma_f32_16x16x32_bf16 v[180:183], a[92:95], v[96:99], v[180:183]
    s_add_u32 m0, s32, 32768
    ds_read_b128 a[164:167], v28 offset:57600
    v_add_f32 v47, v47, v95
    v_mfma_f32_16x16x32_bf16 v[192:195], a[96:99], v[96:99], v[192:195]
    s_add_u32 s35, s35, 16384
    ds_read_b128 a[168:171], v29 offset:49408
    v_max3_f32 v48, v64, v65, v66
    v_mfma_f32_16x16x32_bf16 v[200:203], a[96:99], v[100:103], v[200:203]
    s_and_b32 s35, s35, 0x7ffff
    v_max3_f32 v48, v48, v67, v68
    v_max3_f32 v48, v48, v69, v70
    v_mfma_f32_16x16x32_bf16 v[204:207], a[100:103], v[100:103], v[204:207]
    ds_read_b128 a[172:175], v29 offset:57600
    v_mfma_f32_16x16x32_bf16 v[196:199], a[100:103], v[96:99], v[196:199]
    buffer_load_dwordx4 v12, s[12:15], s35 offen offset:0 nt lds
    v_mfma_f32_16x16x32_bf16 v[208:211], a[104:107], v[96:99], v[208:211]
    ds_read_b128 a[176:179], v30 offset:49408
    v_max3_f32 v48, v48, v71, v72
    v_mfma_f32_16x16x32_bf16 v[216:219], a[104:107], v[100:103], v[216:219]
    v_max3_f32 v48, v48, v73, v74
    v_mfma_f32_16x16x32_bf16 v[220:223], a[108:111], v[100:103], v[220:223]
    ds_read_b128 a[180:183], v30 offset:57600
    v_max3_f32 v48, v48, v75, v76
    v_mfma_f32_16x16x32_bf16 v[212:215], a[108:111], v[96:99], v[212:215]
    buffer_load_dwordx4 v13, s[12:15], s35 offen offset:1024 nt lds
    v_mfma_f32_16x16x32_bf16 v[224:227], a[112:115], v[96:99], v[224:227]
    ds_read_b128 a[184:187], v31 offset:49408
    v_max3_f32 v48, v48, v77, v78
    v_mfma_f32_16x16x32_bf16 v[232:235], a[112:115], v[100:103], v[232:235]
    ds_read_b128 a[188:191], v31 offset:57600
    v_max_f32 v48, v48, v79
    v_mfma_f32_16x16x32_bf16 v[236:239], a[116:119], v[100:103], v[236:239]
    v_cmp_lt_f32 vcc, s40, v48
    v_mfma_f32_16x16x32_bf16 v[228:231], a[116:119], v[96:99], v[228:231]
    v_mfma_f32_16x16x32_bf16 v[240:243], a[120:123], v[96:99], v[240:243]
    v_mfma_f32_16x16x32_bf16 v[248:251], a[120:123], v[100:103], v[248:251]
    v_mfma_f32_16x16x32_bf16 v[252:255], a[124:127], v[100:103], v[252:255]
    v_mfma_f32_16x16x32_bf16 v[244:247], a[124:127], v[96:99], v[244:247]
    s_cbranch_vccnz L_rs1
L_rb1:
    s_waitcnt vmcnt(6) lgkmcnt(0)
    s_barrier
    v_mfma_f32_16x16x32_bf16 v[80:83], a[128:131], a[0:3], v[104:107]
    s_add_u32 m0, s32, 32768
    ds_read_b64_tr_b16 a[64:65], v32 offset:0
    s_nop 0
    v_mfma_f32_16x16x32_bf16 v[84:87], a[132:135], a[0:3], v[104:107]
    v_exp_f32 v64, v64
    v_mfma_f32_16x16x32_bf16 v[92:95], a[132:135], a[4:7], v[108:111]
    ds_read_b64_tr_b16 a[66:67], v32 offset:8192
    ds_read_b64_tr_b16 a[68:69], v33 offset:0
    v_mfma_f32_16x16x32_bf16 v[88:91], a[128:131], a[4:7], v[108:111]
    v_exp_f32 v65, v65
    v_mfma_f32_16x16x32_bf16 v[80:83], a[136:139], a[8:11], v[80:83]
    ds_read_b64_tr_b16 a[70:71], v33 offset:8192
    ds_read_b64_tr_b16 a[72:73], v34 offset:0
    v_mfma_f32_16x16x32_bf16 v[84:87], a[140:143], a[8:11], v[84:87]
    v_exp_f32 v66, v66
    v_mfma_f32_16x16x32_bf16 v[92:95], a[140:143], a[12:15], v[92:95]
    ds_read_b64_tr_b16 a[74:75], v34 offset:8192
    ds_read_b64_tr_b16 a[76:77], v35 offset:0
    v_mfma_f32_16x16x32_bf16 v[88:91], a[136:139], a[12:15], v[88:91]
    ds_read_b64_tr_b16 a[78:79], v35 offset:8192
    v_cvt_pk_bf16_f32 v96, v64, v65
    v_exp_f32 v67, v67
    v_mfma_f32_16x16x32_bf16 v[80:83], a[144:147], a[16:19], v[80:83]
    ds_read_b64_tr_b16 a[80:81], v36 offset:0
    buffer_load_dwordx4 v14, s[12:15], s35 offen offset:2048 nt lds
    v_mfma_f32_16x16x32_bf16 v[84:87], a[148:151], a[16:19], v[84:87]
    ds_read_b64_tr_b16 a[82:83], v36 offset:8192
    v_exp_f32 v68, v68
    v_mfma_f32_16x16x32_bf16 v[92:95], a[148:151], a[20:23], v[92:95]
    ds_read_b64_tr_b16 a[84:85], v37 offset:0
    v_cvt_pk_bf16_f32 v97, v66, v67
    v_mfma_f32_16x16x32_bf16 v[88:91], a[144:147], a[20:23], v[88:91]
    ds_read_b64_tr_b16 a[86:87], v37 offset:8192
    v_exp_f32 v69, v69
    v_mfma_f32_16x16x32_bf16 v[80:83], a[152:155], a[24:27], v[80:83]
    ds_read_b64_tr_b16 a[88:89], v38 offset:0
    v_exp_f32 v70, v70
    v_mfma_f32_16x16x32_bf16 v[84:87], a[156:159], a[24:27], v[84:87]
    ds_read_b64_tr_b16 a[90:91], v38 offset:8192
    v_cvt_pk_bf16_f32 v98, v68, v69
    v_mfma_f32_16x16x32_bf16 v[92:95], a[156:159], a[28:31], v[92:95]
    ds_read_b64_tr_b16 a[92:93], v39 offset:0
    buffer_load_dwordx4 v15, s[12:15], s35 offen offset:3072 nt lds
    v_mfma_f32_16x16x32_bf16 v[88:91], a[152:155], a[28:31], v[88:91]
    s_add_u32 m0, s32, 49152
    ds_read_b64_tr_b16 a[94:95], v39 offset:8192
    v_exp_f32 v71, v71
    v_mfma_f32_16x16x32_bf16 v[80:83], a[160:163], a[32:35], v[80:83]
    s_add_u32 s34, s34, 16384
    ds_read_b64_tr_b16 a[96:97], v32 offset:256
    ds_read_b64_tr_b16 a[98:99], v32 offset:8448
    v_mfma_f32_16x16x32_bf16 v[84:87], a[164:167], a[32:35], v[84:87]
    ds_read_b64_tr_b16 a[100:101], v33 offset:256
    v_exp_f32 v72, v72
    v_mfma_f32_16x16x32_bf16 v[92:95], a[164:167], a[36:39], v[92:95]
    s_and_b32 s34, s34, 0x7ffff
    ds_read_b64_tr_b16 a[102:103], v33 offset:8448
    v_cvt_pk_bf16_f32 v99, v70, v71
    v_mfma_f32_16x16x32_bf16 v[88:91], a[160:163], a[36:39], v[88:91]
    ds_read_b64_tr_b16 a[104:105], v34 offset:256
    v_exp_f32 v73, v73
    v_mfma_f32_16x16x32_bf16 v[80:83], a[168:171], a[40:43], v[80:83]
    ds_read_b64_tr_b16 a[106:107], v34 offset:8448
    v_exp_f32 v74, v74
    v_mfma_f32_16x16x32_bf16 v[84:87], a[172:175], a[40:43], v[84:87]
    ds_read_b64_tr_b16 a[108:109], v35 offset:256
    v_cvt_pk_bf16_f32 v100, v72, v73
    v_mfma_f32_16x16x32_bf16 v[92:95], a[172:175], a[44:47], v[92:95]
    ds_read_b64_tr_b16 a[110:111], v35 offset:8448
    v_exp_f32 v75, v75
    v_mfma_f32_16x16x32_bf16 v[88:91], a[168:171], a[44:47], v[88:91]
    ds_read_b64_tr_b16 a[112:113], v36 offset:256
    v_exp_f32 v76, v76
    v_mfma_f32_16x16x32_bf16 v[80:83], a[176:179], a[48:51], v[80:83]
    ds_read_b64_tr_b16 a[114:115], v36 offset:8448
    v_cvt_pk_bf16_f32 v101, v74, v75
    v_mfma_f32_16x16x32_bf16 v[84:87], a[180:183], a[48:51], v[84:87]
    ds_read_b64_tr_b16 a[116:117], v37 offset:256
    buffer_load_dwordx4 v8, s[8:11], s34 offen offset:0 nt lds
    v_mfma_f32_16x16x32_bf16 v[92:95], a[180:183], a[52:55], v[92:95]
    ds_read_b64_tr_b16 a[118:119], v37 offset:8448
    ds_read_b64_tr_b16 a[120:121], v38 offset:256
    v_mfma_f32_16x16x32_bf16 v[88:91], a[176:179], a[52:55], v[88:91]
    ds_read_b64_tr_b16 a[122:123], v38 offset:8448
    v_exp_f32 v77, v77
    v_mfma_f32_16x16x32_bf16 v[80:83], a[184:187], a[56:59], v[80:83]
    ds_read_b64_tr_b16 a[124:125], v39 offset:256
    v_exp_f32 v78, v78
    ds_read_b64_tr_b16 a[126:127], v39 offset:8448
    v_mfma_f32_16x16x32_bf16 v[84:87], a[188:191], a[56:59], v[84:87]
    v_cvt_pk_bf16_f32 v102, v76, v77
    v_exp_f32 v79, v79
    v_mfma_f32_16x16x32_bf16 v[92:95], a[188:191], a[60:63], v[92:95]
    v_cvt_pk_bf16_f32 v103, v78, v79
    v_mfma_f32_16x16x32_bf16 v[88:91], a[184:187], a[60:63], v[88:91]
    s_waitcnt vmcnt(5) lgkmcnt(0)
    s_barrier
    v_mfma_f32_16x16x32_bf16 v[128:131], a[64:67], v[96:99], v[128:131]
    s_add_u32 m0, s32, 49152
    ds_read_b128 a[128:131], v28 offset:16384
    v_add_f32 v46, v46, v64
    v_mfma_f32_16x16x32_bf16 v[136:139], a[64:67], v[100:103], v[136:139]
    s_nop 0
    ds_read_b128 a[132:135], v28 offset:24576
    v_add_f32 v47, v47, v72
    v_mfma_f32_16x16x32_bf16 v[140:143], a[68:71], v[100:103], v[140:143]
    ds_read_b128 a[136:139], v29 offset:16384
    v_add_f32 v46, v46, v65
    v_mfma_f32_16x16x32_bf16 v[132:135], a[68:71], v[96:99], v[132:135]
    ds_read_b128 a[140:143], v29 offset:24576
    v_add_f32 v47, v47, v73
    v_mfma_f32_16x16x32_bf16 v[144:147], a[72:75], v[96:99], v[144:147]
    buffer_load_dwordx4 v9, s[8:11], s34 offen offset:1024 nt lds
    v_mfma_f32_16x16x32_bf16 v[152:155], a[72:75], v[100:103], v[152:155]
    ds_read_b128 a[144:147], v30 offset:16384
    v_add_f32 v46, v46, v66
    v_mfma_f32_16x16x32_bf16 v[156:159], a[76:79], v[100:103], v[156:159]
    v_add_f32 v47, v47, v74
    v_add_f32 v46, v46, v67
    v_mfma_f32_16x16x32_bf16 v[148:151], a[76:79], v[96:99], v[148:151]
    ds_read_b128 a[148:151], v30 offset:24576
    v_add_f32 v47, v47, v75
    v_mfma_f32_16x16x32_bf16 v[160:163], a[80:83], v[96:99], v[160:163]
    v_add_f32 v46, v46, v68
    v_add_f32 v47, v47, v76
    v_mfma_f32_16x16x32_bf16 v[168:171], a[80:83], v[100:103], v[168:171]
    buffer_load_dwordx4 v10, s[8:11], s34 offen offset:2048 nt lds
    v_mfma_f32_16x16x32_bf16 v[172:175], a[84:87], v[100:103], v[172:175]
    ds_read_b128 a[152:155], v31 offset:16384
    v_add_f32 v46, v46, v69
    v_mfma_f32_16x16x32_bf16 v[164:167], a[84:87], v[96:99], v[164:167]
    ds_read_b128 a[156:159], v31 offset:24576
    v_add_f32 v47, v47, v77
    v_mfma_f32_16x16x32_bf16 v[176:179], a[88:91], v[96:99], v[176:179]
    ds_read_b128 a[160:163], v28 offset:16640
    v_add_f32 v46, v46, v70
    v_mfma_f32_16x16x32_bf16 v[184:187], a[88:91], v[100:103], v[184:187]
    v_add_f32 v47, v47, v78
    v_add_f32 v46, v46, v71
    v_mfma_f32_16x16x32_bf16 v[188:191], a[92:95], v[100:103], v[188:191]
    buffer_load_dwordx4 v11, s[8:11], s34 offen offset:3072 nt lds
    v_mfma_f32_16x16x32_bf16 v[180:183], a[92:95], v[96:99], v[180:183]
    s_add_u32 m0, s32, 0
    ds_read_b128 a[164:167], v28 offset:24832
    v_add_f32 v47, v47, v79
    v_mfma_f32_16x16x32_bf16 v[192:195], a[96:99], v[96:99], v[192:195]
    s_add_u32 s35, s35, 16384
    ds_read_b128 a[168:171], v29 offset:16640
    v_max3_f32 v48, v80, v81, v82
    v_mfma_f32_16x16x32_bf16 v[200:203], a[96:99], v[100:103], v[200:203]
    s_and_b32 s35, s35, 0x7ffff
    v_max3_f32 v48, v48, v83, v84
    v_max3_f32 v48, v48, v85, v86
    v_mfma_f32_16x16x32_bf16 v[204:207], a[100:103], v[100:103], v[204:207]
    ds_read_b128 a[172:175], v29 offset:24832
    v_mfma_f32_16x16x32_bf16 v[196:199], a[100:103], v[96:99], v[196:199]
    buffer_load_dwordx4 v12, s[12:15], s35 offen offset:0 nt lds
    v_mfma_f32_16x16x32_bf16 v[208:211], a[104:107], v[96:99], v[208:211]
    ds_read_b128 a[176:179], v30 offset:16640
    v_max3_f32 v48, v48, v87, v88
    v_mfma_f32_16x16x32_bf16 v[216:219], a[104:107], v[100:103], v[216:219]
    v_max3_f32 v48, v48, v89, v90
    v_mfma_f32_16x16x32_bf16 v[220:223], a[108:111], v[100:103], v[220:223]
    ds_read_b128 a[180:183], v30 offset:24832
    v_max3_f32 v48, v48, v91, v92
    v_mfma_f32_16x16x32_bf16 v[212:215], a[108:111], v[96:99], v[212:215]
    buffer_load_dwordx4 v13, s[12:15], s35 offen offset:1024 nt lds
    v_mfma_f32_16x16x32_bf16 v[224:227], a[112:115], v[96:99], v[224:227]
    ds_read_b128 a[184:187], v31 offset:16640
    v_max3_f32 v48, v48, v93, v94
    v_mfma_f32_16x16x32_bf16 v[232:235], a[112:115], v[100:103], v[232:235]
    ds_read_b128 a[188:191], v31 offset:24832
    v_max_f32 v48, v48, v95
    v_mfma_f32_16x16x32_bf16 v[236:239], a[116:119], v[100:103], v[236:239]
    v_cmp_lt_f32 vcc, s40, v48
    v_mfma_f32_16x16x32_bf16 v[228:231], a[116:119], v[96:99], v[228:231]
    v_mfma_f32_16x16x32_bf16 v[240:243], a[120:123], v[96:99], v[240:243]
    v_mfma_f32_16x16x32_bf16 v[248:251], a[120:123], v[100:103], v[248:251]
    v_mfma_f32_16x16x32_bf16 v[252:255], a[124:127], v[100:103], v[252:255]
    s_sub_u32 s39, s39, 1
    s_cmp_lg_u32 s39, 0
    v_mfma_f32_16x16x32_bf16 v[244:247], a[124:127], v[96:99], v[244:247]
    s_cbranch_vccnz L_rs2
L_rb2:
    s_cbranch_scc1 L_loopaA
    buffer_load_dword v6, off, s[68:71], 0 sc1
    s_mov_b32 s39, 8
L_loopbA:
    s_waitcnt vmcnt(6) lgkmcnt(0)
    s_barrier
    v_mfma_f32_16x16x32_bf16 v[64:67], a[128:131], a[0:3], v[104:107]
    s_add_u32 m0, s32, 0
    ds_read_b64_tr_b16 a[64:65], v32 offset:32768
    s_nop 0
    v_mfma_f32_16x16x32_bf16 v[68:71], a[132:135], a[0:3], v[104:107]
    v_exp_f32 v80, v80
    v_mfma_f32_16x16x32_bf16 v[76:79], a[132:135], a[4:7], v[108:111]
    ds_read_b64_tr_b16 a[66:67], v32 offset:40960
    ds_read_b64_tr_b16 a[68:69], v33 offset:32768
    v_mfma_f32_16x16x32_bf16 v[72:75], a[128:131], a[4:7], v[108:111]
    v_exp_f32 v81, v81
    v_mfma_f32_16x16x32_bf16 v[64:67], a[136:139], a[8:11], v[64:67]
    ds_read_b64_tr_b16 a[70:71], v33 offset:40960
    ds_read_b64_tr_b16 a[72:73], v34 offset:32768
    v_mfma_f32_16x16x32_bf16 v[68:71], a[140:143], a[8:11], v[68:71]
    v_exp_f32 v82, v82
    v_mfma_f32_16x16x32_bf16 v[76:79], a[140:143], a[12:15], v[76:79]
    ds_read_b64_tr_b16 a[74:75], v34 offset:40960
    ds_read_b64_tr_b16 a[76:77], v35 offset:32768
    v_mfma_f32_16x16x32_bf16 v[72:75], a[136:139], a[12:15], v[72:75]
    ds_read_b64_tr_b16 a[78:79], v35 offset:40960
    v_cvt_pk_bf16_f32 v96, v80, v81
    v_exp_f32 v83, v83
    v_mfma_f32_16x16x32_bf16 v[64:67], a[144:147], a[16:19], v[64:67]
    ds_read_b64_tr_b16 a[80:81], v36 offset:32768
    buffer_load_dwordx4 v14, s[12:15], s35 offen offset:2048 nt lds
    v_mfma_f32_16x16x32_bf16 v[68:71], a[148:151], a[16:19], v[68:71]
    ds_read_b64_tr_b16 a[82:83], v36 offset:40960
    v_exp_f32 v84, v84
    v_mfma_f32_16x16x32_bf16 v[76:79], a[148:151], a[20:23], v[76:79]
    ds_read_b64_tr_b16 a[84:85], v37 offset:32768
    v_cvt_pk_bf16_f32 v97, v82, v83
    v_mfma_f32_16x16x32_bf16 v[72:75], a[144:147], a[20:23], v[72:75]
    ds_read_b64_tr_b16 a[86:87], v37 offset:40960
    v_exp_f32 v85, v85
    v_mfma_f32_16x16x32_bf16 v[64:67], a[152:155], a[24:27], v[64:67]
    ds_read_b64_tr_b16 a[88:89], v38 offset:32768
    v_exp_f32 v86, v86
    v_mfma_f32_16x16x32_bf16 v[68:71], a[156:159], a[24:27], v[68:71]
    ds_read_b64_tr_b16 a[90:91], v38 offset:40960
    v_cvt_pk_bf16_f32 v98, v84, v85
    v_mfma_f32_16x16x32_bf16 v[76:79], a[156:159], a[28:31], v[76:79]
    ds_read_b64_tr_b16 a[92:93], v39 offset:32768
    buffer_load_dwordx4 v15, s[12:15], s35 offen offset:3072 nt lds
    v_mfma_f32_16x16x32_bf16 v[72:75], a[152:155], a[28:31], v[72:75]
    s_add_u32 m0, s32, 16384
    ds_read_b64_tr_b16 a[94:95], v39 offset:40960
    v_exp_f32 v87, v87
    v_mfma_f32_16x16x32_bf16 v[64:67], a[160:163], a[32:35], v[64:67]
    s_add_u32 s34, s34, 16384
    ds_read_b64_tr_b16 a[96:97], v32 offset:33024
    ds_read_b64_tr_b16 a[98:99], v32 offset:41216
    v_mfma_f32_16x16x32_bf16 v[68:71], a[164:167], a[32:35], v[68:71]
    ds_read_b64_tr_b16 a[100:101], v33 offset:33024
    v_exp_f32 v88, v88
    v_mfma_f32_16x16x32_bf16 v[76:79], a[164:167], a[36:39], v[76:79]
    s_and_b32 s34, s34, 0x7ffff
    ds_read_b64_tr_b16 a[102:103], v33 offset:41216
    v_cvt_pk_bf16_f32 v99, v86, v87
    v_mfma_f32_16x16x32_bf16 v[72:75], a[160:163], a[36:39], v[72:75]
    ds_read_b64_tr_b16 a[104:105], v34 offset:33024
    v_exp_f32 v89, v89
    v_mfma_f32_16x16x32_bf16 v[64:67], a[168:171], a[40:43], v[64:67]
    ds_read_b64_tr_b16 a[106:107], v34 offset:41216
    v_exp_f32 v90, v90
    v_mfma_f32_16x16x32_bf16 v[68:71], a[172:175], a[40:43], v[68:71]
    ds_read_b64_tr_b16 a[108:109], v35 offset:33024
    v_cvt_pk_bf16_f32 v100, v88, v89
    v_mfma_f32_16x16x32_bf16 v[76:79], a[172:175], a[44:47], v[76:79]
    ds_read_b64_tr_b16 a[110:111], v35 offset:41216
    v_exp_f32 v91, v91
    v_mfma_f32_16x16x32_bf16 v[72:75], a[168:171], a[44:47], v[72:75]
    ds_read_b64_tr_b16 a[112:113], v36 offset:33024
    v_exp_f32 v92, v92
    v_mfma_f32_16x16x32_bf16 v[64:67], a[176:179], a[48:51], v[64:67]
    ds_read_b64_tr_b16 a[114:115], v36 offset:41216
    v_cvt_pk_bf16_f32 v101, v90, v91
    v_mfma_f32_16x16x32_bf16 v[68:71], a[180:183], a[48:51], v[68:71]
    ds_read_b64_tr_b16 a[116:117], v37 offset:33024
    buffer_load_dwordx4 v8, s[8:11], s34 offen offset:0 nt lds
    v_mfma_f32_16x16x32_bf16 v[76:79], a[180:183], a[52:55], v[76:79]
    ds_read_b64_tr_b16 a[118:119], v37 offset:41216
    ds_read_b64_tr_b16 a[120:121], v38 offset:33024
    v_mfma_f32_16x16x32_bf16 v[72:75], a[176:179], a[52:55], v[72:75]
    ds_read_b64_tr_b16 a[122:123], v38 offset:41216
    v_exp_f32 v93, v93
    v_mfma_f32_16x16x32_bf16 v[64:67], a[184:187], a[56:59], v[64:67]
    ds_read_b64_tr_b16 a[124:125], v39 offset:33024
    v_exp_f32 v94, v94
    ds_read_b64_tr_b16 a[126:127], v39 offset:41216
    v_mfma_f32_16x16x32_bf16 v[68:71], a[188:191], a[56:59], v[68:71]
    v_cvt_pk_bf16_f32 v102, v92, v93
    v_exp_f32 v95, v95
    v_mfma_f32_16x16x32_bf16 v[76:79], a[188:191], a[60:63], v[76:79]
    v_cvt_pk_bf16_f32 v103, v94, v95
    v_mfma_f32_16x16x32_bf16 v[72:75], a[184:187], a[60:63], v[72:75]
    s_waitcnt vmcnt(5) lgkmcnt(0)
    s_barrier
    v_mfma_f32_16x16x32_bf16 v[128:131], a[64:67], v[96:99], v[128:131]
    s_add_u32 m0, s32, 16384
    ds_read_b128 a[128:131], v28 offset:49152
    v_add_f32 v46, v46, v80
    v_mfma_f32_16x16x32_bf16 v[136:139], a[64:67], v[100:103], v[136:139]
    s_nop 0
    ds_read_b128 a[132:135], v28 offset:57344
    v_add_f32 v47, v47, v88
    v_mfma_f32_16x16x32_bf16 v[140:143], a[68:71], v[100:103], v[140:143]
    buffer_load_dwordx4 v9, s[8:11], s34 offen offset:1024 nt lds
    v_mfma_f32_16x16x32_bf16 v[132:135], a[68:71], v[96:99], v[132:135]
    ds_read_b128 a[136:139], v29 offset:49152
    v_add_f32 v46, v46, v81
    v_mfma_f32_16x16x32_bf16 v[144:147], a[72:75], v[96:99], v[144:147]
    ds_read_b128 a[140:143], v29 offset:57344
    v_add_f32 v47, v47, v89
    v_mfma_f32_16x16x32_bf16 v[152:155], a[72:75], v[100:103], v[152:155]
    ds_read_b128 a[144:147], v30 offset:49152
    v_add_f32 v46, v46, v82
    v_mfma_f32_16x16x32_bf16 v[156:159], a[76:79], v[100:103], v[156:159]
    buffer_load_dwordx4 v10, s[8:11], s34 offen offset:2048 nt lds
    v_mfma_f32_16x16x32_bf16 v[148:151], a[76:79], v[96:99], v[148:151]
    ds_read_b128 a[148:151], v30 offset:57344
    v_add_f32 v47, v47, v90
    v_mfma_f32_16x16x32_bf16 v[160:163], a[80:83], v[96:99], v[160:163]
    v_add_f32 v46, v46, v83
    v_add_f32 v47, v47, v91
    v_mfma_f32_16x16x32_bf16 v[168:171], a[80:83], v[100:103], v[168:171]
    buffer_load_dwordx4 v11, s[8:11], s34 offen offset:3072 nt lds
    v_mfma_f32_16x16x32_bf16 v[172:175], a[84:87], v[100:103], v[172:175]
    s_add_u32 m0, s32, 32768
    ds_read_b128 a[152:155], v31 offset:49152
    v_add_f32 v46, v46, v84
    v_mfma_f32_16x16x32_bf16 v[164:167], a[84:87], v[96:99], v[164:167]
    s_add_u32 s35, s35, 16384
    ds_read_b128 a[156:159], v31 offset:57344
    v_add_f32 v47, v47, v92
    v_mfma_f32_16x16x32_bf16 v[176:179], a[88:91], v[96:99], v[176:179]
    s_and_b32 s35, s35, 0x7ffff
    ds_read_b128 a[160:163], v28 offset:49408
    v_add_f32 v46, v46, v85
    v_mfma_f32_16x16x32_bf16 v[184:187], a[88:91], v[100:103], v[184:187]
    v_add_f32 v47, v47, v93
    v_add_f32 v46, v46, v86
    v_mfma_f32_16x16x32_bf16 v[188:191], a[92:95], v[100:103], v[188:191]
    buffer_load_dwordx4 v12, s[12:15], s35 offen offset:0 nt lds
    v_mfma_f32_16x16x32_bf16 v[180:183], a[92:95], v[96:99], v[180:183]
    ds_read_b128 a[164:167], v28 offset:57600
    v_add_f32 v47, v47, v94
    v_add_f32 v46, v46, v87
    v_add_f32 v47, v47, v95
    v_mfma_f32_16x16x32_bf16 v[192:195], a[96:99], v[96:99], v[192:195]
    buffer_load_dwordx4 v13, s[12:15], s35 offen offset:1024 nt lds
    v_mfma_f32_16x16x32_bf16 v[200:203], a[96:99], v[100:103], v[200:203]
    s_mov_b32 m0, s83
    ds_read_b128 a[168:171], v29 offset:49408
    v_max3_f32 v48, v64, v65, v66
    v_mfma_f32_16x16x32_bf16 v[204:207], a[100:103], v[100:103], v[204:207]
    s_add_u32 s83, s83, 8192
    ds_read_b128 a[172:175], v29 offset:57600
    v_max3_f32 v48, v48, v67, v68
    v_mfma_f32_16x16x32_bf16 v[196:199], a[100:103], v[96:99], v[196:199]
    buffer_load_dwordx4 v16, s[24:27], s84 offen offset:0  lds
    v_mfma_f32_16x16x32_bf16 v[208:211], a[104:107], v[96:99], v[208:211]
    ds_read_b128 a[176:179], v30 offset:49408
    v_max3_f32 v48, v48, v69, v70
    v_mfma_f32_16x16x32_bf16 v[216:219], a[104:107], v[100:103], v[216:219]
    v_max3_f32 v48, v48, v71, v72
    v_max3_f32 v48, v48, v73, v74
    v_mfma_f32_16x16x32_bf16 v[220:223], a[108:111], v[100:103], v[220:223]
    buffer_load_dwordx4 v17, s[24:27], s84 offen offset:1024  lds
    v_mfma_f32_16x16x32_bf16 v[212:215], a[108:111], v[96:99], v[212:215]
    s_add_u32 s84, s84, 57344
    ds_read_b128 a[180:183], v30 offset:57600
    v_max3_f32 v48, v48, v75, v76
    v_mfma_f32_16x16x32_bf16 v[224:227], a[112:115], v[96:99], v[224:227]
    s_cmp_ge_u32 s84, 229376
    s_cselect_b32 s84, s85, s84
    s_cselect_b32 s85, s78, s85
    ds_read_b128 a[184:187], v31 offset:49408
    v_mfma_f32_16x16x32_bf16 v[232:235], a[112:115], v[100:103], v[232:235]
    ds_read_b128 a[188:191], v31 offset:57600
    v_max3_f32 v48, v48, v77, v78
    v_mfma_f32_16x16x32_bf16 v[236:239], a[116:119], v[100:103], v[236:239]
    v_max_f32 v48, v48, v79
    v_cmp_lt_f32 vcc, s40, v48
    v_mfma_f32_16x16x32_bf16 v[228:231], a[116:119], v[96:99], v[228:231]
    v_mfma_f32_16x16x32_bf16 v[240:243], a[120:123], v[96:99], v[240:243]
    v_mfma_f32_16x16x32_bf16 v[248:251], a[120:123], v[100:103], v[248:251]
    v_mfma_f32_16x16x32_bf16 v[252:255], a[124:127], v[100:103], v[252:255]
    v_mfma_f32_16x16x32_bf16 v[244:247], a[124:127], v[96:99], v[244:247]
    s_cbranch_vccnz L_rs3
L_rb3:
    s_waitcnt vmcnt(8) lgkmcnt(0)
    s_barrier
    v_mfma_f32_16x16x32_bf16 v[80:83], a[128:131], a[0:3], v[104:107]
    s_add_u32 m0, s32, 32768
    ds_read_b64_tr_b16 a[64:65], v32 offset:0
    s_nop 0
    v_mfma_f32_16x16x32_bf16 v[84:87], a[132:135], a[0:3], v[104:107]
    v_exp_f32 v64, v64
    v_mfma_f32_16x16x32_bf16 v[92:95], a[132:135], a[4:7], v[108:111]
    ds_read_b64_tr_b16 a[66:67], v32 offset:8192
    ds_read_b64_tr_b16 a[68:69], v33 offset:0
    v_mfma_f32_16x16x32_bf16 v[88:91], a[128:131], a[4:7], v[108:111]
    v_exp_f32 v65, v65
    v_mfma_f32_16x16x32_bf16 v[80:83], a[136:139], a[8:11], v[80:83]
    ds_read_b64_tr_b16 a[70:71], v33 offset:8192
    ds_read_b64_tr_b16 a[72:73], v34 offset:0
    v_mfma_f32_16x16x32_bf16 v[84:87], a[140:143], a[8:11], v[84:87]
    v_exp_f32 v66, v66
    v_mfma_f32_16x16x32_bf16 v[92:95], a[140:143], a[12:15], v[92:95]
    ds_read_b64_tr_b16 a[74:75], v34 offset:8192
    ds_read_b64_tr_b16 a[76:77], v35 offset:0
    v_mfma_f32_16x16x32_bf16 v[88:91], a[136:139], a[12:15], v[88:91]
    ds_read_b64_tr_b16 a[78:79], v35 offset:8192
    v_cvt_pk_bf16_f32 v96, v64, v65
    v_exp_f32 v67, v67
    v_mfma_f32_16x16x32_bf16 v[80:83], a[144:147], a[16:19], v[80:83]
    ds_read_b64_tr_b16 a[80:81], v36 offset:0
    buffer_load_dwordx4 v14, s[12:15], s35 offen offset:2048 nt lds
    v_mfma_f32_16x16x32_bf16 v[84:87], a[148:151], a[16:19], v[84:87]
    ds_read_b64_tr_b16 a[82:83], v36 offset:8192
    v_exp_f32 v68, v68
    v_mfma_f32_16x16x32_bf16 v[92:95], a[148:151], a[20:23], v[92:95]
    ds_read_b64_tr_b16 a[84:85], v37 offset:0
    v_cvt_pk_bf16_f32 v97, v66, v67
    v_mfma_f32_16x16x32_bf16 v[88:91], a[144:147], a[20:23], v[88:91]
    ds_read_b64_tr_b16 a[86:87], v37 offset:8192
    v_exp_f32 v69, v69
    v_mfma_f32_16x16x32_bf16 v[80:83], a[152:155], a[24:27], v[80:83]
    ds_read_b64_tr_b16 a[88:89], v38 offset:0
    v_exp_f32 v70, v70
    v_mfma_f32_16x16x32_bf16 v[84:87], a[156:159], a[24:27], v[84:87]
    ds_read_b64_tr_b16 a[90:91], v38 offset:8192
    v_cvt_pk_bf16_f32 v98, v68, v69
    v_mfma_f32_16x16x32_bf16 v[92:95], a[156:159], a[28:31], v[92:95]
    ds_read_b64_tr_b16 a[92:93], v39 offset:0
    buffer_load_dwordx4 v15, s[12:15], s35 offen offset:3072 nt lds
    v_mfma_f32_16x16x32_bf16 v[88:91], a[152:155], a[28:31], v[88:91]
    s_add_u32 m0, s32, 49152
    ds_read_b64_tr_b16 a[94:95], v39 offset:8192
    v_exp_f32 v71, v71
    v_mfma_f32_16x16x32_bf16 v[80:83], a[160:163], a[32:35], v[80:83]
    s_add_u32 s34, s34, 16384
    ds_read_b64_tr_b16 a[96:97], v32 offset:256
    ds_read_b64_tr_b16 a[98:99], v32 offset:8448
    v_mfma_f32_16x16x32_bf16 v[84:87], a[164:167], a[32:35], v[84:87]
    ds_read_b64_tr_b16 a[100:101], v33 offset:256
    v_exp_f32 v72, v72
    v_mfma_f32_16x16x32_bf16 v[92:95], a[164:167], a[36:39], v[92:95]
    s_and_b32 s34, s34, 0x7ffff
    ds_read_b64_tr_b16 a[102:103], v33 offset:8448
    v_cvt_pk_bf16_f32 v99, v70, v71
    v_mfma_f32_16x16x32_bf16 v[88:91], a[160:163], a[36:39], v[88:91]
    ds_read_b64_tr_b16 a[104:105], v34 offset:256
    v_exp_f32 v73, v73
    v_mfma_f32_16x16x32_bf16 v[80:83], a[168:171], a[40:43], v[80:83]
    ds_read_b64_tr_b16 a[106:107], v34 offset:8448
    v_exp_f32 v74, v74
    v_mfma_f32_16x16x32_bf16 v[84:87], a[172:175], a[40:43], v[84:87]
    ds_read_b64_tr_b16 a[108:109], v35 offset:256
    v_cvt_pk_bf16_f32 v100, v72, v73
    v_mfma_f32_16x16x32_bf16 v[92:95], a[172:175], a[44:47], v[92:95]
    ds_read_b64_tr_b16 a[110:111], v35 offset:8448
    v_exp_f32 v75, v75
    v_mfma_f32_16x16x32_bf16 v[88:91], a[168:171], a[44:47], v[88:91]
    ds_read_b64_tr_b16 a[112:113], v36 offset:256
    v_exp_f32 v76, v76
    v_mfma_f32_16x16x32_bf16 v[80:83], a[176:179], a[48:51], v[80:83]
    ds_read_b64_tr_b16 a[114:115], v36 offset:8448
    v_cvt_pk_bf16_f32 v101, v74, v75
    v_mfma_f32_16x16x32_bf16 v[84:87], a[180:183], a[48:51], v[84:87]
    ds_read_b64_tr_b16 a[116:117], v37 offset:256
    buffer_load_dwordx4 v8, s[8:11], s34 offen offset:0 nt lds
    v_mfma_f32_16x16x32_bf16 v[92:95], a[180:183], a[52:55], v[92:95]
    ds_read_b64_tr_b16 a[118:119], v37 offset:8448
    ds_read_b64_tr_b16 a[120:121], v38 offset:256
    v_mfma_f32_16x16x32_bf16 v[88:91], a[176:179], a[52:55], v[88:91]
    ds_read_b64_tr_b16 a[122:123], v38 offset:8448
    v_exp_f32 v77, v77
    v_mfma_f32_16x16x32_bf16 v[80:83], a[184:187], a[56:59], v[80:83]
    ds_read_b64_tr_b16 a[124:125], v39 offset:256
    v_exp_f32 v78, v78
    ds_read_b64_tr_b16 a[126:127], v39 offset:8448
    v_mfma_f32_16x16x32_bf16 v[84:87], a[188:191], a[56:59], v[84:87]
    v_cvt_pk_bf16_f32 v102, v76, v77
    v_exp_f32 v79, v79
    v_mfma_f32_16x16x32_bf16 v[92:95], a[188:191], a[60:63], v[92:95]
    v_cvt_pk_bf16_f32 v103, v78, v79
    v_mfma_f32_16x16x32_bf16 v[88:91], a[184:187], a[60:63], v[88:91]
    s_waitcnt vmcnt(7) lgkmcnt(0)
    s_barrier
    v_mfma_f32_16x16x32_bf16 v[128:131], a[64:67], v[96:99], v[128:131]
    s_add_u32 m0, s32, 49152
    ds_read_b128 a[128:131], v28 offset:16384
    v_add_f32 v46, v46, v64
    v_mfma_f32_16x16x32_bf16 v[136:139], a[64:67], v[100:103], v[136:139]
    s_nop 0
    ds_read_b128 a[132:135], v28 offset:24576
    v_add_f32 v47, v47, v72
    v_mfma_f32_16x16x32_bf16 v[140:143], a[68:71], v[100:103], v[140:143]
    ds_read_b128 a[136:139], v29 offset:16384
    v_add_f32 v46, v46, v65
    v_mfma_f32_16x16x32_bf16 v[132:135], a[68:71], v[96:99], v[132:135]
    ds_read_b128 a[140:143], v29 offset:24576
    v_add_f32 v47, v47, v73
    v_mfma_f32_16x16x32_bf16 v[144:147], a[72:75], v[96:99], v[144:147]
    buffer_load_dwordx4 v9, s[8:11], s34 offen offset:1024 nt lds
    v_mfma_f32_16x16x32_bf16 v[152:155], a[72:75], v[100:103], v[152:155]
    ds_read_b128 a[144:147], v30 offset:16384
    v_add_f32 v46, v46, v66
    v_mfma_f32_16x16x32_bf16 v[156:159], a[76:79], v[100:103], v[156:159]
    v_add_f32 v47, v47, v74
    v_add_f32 v46, v46, v67
    v_mfma_f32_16x16x32_bf16 v[148:151], a[76:79], v[96:99], v[148:151]
    ds_read_b128 a[148:151], v30 offset:24576
    v_add_f32 v47, v47, v75
    v_mfma_f32_16x16x32_bf16 v[160:163], a[80:83], v[96:99], v[160:163]
    v_add_f32 v46, v46, v68
    v_add_f32 v47, v47, v76
    v_mfma_f32_16x16x32_bf16 v[168:171], a[80:83], v[100:103], v[168:171]
    buffer_load_dwordx4 v10, s[8:11], s34 offen offset:2048 nt lds
    v_mfma_f32_16x16x32_bf16 v[172:175], a[84:87], v[100:103], v[172:175]
    ds_read_b128 a[152:155], v31 offset:16384
    v_add_f32 v46, v46, v69
    v_mfma_f32_16x16x32_bf16 v[164:167], a[84:87], v[96:99], v[164:167]
    ds_read_b128 a[156:159], v31 offset:24576
    v_add_f32 v47, v47, v77
    v_mfma_f32_16x16x32_bf16 v[176:179], a[88:91], v[96:99], v[176:179]
    ds_read_b128 a[160:163], v28 offset:16640
    v_add_f32 v46, v46, v70
    v_mfma_f32_16x16x32_bf16 v[184:187], a[88:91], v[100:103], v[184:187]
    v_add_f32 v47, v47, v78
    v_add_f32 v46, v46, v71
    v_mfma_f32_16x16x32_bf16 v[188:191], a[92:95], v[100:103], v[188:191]
    buffer_load_dwordx4 v11, s[8:11], s34 offen offset:3072 nt lds
    v_mfma_f32_16x16x32_bf16 v[180:183], a[92:95], v[96:99], v[180:183]
    s_add_u32 m0, s32, 0
    ds_read_b128 a[164:167], v28 offset:24832
    v_add_f32 v47, v47, v79
    v_mfma_f32_16x16x32_bf16 v[192:195], a[96:99], v[96:99], v[192:195]
    s_add_u32 s35, s35, 16384
    ds_read_b128 a[168:171], v29 offset:16640
    v_max3_f32 v48, v80, v81, v82
    v_mfma_f32_16x16x32_bf16 v[200:203], a[96:99], v[100:103], v[200:203]
    s_and_b32 s35, s35, 0x7ffff
    v_max3_f32 v48, v48, v83, v84
    v_max3_f32 v48, v48, v85, v86
    v_mfma_f32_16x16x32_bf16 v[204:207], a[100:103], v[100:103], v[204:207]
    ds_read_b128 a[172:175], v29 offset:24832
    v_mfma_f32_16x16x32_bf16 v[196:199], a[100:103], v[96:99], v[196:199]
    buffer_load_dwordx4 v12, s[12:15], s35 offen offset:0 nt lds
    v_mfma_f32_16x16x32_bf16 v[208:211], a[104:107], v[96:99], v[208:211]
    ds_read_b128 a[176:179], v30 offset:16640
    v_max3_f32 v48, v48, v87, v88
    v_mfma_f32_16x16x32_bf16 v[216:219], a[104:107], v[100:103], v[216:219]
    v_max3_f32 v48, v48, v89, v90
    v_mfma_f32_16x16x32_bf16 v[220:223], a[108:111], v[100:103], v[220:223]
    ds_read_b128 a[180:183], v30 offset:24832
    v_max3_f32 v48, v48, v91, v92
    v_mfma_f32_16x16x32_bf16 v[212:215], a[108:111], v[96:99], v[212:215]
    buffer_load_dwordx4 v13, s[12:15], s35 offen offset:1024 nt lds
    v_mfma_f32_16x16x32_bf16 v[224:227], a[112:115], v[96:99], v[224:227]
    ds_read_b128 a[184:187], v31 offset:16640
    v_max3_f32 v48, v48, v93, v94
    v_mfma_f32_16x16x32_bf16 v[232:235], a[112:115], v[100:103], v[232:235]
    ds_read_b128 a[188:191], v31 offset:24832
    v_max_f32 v48, v48, v95
    v_mfma_f32_16x16x32_bf16 v[236:239], a[116:119], v[100:103], v[236:239]
    v_cmp_lt_f32 vcc, s40, v48
    v_mfma_f32_16x16x32_bf16 v[228:231], a[116:119], v[96:99], v[228:231]
    v_mfma_f32_16x16x32_bf16 v[240:243], a[120:123], v[96:99], v[240:243]
    v_mfma_f32_16x16x32_bf16 v[248:251], a[120:123], v[100:103], v[248:251]
    v_mfma_f32_16x16x32_bf16 v[252:255], a[124:127], v[100:103], v[252:255]
    s_sub_u32 s39, s39, 1
    s_cmp_lg_u32 s39, 0
    v_mfma_f32_16x16x32_bf16 v[244:247], a[124:127], v[96:99], v[244:247]
    s_cbranch_vccnz L_rs4
L_rb4:
    s_cbranch_scc1 L_loopbA
    v_and_b32 v49, 0xff, v6
    v_cmp_gt_u32 vcc, 16, v49
    s_cbranch_vccnz L_hsA
L_hsbA:
    v_and_b32 v49, 8, v0
    v_lshrrev_b32 v49, 1, v49
    v_lshrrev_b32 v50, v49, v6
    v_bfe_u32 v49, v50, 8, 4
    v_bfe_u32 v50, v50, 16, 4
    v_sub_u32 v49, v49, v50
    v_and_b32 v49, 0x2000, v49
    v_xor_b32 v53, v49, v53
    v_mov_b32 v49, s4
    v_and_b32 v49, 4, v49
    v_lshrrev_b32 v50, v49, v6
    v_bfe_u32 v49, v50, 8, 4
    v_bfe_u32 v50, v50, 16, 4
    v_sub_u32 v49, v49, v50
    v_and_b32 v49, 0x2000, v49
    v_xor_b32 v3, v49, v3
    v_xor_b32 v19, 0x2000, v53
    s_waitcnt vmcnt(6) lgkmcnt(0)
    s_barrier
    v_mfma_f32_16x16x32_bf16 v[64:67], a[128:131], a[0:3], v[104:107]
    s_add_u32 m0, s32, 0
    ds_read_b64_tr_b16 a[64:65], v32 offset:32768
    s_nop 0
    v_mfma_f32_16x16x32_bf16 v[68:71], a[132:135], a[0:3], v[104:107]
    v_exp_f32 v80, v80
    v_mfma_f32_16x16x32_bf16 v[76:79], a[132:135], a[4:7], v[108:111]
    ds_read_b64_tr_b16 a[66:67], v32 offset:40960
    ds_read_b64_tr_b16 a[68:69], v33 offset:32768
    v_mfma_f32_16x16x32_bf16 v[72:75], a[128:131], a[4:7], v[108:111]
    v_exp_f32 v81, v81
    v_mfma_f32_16x16x32_bf16 v[64:67], a[136:139], a[8:11], v[64:67]
    ds_read_b64_tr_b16 a[70:71], v33 offset:40960
    ds_read_b64_tr_b16 a[72:73], v34 offset:32768
    v_mfma_f32_16x16x32_bf16 v[68:71], a[140:143], a[8:11], v[68:71]
    buffer_load_dwordx4 v14, s[12:15], s35 offen offset:2048 nt lds
    v_exp_f32 v82, v82
    v_mfma_f32_16x16x32_bf16 v[76:79], a[140:143], a[12:15], v[76:79]
    ds_read_b64_tr_b16 a[74:75], v34 offset:40960
    ds_read_b64_tr_b16 a[76:77], v35 offset:32768
    v_mfma_f32_16x16x32_bf16 v[72:75], a[136:139], a[12:15], v[72:75]
    ds_read_b64_tr_b16 a[78:79], v35 offset:40960
    v_cvt_pk_bf16_f32 v96, v80, v81
    v_exp_f32 v83, v83
    v_mfma_f32_16x16x32_bf16 v[64:67], a[144:147], a[16:19], v[64:67]
    ds_read_b64_tr_b16 a[80:81], v36 offset:32768
    v_exp_f32 v84, v84
    v_mfma_f32_16x16x32_bf16 v[68:71], a[148:151], a[16:19], v[68:71]
    ds_read_b64_tr_b16 a[82:83], v36 offset:40960
    buffer_load_dwordx4 v15, s[12:15], s35 offen offset:3072 nt lds
    v_mfma_f32_16x16x32_bf16 v[76:79], a[148:151], a[20:23], v[76:79]
    s_add_u32 m0, s32, 16384
    ds_read_b64_tr_b16 a[84:85], v37 offset:32768
    v_cvt_pk_bf16_f32 v97, v82, v83
    v_mfma_f32_16x16x32_bf16 v[72:75], a[144:147], a[20:23], v[72:75]
    s_add_u32 s35, s35, 16384
    ds_read_b64_tr_b16 a[86:87], v37 offset:40960
    v_exp_f32 v85, v85
    v_mfma_f32_16x16x32_bf16 v[64:67], a[152:155], a[24:27], v[64:67]
    s_and_b32 s35, s35, 0x7ffff
    ds_read_b64_tr_b16 a[88:89], v38 offset:32768
    v_exp_f32 v86, v86
    v_mfma_f32_16x16x32_bf16 v[68:71], a[156:159], a[24:27], v[68:71]
    ds_read_b64_tr_b16 a[90:91], v38 offset:40960
    v_cvt_pk_bf16_f32 v98, v84, v85
    v_mfma_f32_16x16x32_bf16 v[76:79], a[156:159], a[28:31], v[76:79]
    ds_read_b64_tr_b16 a[92:93], v39 offset:32768
    v_exp_f32 v87, v87
    v_mfma_f32_16x16x32_bf16 v[72:75], a[152:155], a[28:31], v[72:75]
    ds_read_b64_tr_b16 a[94:95], v39 offset:40960
    buffer_load_dwordx4 v12, s[12:15], s35 offen offset:0 nt lds
    v_mfma_f32_16x16x32_bf16 v[64:67], a[160:163], a[32:35], v[64:67]
    ds_read_b64_tr_b16 a[96:97], v32 offset:33024
    ds_read_b64_tr_b16 a[98:99], v32 offset:41216
    v_mfma_f32_16x16x32_bf16 v[68:71], a[164:167], a[32:35], v[68:71]
    ds_read_b64_tr_b16 a[100:101], v33 offset:33024
    v_exp_f32 v88, v88
    v_mfma_f32_16x16x32_bf16 v[76:79], a[164:167], a[36:39], v[76:79]
    ds_read_b64_tr_b16 a[102:103], v33 offset:41216
    v_cvt_pk_bf16_f32 v99, v86, v87
    v_mfma_f32_16x16x32_bf16 v[72:75], a[160:163], a[36:39], v[72:75]
    ds_read_b64_tr_b16 a[104:105], v34 offset:33024
    v_exp_f32 v89, v89
    v_mfma_f32_16x16x32_bf16 v[64:67], a[168:171], a[40:43], v[64:67]
    ds_read_b64_tr_b16 a[106:107], v34 offset:41216
    buffer_load_dwordx4 v13, s[12:15], s35 offen offset:1024 nt lds
    v_exp_f32 v90, v90
    v_mfma_f32_16x16x32_bf16 v[68:71], a[172:175], a[40:43], v[68:71]
    ds_read_b64_tr_b16 a[108:109], v35 offset:33024
    v_cvt_pk_bf16_f32 v100, v88, v89
    v_mfma_f32_16x16x32_bf16 v[76:79], a[172:175], a[44:47], v[76:79]
    ds_read_b64_tr_b16 a[110:111], v35 offset:41216
    v_exp_f32 v91, v91
    v_mfma_f32_16x16x32_bf16 v[72:75], a[168:171], a[44:47], v[72:75]
    ds_read_b64_tr_b16 a[112:113], v36 offset:33024
    buffer_load_dwordx4 v14, s[12:15], s35 offen offset:2048 nt lds
    v_mfma_f32_16x16x32_bf16 v[64:67], a[176:179], a[48:51], v[64:67]
    ds_read_b64_tr_b16 a[114:115], v36 offset:41216
    v_exp_f32 v92, v92
    v_mfma_f32_16x16x32_bf16 v[68:71], a[180:183], a[48:51], v[68:71]
    ds_read_b64_tr_b16 a[116:117], v37 offset:33024
    ds_read_b64_tr_b16 a[118:119], v37 offset:41216
    v_mfma_f32_16x16x32_bf16 v[76:79], a[180:183], a[52:55], v[76:79]
    ds_read_b64_tr_b16 a[120:121], v38 offset:33024
    v_cvt_pk_bf16_f32 v101, v90, v91
    v_mfma_f32_16x16x32_bf16 v[72:75], a[176:179], a[52:55], v[72:75]
    ds_read_b64_tr_b16 a[122:123], v38 offset:41216
    v_exp_f32 v93, v93
    v_mfma_f32_16x16x32_bf16 v[64:67], a[184:187], a[56:59], v[64:67]
    ds_read_b64_tr_b16 a[124:125], v39 offset:33024
    buffer_load_dwordx4 v15, s[12:15], s35 offen offset:3072 nt lds
    ds_read_b64_tr_b16 a[126:127], v39 offset:41216
    v_exp_f32 v94, v94
    v_mfma_f32_16x16x32_bf16 v[68:71], a[188:191], a[56:59], v[68:71]
    v_cvt_pk_bf16_f32 v102, v92, v93
    v_exp_f32 v95, v95
    v_mfma_f32_16x16x32_bf16 v[76:79], a[188:191], a[60:63], v[76:79]
    v_cvt_pk_bf16_f32 v103, v94, v95
    v_mfma_f32_16x16x32_bf16 v[72:75], a[184:187], a[60:63], v[72:75]
    s_waitcnt vmcnt(8) lgkmcnt(0)
    s_barrier
    v_mfma_f32_16x16x32_bf16 v[128:131], a[64:67], v[96:99], v[128:131]
    s_add_u32 m0, s32, 32768
    ds_read_b128 a[128:131], v28 offset:49152
    v_add_f32 v46, v46, v80
    v_mfma_f32_16x16x32_bf16 v[136:139], a[64:67], v[100:103], v[136:139]
    s_add_u32 s38, s79, 0
    ds_read_b128 a[132:135], v28 offset:57344
    v_add_f32 v47, v47, v88
    v_mfma_f32_16x16x32_bf16 v[140:143], a[68:71], v[100:103], v[140:143]
    ds_read_b128 a[136:139], v29 offset:49152
    v_add_f32 v46, v46, v81
    v_mfma_f32_16x16x32_bf16 v[132:135], a[68:71], v[96:99], v[132:135]
    buffer_load_dwordx4 v24, s[24:27], s38 offen offset:0  lds
    v_mfma_f32_16x16x32_bf16 v[144:147], a[72:75], v[96:99], v[144:147]
    ds_read_b128 a[140:143], v29 offset:57344
    v_add_f32 v47, v47, v89
    v_mfma_f32_16x16x32_bf16 v[152:155], a[72:75], v[100:103], v[152:155]
    ds_read_b128 a[144:147], v30 offset:49152
    v_add_f32 v46, v46, v82
    v_mfma_f32_16x16x32_bf16 v[156:159], a[76:79], v[100:103], v[156:159]
    v_add_f32 v47, v47, v90
    v_add_f32 v46, v46, v83
    v_mfma_f32_16x16x32_bf16 v[148:151], a[76:79], v[96:99], v[148:151]
    ds_read_b128 a[148:151], v30 offset:57344
    v_add_f32 v47, v47, v91
    v_mfma_f32_16x16x32_bf16 v[160:163], a[80:83], v[96:99], v[160:163]
    v_add_f32 v46, v46, v84
    v_add_f32 v47, v47, v92
    v_mfma_f32_16x16x32_bf16 v[168:171], a[80:83], v[100:103], v[168:171]
    buffer_load_dwordx4 v25, s[24:27], s38 offen offset:1024  lds
    v_mfma_f32_16x16x32_bf16 v[172:175], a[84:87], v[100:103], v[172:175]
    ds_read_b128 a[152:155], v31 offset:49152
    v_add_f32 v46, v46, v85
    v_mfma_f32_16x16x32_bf16 v[164:167], a[84:87], v[96:99], v[164:167]
    ds_read_b128 a[156:159], v31 offset:57344
    v_add_f32 v47, v47, v93
    v_mfma_f32_16x16x32_bf16 v[176:179], a[88:91], v[96:99], v[176:179]
    ds_read_b128 a[160:163], v28 offset:49408
    v_add_f32 v46, v46, v86
    v_mfma_f32_16x16x32_bf16 v[184:187], a[88:91], v[100:103], v[184:187]
    v_add_f32 v47, v47, v94
    v_add_f32 v46, v46, v87
    v_mfma_f32_16x16x32_bf16 v[188:191], a[92:95], v[100:103], v[188:191]
    ds_read_b128 a[164:167], v28 offset:57600
    v_add_f32 v47, v47, v95
    v_mfma_f32_16x16x32_bf16 v[180:183], a[92:95], v[96:99], v[180:183]
    buffer_load_dwordx4 v26, s[24:27], s38 offen offset:2048  lds
    v_mfma_f32_16x16x32_bf16 v[192:195], a[96:99], v[96:99], v[192:195]
    ds_read_b128 a[168:171], v29 offset:49408
    v_max3_f32 v48, v64, v65, v66
    v_mfma_f32_16x16x32_bf16 v[200:203], a[96:99], v[100:103], v[200:203]
    v_max3_f32 v48, v48, v67, v68
    v_max3_f32 v48, v48, v69, v70
    v_mfma_f32_16x16x32_bf16 v[204:207], a[100:103], v[100:103], v[204:207]
    ds_read_b128 a[172:175], v29 offset:57600
    v_mfma_f32_16x16x32_bf16 v[196:199], a[100:103], v[96:99], v[196:199]
    v_max3_f32 v48, v48, v71, v72
    v_mfma_f32_16x16x32_bf16 v[208:211], a[104:107], v[96:99], v[208:211]
    ds_read_b128 a[176:179], v30 offset:49408
    v_max3_f32 v48, v48, v73, v74
    v_mfma_f32_16x16x32_bf16 v[216:219], a[104:107], v[100:103], v[216:219]
    buffer_load_dwordx4 v27, s[24:27], s38 offen offset:3072  lds
    v_mfma_f32_16x16x32_bf16 v[220:223], a[108:111], v[100:103], v[220:223]
    ds_read_b128 a[180:183], v30 offset:57600
    v_max3_f32 v48, v48, v75, v76
    v_mfma_f32_16x16x32_bf16 v[212:215], a[108:111], v[96:99], v[212:215]
    ds_read_b128 a[184:187], v31 offset:49408
    v_max3_f32 v48, v48, v77, v78
    v_mfma_f32_16x16x32_bf16 v[224:227], a[112:115], v[96:99], v[224:227]
    v_mfma_f32_16x16x32_bf16 v[232:235], a[112:115], v[100:103], v[232:235]
    ds_read_b128 a[188:191], v31 offset:57600
    v_max_f32 v48, v48, v79
    v_mfma_f32_16x16x32_bf16 v[236:239], a[116:119], v[100:103], v[236:239]
    v_cmp_lt_f32 vcc, s40, v48
    v_mfma_f32_16x16x32_bf16 v[228:231], a[116:119], v[96:99], v[228:231]
    v_mfma_f32_16x16x32_bf16 v[240:243], a[120:123], v[96:99], v[240:243]
    v_mfma_f32_16x16x32_bf16 v[248:251], a[120:123], v[100:103], v[248:251]
    v_mfma_f32_16x16x32_bf16 v[252:255], a[124:127], v[100:103], v[252:255]
    v_mfma_f32_16x16x32_bf16 v[244:247], a[124:127], v[96:99], v[244:247]
    s_cbranch_vccnz L_rs5
L_rb5:
    s_waitcnt vmcnt(8) lgkmcnt(0)
    s_barrier
    v_mfma_f32_16x16x32_bf16 v[80:83], a[128:131], a[0:3], v[104:107]
    s_add_u32 m0, s32, 49152
    ds_read_b64_tr_b16 a[64:65], v32 offset:0
    s_add_u32 s38, s79, 114688
    v_mfma_f32_16x16x32_bf16 v[84:87], a[132:135], a[0:3], v[104:107]
    v_exp_f32 v64, v64
    v_mfma_f32_16x16x32_bf16 v[92:95], a[132:135], a[4:7], v[108:111]
    ds_read_b64_tr_b16 a[66:67], v32 offset:8192
    ds_read_b64_tr_b16 a[68:69], v33 offset:0
    v_mfma_f32_16x16x32_bf16 v[88:91], a[128:131], a[4:7], v[108:111]
    v_exp_f32 v65, v65
    v_mfma_f32_16x16x32_bf16 v[80:83], a[136:139], a[8:11], v[80:83]
    ds_read_b64_tr_b16 a[70:71], v33 offset:8192
    buffer_load_dwordx4 v24, s[24:27], s38 offen offset:0  lds
    v_mfma_f32_16x16x32_bf16 v[84:87], a[140:143], a[8:11], v[84:87]
    ds_read_b64_tr_b16 a[72:73], v34 offset:0
    v_exp_f32 v66, v66
    v_mfma_f32_16x16x32_bf16 v[92:95], a[140:143], a[12:15], v[92:95]
    ds_read_b64_tr_b16 a[74:75], v34 offset:8192
    ds_read_b64_tr_b16 a[76:77], v35 offset:0
    v_mfma_f32_16x16x32_bf16 v[88:91], a[136:139], a[12:15], v[88:91]
    ds_read_b64_tr_b16 a[78:79], v35 offset:8192
    v_cvt_pk_bf16_f32 v96, v64, v65
    v_exp_f32 v67, v67
    v_mfma_f32_16x16x32_bf16 v[80:83], a[144:147], a[16:19], v[80:83]
    ds_read_b64_tr_b16 a[80:81], v36 offset:0
    v_exp_f32 v68, v68
    v_mfma_f32_16x16x32_bf16 v[84:87], a[148:151], a[16:19], v[84:87]
    ds_read_b64_tr_b16 a[82:83], v36 offset:8192
    v_cvt_pk_bf16_f32 v97, v66, v67
    v_mfma_f32_16x16x32_bf16 v[92:95], a[148:151], a[20:23], v[92:95]
    ds_read_b64_tr_b16 a[84:85], v37 offset:0
    v_exp_f32 v69, v69
    v_mfma_f32_16x16x32_bf16 v[88:91], a[144:147], a[20:23], v[88:91]
    ds_read_b64_tr_b16 a[86:87], v37 offset:8192
    buffer_load_dwordx4 v25, s[24:27], s38 offen offset:1024  lds
    v_mfma_f32_16x16x32_bf16 v[80:83], a[152:155], a[24:27], v[80:83]
    ds_read_b64_tr_b16 a[88:89], v38 offset:0
    v_exp_f32 v70, v70
    v_mfma_f32_16x16x32_bf16 v[84:87], a[156:159], a[24:27], v[84:87]
    ds_read_b64_tr_b16 a[90:91], v38 offset:8192
    v_cvt_pk_bf16_f32 v98, v68, v69
    v_mfma_f32_16x16x32_bf16 v[92:95], a[156:159], a[28:31], v[92:95]
    ds_read_b64_tr_b16 a[92:93], v39 offset:0
    v_exp_f32 v71, v71
    v_mfma_f32_16x16x32_bf16 v[88:91], a[152:155], a[28:31], v[88:91]
    ds_read_b64_tr_b16 a[94:95], v39 offset:8192
    ds_read_b64_tr_b16 a[96:97], v32 offset:256
    v_mfma_f32_16x16x32_bf16 v[80:83], a[160:163], a[32:35], v[80:83]
    ds_read_b64_tr_b16 a[98:99], v32 offset:8448
    v_exp_f32 v72, v72
    v_mfma_f32_16x16x32_bf16 v[84:87], a[164:167], a[32:35], v[84:87]
    ds_read_b64_tr_b16 a[100:101], v33 offset:256
    buffer_load_dwordx4 v26, s[24:27], s38 offen offset:2048  lds
    v_mfma_f32_16x16x32_bf16 v[92:95], a[164:167], a[36:39], v[92:95]
    ds_read_b64_tr_b16 a[102:103], v33 offset:8448
    v_cvt_pk_bf16_f32 v99, v70, v71
    v_mfma_f32_16x16x32_bf16 v[88:91], a[160:163], a[36:39], v[88:91]
    ds_read_b64_tr_b16 a[104:105], v34 offset:256
    v_exp_f32 v73, v73
    v_mfma_f32_16x16x32_bf16 v[80:83], a[168:171], a[40:43], v[80:83]
    ds_read_b64_tr_b16 a[106:107], v34 offset:8448
    v_exp_f32 v74, v74
    v_mfma_f32_16x16x32_bf16 v[84:87], a[172:175], a[40:43], v[84:87]
    ds_read_b64_tr_b16 a[108:109], v35 offset:256
    v_cvt_pk_bf16_f32 v100, v72, v73
    v_mfma_f32_16x16x32_bf16 v[92:95], a[172:175], a[44:47], v[92:95]
    ds_read_b64_tr_b16 a[110:111], v35 offset:8448
    v_exp_f32 v75, v75
    v_mfma_f32_16x16x32_bf16 v[88:91], a[168:171], a[44:47], v[88:91]
    ds_read_b64_tr_b16 a[112:113], v36 offset:256
    v_exp_f32 v76, v76
    v_mfma_f32_16x16x32_bf16 v[80:83], a[176:179], a[48:51], v[80:83]
    ds_read_b64_tr_b16 a[114:115], v36 offset:8448
    v_cvt_pk_bf16_f32 v101, v74, v75
    v_mfma_f32_16x16x32_bf16 v[84:87], a[180:183], a[48:51], v[84:87]
    ds_read_b64_tr_b16 a[116:117], v37 offset:256
    buffer_load_dwordx4 v27, s[24:27], s38 offen offset:3072  lds
    v_mfma_f32_16x16x32_bf16 v[92:95], a[180:183], a[52:55], v[92:95]
    ds_read_b64_tr_b16 a[118:119], v37 offset:8448
    ds_read_b64_tr_b16 a[120:121], v38 offset:256
    v_mfma_f32_16x16x32_bf16 v[88:91], a[176:179], a[52:55], v[88:91]
    ds_read_b64_tr_b16 a[122:123], v38 offset:8448
    v_exp_f32 v77, v77
    v_mfma_f32_16x16x32_bf16 v[80:83], a[184:187], a[56:59], v[80:83]
    ds_read_b64_tr_b16 a[124:125], v39 offset:256
    v_exp_f32 v78, v78
    ds_read_b64_tr_b16 a[126:127], v39 offset:8448
    v_mfma_f32_16x16x32_bf16 v[84:87], a[188:191], a[56:59], v[84:87]
    v_cvt_pk_bf16_f32 v102, v76, v77
    v_exp_f32 v79, v79
    v_mfma_f32_16x16x32_bf16 v[92:95], a[188:191], a[60:63], v[92:95]
    v_cvt_pk_bf16_f32 v103, v78, v79
    v_mfma_f32_16x16x32_bf16 v[88:91], a[184:187], a[60:63], v[88:91]
    s_waitcnt vmcnt(8) lgkmcnt(0)
    s_barrier
    v_mfma_f32_16x16x32_bf16 v[128:131], a[64:67], v[96:99], v[128:131]
    s_add_u32 m0, s32, 0
    ds_read_b64_tr_b16 a[128:129], v32 offset:16384
    v_add_f32 v46, v46, v64
    v_mfma_f32_16x16x32_bf16 v[136:139], a[64:67], v[100:103], v[136:139]
    s_add_u32 s38, s80, 0
    ds_read_b64_tr_b16 a[130:131], v32 offset:24576
    v_add_f32 v47, v47, v72
    v_mfma_f32_16x16x32_bf16 v[140:143], a[68:71], v[100:103], v[140:143]
    ds_read_b64_tr_b16 a[132:133], v33 offset:16384
    v_add_f32 v46, v46, v65
    v_mfma_f32_16x16x32_bf16 v[132:135], a[68:71], v[96:99], v[132:135]
    buffer_load_dwordx4 v24, s[24:27], s38 offen offset:0  lds
    v_mfma_f32_16x16x32_bf16 v[144:147], a[72:75], v[96:99], v[144:147]
    ds_read_b64_tr_b16 a[134:135], v33 offset:24576
    v_add_f32 v47, v47, v73
    v_mfma_f32_16x16x32_bf16 v[152:155], a[72:75], v[100:103], v[152:155]
    ds_read_b64_tr_b16 a[136:137], v34 offset:16384
    v_add_f32 v46, v46, v66
    v_mfma_f32_16x16x32_bf16 v[156:159], a[76:79], v[100:103], v[156:159]
    ds_read_b64_tr_b16 a[138:139], v34 offset:24576
    ds_read_b64_tr_b16 a[140:141], v35 offset:16384
    v_add_f32 v47, v47, v74
    v_mfma_f32_16x16x32_bf16 v[148:151], a[76:79], v[96:99], v[148:151]
    ds_read_b64_tr_b16 a[142:143], v35 offset:24576
    v_add_f32 v46, v46, v67
    v_mfma_f32_16x16x32_bf16 v[160:163], a[80:83], v[96:99], v[160:163]
    ds_read_b64_tr_b16 a[144:145], v36 offset:16384
    v_add_f32 v47, v47, v75
    v_add_f32 v46, v46, v68
    v_mfma_f32_16x16x32_bf16 v[168:171], a[80:83], v[100:103], v[168:171]
    ds_read_b64_tr_b16 a[146:147], v36 offset:24576
    v_add_f32 v47, v47, v76
    v_mfma_f32_16x16x32_bf16 v[172:175], a[84:87], v[100:103], v[172:175]
    ds_read_b64_tr_b16 a[148:149], v37 offset:16384
    v_add_f32 v46, v46, v69
    v_mfma_f32_16x16x32_bf16 v[164:167], a[84:87], v[96:99], v[164:167]
    ds_read_b64_tr_b16 a[150:151], v37 offset:24576
    v_add_f32 v47, v47, v77
    v_mfma_f32_16x16x32_bf16 v[176:179], a[88:91], v[96:99], v[176:179]
    ds_read_b64_tr_b16 a[152:153], v38 offset:16384
    buffer_load_dwordx4 v25, s[24:27], s38 offen offset:1024  lds
    v_add_f32 v46, v46, v70
    v_add_f32 v47, v47, v78
    v_mfma_f32_16x16x32_bf16 v[184:187], a[88:91], v[100:103], v[184:187]
    ds_read_b64_tr_b16 a[154:155], v38 offset:24576
    v_add_f32 v46, v46, v71
    v_mfma_f32_16x16x32_bf16 v[188:191], a[92:95], v[100:103], v[188:191]
    ds_read_b64_tr_b16 a[156:157], v39 offset:16384
    v_add_f32 v47, v47, v79
    v_mfma_f32_16x16x32_bf16 v[180:183], a[92:95], v[96:99], v[180:183]
    ds_read_b64_tr_b16 a[158:159], v39 offset:24576
    ds_read_b64_tr_b16 a[160:161], v32 offset:16640
    v_add_u32 v28, 0x20000, v42
    v_add_u32 v29, 0x20000, v43
    v_add_u32 v30, 0x20000, v44
    v_add_u32 v31, 0x20000, v45
    v_mfma_f32_16x16x32_bf16 v[192:195], a[96:99], v[96:99], v[192:195]
    ds_read_b64_tr_b16 a[162:163], v32 offset:24832
    v_max3_f32 v48, v80, v81, v82
    v_mfma_f32_16x16x32_bf16 v[200:203], a[96:99], v[100:103], v[200:203]
    ds_read_b64_tr_b16 a[164:165], v33 offset:16640
    buffer_load_dwordx4 v26, s[24:27], s38 offen offset:2048  lds
    v_mfma_f32_16x16x32_bf16 v[204:207], a[100:103], v[100:103], v[204:207]
    ds_read_b64_tr_b16 a[166:167], v33 offset:24832
    v_max3_f32 v48, v48, v83, v84
    v_mfma_f32_16x16x32_bf16 v[196:199], a[100:103], v[96:99], v[196:199]
    ds_read_b64_tr_b16 a[168:169], v34 offset:16640
    v_max3_f32 v48, v48, v85, v86
    v_mfma_f32_16x16x32_bf16 v[208:211], a[104:107], v[96:99], v[208:211]
    ds_read_b64_tr_b16 a[170:171], v34 offset:24832
    v_max3_f32 v48, v48, v87, v88
    v_mfma_f32_16x16x32_bf16 v[216:219], a[104:107], v[100:103], v[216:219]
    ds_read_b64_tr_b16 a[172:173], v35 offset:16640
    v_max3_f32 v48, v48, v89, v90
    v_mfma_f32_16x16x32_bf16 v[220:223], a[108:111], v[100:103], v[220:223]
    ds_read_b64_tr_b16 a[174:175], v35 offset:24832
    v_max3_f32 v48, v48, v91, v92
    v_mfma_f32_16x16x32_bf16 v[212:215], a[108:111], v[96:99], v[212:215]
    ds_read_b64_tr_b16 a[176:177], v36 offset:16640
    v_max3_f32 v48, v48, v93, v94
    v_mfma_f32_16x16x32_bf16 v[224:227], a[112:115], v[96:99], v[224:227]
    ds_read_b64_tr_b16 a[178:179], v36 offset:24832
    v_mfma_f32_16x16x32_bf16 v[232:235], a[112:115], v[100:103], v[232:235]
    ds_read_b64_tr_b16 a[180:181], v37 offset:16640
    buffer_load_dwordx4 v27, s[24:27], s38 offen offset:3072  lds
    v_mfma_f32_16x16x32_bf16 v[236:239], a[116:119], v[100:103], v[236:239]
    ds_read_b64_tr_b16 a[182:183], v37 offset:24832
    ds_read_b64_tr_b16 a[184:185], v38 offset:16640
    v_mfma_f32_16x16x32_bf16 v[228:231], a[116:119], v[96:99], v[228:231]
    ds_read_b64_tr_b16 a[186:187], v38 offset:24832
    v_max_f32 v48, v48, v95
    v_mfma_f32_16x16x32_bf16 v[240:243], a[120:123], v[96:99], v[240:243]
    ds_read_b64_tr_b16 a[188:189], v39 offset:16640
    ds_read_b64_tr_b16 a[190:191], v39 offset:24832
    v_mfma_f32_16x16x32_bf16 v[248:251], a[120:123], v[100:103], v[248:251]
    v_cmp_lt_f32 vcc, s40, v48
    v_mfma_f32_16x16x32_bf16 v[252:255], a[124:127], v[100:103], v[252:255]
    v_mfma_f32_16x16x32_bf16 v[244:247], a[124:127], v[96:99], v[244:247]
    s_cbranch_vccnz L_rs6
L_rb6:
    v_exp_f32 v80, v80
    v_exp_f32 v81, v81
    v_exp_f32 v82, v82
    v_exp_f32 v83, v83
    v_exp_f32 v84, v84
    v_exp_f32 v85, v85
    v_exp_f32 v86, v86
    v_exp_f32 v87, v87
    v_exp_f32 v88, v88
    v_exp_f32 v89, v89
    v_exp_f32 v90, v90
    v_exp_f32 v91, v91
    v_exp_f32 v92, v92
    v_exp_f32 v93, v93
    v_exp_f32 v94, v94
    v_exp_f32 v95, v95
    v_cvt_pk_bf16_f32 v96, v80, v81
    v_cvt_pk_bf16_f32 v97, v82, v83
    v_cvt_pk_bf16_f32 v98, v84, v85
    v_cvt_pk_bf16_f32 v99, v86, v87
    v_cvt_pk_bf16_f32 v100, v88, v89
    v_cvt_pk_bf16_f32 v101, v90, v91
    v_cvt_pk_bf16_f32 v102, v92, v93
    v_cvt_pk_bf16_f32 v103, v94, v95
    s_waitcnt lgkmcnt(0)
    s_barrier
    v_mfma_f32_16x16x32_bf16 v[128:131], a[128:131], v[96:99], v[128:131]
    s_add_u32 m0, s32, 16384
    ds_read_b64_tr_b16 a[64:65], v20 offset:0
    v_add_f32 v46, v46, v80
    v_mfma_f32_16x16x32_bf16 v[136:139], a[128:131], v[100:103], v[136:139]
    s_add_u32 s38, s80, 114688
    ds_read_b64_tr_b16 a[66:67], v20 offset:2048
    v_add_f32 v47, v47, v88
    v_mfma_f32_16x16x32_bf16 v[140:143], a[132:135], v[100:103], v[140:143]
    ds_read_b64_tr_b16 a[68:69], v21 offset:0
    v_add_f32 v46, v46, v81
    v_mfma_f32_16x16x32_bf16 v[132:135], a[132:135], v[96:99], v[132:135]
    ds_read_b64_tr_b16 a[70:71], v21 offset:2048
    v_add_f32 v47, v47, v89
    v_mfma_f32_16x16x32_bf16 v[144:147], a[136:139], v[96:99], v[144:147]
    ds_read_b64_tr_b16 a[72:73], v22 offset:0
    v_add_f32 v46, v46, v82
    v_add_f32 v47, v47, v90
    v_mfma_f32_16x16x32_bf16 v[152:155], a[136:139], v[100:103], v[152:155]
    buffer_load_dwordx4 v24, s[24:27], s38 offen offset:0  lds
    v_add_f32 v46, v46, v83
    v_add_f32 v47, v47, v91
    v_add_f32 v46, v46, v84
    v_mfma_f32_16x16x32_bf16 v[156:159], a[140:143], v[100:103], v[156:159]
    ds_read_b64_tr_b16 a[74:75], v22 offset:2048
    ds_read_b64_tr_b16 a[76:77], v23 offset:0
    v_add_f32 v47, v47, v92
    v_add_f32 v46, v46, v85
    v_mfma_f32_16x16x32_bf16 v[148:151], a[140:143], v[96:99], v[148:151]
    ds_read_b64_tr_b16 a[78:79], v23 offset:2048
    v_add_f32 v47, v47, v93
    v_add_f32 v46, v46, v86
    v_mfma_f32_16x16x32_bf16 v[160:163], a[144:147], v[96:99], v[160:163]
    ds_read_b64_tr_b16 a[80:81], v20 offset:4096
    v_add_f32 v47, v47, v94
    v_add_f32 v46, v46, v87
    v_add_f32 v47, v47, v95
    v_mfma_f32_16x16x32_bf16 v[168:171], a[144:147], v[100:103], v[168:171]
    ds_read_b64_tr_b16 a[82:83], v20 offset:6144
    v_mov_b32 v49, v46
    s_nop 1
    v_mfma_f32_16x16x32_bf16 v[172:175], a[148:151], v[100:103], v[172:175]
    ds_read_b64_tr_b16 a[84:85], v21 offset:4096
    v_permlane32_swap_b32 v49, v46
    v_add_f32 v46, v49, v46
    v_mfma_f32_16x16x32_bf16 v[164:167], a[148:151], v[96:99], v[164:167]
    ds_read_b64_tr_b16 a[86:87], v21 offset:6144
    v_mov_b32 v49, v46
    s_nop 1
    v_mfma_f32_16x16x32_bf16 v[176:179], a[152:155], v[96:99], v[176:179]
    ds_read_b64_tr_b16 a[88:89], v22 offset:4096
    buffer_load_dwordx4 v25, s[24:27], s38 offen offset:1024  lds
    v_permlane16_swap_b32 v49, v46
    v_mfma_f32_16x16x32_bf16 v[184:187], a[152:155], v[100:103], v[184:187]
    ds_read_b64_tr_b16 a[90:91], v22 offset:6144
    v_add_f32 v46, v49, v46
    v_rcp_f32 v51, v46
    v_mfma_f32_16x16x32_bf16 v[188:191], a[156:159], v[100:103], v[188:191]
    ds_read_b64_tr_b16 a[92:93], v23 offset:4096
    v_mov_b32 v49, v47
    s_nop 1
    v_mfma_f32_16x16x32_bf16 v[180:183], a[156:159], v[96:99], v[180:183]
    ds_read_b64_tr_b16 a[94:95], v23 offset:6144
    ds_read_b64_tr_b16 a[96:97], v20 offset:8192
    v_permlane32_swap_b32 v49, v47
    v_mfma_f32_16x16x32_bf16 v[192:195], a[160:163], v[96:99], v[192:195]
    ds_read_b64_tr_b16 a[98:99], v20 offset:10240
    v_add_f32 v47, v49, v47
    v_mov_b32 v49, v47
    s_nop 1
    v_permlane16_swap_b32 v49, v47
    v_add_f32 v47, v49, v47
    v_rcp_f32 v52, v47
    v_mfma_f32_16x16x32_bf16 v[200:203], a[160:163], v[100:103], v[200:203]
    ds_read_b64_tr_b16 a[100:101], v21 offset:8192
    buffer_load_dwordx4 v26, s[24:27], s38 offen offset:2048  lds
    v_mfma_f32_16x16x32_bf16 v[204:207], a[164:167], v[100:103], v[204:207]
    ds_read_b64_tr_b16 a[102:103], v21 offset:10240
    v_cvt_pk_bf16_f32 v128, v128, v129
    v_mfma_f32_16x16x32_bf16 v[196:199], a[164:167], v[96:99], v[196:199]
    ds_read_b64_tr_b16 a[104:105], v22 offset:8192
    v_cvt_pk_bf16_f32 v129, v130, v131
    v_mfma_f32_16x16x32_bf16 v[208:211], a[168:171], v[96:99], v[208:211]
    ds_read_b64_tr_b16 a[106:107], v22 offset:10240
    v_cvt_pk_bf16_f32 v130, v132, v133
    v_cvt_pk_bf16_f32 v131, v134, v135
    v_mfma_f32_16x16x32_bf16 v[216:219], a[168:171], v[100:103], v[216:219]
    ds_read_b64_tr_b16 a[108:109], v23 offset:8192
    v_cvt_pk_bf16_f32 v136, v136, v137
    v_cvt_pk_bf16_f32 v137, v138, v139
    v_mfma_f32_16x16x32_bf16 v[220:223], a[172:175], v[100:103], v[220:223]
    ds_read_b64_tr_b16 a[110:111], v23 offset:10240
    v_cvt_pk_bf16_f32 v138, v140, v141
    v_cvt_pk_bf16_f32 v139, v142, v143
    v_mfma_f32_16x16x32_bf16 v[212:215], a[172:175], v[96:99], v[212:215]
    ds_read_b64_tr_b16 a[112:113], v20 offset:12288
    v_cvt_pk_bf16_f32 v144, v144, v145
    v_cvt_pk_bf16_f32 v145, v146, v147
    v_mfma_f32_16x16x32_bf16 v[224:227], a[176:179], v[96:99], v[224:227]
    ds_read_b64_tr_b16 a[114:115], v20 offset:14336
    v_cvt_pk_bf16_f32 v146, v148, v149
    v_cvt_pk_bf16_f32 v147, v150, v151
    v_mfma_f32_16x16x32_bf16 v[232:235], a[176:179], v[100:103], v[232:235]
    ds_read_b64_tr_b16 a[116:117], v21 offset:12288
    ds_read_b64_tr_b16 a[118:119], v21 offset:14336
    v_cvt_pk_bf16_f32 v152, v152, v153
    v_cvt_pk_bf16_f32 v153, v154, v155
    v_mfma_f32_16x16x32_bf16 v[236:239], a[180:183], v[100:103], v[236:239]
    ds_read_b64_tr_b16 a[120:121], v22 offset:12288
    buffer_load_dwordx4 v27, s[24:27], s38 offen offset:3072  lds
    v_cvt_pk_bf16_f32 v154, v156, v157
    v_cvt_pk_bf16_f32 v155, v158, v159
    v_cvt_pk_bf16_f32 v160, v160, v161
    v_mfma_f32_16x16x32_bf16 v[228:231], a[180:183], v[96:99], v[228:231]
    ds_read_b64_tr_b16 a[122:123], v22 offset:14336
    v_cvt_pk_bf16_f32 v161, v162, v163
    v_cvt_pk_bf16_f32 v162, v164, v165
    v_mfma_f32_16x16x32_bf16 v[240:243], a[184:187], v[96:99], v[240:243]
    ds_read_b64_tr_b16 a[124:125], v23 offset:12288
    ds_read_b64_tr_b16 a[126:127], v23 offset:14336
    v_cvt_pk_bf16_f32 v163, v166, v167
    v_cvt_pk_bf16_f32 v168, v168, v169
    v_mfma_f32_16x16x32_bf16 v[248:251], a[184:187], v[100:103], v[248:251]
    v_cvt_pk_bf16_f32 v169, v170, v171
    v_cvt_pk_bf16_f32 v170, v172, v173
    v_mfma_f32_16x16x32_bf16 v[252:255], a[188:191], v[100:103], v[252:255]
    v_cvt_pk_bf16_f32 v171, v174, v175
    v_cvt_pk_bf16_f32 v176, v176, v177
    v_mfma_f32_16x16x32_bf16 v[244:247], a[188:191], v[96:99], v[244:247]
    v_cvt_pk_bf16_f32 v177, v178, v179
    v_cvt_pk_bf16_f32 v178, v180, v181
    v_cvt_pk_bf16_f32 v179, v182, v183
    v_cvt_pk_bf16_f32 v184, v184, v185
    v_cvt_pk_bf16_f32 v185, v186, v187
    v_cvt_pk_bf16_f32 v186, v188, v189
    v_cvt_pk_bf16_f32 v187, v190, v191
    s_waitcnt lgkmcnt(0)
    s_barrier
    v_mfma_f32_16x16x32_bf16 v[64:67], a[64:67], v[128:131], 0
    ds_read_b64_tr_b16 a[128:129], v20 offset:16384
    v_mfma_f32_16x16x32_bf16 v[80:83], a[64:67], v[136:139], 0
    ds_read_b64_tr_b16 a[130:131], v20 offset:18432
    v_mfma_f32_16x16x32_bf16 v[84:87], a[68:71], v[136:139], 0
    s_add_u32 m0, s32, 65536
    ds_read_b64_tr_b16 a[132:133], v21 offset:16384
    s_add_u32 s38, s81, 0
    v_mfma_f32_16x16x32_bf16 v[68:71], a[68:71], v[128:131], 0
    ds_read_b64_tr_b16 a[134:135], v21 offset:18432
    v_mfma_f32_16x16x32_bf16 v[72:75], a[72:75], v[128:131], 0
    ds_read_b64_tr_b16 a[144:145], v20 offset:20480
    v_cvt_pk_bf16_f32 v192, v192, v193
    v_mfma_f32_16x16x32_bf16 v[88:91], a[72:75], v[136:139], 0
    buffer_load_dwordx4 v24, s[24:27], s38 offen offset:0  lds
    v_mfma_f32_16x16x32_bf16 v[92:95], a[76:79], v[136:139], 0
    ds_read_b64_tr_b16 a[146:147], v20 offset:22528
    ds_read_b64_tr_b16 a[148:149], v21 offset:20480
    v_mfma_f32_16x16x32_bf16 v[76:79], a[76:79], v[128:131], 0
    ds_read_b64_tr_b16 a[150:151], v21 offset:22528
    v_cvt_pk_bf16_f32 v193, v194, v195
    v_mfma_f32_16x16x32_bf16 v[64:67], a[80:83], v[144:147], v[64:67]
    ds_read_b64_tr_b16 a[160:161], v20 offset:24576
    v_cvt_pk_bf16_f32 v194, v196, v197
    v_cvt_pk_bf16_f32 v195, v198, v199
    v_mfma_f32_16x16x32_bf16 v[80:83], a[80:83], v[152:155], v[80:83]
    ds_read_b64_tr_b16 a[162:163], v20 offset:26624
    v_cvt_pk_bf16_f32 v200, v200, v201
    v_mfma_f32_16x16x32_bf16 v[84:87], a[84:87], v[152:155], v[84:87]
    ds_read_b64_tr_b16 a[164:165], v21 offset:24576
    v_cvt_pk_bf16_f32 v201, v202, v203
    v_mfma_f32_16x16x32_bf16 v[68:71], a[84:87], v[144:147], v[68:71]
    ds_read_b64_tr_b16 a[166:167], v21 offset:26624
    v_cvt_pk_bf16_f32 v202, v204, v205
    v_mfma_f32_16x16x32_bf16 v[72:75], a[88:91], v[144:147], v[72:75]
    ds_read_b64_tr_b16 a[176:177], v20 offset:28672
    v_cvt_pk_bf16_f32 v203, v206, v207
    v_cvt_pk_bf16_f32 v208, v208, v209
    v_mfma_f32_16x16x32_bf16 v[88:91], a[88:91], v[152:155], v[88:91]
    ds_read_b64_tr_b16 a[178:179], v20 offset:30720
    buffer_load_dwordx4 v25, s[24:27], s38 offen offset:1024  lds
    v_cvt_pk_bf16_f32 v209, v210, v211
    v_mfma_f32_16x16x32_bf16 v[92:95], a[92:95], v[152:155], v[92:95]
    ds_read_b64_tr_b16 a[180:181], v21 offset:28672
    v_cvt_pk_bf16_f32 v210, v212, v213
    v_mfma_f32_16x16x32_bf16 v[76:79], a[92:95], v[144:147], v[76:79]
    ds_read_b64_tr_b16 a[182:183], v21 offset:30720
    ds_read_b64_tr_b16 a[136:137], v22 offset:16384
    v_cvt_pk_bf16_f32 v211, v214, v215
    v_mfma_f32_16x16x32_bf16 v[64:67], a[96:99], v[160:163], v[64:67]
    ds_read_b64_tr_b16 a[138:139], v22 offset:18432
    v_cvt_pk_bf16_f32 v216, v216, v217
    v_mfma_f32_16x16x32_bf16 v[80:83], a[96:99], v[168:171], v[80:83]
    ds_read_b64_tr_b16 a[140:141], v23 offset:16384
    v_cvt_pk_bf16_f32 v217, v218, v219
    v_cvt_pk_bf16_f32 v218, v220, v221
    v_mfma_f32_16x16x32_bf16 v[84:87], a[100:103], v[168:171], v[84:87]
    ds_read_b64_tr_b16 a[142:143], v23 offset:18432
    v_cvt_pk_bf16_f32 v219, v222, v223
    v_mfma_f32_16x16x32_bf16 v[68:71], a[100:103], v[160:163], v[68:71]
    ds_read_b64_tr_b16 a[152:153], v22 offset:20480
    buffer_load_dwordx4 v26, s[24:27], s38 offen offset:2048  lds
    v_cvt_pk_bf16_f32 v224, v224, v225
    v_mfma_f32_16x16x32_bf16 v[72:75], a[104:107], v[160:163], v[72:75]
    ds_read_b64_tr_b16 a[154:155], v22 offset:22528
    v_cvt_pk_bf16_f32 v225, v226, v227
    v_mfma_f32_16x16x32_bf16 v[88:91], a[104:107], v[168:171], v[88:91]
    ds_read_b64_tr_b16 a[156:157], v23 offset:20480
    v_cvt_pk_bf16_f32 v226, v228, v229
    v_cvt_pk_bf16_f32 v227, v230, v231
    v_mfma_f32_16x16x32_bf16 v[92:95], a[108:111], v[168:171], v[92:95]
    ds_read_b64_tr_b16 a[158:159], v23 offset:22528
    v_cvt_pk_bf16_f32 v232, v232, v233
    v_mfma_f32_16x16x32_bf16 v[76:79], a[108:111], v[160:163], v[76:79]
    ds_read_b64_tr_b16 a[168:169], v22 offset:24576
    v_cvt_pk_bf16_f32 v233, v234, v235
    v_mfma_f32_16x16x32_bf16 v[64:67], a[112:115], v[176:179], v[64:67]
    ds_read_b64_tr_b16 a[170:171], v22 offset:26624
    v_cvt_pk_bf16_f32 v234, v236, v237
    v_mfma_f32_16x16x32_bf16 v[80:83], a[112:115], v[184:187], v[80:83]
    ds_read_b64_tr_b16 a[172:173], v23 offset:24576
    ds_read_b64_tr_b16 a[174:175], v23 offset:26624
    v_cvt_pk_bf16_f32 v235, v238, v239
    v_cvt_pk_bf16_f32 v240, v240, v241
    v_mfma_f32_16x16x32_bf16 v[84:87], a[116:119], v[184:187], v[84:87]
    ds_read_b64_tr_b16 a[184:185], v22 offset:28672
    buffer_load_dwordx4 v27, s[24:27], s38 offen offset:3072  lds
    v_cvt_pk_bf16_f32 v241, v242, v243
    v_mfma_f32_16x16x32_bf16 v[68:71], a[116:119], v[176:179], v[68:71]
    ds_read_b64_tr_b16 a[186:187], v22 offset:30720
    v_cvt_pk_bf16_f32 v242, v244, v245
    v_mfma_f32_16x16x32_bf16 v[72:75], a[120:123], v[176:179], v[72:75]
    ds_read_b64_tr_b16 a[188:189], v23 offset:28672
    ds_read_b64_tr_b16 a[190:191], v23 offset:30720
    v_cvt_pk_bf16_f32 v243, v246, v247
    v_mfma_f32_16x16x32_bf16 v[88:91], a[120:123], v[184:187], v[88:91]
    v_cvt_pk_bf16_f32 v248, v248, v249
    v_cvt_pk_bf16_f32 v249, v250, v251
    v_cvt_pk_bf16_f32 v250, v252, v253
    v_cvt_pk_bf16_f32 v251, v254, v255
    v_mfma_f32_16x16x32_bf16 v[92:95], a[124:127], v[184:187], v[92:95]
    v_mfma_f32_16x16x32_bf16 v[76:79], a[124:127], v[176:179], v[76:79]
    s_waitcnt lgkmcnt(0)
    s_barrier
    v_mfma_f32_16x16x32_bf16 v[64:67], a[128:131], v[192:195], v[64:67]
    ds_read_b64_tr_b16 a[64:65], v20 offset:32768
    v_mfma_f32_16x16x32_bf16 v[68:71], a[132:135], v[192:195], v[68:71]
    ds_read_b64_tr_b16 a[66:67], v20 offset:34816
    v_mfma_f32_16x16x32_bf16 v[64:67], a[144:147], v[208:211], v[64:67]
    s_add_u32 m0, s32, 81920
    ds_read_b64_tr_b16 a[68:69], v21 offset:32768
    s_add_u32 s38, s81, 114688
    v_mfma_f32_16x16x32_bf16 v[68:71], a[148:151], v[208:211], v[68:71]
    ds_read_b64_tr_b16 a[70:71], v21 offset:34816
    v_mfma_f32_16x16x32_bf16 v[64:67], a[160:163], v[224:227], v[64:67]
    ds_read_b64_tr_b16 a[72:73], v22 offset:32768
    v_mfma_f32_16x16x32_bf16 v[68:71], a[164:167], v[224:227], v[68:71]
    buffer_load_dwordx4 v24, s[24:27], s38 offen offset:0  lds
    v_mfma_f32_16x16x32_bf16 v[64:67], a[176:179], v[240:243], v[64:67]
    ds_read_b64_tr_b16 a[74:75], v22 offset:34816
    ds_read_b64_tr_b16 a[76:77], v23 offset:32768
    v_mfma_f32_16x16x32_bf16 v[68:71], a[180:183], v[240:243], v[68:71]
    ds_read_b64_tr_b16 a[78:79], v23 offset:34816
    v_mfma_f32_16x16x32_bf16 v[72:75], a[136:139], v[192:195], v[72:75]
    ds_read_b64_tr_b16 a[80:81], v20 offset:36864
    v_mfma_f32_16x16x32_bf16 v[76:79], a[140:143], v[192:195], v[76:79]
    ds_read_b64_tr_b16 a[82:83], v20 offset:38912
    v_mfma_f32_16x16x32_bf16 v[72:75], a[152:155], v[208:211], v[72:75]
    ds_read_b64_tr_b16 a[84:85], v21 offset:36864
    v_mfma_f32_16x16x32_bf16 v[76:79], a[156:159], v[208:211], v[76:79]
    ds_read_b64_tr_b16 a[86:87], v21 offset:38912
    v_mfma_f32_16x16x32_bf16 v[72:75], a[168:171], v[224:227], v[72:75]
    ds_read_b64_tr_b16 a[88:89], v22 offset:36864
    buffer_load_dwordx4 v25, s[24:27], s38 offen offset:1024  lds
    v_mfma_f32_16x16x32_bf16 v[76:79], a[172:175], v[224:227], v[76:79]
    ds_read_b64_tr_b16 a[90:91], v22 offset:38912
    v_mul_f32 v64, v51, v64
    v_mfma_f32_16x16x32_bf16 v[72:75], a[184:187], v[240:243], v[72:75]
    ds_read_b64_tr_b16 a[92:93], v23 offset:36864
    v_mul_f32 v65, v51, v65
    v_mfma_f32_16x16x32_bf16 v[76:79], a[188:191], v[240:243], v[76:79]
    ds_read_b64_tr_b16 a[94:95], v23 offset:38912
    ds_read_b64_tr_b16 a[96:97], v20 offset:40960
    v_mfma_f32_16x16x32_bf16 v[80:83], a[128:131], v[200:203], v[80:83]
    ds_read_b64_tr_b16 a[98:99], v20 offset:43008
    v_mul_f32 v66, v51, v66
    v_mfma_f32_16x16x32_bf16 v[84:87], a[132:135], v[200:203], v[84:87]
    ds_read_b64_tr_b16 a[100:101], v21 offset:40960
    v_mul_f32 v67, v51, v67
    v_mfma_f32_16x16x32_bf16 v[80:83], a[144:147], v[216:219], v[80:83]
    ds_read_b64_tr_b16 a[102:103], v21 offset:43008
    v_mul_f32 v68, v51, v68
    v_mfma_f32_16x16x32_bf16 v[84:87], a[148:151], v[216:219], v[84:87]
    ds_read_b64_tr_b16 a[104:105], v22 offset:40960
    v_mul_f32 v69, v51, v69
    v_mfma_f32_16x16x32_bf16 v[80:83], a[160:163], v[232:235], v[80:83]
    ds_read_b64_tr_b16 a[106:107], v22 offset:43008
    buffer_load_dwordx4 v26, s[24:27], s38 offen offset:2048  lds
    v_mul_f32 v70, v51, v70
    v_mfma_f32_16x16x32_bf16 v[84:87], a[164:167], v[232:235], v[84:87]
    ds_read_b64_tr_b16 a[108:109], v23 offset:40960
    v_mul_f32 v71, v51, v71
    v_mfma_f32_16x16x32_bf16 v[80:83], a[176:179], v[248:251], v[80:83]
    ds_read_b64_tr_b16 a[110:111], v23 offset:43008
    v_cvt_pk_bf16_f32 v64, v64, v65
    v_mfma_f32_16x16x32_bf16 v[84:87], a[180:183], v[248:251], v[84:87]
    ds_read_b64_tr_b16 a[112:113], v20 offset:45056
    v_cvt_pk_bf16_f32 v65, v66, v67
    v_mfma_f32_16x16x32_bf16 v[88:91], a[136:139], v[200:203], v[88:91]
    ds_read_b64_tr_b16 a[114:115], v20 offset:47104
    v_cvt_pk_bf16_f32 v66, v68, v69
    v_cvt_pk_bf16_f32 v67, v70, v71
    v_mfma_f32_16x16x32_bf16 v[92:95], a[140:143], v[200:203], v[92:95]
    ds_read_b64_tr_b16 a[116:117], v21 offset:45056
    buffer_store_dwordx4 v[64:67], v53, s[28:31], s46 offen sc1
    v_mfma_f32_16x16x32_bf16 v[88:91], a[152:155], v[216:219], v[88:91]
    ds_read_b64_tr_b16 a[118:119], v21 offset:47104
    buffer_load_dwordx4 v27, s[24:27], s38 offen offset:3072  lds
    v_mfma_f32_16x16x32_bf16 v[92:95], a[156:159], v[216:219], v[92:95]
    ds_read_b64_tr_b16 a[120:121], v22 offset:45056
    ds_read_b64_tr_b16 a[122:123], v22 offset:47104
    v_mul_f32 v72, v51, v72
    v_mfma_f32_16x16x32_bf16 v[88:91], a[168:171], v[232:235], v[88:91]
    ds_read_b64_tr_b16 a[124:125], v23 offset:45056
    ds_read_b64_tr_b16 a[126:127], v23 offset:47104
    v_mul_f32 v73, v51, v73
    v_mfma_f32_16x16x32_bf16 v[92:95], a[172:175], v[232:235], v[92:95]
    v_mul_f32 v74, v51, v74
    v_mul_f32 v75, v51, v75
    v_mfma_f32_16x16x32_bf16 v[88:91], a[184:187], v[248:251], v[88:91]
    v_mul_f32 v76, v51, v76
    v_mul_f32 v77, v51, v77
    v_mfma_f32_16x16x32_bf16 v[92:95], a[188:191], v[248:251], v[92:95]
    v_mul_f32 v78, v51, v78
    s_waitcnt lgkmcnt(0)
    s_barrier
    v_mfma_f32_16x16x32_bf16 v[96:99], a[64:67], v[128:131], 0
    ds_read_b64_tr_b16 a[128:129], v20 offset:49152
    v_mul_f32 v79, v51, v79
    v_mfma_f32_16x16x32_bf16 v[112:115], a[64:67], v[136:139], 0
    ds_read_b64_tr_b16 a[130:131], v20 offset:51200
    v_cvt_pk_bf16_f32 v72, v72, v73
    v_mfma_f32_16x16x32_bf16 v[116:119], a[68:71], v[136:139], 0
    s_add_u32 m0, s32, 98304
    ds_read_b64_tr_b16 a[132:133], v21 offset:49152
    v_cvt_pk_bf16_f32 v73, v74, v75
    v_mfma_f32_16x16x32_bf16 v[100:103], a[68:71], v[128:131], 0
    s_add_u32 s38, s82, 0
    ds_read_b64_tr_b16 a[134:135], v21 offset:51200
    v_cvt_pk_bf16_f32 v74, v76, v77
    v_mfma_f32_16x16x32_bf16 v[104:107], a[72:75], v[128:131], 0
    ds_read_b64_tr_b16 a[144:145], v20 offset:53248
    v_cvt_pk_bf16_f32 v75, v78, v79
    v_mfma_f32_16x16x32_bf16 v[120:123], a[72:75], v[136:139], 0
    buffer_load_dwordx4 v24, s[24:27], s38 offen offset:0  lds
    v_mfma_f32_16x16x32_bf16 v[124:127], a[76:79], v[136:139], 0
    ds_read_b64_tr_b16 a[146:147], v20 offset:55296
    buffer_store_dwordx4 v[72:75], v53, s[28:31], s87 offen sc1
    v_mfma_f32_16x16x32_bf16 v[108:111], a[76:79], v[128:131], 0
    ds_read_b64_tr_b16 a[148:149], v21 offset:53248
    ds_read_b64_tr_b16 a[150:151], v21 offset:55296
    v_mfma_f32_16x16x32_bf16 v[96:99], a[80:83], v[144:147], v[96:99]
    ds_read_b64_tr_b16 a[160:161], v20 offset:57344
    v_mul_f32 v80, v52, v80
    v_mfma_f32_16x16x32_bf16 v[112:115], a[80:83], v[152:155], v[112:115]
    ds_read_b64_tr_b16 a[162:163], v20 offset:59392
    v_mul_f32 v81, v52, v81
    v_mfma_f32_16x16x32_bf16 v[116:119], a[84:87], v[152:155], v[116:119]
    ds_read_b64_tr_b16 a[164:165], v21 offset:57344
    v_mul_f32 v82, v52, v82
    v_mfma_f32_16x16x32_bf16 v[100:103], a[84:87], v[144:147], v[100:103]
    ds_read_b64_tr_b16 a[166:167], v21 offset:59392
    v_mul_f32 v83, v52, v83
    v_mfma_f32_16x16x32_bf16 v[104:107], a[88:91], v[144:147], v[104:107]
    ds_read_b64_tr_b16 a[176:177], v20 offset:61440
    v_mul_f32 v84, v52, v84
    v_mfma_f32_16x16x32_bf16 v[120:123], a[88:91], v[152:155], v[120:123]
    ds_read_b64_tr_b16 a[178:179], v20 offset:63488
    buffer_load_dwordx4 v25, s[24:27], s38 offen offset:1024  lds
    v_mul_f32 v85, v52, v85
    v_mfma_f32_16x16x32_bf16 v[124:127], a[92:95], v[152:155], v[124:127]
    ds_read_b64_tr_b16 a[180:181], v21 offset:61440
    v_mul_f32 v86, v52, v86
    v_mfma_f32_16x16x32_bf16 v[108:111], a[92:95], v[144:147], v[108:111]
    ds_read_b64_tr_b16 a[182:183], v21 offset:63488
    ds_read_b64_tr_b16 a[136:137], v22 offset:49152
    v_mul_f32 v87, v52, v87
    v_cvt_pk_bf16_f32 v80, v80, v81
    v_mfma_f32_16x16x32_bf16 v[96:99], a[96:99], v[160:163], v[96:99]
    ds_read_b64_tr_b16 a[138:139], v22 offset:51200
    v_cvt_pk_bf16_f32 v81, v82, v83
    v_mfma_f32_16x16x32_bf16 v[112:115], a[96:99], v[168:171], v[112:115]
    ds_read_b64_tr_b16 a[140:141], v23 offset:49152
    v_cvt_pk_bf16_f32 v82, v84, v85
    v_mfma_f32_16x16x32_bf16 v[116:119], a[100:103], v[168:171], v[116:119]
    ds_read_b64_tr_b16 a[142:143], v23 offset:51200
    v_cvt_pk_bf16_f32 v83, v86, v87
    v_mfma_f32_16x16x32_bf16 v[100:103], a[100:103], v[160:163], v[100:103]
    ds_read_b64_tr_b16 a[152:153], v22 offset:53248
    buffer_load_dwordx4 v26, s[24:27], s38 offen offset:2048  lds
    v_mfma_f32_16x16x32_bf16 v[104:107], a[104:107], v[160:163], v[104:107]
    ds_read_b64_tr_b16 a[154:155], v22 offset:55296
    buffer_store_dwordx4 v[80:83], v19, s[28:31], s46 offen sc1
    v_mfma_f32_16x16x32_bf16 v[120:123], a[104:107], v[168:171], v[120:123]
    ds_read_b64_tr_b16 a[156:157], v23 offset:53248
    v_mul_f32 v88, v52, v88
    v_mfma_f32_16x16x32_bf16 v[124:127], a[108:111], v[168:171], v[124:127]
    ds_read_b64_tr_b16 a[158:159], v23 offset:55296
    v_mul_f32 v89, v52, v89
    v_mfma_f32_16x16x32_bf16 v[108:111], a[108:111], v[160:163], v[108:111]
    ds_read_b64_tr_b16 a[168:169], v22 offset:57344
    v_mul_f32 v90, v52, v90
    v_mfma_f32_16x16x32_bf16 v[96:99], a[112:115], v[176:179], v[96:99]
    ds_read_b64_tr_b16 a[170:171], v22 offset:59392
    v_mul_f32 v91, v52, v91
    v_mul_f32 v92, v52, v92
    v_mfma_f32_16x16x32_bf16 v[112:115], a[112:115], v[184:187], v[112:115]
    ds_read_b64_tr_b16 a[172:173], v23 offset:57344
    ds_read_b64_tr_b16 a[174:175], v23 offset:59392
    v_mul_f32 v93, v52, v93
    v_mfma_f32_16x16x32_bf16 v[116:119], a[116:119], v[184:187], v[116:119]
    ds_read_b64_tr_b16 a[184:185], v22 offset:61440
    buffer_load_dwordx4 v27, s[24:27], s38 offen offset:3072  lds
    v_mul_f32 v94, v52, v94
    v_mfma_f32_16x16x32_bf16 v[100:103], a[116:119], v[176:179], v[100:103]
    ds_read_b64_tr_b16 a[186:187], v22 offset:63488
    v_mul_f32 v95, v52, v95
    v_mfma_f32_16x16x32_bf16 v[104:107], a[120:123], v[176:179], v[104:107]
    ds_read_b64_tr_b16 a[188:189], v23 offset:61440
    ds_read_b64_tr_b16 a[190:191], v23 offset:63488
    v_cvt_pk_bf16_f32 v88, v88, v89
    v_mfma_f32_16x16x32_bf16 v[120:123], a[120:123], v[184:187], v[120:123]
    v_cvt_pk_bf16_f32 v89, v90, v91
    v_cvt_pk_bf16_f32 v90, v92, v93
    v_mfma_f32_16x16x32_bf16 v[124:127], a[124:127], v[184:187], v[124:127]
    v_cvt_pk_bf16_f32 v91, v94, v95
    v_mfma_f32_16x16x32_bf16 v[108:111], a[124:127], v[176:179], v[108:111]
    buffer_store_dwordx4 v[88:91], v19, s[28:31], s87 offen sc1
    s_add_u32 s46, s46, 0x8000
    s_add_u32 s87, s87, 0x8000
    s_waitcnt vmcnt(16) lgkmcnt(0)
    s_barrier
    v_mfma_f32_16x16x32_bf16 v[96:99], a[128:131], v[192:195], v[96:99]
    ds_read_b64_tr_b16 a[64:65], v28 offset:0
    v_mfma_f32_16x16x32_bf16 v[100:103], a[132:135], v[192:195], v[100:103]
    ds_read_b64_tr_b16 a[66:67], v28 offset:2048
    v_mfma_f32_16x16x32_bf16 v[96:99], a[144:147], v[208:211], v[96:99]
    s_add_u32 m0, s32, 114688
    ds_read_b64_tr_b16 a[68:69], v29 offset:0
    s_add_u32 s38, s82, 114688
    v_mfma_f32_16x16x32_bf16 v[100:103], a[148:151], v[208:211], v[100:103]
    ds_read_b64_tr_b16 a[70:71], v29 offset:2048
    v_mfma_f32_16x16x32_bf16 v[96:99], a[160:163], v[224:227], v[96:99]
    buffer_load_dwordx4 v24, s[24:27], s38 offen offset:0  lds
    v_mfma_f32_16x16x32_bf16 v[100:103], a[164:167], v[224:227], v[100:103]
    ds_read_b64_tr_b16 a[72:73], v30 offset:0
    v_mfma_f32_16x16x32_bf16 v[96:99], a[176:179], v[240:243], v[96:99]
    ds_read_b64_tr_b16 a[74:75], v30 offset:2048
    v_mfma_f32_16x16x32_bf16 v[100:103], a[180:183], v[240:243], v[100:103]
    ds_read_b64_tr_b16 a[76:77], v31 offset:0
    v_mfma_f32_16x16x32_bf16 v[104:107], a[136:139], v[192:195], v[104:107]
    ds_read_b64_tr_b16 a[78:79], v31 offset:2048
    v_mfma_f32_16x16x32_bf16 v[108:111], a[140:143], v[192:195], v[108:111]
    ds_read_b64_tr_b16 a[80:81], v28 offset:4096
    v_mfma_f32_16x16x32_bf16 v[104:107], a[152:155], v[208:211], v[104:107]
    ds_read_b64_tr_b16 a[82:83], v28 offset:6144
    v_mfma_f32_16x16x32_bf16 v[108:111], a[156:159], v[208:211], v[108:111]
    ds_read_b64_tr_b16 a[84:85], v29 offset:4096
    v_mfma_f32_16x16x32_bf16 v[104:107], a[168:171], v[224:227], v[104:107]
    ds_read_b64_tr_b16 a[86:87], v29 offset:6144
    buffer_load_dwordx4 v25, s[24:27], s38 offen offset:1024  lds
    v_mfma_f32_16x16x32_bf16 v[108:111], a[172:175], v[224:227], v[108:111]
    ds_read_b64_tr_b16 a[88:89], v30 offset:4096
    v_mul_f32 v96, v51, v96
    v_mfma_f32_16x16x32_bf16 v[104:107], a[184:187], v[240:243], v[104:107]
    ds_read_b64_tr_b16 a[90:91], v30 offset:6144
    v_mul_f32 v97, v51, v97
    v_mfma_f32_16x16x32_bf16 v[108:111], a[188:191], v[240:243], v[108:111]
    ds_read_b64_tr_b16 a[92:93], v31 offset:4096
    v_mul_f32 v98, v51, v98
    v_mfma_f32_16x16x32_bf16 v[112:115], a[128:131], v[200:203], v[112:115]
    ds_read_b64_tr_b16 a[94:95], v31 offset:6144
    v_mul_f32 v99, v51, v99
    v_mfma_f32_16x16x32_bf16 v[116:119], a[132:135], v[200:203], v[116:119]
    ds_read_b64_tr_b16 a[96:97], v28 offset:8192
    v_mul_f32 v100, v51, v100
    v_mfma_f32_16x16x32_bf16 v[112:115], a[144:147], v[216:219], v[112:115]
    ds_read_b64_tr_b16 a[98:99], v28 offset:10240
    v_mul_f32 v101, v51, v101
    v_mfma_f32_16x16x32_bf16 v[116:119], a[148:151], v[216:219], v[116:119]
    ds_read_b64_tr_b16 a[100:101], v29 offset:8192
    buffer_load_dwordx4 v26, s[24:27], s38 offen offset:2048  lds
    v_mfma_f32_16x16x32_bf16 v[112:115], a[160:163], v[232:235], v[112:115]
    ds_read_b64_tr_b16 a[102:103], v29 offset:10240
    v_mul_f32 v102, v51, v102
    v_mfma_f32_16x16x32_bf16 v[116:119], a[164:167], v[232:235], v[116:119]
    ds_read_b64_tr_b16 a[104:105], v30 offset:8192
    v_mul_f32 v103, v51, v103
    v_mfma_f32_16x16x32_bf16 v[112:115], a[176:179], v[248:251], v[112:115]
    ds_read_b64_tr_b16 a[106:107], v30 offset:10240
    v_cvt_pk_bf16_f32 v96, v96, v97
    v_mfma_f32_16x16x32_bf16 v[116:119], a[180:183], v[248:251], v[116:119]
    ds_read_b64_tr_b16 a[108:109], v31 offset:8192
    v_cvt_pk_bf16_f32 v97, v98, v99
    v_mfma_f32_16x16x32_bf16 v[120:123], a[136:139], v[200:203], v[120:123]
    ds_read_b64_tr_b16 a[110:111], v31 offset:10240
    v_cvt_pk_bf16_f32 v98, v100, v101
    v_cvt_pk_bf16_f32 v99, v102, v103
    v_mfma_f32_16x16x32_bf16 v[124:127], a[140:143], v[200:203], v[124:127]
    ds_read_b64_tr_b16 a[112:113], v28 offset:12288
    buffer_store_dwordx4 v[96:99], v53, s[28:31], s46 offen sc1
    v_mfma_f32_16x16x32_bf16 v[120:123], a[152:155], v[216:219], v[120:123]
    ds_read_b64_tr_b16 a[114:115], v28 offset:14336
    buffer_load_dwordx4 v27, s[24:27], s38 offen offset:3072  lds
    v_mfma_f32_16x16x32_bf16 v[124:127], a[156:159], v[216:219], v[124:127]
    ds_read_b64_tr_b16 a[116:117], v29 offset:12288
    v_mul_f32 v104, v51, v104
    v_mfma_f32_16x16x32_bf16 v[120:123], a[168:171], v[232:235], v[120:123]
    ds_read_b64_tr_b16 a[118:119], v29 offset:14336
    v_mul_f32 v105, v51, v105
    v_mfma_f32_16x16x32_bf16 v[124:127], a[172:175], v[232:235], v[124:127]
    ds_read_b64_tr_b16 a[120:121], v30 offset:12288
    v_mul_f32 v106, v51, v106
    v_mfma_f32_16x16x32_bf16 v[120:123], a[184:187], v[248:251], v[120:123]
    ds_read_b64_tr_b16 a[122:123], v30 offset:14336
    v_mul_f32 v107, v51, v107
    v_mfma_f32_16x16x32_bf16 v[124:127], a[188:191], v[248:251], v[124:127]
    ds_read_b64_tr_b16 a[124:125], v31 offset:12288
    ds_read_b64_tr_b16 a[126:127], v31 offset:14336
    v_mul_f32 v108, v51, v108
    v_mul_f32 v109, v51, v109
    v_mul_f32 v110, v51, v110
    s_waitcnt lgkmcnt(6)
    v_mfma_f32_16x16x32_bf16 v[64:67], a[64:67], v[128:131], 0
    ds_read_b64_tr_b16 a[128:129], v28 offset:16384
    v_mul_f32 v111, v51, v111
    v_mfma_f32_16x16x32_bf16 v[80:83], a[64:67], v[136:139], 0
    ds_read_b64_tr_b16 a[130:131], v28 offset:18432
    v_cvt_pk_bf16_f32 v104, v104, v105
    v_mfma_f32_16x16x32_bf16 v[84:87], a[68:71], v[136:139], 0
    ds_read_b64_tr_b16 a[132:133], v29 offset:16384
    v_cvt_pk_bf16_f32 v105, v106, v107
    v_mfma_f32_16x16x32_bf16 v[68:71], a[68:71], v[128:131], 0
    s_waitcnt lgkmcnt(3)
    ds_read_b64_tr_b16 a[134:135], v29 offset:18432
    v_cvt_pk_bf16_f32 v106, v108, v109
    v_mfma_f32_16x16x32_bf16 v[72:75], a[72:75], v[128:131], 0
    ds_read_b64_tr_b16 a[144:145], v28 offset:20480
    v_cvt_pk_bf16_f32 v107, v110, v111
    v_mfma_f32_16x16x32_bf16 v[88:91], a[72:75], v[136:139], 0
    buffer_store_dwordx4 v[104:107], v53, s[28:31], s87 offen sc1
    v_mfma_f32_16x16x32_bf16 v[92:95], a[76:79], v[136:139], 0
    ds_read_b64_tr_b16 a[146:147], v28 offset:22528
    v_mul_f32 v112, v52, v112
    v_mfma_f32_16x16x32_bf16 v[76:79], a[76:79], v[128:131], 0
    ds_read_b64_tr_b16 a[148:149], v29 offset:20480
    v_mul_f32 v113, v52, v113
    v_mfma_f32_16x16x32_bf16 v[64:67], a[80:83], v[144:147], v[64:67]
    ds_read_b64_tr_b16 a[150:151], v29 offset:22528
    v_mul_f32 v114, v52, v114
    v_mfma_f32_16x16x32_bf16 v[80:83], a[80:83], v[152:155], v[80:83]
    ds_read_b64_tr_b16 a[160:161], v28 offset:24576
    v_mul_f32 v115, v52, v115
    v_mfma_f32_16x16x32_bf16 v[84:87], a[84:87], v[152:155], v[84:87]
    ds_read_b64_tr_b16 a[162:163], v28 offset:26624
    v_mul_f32 v116, v52, v116
    v_mfma_f32_16x16x32_bf16 v[68:71], a[84:87], v[144:147], v[68:71]
    ds_read_b64_tr_b16 a[164:165], v29 offset:24576
    v_mul_f32 v117, v52, v117
    v_mfma_f32_16x16x32_bf16 v[72:75], a[88:91], v[144:147], v[72:75]
    ds_read_b64_tr_b16 a[166:167], v29 offset:26624
    v_mul_f32 v118, v52, v118
    v_mfma_f32_16x16x32_bf16 v[88:91], a[88:91], v[152:155], v[88:91]
    ds_read_b64_tr_b16 a[176:177], v28 offset:28672
    v_mul_f32 v119, v52, v119
    v_mfma_f32_16x16x32_bf16 v[92:95], a[92:95], v[152:155], v[92:95]
    ds_read_b64_tr_b16 a[178:179], v28 offset:30720
    v_cvt_pk_bf16_f32 v112, v112, v113
    v_mfma_f32_16x16x32_bf16 v[76:79], a[92:95], v[144:147], v[76:79]
    ds_read_b64_tr_b16 a[180:181], v29 offset:28672
    v_cvt_pk_bf16_f32 v113, v114, v115
    v_mfma_f32_16x16x32_bf16 v[64:67], a[96:99], v[160:163], v[64:67]
    ds_read_b64_tr_b16 a[182:183], v29 offset:30720
    v_cvt_pk_bf16_f32 v114, v116, v117
    v_mfma_f32_16x16x32_bf16 v[80:83], a[96:99], v[168:171], v[80:83]
    ds_read_b64_tr_b16 a[136:137], v30 offset:16384
    v_cvt_pk_bf16_f32 v115, v118, v119
    v_mfma_f32_16x16x32_bf16 v[84:87], a[100:103], v[168:171], v[84:87]
    ds_read_b64_tr_b16 a[138:139], v30 offset:18432
    v_mfma_f32_16x16x32_bf16 v[68:71], a[100:103], v[160:163], v[68:71]
    ds_read_b64_tr_b16 a[140:141], v31 offset:16384
    buffer_store_dwordx4 v[112:115], v19, s[28:31], s46 offen sc1
    v_mfma_f32_16x16x32_bf16 v[72:75], a[104:107], v[160:163], v[72:75]
    ds_read_b64_tr_b16 a[142:143], v31 offset:18432
    v_mul_f32 v120, v52, v120
    v_mfma_f32_16x16x32_bf16 v[88:91], a[104:107], v[168:171], v[88:91]
    ds_read_b64_tr_b16 a[152:153], v30 offset:20480
    v_mul_f32 v121, v52, v121
    v_mfma_f32_16x16x32_bf16 v[92:95], a[108:111], v[168:171], v[92:95]
    ds_read_b64_tr_b16 a[154:155], v30 offset:22528
    v_mul_f32 v122, v52, v122
    v_mfma_f32_16x16x32_bf16 v[76:79], a[108:111], v[160:163], v[76:79]
    ds_read_b64_tr_b16 a[156:157], v31 offset:20480
    v_mul_f32 v123, v52, v123
    v_mfma_f32_16x16x32_bf16 v[64:67], a[112:115], v[176:179], v[64:67]
    ds_read_b64_tr_b16 a[158:159], v31 offset:22528
    v_mul_f32 v124, v52, v124
    v_mfma_f32_16x16x32_bf16 v[80:83], a[112:115], v[184:187], v[80:83]
    ds_read_b64_tr_b16 a[168:169], v30 offset:24576
    v_mul_f32 v125, v52, v125
    v_mfma_f32_16x16x32_bf16 v[84:87], a[116:119], v[184:187], v[84:87]
    ds_read_b64_tr_b16 a[170:171], v30 offset:26624
    v_mul_f32 v126, v52, v126
    v_mfma_f32_16x16x32_bf16 v[68:71], a[116:119], v[176:179], v[68:71]
    ds_read_b64_tr_b16 a[172:173], v31 offset:24576
    v_mul_f32 v127, v52, v127
    v_mfma_f32_16x16x32_bf16 v[72:75], a[120:123], v[176:179], v[72:75]
    ds_read_b64_tr_b16 a[174:175], v31 offset:26624
    v_cvt_pk_bf16_f32 v120, v120, v121
    v_mfma_f32_16x16x32_bf16 v[88:91], a[120:123], v[184:187], v[88:91]
    ds_read_b64_tr_b16 a[184:185], v30 offset:28672
    v_cvt_pk_bf16_f32 v121, v122, v123
    v_mfma_f32_16x16x32_bf16 v[92:95], a[124:127], v[184:187], v[92:95]
    ds_read_b64_tr_b16 a[186:187], v30 offset:30720
    v_cvt_pk_bf16_f32 v122, v124, v125
    v_mfma_f32_16x16x32_bf16 v[76:79], a[124:127], v[176:179], v[76:79]
    ds_read_b64_tr_b16 a[188:189], v31 offset:28672
    ds_read_b64_tr_b16 a[190:191], v31 offset:30720
    v_cvt_pk_bf16_f32 v123, v126, v127
    buffer_store_dwordx4 v[120:123], v19, s[28:31], s87 offen sc1
    s_add_u32 s46, s46, 0x8000
    s_add_u32 s87, s87, 0x8000
    s_waitcnt vmcnt(8) lgkmcnt(6)
    v_mfma_f32_16x16x32_bf16 v[64:67], a[128:131], v[192:195], v[64:67]
    ds_read_b64_tr_b16 a[64:65], v42 offset:32768
    v_mov_b32 v5, 0x1
    v_mfma_f32_16x16x32_bf16 v[68:71], a[132:135], v[192:195], v[68:71]
    buffer_atomic_add v5, v2, s[64:67], 0 offen sc0
    v_mfma_f32_16x16x32_bf16 v[64:67], a[144:147], v[208:211], v[64:67]
    ds_read_b64_tr_b16 a[66:67], v42 offset:34816
    v_mfma_f32_16x16x32_bf16 v[68:71], a[148:151], v[208:211], v[68:71]
    s_waitcnt lgkmcnt(2)
    ds_read_b64_tr_b16 a[68:69], v43 offset:32768
    v_mfma_f32_16x16x32_bf16 v[64:67], a[160:163], v[224:227], v[64:67]
    ds_read_b64_tr_b16 a[70:71], v43 offset:34816
    v_mfma_f32_16x16x32_bf16 v[68:71], a[164:167], v[224:227], v[68:71]
    ds_read_b64_tr_b16 a[72:73], v44 offset:32768
    v_mfma_f32_16x16x32_bf16 v[64:67], a[176:179], v[240:243], v[64:67]
    ds_read_b64_tr_b16 a[74:75], v44 offset:34816
    v_mfma_f32_16x16x32_bf16 v[68:71], a[180:183], v[240:243], v[68:71]
    ds_read_b64_tr_b16 a[76:77], v45 offset:32768
    v_mfma_f32_16x16x32_bf16 v[72:75], a[136:139], v[192:195], v[72:75]
    ds_read_b64_tr_b16 a[78:79], v45 offset:34816
    v_mfma_f32_16x16x32_bf16 v[76:79], a[140:143], v[192:195], v[76:79]
    ds_read_b64_tr_b16 a[80:81], v42 offset:36864
    v_mfma_f32_16x16x32_bf16 v[72:75], a[152:155], v[208:211], v[72:75]
    ds_read_b64_tr_b16 a[82:83], v42 offset:38912
    v_mfma_f32_16x16x32_bf16 v[76:79], a[156:159], v[208:211], v[76:79]
    ds_read_b64_tr_b16 a[84:85], v43 offset:36864
    v_mfma_f32_16x16x32_bf16 v[72:75], a[168:171], v[224:227], v[72:75]
    ds_read_b64_tr_b16 a[86:87], v43 offset:38912
    v_mul_f32 v64, v51, v64
    v_mfma_f32_16x16x32_bf16 v[76:79], a[172:175], v[224:227], v[76:79]
    ds_read_b64_tr_b16 a[88:89], v44 offset:36864
    v_mul_f32 v65, v51, v65
    v_mfma_f32_16x16x32_bf16 v[72:75], a[184:187], v[240:243], v[72:75]
    ds_read_b64_tr_b16 a[90:91], v44 offset:38912
    v_mul_f32 v66, v51, v66
    v_mfma_f32_16x16x32_bf16 v[76:79], a[188:191], v[240:243], v[76:79]
    ds_read_b64_tr_b16 a[92:93], v45 offset:36864
    v_mul_f32 v67, v51, v67
    v_mfma_f32_16x16x32_bf16 v[80:83], a[128:131], v[200:203], v[80:83]
    ds_read_b64_tr_b16 a[94:95], v45 offset:38912
    v_mul_f32 v68, v51, v68
    v_mfma_f32_16x16x32_bf16 v[84:87], a[132:135], v[200:203], v[84:87]
    ds_read_b64_tr_b16 a[96:97], v42 offset:40960
    v_mul_f32 v69, v51, v69
    v_mfma_f32_16x16x32_bf16 v[80:83], a[144:147], v[216:219], v[80:83]
    ds_read_b64_tr_b16 a[98:99], v42 offset:43008
    v_mul_f32 v70, v51, v70
    v_mfma_f32_16x16x32_bf16 v[84:87], a[148:151], v[216:219], v[84:87]
    ds_read_b64_tr_b16 a[100:101], v43 offset:40960
    v_mul_f32 v71, v51, v71
    v_mfma_f32_16x16x32_bf16 v[80:83], a[160:163], v[232:235], v[80:83]
    ds_read_b64_tr_b16 a[102:103], v43 offset:43008
    v_cvt_pk_bf16_f32 v64, v64, v65
    v_mfma_f32_16x16x32_bf16 v[84:87], a[164:167], v[232:235], v[84:87]
    ds_read_b64_tr_b16 a[104:105], v44 offset:40960
    v_cvt_pk_bf16_f32 v65, v66, v67
    v_mfma_f32_16x16x32_bf16 v[80:83], a[176:179], v[248:251], v[80:83]
    ds_read_b64_tr_b16 a[106:107], v44 offset:43008
    v_cvt_pk_bf16_f32 v66, v68, v69
    v_mfma_f32_16x16x32_bf16 v[84:87], a[180:183], v[248:251], v[84:87]
    ds_read_b64_tr_b16 a[108:109], v45 offset:40960
    v_cvt_pk_bf16_f32 v67, v70, v71
    v_mfma_f32_16x16x32_bf16 v[88:91], a[136:139], v[200:203], v[88:91]
    ds_read_b64_tr_b16 a[110:111], v45 offset:43008
    v_mfma_f32_16x16x32_bf16 v[92:95], a[140:143], v[200:203], v[92:95]
    ds_read_b64_tr_b16 a[112:113], v42 offset:45056
    buffer_store_dwordx4 v[64:67], v53, s[28:31], s46 offen sc1
    v_mfma_f32_16x16x32_bf16 v[88:91], a[152:155], v[216:219], v[88:91]
    ds_read_b64_tr_b16 a[114:115], v42 offset:47104
    v_mul_f32 v72, v51, v72
    v_mfma_f32_16x16x32_bf16 v[92:95], a[156:159], v[216:219], v[92:95]
    ds_read_b64_tr_b16 a[116:117], v43 offset:45056
    v_mul_f32 v73, v51, v73
    v_mfma_f32_16x16x32_bf16 v[88:91], a[168:171], v[232:235], v[88:91]
    ds_read_b64_tr_b16 a[118:119], v43 offset:47104
    v_mul_f32 v74, v51, v74
    v_mfma_f32_16x16x32_bf16 v[92:95], a[172:175], v[232:235], v[92:95]
    ds_read_b64_tr_b16 a[120:121], v44 offset:45056
    v_mul_f32 v75, v51, v75
    v_mfma_f32_16x16x32_bf16 v[88:91], a[184:187], v[248:251], v[88:91]
    ds_read_b64_tr_b16 a[122:123], v44 offset:47104
    v_mul_f32 v76, v51, v76
    v_mfma_f32_16x16x32_bf16 v[92:95], a[188:191], v[248:251], v[92:95]
    ds_read_b64_tr_b16 a[124:125], v45 offset:45056
    ds_read_b64_tr_b16 a[126:127], v45 offset:47104
    v_mul_f32 v77, v51, v77
    v_mul_f32 v78, v51, v78
    s_waitcnt vmcnt(5) lgkmcnt(6)
    s_barrier
    v_mfma_f32_16x16x32_bf16 v[96:99], a[64:67], v[128:131], 0
    ds_read_b64_tr_b16 a[128:129], v42 offset:49152
    v_mul_f32 v79, v51, v79
    v_mfma_f32_16x16x32_bf16 v[112:115], a[64:67], v[136:139], 0
    ds_read_b64_tr_b16 a[130:131], v42 offset:51200
    v_cvt_pk_bf16_f32 v72, v72, v73
    v_mfma_f32_16x16x32_bf16 v[116:119], a[68:71], v[136:139], 0
    ds_read_b64_tr_b16 a[132:133], v43 offset:49152
    v_cvt_pk_bf16_f32 v73, v74, v75
    v_mfma_f32_16x16x32_bf16 v[100:103], a[68:71], v[128:131], 0
    s_waitcnt lgkmcnt(3)
    ds_read_b64_tr_b16 a[134:135], v43 offset:51200
    v_cvt_pk_bf16_f32 v74, v76, v77
    v_mfma_f32_16x16x32_bf16 v[104:107], a[72:75], v[128:131], 0
    ds_read_b64_tr_b16 a[144:145], v42 offset:53248
    v_cvt_pk_bf16_f32 v75, v78, v79
    v_mfma_f32_16x16x32_bf16 v[120:123], a[72:75], v[136:139], 0
    buffer_store_dwordx4 v[72:75], v53, s[28:31], s87 offen sc1
    v_mfma_f32_16x16x32_bf16 v[124:127], a[76:79], v[136:139], 0
    ds_read_b64_tr_b16 a[146:147], v42 offset:55296
    v_mul_f32 v80, v52, v80
    v_mfma_f32_16x16x32_bf16 v[108:111], a[76:79], v[128:131], 0
    ds_read_b64_tr_b16 a[148:149], v43 offset:53248
    v_mul_f32 v81, v52, v81
    v_mfma_f32_16x16x32_bf16 v[96:99], a[80:83], v[144:147], v[96:99]
    ds_read_b64_tr_b16 a[150:151], v43 offset:55296
    v_mul_f32 v82, v52, v82
    v_mfma_f32_16x16x32_bf16 v[112:115], a[80:83], v[152:155], v[112:115]
    ds_read_b64_tr_b16 a[160:161], v42 offset:57344
    v_mul_f32 v83, v52, v83
    v_mfma_f32_16x16x32_bf16 v[116:119], a[84:87], v[152:155], v[116:119]
    ds_read_b64_tr_b16 a[162:163], v42 offset:59392
    v_mul_f32 v84, v52, v84
    v_mfma_f32_16x16x32_bf16 v[100:103], a[84:87], v[144:147], v[100:103]
    ds_read_b64_tr_b16 a[164:165], v43 offset:57344
    v_mul_f32 v85, v52, v85
    v_mfma_f32_16x16x32_bf16 v[104:107], a[88:91], v[144:147], v[104:107]
    ds_read_b64_tr_b16 a[166:167], v43 offset:59392
    v_mul_f32 v86, v52, v86
    v_mfma_f32_16x16x32_bf16 v[120:123], a[88:91], v[152:155], v[120:123]
    ds_read_b64_tr_b16 a[176:177], v42 offset:61440
    v_mul_f32 v87, v52, v87
    v_mfma_f32_16x16x32_bf16 v[124:127], a[92:95], v[152:155], v[124:127]
    ds_read_b64_tr_b16 a[178:179], v42 offset:63488
    v_cvt_pk_bf16_f32 v80, v80, v81
    v_mfma_f32_16x16x32_bf16 v[108:111], a[92:95], v[144:147], v[108:111]
    ds_read_b64_tr_b16 a[180:181], v43 offset:61440
    v_cvt_pk_bf16_f32 v81, v82, v83
    v_mfma_f32_16x16x32_bf16 v[96:99], a[96:99], v[160:163], v[96:99]
    ds_read_b64_tr_b16 a[182:183], v43 offset:63488
    v_cvt_pk_bf16_f32 v82, v84, v85
    v_mfma_f32_16x16x32_bf16 v[112:115], a[96:99], v[168:171], v[112:115]
    ds_read_b64_tr_b16 a[136:137], v44 offset:49152
    v_cvt_pk_bf16_f32 v83, v86, v87
    v_mfma_f32_16x16x32_bf16 v[116:119], a[100:103], v[168:171], v[116:119]
    ds_read_b64_tr_b16 a[138:139], v44 offset:51200
    v_mfma_f32_16x16x32_bf16 v[100:103], a[100:103], v[160:163], v[100:103]
    ds_read_b64_tr_b16 a[140:141], v45 offset:49152
    buffer_store_dwordx4 v[80:83], v19, s[28:31], s46 offen sc1
    v_mfma_f32_16x16x32_bf16 v[104:107], a[104:107], v[160:163], v[104:107]
    ds_read_b64_tr_b16 a[142:143], v45 offset:51200
    v_mul_f32 v88, v52, v88
    v_mfma_f32_16x16x32_bf16 v[120:123], a[104:107], v[168:171], v[120:123]
    ds_read_b64_tr_b16 a[152:153], v44 offset:53248
    v_mul_f32 v89, v52, v89
    v_mfma_f32_16x16x32_bf16 v[124:127], a[108:111], v[168:171], v[124:127]
    ds_read_b64_tr_b16 a[154:155], v44 offset:55296
    v_mul_f32 v90, v52, v90
    v_mfma_f32_16x16x32_bf16 v[108:111], a[108:111], v[160:163], v[108:111]
    ds_read_b64_tr_b16 a[156:157], v45 offset:53248
    v_mul_f32 v91, v52, v91
    v_mfma_f32_16x16x32_bf16 v[96:99], a[112:115], v[176:179], v[96:99]
    ds_read_b64_tr_b16 a[158:159], v45 offset:55296
    v_mul_f32 v92, v52, v92
    v_mfma_f32_16x16x32_bf16 v[112:115], a[112:115], v[184:187], v[112:115]
    ds_read_b64_tr_b16 a[168:169], v44 offset:57344
    v_mul_f32 v93, v52, v93
    v_mfma_f32_16x16x32_bf16 v[116:119], a[116:119], v[184:187], v[116:119]
    ds_read_b64_tr_b16 a[170:171], v44 offset:59392
    v_mul_f32 v94, v52, v94
    v_mfma_f32_16x16x32_bf16 v[100:103], a[116:119], v[176:179], v[100:103]
    ds_read_b64_tr_b16 a[172:173], v45 offset:57344
    v_mul_f32 v95, v52, v95
    v_mfma_f32_16x16x32_bf16 v[104:107], a[120:123], v[176:179], v[104:107]
    ds_read_b64_tr_b16 a[174:175], v45 offset:59392
    v_cvt_pk_bf16_f32 v88, v88, v89
    v_mfma_f32_16x16x32_bf16 v[120:123], a[120:123], v[184:187], v[120:123]
    ds_read_b64_tr_b16 a[184:185], v44 offset:61440
    v_cvt_pk_bf16_f32 v89, v90, v91
    v_mfma_f32_16x16x32_bf16 v[124:127], a[124:127], v[184:187], v[124:127]
    ds_read_b64_tr_b16 a[186:187], v44 offset:63488
    v_cvt_pk_bf16_f32 v90, v92, v93
    v_mfma_f32_16x16x32_bf16 v[108:111], a[124:127], v[176:179], v[108:111]
    ds_read_b64_tr_b16 a[188:189], v45 offset:61440
    ds_read_b64_tr_b16 a[190:191], v45 offset:63488
    v_cvt_pk_bf16_f32 v91, v94, v95
    buffer_store_dwordx4 v[88:91], v19, s[28:31], s87 offen sc1
    s_add_u32 s46, s46, 0x8000
    s_add_u32 s87, s87, 0x8000
    s_waitcnt vmcnt(4) lgkmcnt(6)
    v_mfma_f32_16x16x32_bf16 v[96:99], a[128:131], v[192:195], v[96:99]
    ds_read_b64_tr_b16 a[64:65], v42 offset:0
    v_readfirstlane_b32 s54, v5
    v_mfma_f32_16x16x32_bf16 v[100:103], a[132:135], v[192:195], v[100:103]
    ds_read_b64_tr_b16 a[66:67], v42 offset:2048
    v_mov_b32 v5, 0x20
    v_mfma_f32_16x16x32_bf16 v[96:99], a[144:147], v[208:211], v[96:99]
    buffer_atomic_add v5, v2, s[64:67], 0 offen sc0
    v_mfma_f32_16x16x32_bf16 v[100:103], a[148:151], v[208:211], v[100:103]
    s_waitcnt lgkmcnt(2)
    ds_read_b64_tr_b16 a[68:69], v43 offset:0
    s_lshl_b32 s53, s52, 15
    v_mfma_f32_16x16x32_bf16 v[96:99], a[160:163], v[224:227], v[96:99]
    s_cmp_lt_u32 s52, 2
    s_cselect_b32 s47, 8, -2
    ds_read_b64_tr_b16 a[70:71], v43 offset:2048
    v_mfma_f32_16x16x32_bf16 v[100:103], a[164:167], v[224:227], v[100:103]
    s_add_u32 s47, s47, s52
    ds_read_b64_tr_b16 a[72:73], v44 offset:0
    s_lshl_b32 s47, s47, 14
    v_mfma_f32_16x16x32_bf16 v[96:99], a[176:179], v[240:243], v[96:99]
    s_add_u32 m0, s47, s32
    ds_read_b64_tr_b16 a[74:75], v44 offset:2048
    s_add_u32 s54, s54, 0x1
    v_mfma_f32_16x16x32_bf16 v[100:103], a[180:183], v[240:243], v[100:103]
    s_min_u32 s55, s52, 5
    ds_read_b64_tr_b16 a[76:77], v45 offset:0
    s_mul_i32 s55, s55, 5
    v_mfma_f32_16x16x32_bf16 v[104:107], a[136:139], v[192:195], v[104:107]
    s_add_u32 s55, s55, 4
    ds_read_b64_tr_b16 a[78:79], v45 offset:2048
    s_bitcmp1_b32 s54, s55
    s_cselect_b32 s50, 0x200000, 0
    s_addc_u32 s52, s52, 0
    v_mfma_f32_16x16x32_bf16 v[108:111], a[140:143], v[192:195], v[108:111]
    ds_read_b64_tr_b16 a[80:81], v42 offset:4096
    v_mfma_f32_16x16x32_bf16 v[104:107], a[152:155], v[208:211], v[104:107]
    ds_read_b64_tr_b16 a[82:83], v42 offset:6144
    v_mfma_f32_16x16x32_bf16 v[108:111], a[156:159], v[208:211], v[108:111]
    ds_read_b64_tr_b16 a[84:85], v43 offset:4096
    buffer_load_dwordx4 v3, s[48:51], s53 offen offset:0 sc1 lds
    v_mfma_f32_16x16x32_bf16 v[104:107], a[168:171], v[224:227], v[104:107]
    ds_read_b64_tr_b16 a[86:87], v43 offset:6144
    v_mul_f32 v96, v51, v96
    v_mfma_f32_16x16x32_bf16 v[108:111], a[172:175], v[224:227], v[108:111]
    ds_read_b64_tr_b16 a[88:89], v44 offset:4096
    buffer_load_dwordx4 v3, s[48:51], s53 offen offset:1024 sc1 lds
    v_mfma_f32_16x16x32_bf16 v[104:107], a[184:187], v[240:243], v[104:107]
    ds_read_b64_tr_b16 a[90:91], v44 offset:6144
    v_mul_f32 v97, v51, v97
    v_mfma_f32_16x16x32_bf16 v[108:111], a[188:191], v[240:243], v[108:111]
    ds_read_b64_tr_b16 a[92:93], v45 offset:4096
    buffer_load_dwordx4 v3, s[48:51], s53 offen offset:2048 sc1 lds
    v_mfma_f32_16x16x32_bf16 v[112:115], a[128:131], v[200:203], v[112:115]
    ds_read_b64_tr_b16 a[94:95], v45 offset:6144
    buffer_load_dwordx4 v3, s[48:51], s53 offen offset:3072 sc1 lds
    v_mul_f32 v98, v51, v98
    v_mfma_f32_16x16x32_bf16 v[116:119], a[132:135], v[200:203], v[116:119]
    ds_read_b64_tr_b16 a[96:97], v42 offset:8192
    v_mul_f32 v99, v51, v99
    v_mfma_f32_16x16x32_bf16 v[112:115], a[144:147], v[216:219], v[112:115]
    ds_read_b64_tr_b16 a[98:99], v42 offset:10240
    v_mul_f32 v100, v51, v100
    v_mfma_f32_16x16x32_bf16 v[116:119], a[148:151], v[216:219], v[116:119]
    ds_read_b64_tr_b16 a[100:101], v43 offset:8192
    v_mul_f32 v101, v51, v101
    v_mfma_f32_16x16x32_bf16 v[112:115], a[160:163], v[232:235], v[112:115]
    ds_read_b64_tr_b16 a[102:103], v43 offset:10240
    v_mul_f32 v102, v51, v102
    v_mfma_f32_16x16x32_bf16 v[116:119], a[164:167], v[232:235], v[116:119]
    ds_read_b64_tr_b16 a[104:105], v44 offset:8192
    v_mul_f32 v103, v51, v103
    v_mfma_f32_16x16x32_bf16 v[112:115], a[176:179], v[248:251], v[112:115]
    ds_read_b64_tr_b16 a[106:107], v44 offset:10240
    v_cvt_pk_bf16_f32 v96, v96, v97
    v_mfma_f32_16x16x32_bf16 v[116:119], a[180:183], v[248:251], v[116:119]
    ds_read_b64_tr_b16 a[108:109], v45 offset:8192
    v_cvt_pk_bf16_f32 v97, v98, v99
    v_mfma_f32_16x16x32_bf16 v[120:123], a[136:139], v[200:203], v[120:123]
    ds_read_b64_tr_b16 a[110:111], v45 offset:10240
    v_cvt_pk_bf16_f32 v98, v100, v101
    v_cvt_pk_bf16_f32 v99, v102, v103
    v_mfma_f32_16x16x32_bf16 v[124:127], a[140:143], v[200:203], v[124:127]
    ds_read_b64_tr_b16 a[112:113], v42 offset:12288
    buffer_store_dwordx4 v[96:99], v53, s[28:31], s46 offen sc1
    v_mfma_f32_16x16x32_bf16 v[120:123], a[152:155], v[216:219], v[120:123]
    ds_read_b64_tr_b16 a[114:115], v42 offset:14336
    v_mul_f32 v104, v51, v104
    v_mfma_f32_16x16x32_bf16 v[124:127], a[156:159], v[216:219], v[124:127]
    ds_read_b64_tr_b16 a[116:117], v43 offset:12288
    v_mul_f32 v105, v51, v105
    v_mfma_f32_16x16x32_bf16 v[120:123], a[168:171], v[232:235], v[120:123]
    ds_read_b64_tr_b16 a[118:119], v43 offset:14336
    v_mul_f32 v106, v51, v106
    v_mfma_f32_16x16x32_bf16 v[124:127], a[172:175], v[232:235], v[124:127]
    ds_read_b64_tr_b16 a[120:121], v44 offset:12288
    v_mul_f32 v107, v51, v107
    v_mfma_f32_16x16x32_bf16 v[120:123], a[184:187], v[248:251], v[120:123]
    ds_read_b64_tr_b16 a[122:123], v44 offset:14336
    v_mul_f32 v108, v51, v108
    v_mfma_f32_16x16x32_bf16 v[124:127], a[188:191], v[248:251], v[124:127]
    ds_read_b64_tr_b16 a[124:125], v45 offset:12288
    ds_read_b64_tr_b16 a[126:127], v45 offset:14336
    v_mul_f32 v109, v51, v109
    v_mul_f32 v110, v51, v110
    s_waitcnt lgkmcnt(6)
    v_mfma_f32_16x16x32_bf16 v[64:67], a[64:67], v[128:131], 0
    ds_read_b64_tr_b16 a[128:129], v42 offset:16384
    v_mul_f32 v111, v51, v111
    v_mfma_f32_16x16x32_bf16 v[80:83], a[64:67], v[136:139], 0
    ds_read_b64_tr_b16 a[130:131], v42 offset:18432
    v_cvt_pk_bf16_f32 v104, v104, v105
    v_mfma_f32_16x16x32_bf16 v[84:87], a[68:71], v[136:139], 0
    ds_read_b64_tr_b16 a[132:133], v43 offset:16384
    v_cvt_pk_bf16_f32 v105, v106, v107
    v_mfma_f32_16x16x32_bf16 v[68:71], a[68:71], v[128:131], 0
    s_waitcnt lgkmcnt(3)
    ds_read_b64_tr_b16 a[134:135], v43 offset:18432
    v_cvt_pk_bf16_f32 v106, v108, v109
    v_mfma_f32_16x16x32_bf16 v[72:75], a[72:75], v[128:131], 0
    ds_read_b64_tr_b16 a[144:145], v42 offset:20480
    v_cvt_pk_bf16_f32 v107, v110, v111
    v_mfma_f32_16x16x32_bf16 v[88:91], a[72:75], v[136:139], 0
    buffer_store_dwordx4 v[104:107], v53, s[28:31], s87 offen sc1
    v_mfma_f32_16x16x32_bf16 v[92:95], a[76:79], v[136:139], 0
    ds_read_b64_tr_b16 a[146:147], v42 offset:22528
    v_mul_f32 v112, v52, v112
    v_mfma_f32_16x16x32_bf16 v[76:79], a[76:79], v[128:131], 0
    ds_read_b64_tr_b16 a[148:149], v43 offset:20480
    v_mul_f32 v113, v52, v113
    v_mfma_f32_16x16x32_bf16 v[64:67], a[80:83], v[144:147], v[64:67]
    ds_read_b64_tr_b16 a[150:151], v43 offset:22528
    v_mul_f32 v114, v52, v114
    v_mfma_f32_16x16x32_bf16 v[80:83], a[80:83], v[152:155], v[80:83]
    ds_read_b64_tr_b16 a[160:161], v42 offset:24576
    v_mul_f32 v115, v52, v115
    v_mfma_f32_16x16x32_bf16 v[84:87], a[84:87], v[152:155], v[84:87]
    ds_read_b64_tr_b16 a[162:163], v42 offset:26624
    v_mul_f32 v116, v52, v116
    v_mfma_f32_16x16x32_bf16 v[68:71], a[84:87], v[144:147], v[68:71]
    ds_read_b64_tr_b16 a[164:165], v43 offset:24576
    v_mul_f32 v117, v52, v117
    v_mfma_f32_16x16x32_bf16 v[72:75], a[88:91], v[144:147], v[72:75]
    ds_read_b64_tr_b16 a[166:167], v43 offset:26624
    v_mul_f32 v118, v52, v118
    v_mfma_f32_16x16x32_bf16 v[88:91], a[88:91], v[152:155], v[88:91]
    ds_read_b64_tr_b16 a[176:177], v42 offset:28672
    v_mul_f32 v119, v52, v119
    v_mfma_f32_16x16x32_bf16 v[92:95], a[92:95], v[152:155], v[92:95]
    ds_read_b64_tr_b16 a[178:179], v42 offset:30720
    v_cvt_pk_bf16_f32 v112, v112, v113
    v_mfma_f32_16x16x32_bf16 v[76:79], a[92:95], v[144:147], v[76:79]
    ds_read_b64_tr_b16 a[180:181], v43 offset:28672
    v_cvt_pk_bf16_f32 v113, v114, v115
    v_mfma_f32_16x16x32_bf16 v[64:67], a[96:99], v[160:163], v[64:67]
    ds_read_b64_tr_b16 a[182:183], v43 offset:30720
    v_cvt_pk_bf16_f32 v114, v116, v117
    v_mfma_f32_16x16x32_bf16 v[80:83], a[96:99], v[168:171], v[80:83]
    ds_read_b64_tr_b16 a[136:137], v44 offset:16384
    v_cvt_pk_bf16_f32 v115, v118, v119
    v_mfma_f32_16x16x32_bf16 v[84:87], a[100:103], v[168:171], v[84:87]
    ds_read_b64_tr_b16 a[138:139], v44 offset:18432
    v_mfma_f32_16x16x32_bf16 v[68:71], a[100:103], v[160:163], v[68:71]
    ds_read_b64_tr_b16 a[140:141], v45 offset:16384
    buffer_store_dwordx4 v[112:115], v19, s[28:31], s46 offen sc1
    v_mfma_f32_16x16x32_bf16 v[72:75], a[104:107], v[160:163], v[72:75]
    ds_read_b64_tr_b16 a[142:143], v45 offset:18432
    v_mul_f32 v120, v52, v120
    v_mfma_f32_16x16x32_bf16 v[88:91], a[104:107], v[168:171], v[88:91]
    ds_read_b64_tr_b16 a[152:153], v44 offset:20480
    v_mul_f32 v121, v52, v121
    v_mfma_f32_16x16x32_bf16 v[92:95], a[108:111], v[168:171], v[92:95]
    ds_read_b64_tr_b16 a[154:155], v44 offset:22528
    v_mul_f32 v122, v52, v122
    v_mfma_f32_16x16x32_bf16 v[76:79], a[108:111], v[160:163], v[76:79]
    ds_read_b64_tr_b16 a[156:157], v45 offset:20480
    v_mul_f32 v123, v52, v123
    v_mfma_f32_16x16x32_bf16 v[64:67], a[112:115], v[176:179], v[64:67]
    ds_read_b64_tr_b16 a[158:159], v45 offset:22528
    v_mul_f32 v124, v52, v124
    v_mfma_f32_16x16x32_bf16 v[80:83], a[112:115], v[184:187], v[80:83]
    ds_read_b64_tr_b16 a[168:169], v44 offset:24576
    v_mul_f32 v125, v52, v125
    v_mfma_f32_16x16x32_bf16 v[84:87], a[116:119], v[184:187], v[84:87]
    ds_read_b64_tr_b16 a[170:171], v44 offset:26624
    v_mul_f32 v126, v52, v126
    v_mfma_f32_16x16x32_bf16 v[68:71], a[116:119], v[176:179], v[68:71]
    ds_read_b64_tr_b16 a[172:173], v45 offset:24576
    v_mul_f32 v127, v52, v127
    v_mfma_f32_16x16x32_bf16 v[72:75], a[120:123], v[176:179], v[72:75]
    ds_read_b64_tr_b16 a[174:175], v45 offset:26624
    v_cvt_pk_bf16_f32 v120, v120, v121
    v_mfma_f32_16x16x32_bf16 v[88:91], a[120:123], v[184:187], v[88:91]
    ds_read_b64_tr_b16 a[184:185], v44 offset:28672
    v_cvt_pk_bf16_f32 v121, v122, v123
    v_mfma_f32_16x16x32_bf16 v[92:95], a[124:127], v[184:187], v[92:95]
    ds_read_b64_tr_b16 a[186:187], v44 offset:30720
    v_cvt_pk_bf16_f32 v122, v124, v125
    v_mfma_f32_16x16x32_bf16 v[76:79], a[124:127], v[176:179], v[76:79]
    ds_read_b64_tr_b16 a[188:189], v45 offset:28672
    ds_read_b64_tr_b16 a[190:191], v45 offset:30720
    v_cvt_pk_bf16_f32 v123, v126, v127
    buffer_store_dwordx4 v[120:123], v19, s[28:31], s87 offen sc1
    s_add_u32 s46, s46, 0x8000
    s_add_u32 s87, s87, 0x8000
    s_waitcnt vmcnt(8) lgkmcnt(6)
    v_mfma_f32_16x16x32_bf16 v[64:67], a[128:131], v[192:195], v[64:67]
    ds_read_b64_tr_b16 a[64:65], v20 offset:0
    v_readfirstlane_b32 s54, v5
    v_mfma_f32_16x16x32_bf16 v[68:71], a[132:135], v[192:195], v[68:71]
    ds_read_b64_tr_b16 a[66:67], v20 offset:2048
    v_mov_b32 v5, 0x400
    v_mfma_f32_16x16x32_bf16 v[64:67], a[144:147], v[208:211], v[64:67]
    buffer_atomic_add v5, v2, s[64:67], 0 offen sc0
    v_mfma_f32_16x16x32_bf16 v[68:71], a[148:151], v[208:211], v[68:71]
    s_waitcnt lgkmcnt(2)
    ds_read_b64_tr_b16 a[68:69], v21 offset:0
    s_lshl_b32 s53, s52, 15
    v_mfma_f32_16x16x32_bf16 v[64:67], a[160:163], v[224:227], v[64:67]
    s_cmp_lt_u32 s52, 2
    s_cselect_b32 s47, 8, -2
    ds_read_b64_tr_b16 a[70:71], v21 offset:2048
    v_mfma_f32_16x16x32_bf16 v[68:71], a[164:167], v[224:227], v[68:71]
    s_add_u32 s47, s47, s52
    ds_read_b64_tr_b16 a[72:73], v22 offset:0
    s_lshl_b32 s47, s47, 14
    v_mfma_f32_16x16x32_bf16 v[64:67], a[176:179], v[240:243], v[64:67]
    s_add_u32 m0, s47, s32
    ds_read_b64_tr_b16 a[74:75], v22 offset:2048
    s_add_u32 s54, s54, 0x20
    v_mfma_f32_16x16x32_bf16 v[68:71], a[180:183], v[240:243], v[68:71]
    s_min_u32 s55, s52, 5
    ds_read_b64_tr_b16 a[76:77], v23 offset:0
    s_mul_i32 s55, s55, 5
    v_mfma_f32_16x16x32_bf16 v[72:75], a[136:139], v[192:195], v[72:75]
    s_add_u32 s55, s55, 4
    ds_read_b64_tr_b16 a[78:79], v23 offset:2048
    s_bitcmp1_b32 s54, s55
    s_cselect_b32 s50, 0x200000, 0
    s_addc_u32 s52, s52, 0
    v_mfma_f32_16x16x32_bf16 v[76:79], a[140:143], v[192:195], v[76:79]
    ds_read_b64_tr_b16 a[80:81], v20 offset:4096
    v_mfma_f32_16x16x32_bf16 v[72:75], a[152:155], v[208:211], v[72:75]
    ds_read_b64_tr_b16 a[82:83], v20 offset:6144
    v_mfma_f32_16x16x32_bf16 v[76:79], a[156:159], v[208:211], v[76:79]
    ds_read_b64_tr_b16 a[84:85], v21 offset:4096
    buffer_load_dwordx4 v3, s[48:51], s53 offen offset:0 sc1 lds
    v_mfma_f32_16x16x32_bf16 v[72:75], a[168:171], v[224:227], v[72:75]
    ds_read_b64_tr_b16 a[86:87], v21 offset:6144
    v_mul_f32 v64, v51, v64
    v_mfma_f32_16x16x32_bf16 v[76:79], a[172:175], v[224:227], v[76:79]
    ds_read_b64_tr_b16 a[88:89], v22 offset:4096
    buffer_load_dwordx4 v3, s[48:51], s53 offen offset:1024 sc1 lds
    v_mfma_f32_16x16x32_bf16 v[72:75], a[184:187], v[240:243], v[72:75]
    ds_read_b64_tr_b16 a[90:91], v22 offset:6144
    v_mul_f32 v65, v51, v65
    v_mfma_f32_16x16x32_bf16 v[76:79], a[188:191], v[240:243], v[76:79]
    ds_read_b64_tr_b16 a[92:93], v23 offset:4096
    buffer_load_dwordx4 v3, s[48:51], s53 offen offset:2048 sc1 lds
    v_mfma_f32_16x16x32_bf16 v[80:83], a[128:131], v[200:203], v[80:83]
    ds_read_b64_tr_b16 a[94:95], v23 offset:6144
    buffer_load_dwordx4 v3, s[48:51], s53 offen offset:3072 sc1 lds
    v_mul_f32 v66, v51, v66
    v_mfma_f32_16x16x32_bf16 v[84:87], a[132:135], v[200:203], v[84:87]
    ds_read_b64_tr_b16 a[96:97], v20 offset:8192
    v_mul_f32 v67, v51, v67
    v_mfma_f32_16x16x32_bf16 v[80:83], a[144:147], v[216:219], v[80:83]
    ds_read_b64_tr_b16 a[98:99], v20 offset:10240
    v_mul_f32 v68, v51, v68
    v_mfma_f32_16x16x32_bf16 v[84:87], a[148:151], v[216:219], v[84:87]
    ds_read_b64_tr_b16 a[100:101], v21 offset:8192
    v_mul_f32 v69, v51, v69
    v_mfma_f32_16x16x32_bf16 v[80:83], a[160:163], v[232:235], v[80:83]
    ds_read_b64_tr_b16 a[102:103], v21 offset:10240
    v_mul_f32 v70, v51, v70
    v_mfma_f32_16x16x32_bf16 v[84:87], a[164:167], v[232:235], v[84:87]
    ds_read_b64_tr_b16 a[104:105], v22 offset:8192
    v_mul_f32 v71, v51, v71
    v_mfma_f32_16x16x32_bf16 v[80:83], a[176:179], v[248:251], v[80:83]
    ds_read_b64_tr_b16 a[106:107], v22 offset:10240
    v_cvt_pk_bf16_f32 v64, v64, v65
    v_mfma_f32_16x16x32_bf16 v[84:87], a[180:183], v[248:251], v[84:87]
    ds_read_b64_tr_b16 a[108:109], v23 offset:8192
    v_cvt_pk_bf16_f32 v65, v66, v67
    v_mfma_f32_16x16x32_bf16 v[88:91], a[136:139], v[200:203], v[88:91]
    ds_read_b64_tr_b16 a[110:111], v23 offset:10240
    v_cvt_pk_bf16_f32 v66, v68, v69
    v_cvt_pk_bf16_f32 v67, v70, v71
    v_mfma_f32_16x16x32_bf16 v[92:95], a[140:143], v[200:203], v[92:95]
    ds_read_b64_tr_b16 a[112:113], v20 offset:12288
    buffer_store_dwordx4 v[64:67], v53, s[28:31], s46 offen sc1
    v_mfma_f32_16x16x32_bf16 v[88:91], a[152:155], v[216:219], v[88:91]
    ds_read_b64_tr_b16 a[114:115], v20 offset:14336
    v_mul_f32 v72, v51, v72
    v_mfma_f32_16x16x32_bf16 v[92:95], a[156:159], v[216:219], v[92:95]
    ds_read_b64_tr_b16 a[116:117], v21 offset:12288
    v_mul_f32 v73, v51, v73
    v_mfma_f32_16x16x32_bf16 v[88:91], a[168:171], v[232:235], v[88:91]
    ds_read_b64_tr_b16 a[118:119], v21 offset:14336
    v_mul_f32 v74, v51, v74
    v_mfma_f32_16x16x32_bf16 v[92:95], a[172:175], v[232:235], v[92:95]
    ds_read_b64_tr_b16 a[120:121], v22 offset:12288
    v_mul_f32 v75, v51, v75
    v_mfma_f32_16x16x32_bf16 v[88:91], a[184:187], v[248:251], v[88:91]
    ds_read_b64_tr_b16 a[122:123], v22 offset:14336
    v_mul_f32 v76, v51, v76
    v_mfma_f32_16x16x32_bf16 v[92:95], a[188:191], v[248:251], v[92:95]
    ds_read_b64_tr_b16 a[124:125], v23 offset:12288
    ds_read_b64_tr_b16 a[126:127], v23 offset:14336
    v_mul_f32 v77, v51, v77
    v_mul_f32 v78, v51, v78
    s_waitcnt lgkmcnt(6)
    s_barrier
    v_mfma_f32_16x16x32_bf16 v[96:99], a[64:67], v[128:131], 0
    ds_read_b64_tr_b16 a[128:129], v20 offset:16384
    v_mul_f32 v79, v51, v79
    v_mfma_f32_16x16x32_bf16 v[112:115], a[64:67], v[136:139], 0
    ds_read_b64_tr_b16 a[130:131], v20 offset:18432
    v_cvt_pk_bf16_f32 v72, v72, v73
    v_mfma_f32_16x16x32_bf16 v[116:119], a[68:71], v[136:139], 0
    ds_read_b64_tr_b16 a[132:133], v21 offset:16384
    v_cvt_pk_bf16_f32 v73, v74, v75
    v_mfma_f32_16x16x32_bf16 v[100:103], a[68:71], v[128:131], 0
    s_waitcnt lgkmcnt(3)
    ds_read_b64_tr_b16 a[134:135], v21 offset:18432
    v_cvt_pk_bf16_f32 v74, v76, v77
    v_mfma_f32_16x16x32_bf16 v[104:107], a[72:75], v[128:131], 0
    ds_read_b64_tr_b16 a[144:145], v20 offset:20480
    v_cvt_pk_bf16_f32 v75, v78, v79
    v_mfma_f32_16x16x32_bf16 v[120:123], a[72:75], v[136:139], 0
    buffer_store_dwordx4 v[72:75], v53, s[28:31], s87 offen sc1
    v_mfma_f32_16x16x32_bf16 v[124:127], a[76:79], v[136:139], 0
    ds_read_b64_tr_b16 a[146:147], v20 offset:22528
    v_mul_f32 v80, v52, v80
    v_mfma_f32_16x16x32_bf16 v[108:111], a[76:79], v[128:131], 0
    ds_read_b64_tr_b16 a[148:149], v21 offset:20480
    v_mul_f32 v81, v52, v81
    v_mfma_f32_16x16x32_bf16 v[96:99], a[80:83], v[144:147], v[96:99]
    ds_read_b64_tr_b16 a[150:151], v21 offset:22528
    v_mul_f32 v82, v52, v82
    v_mfma_f32_16x16x32_bf16 v[112:115], a[80:83], v[152:155], v[112:115]
    ds_read_b64_tr_b16 a[160:161], v20 offset:24576
    v_mul_f32 v83, v52, v83
    v_mfma_f32_16x16x32_bf16 v[116:119], a[84:87], v[152:155], v[116:119]
    ds_read_b64_tr_b16 a[162:163], v20 offset:26624
    v_mul_f32 v84, v52, v84
    v_mfma_f32_16x16x32_bf16 v[100:103], a[84:87], v[144:147], v[100:103]
    ds_read_b64_tr_b16 a[164:165], v21 offset:24576
    v_mul_f32 v85, v52, v85
    v_mfma_f32_16x16x32_bf16 v[104:107], a[88:91], v[144:147], v[104:107]
    ds_read_b64_tr_b16 a[166:167], v21 offset:26624
    v_mul_f32 v86, v52, v86
    v_mfma_f32_16x16x32_bf16 v[120:123], a[88:91], v[152:155], v[120:123]
    ds_read_b64_tr_b16 a[176:177], v20 offset:28672
    v_mul_f32 v87, v52, v87
    v_mfma_f32_16x16x32_bf16 v[124:127], a[92:95], v[152:155], v[124:127]
    ds_read_b64_tr_b16 a[178:179], v20 offset:30720
    v_cvt_pk_bf16_f32 v80, v80, v81
    v_mfma_f32_16x16x32_bf16 v[108:111], a[92:95], v[144:147], v[108:111]
    ds_read_b64_tr_b16 a[180:181], v21 offset:28672
    v_cvt_pk_bf16_f32 v81, v82, v83
    v_mfma_f32_16x16x32_bf16 v[96:99], a[96:99], v[160:163], v[96:99]
    ds_read_b64_tr_b16 a[182:183], v21 offset:30720
    v_cvt_pk_bf16_f32 v82, v84, v85
    v_mfma_f32_16x16x32_bf16 v[112:115], a[96:99], v[168:171], v[112:115]
    ds_read_b64_tr_b16 a[136:137], v22 offset:16384
    v_cvt_pk_bf16_f32 v83, v86, v87
    v_mfma_f32_16x16x32_bf16 v[116:119], a[100:103], v[168:171], v[116:119]
    ds_read_b64_tr_b16 a[138:139], v22 offset:18432
    v_mfma_f32_16x16x32_bf16 v[100:103], a[100:103], v[160:163], v[100:103]
    ds_read_b64_tr_b16 a[140:141], v23 offset:16384
    buffer_store_dwordx4 v[80:83], v19, s[28:31], s46 offen sc1
    v_mfma_f32_16x16x32_bf16 v[104:107], a[104:107], v[160:163], v[104:107]
    ds_read_b64_tr_b16 a[142:143], v23 offset:18432
    v_mul_f32 v88, v52, v88
    v_mfma_f32_16x16x32_bf16 v[120:123], a[104:107], v[168:171], v[120:123]
    ds_read_b64_tr_b16 a[152:153], v22 offset:20480
    v_mul_f32 v89, v52, v89
    v_mfma_f32_16x16x32_bf16 v[124:127], a[108:111], v[168:171], v[124:127]
    ds_read_b64_tr_b16 a[154:155], v22 offset:22528
    v_mul_f32 v90, v52, v90
    v_mfma_f32_16x16x32_bf16 v[108:111], a[108:111], v[160:163], v[108:111]
    ds_read_b64_tr_b16 a[156:157], v23 offset:20480
    v_mul_f32 v91, v52, v91
    v_mfma_f32_16x16x32_bf16 v[96:99], a[112:115], v[176:179], v[96:99]
    ds_read_b64_tr_b16 a[158:159], v23 offset:22528
    v_mul_f32 v92, v52, v92
    v_mfma_f32_16x16x32_bf16 v[112:115], a[112:115], v[184:187], v[112:115]
    ds_read_b64_tr_b16 a[168:169], v22 offset:24576
    v_mul_f32 v93, v52, v93
    v_mfma_f32_16x16x32_bf16 v[116:119], a[116:119], v[184:187], v[116:119]
    ds_read_b64_tr_b16 a[170:171], v22 offset:26624
    v_mul_f32 v94, v52, v94
    v_mfma_f32_16x16x32_bf16 v[100:103], a[116:119], v[176:179], v[100:103]
    ds_read_b64_tr_b16 a[172:173], v23 offset:24576
    v_mul_f32 v95, v52, v95
    v_mfma_f32_16x16x32_bf16 v[104:107], a[120:123], v[176:179], v[104:107]
    ds_read_b64_tr_b16 a[174:175], v23 offset:26624
    v_cvt_pk_bf16_f32 v88, v88, v89
    v_mfma_f32_16x16x32_bf16 v[120:123], a[120:123], v[184:187], v[120:123]
    ds_read_b64_tr_b16 a[184:185], v22 offset:28672
    v_cvt_pk_bf16_f32 v89, v90, v91
    v_mfma_f32_16x16x32_bf16 v[124:127], a[124:127], v[184:187], v[124:127]
    ds_read_b64_tr_b16 a[186:187], v22 offset:30720
    v_cvt_pk_bf16_f32 v90, v92, v93
    v_mfma_f32_16x16x32_bf16 v[108:111], a[124:127], v[176:179], v[108:111]
    ds_read_b64_tr_b16 a[188:189], v23 offset:28672
    ds_read_b64_tr_b16 a[190:191], v23 offset:30720
    v_cvt_pk_bf16_f32 v91, v94, v95
    buffer_store_dwordx4 v[88:91], v19, s[28:31], s87 offen sc1
    s_add_u32 s46, s46, 0x8000
    s_add_u32 s87, s87, 0x8000
    s_waitcnt vmcnt(8) lgkmcnt(6)
    v_mfma_f32_16x16x32_bf16 v[96:99], a[128:131], v[192:195], v[96:99]
    ds_read_b64_tr_b16 a[64:65], v20 offset:32768
    v_readfirstlane_b32 s54, v5
    v_mfma_f32_16x16x32_bf16 v[100:103], a[132:135], v[192:195], v[100:103]
    ds_read_b64_tr_b16 a[66:67], v20 offset:34816
    v_mov_b32 v5, 0x8000
    v_mfma_f32_16x16x32_bf16 v[96:99], a[144:147], v[208:211], v[96:99]
    buffer_atomic_add v5, v2, s[64:67], 0 offen sc0
    v_mfma_f32_16x16x32_bf16 v[100:103], a[148:151], v[208:211], v[100:103]
    s_waitcnt lgkmcnt(2)
    ds_read_b64_tr_b16 a[68:69], v21 offset:32768
    s_lshl_b32 s53, s52, 15
    v_mfma_f32_16x16x32_bf16 v[96:99], a[160:163], v[224:227], v[96:99]
    s_cmp_lt_u32 s52, 2
    s_cselect_b32 s47, 8, -2
    ds_read_b64_tr_b16 a[70:71], v21 offset:34816
    v_mfma_f32_16x16x32_bf16 v[100:103], a[164:167], v[224:227], v[100:103]
    s_add_u32 s47, s47, s52
    ds_read_b64_tr_b16 a[72:73], v22 offset:32768
    s_lshl_b32 s47, s47, 14
    v_mfma_f32_16x16x32_bf16 v[96:99], a[176:179], v[240:243], v[96:99]
    s_add_u32 m0, s47, s32
    ds_read_b64_tr_b16 a[74:75], v22 offset:34816
    s_add_u32 s54, s54, 0x400
    v_mfma_f32_16x16x32_bf16 v[100:103], a[180:183], v[240:243], v[100:103]
    s_min_u32 s55, s52, 5
    ds_read_b64_tr_b16 a[76:77], v23 offset:32768
    s_mul_i32 s55, s55, 5
    v_mfma_f32_16x16x32_bf16 v[104:107], a[136:139], v[192:195], v[104:107]
    s_add_u32 s55, s55, 4
    ds_read_b64_tr_b16 a[78:79], v23 offset:34816
    s_bitcmp1_b32 s54, s55
    s_cselect_b32 s50, 0x200000, 0
    s_addc_u32 s52, s52, 0
    v_mfma_f32_16x16x32_bf16 v[108:111], a[140:143], v[192:195], v[108:111]
    ds_read_b64_tr_b16 a[80:81], v20 offset:36864
    v_mfma_f32_16x16x32_bf16 v[104:107], a[152:155], v[208:211], v[104:107]
    ds_read_b64_tr_b16 a[82:83], v20 offset:38912
    v_mfma_f32_16x16x32_bf16 v[108:111], a[156:159], v[208:211], v[108:111]
    ds_read_b64_tr_b16 a[84:85], v21 offset:36864
    buffer_load_dwordx4 v3, s[48:51], s53 offen offset:0 sc1 lds
    v_mfma_f32_16x16x32_bf16 v[104:107], a[168:171], v[224:227], v[104:107]
    ds_read_b64_tr_b16 a[86:87], v21 offset:38912
    v_mul_f32 v96, v51, v96
    v_mfma_f32_16x16x32_bf16 v[108:111], a[172:175], v[224:227], v[108:111]
    ds_read_b64_tr_b16 a[88:89], v22 offset:36864
    buffer_load_dwordx4 v3, s[48:51], s53 offen offset:1024 sc1 lds
    v_mfma_f32_16x16x32_bf16 v[104:107], a[184:187], v[240:243], v[104:107]
    ds_read_b64_tr_b16 a[90:91], v22 offset:38912
    v_mul_f32 v97, v51, v97
    v_mfma_f32_16x16x32_bf16 v[108:111], a[188:191], v[240:243], v[108:111]
    ds_read_b64_tr_b16 a[92:93], v23 offset:36864
    buffer_load_dwordx4 v3, s[48:51], s53 offen offset:2048 sc1 lds
    v_mfma_f32_16x16x32_bf16 v[112:115], a[128:131], v[200:203], v[112:115]
    ds_read_b64_tr_b16 a[94:95], v23 offset:38912
    buffer_load_dwordx4 v3, s[48:51], s53 offen offset:3072 sc1 lds
    v_mul_f32 v98, v51, v98
    v_mfma_f32_16x16x32_bf16 v[116:119], a[132:135], v[200:203], v[116:119]
    ds_read_b64_tr_b16 a[96:97], v20 offset:40960
    v_mul_f32 v99, v51, v99
    v_mfma_f32_16x16x32_bf16 v[112:115], a[144:147], v[216:219], v[112:115]
    ds_read_b64_tr_b16 a[98:99], v20 offset:43008
    v_mul_f32 v100, v51, v100
    v_mfma_f32_16x16x32_bf16 v[116:119], a[148:151], v[216:219], v[116:119]
    ds_read_b64_tr_b16 a[100:101], v21 offset:40960
    v_mul_f32 v101, v51, v101
    v_mfma_f32_16x16x32_bf16 v[112:115], a[160:163], v[232:235], v[112:115]
    ds_read_b64_tr_b16 a[102:103], v21 offset:43008
    v_mul_f32 v102, v51, v102
    v_mfma_f32_16x16x32_bf16 v[116:119], a[164:167], v[232:235], v[116:119]
    ds_read_b64_tr_b16 a[104:105], v22 offset:40960
    v_mul_f32 v103, v51, v103
    v_mfma_f32_16x16x32_bf16 v[112:115], a[176:179], v[248:251], v[112:115]
    ds_read_b64_tr_b16 a[106:107], v22 offset:43008
    v_cvt_pk_bf16_f32 v96, v96, v97
    v_mfma_f32_16x16x32_bf16 v[116:119], a[180:183], v[248:251], v[116:119]
    ds_read_b64_tr_b16 a[108:109], v23 offset:40960
    v_cvt_pk_bf16_f32 v97, v98, v99
    v_mfma_f32_16x16x32_bf16 v[120:123], a[136:139], v[200:203], v[120:123]
    ds_read_b64_tr_b16 a[110:111], v23 offset:43008
    v_cvt_pk_bf16_f32 v98, v100, v101
    v_cvt_pk_bf16_f32 v99, v102, v103
    v_mfma_f32_16x16x32_bf16 v[124:127], a[140:143], v[200:203], v[124:127]
    ds_read_b64_tr_b16 a[112:113], v20 offset:45056
    buffer_store_dwordx4 v[96:99], v53, s[28:31], s46 offen sc1
    v_mfma_f32_16x16x32_bf16 v[120:123], a[152:155], v[216:219], v[120:123]
    ds_read_b64_tr_b16 a[114:115], v20 offset:47104
    v_mul_f32 v104, v51, v104
    v_mfma_f32_16x16x32_bf16 v[124:127], a[156:159], v[216:219], v[124:127]
    ds_read_b64_tr_b16 a[116:117], v21 offset:45056
    v_mul_f32 v105, v51, v105
    v_mfma_f32_16x16x32_bf16 v[120:123], a[168:171], v[232:235], v[120:123]
    ds_read_b64_tr_b16 a[118:119], v21 offset:47104
    v_mul_f32 v106, v51, v106
    v_mfma_f32_16x16x32_bf16 v[124:127], a[172:175], v[232:235], v[124:127]
    ds_read_b64_tr_b16 a[120:121], v22 offset:45056
    v_mul_f32 v107, v51, v107
    v_mfma_f32_16x16x32_bf16 v[120:123], a[184:187], v[248:251], v[120:123]
    ds_read_b64_tr_b16 a[122:123], v22 offset:47104
    v_mul_f32 v108, v51, v108
    v_mfma_f32_16x16x32_bf16 v[124:127], a[188:191], v[248:251], v[124:127]
    ds_read_b64_tr_b16 a[124:125], v23 offset:45056
    ds_read_b64_tr_b16 a[126:127], v23 offset:47104
    v_mul_f32 v109, v51, v109
    v_mul_f32 v110, v51, v110
    s_waitcnt lgkmcnt(6)
    v_mfma_f32_16x16x32_bf16 v[64:67], a[64:67], v[128:131], 0
    ds_read_b64_tr_b16 a[128:129], v20 offset:49152
    v_mul_f32 v111, v51, v111
    v_mfma_f32_16x16x32_bf16 v[80:83], a[64:67], v[136:139], 0
    ds_read_b64_tr_b16 a[130:131], v20 offset:51200
    v_cvt_pk_bf16_f32 v104, v104, v105
    v_mfma_f32_16x16x32_bf16 v[84:87], a[68:71], v[136:139], 0
    ds_read_b64_tr_b16 a[132:133], v21 offset:49152
    v_cvt_pk_bf16_f32 v105, v106, v107
    v_mfma_f32_16x16x32_bf16 v[68:71], a[68:71], v[128:131], 0
    s_waitcnt lgkmcnt(3)
    ds_read_b64_tr_b16 a[134:135], v21 offset:51200
    v_cvt_pk_bf16_f32 v106, v108, v109
    v_mfma_f32_16x16x32_bf16 v[72:75], a[72:75], v[128:131], 0
    ds_read_b64_tr_b16 a[144:145], v20 offset:53248
    v_cvt_pk_bf16_f32 v107, v110, v111
    v_mfma_f32_16x16x32_bf16 v[88:91], a[72:75], v[136:139], 0
    buffer_store_dwordx4 v[104:107], v53, s[28:31], s87 offen sc1
    v_mfma_f32_16x16x32_bf16 v[92:95], a[76:79], v[136:139], 0
    ds_read_b64_tr_b16 a[146:147], v20 offset:55296
    v_mul_f32 v112, v52, v112
    v_mfma_f32_16x16x32_bf16 v[76:79], a[76:79], v[128:131], 0
    ds_read_b64_tr_b16 a[148:149], v21 offset:53248
    v_mul_f32 v113, v52, v113
    v_mfma_f32_16x16x32_bf16 v[64:67], a[80:83], v[144:147], v[64:67]
    ds_read_b64_tr_b16 a[150:151], v21 offset:55296
    v_mul_f32 v114, v52, v114
    v_mfma_f32_16x16x32_bf16 v[80:83], a[80:83], v[152:155], v[80:83]
    ds_read_b64_tr_b16 a[160:161], v20 offset:57344
    v_mul_f32 v115, v52, v115
    v_mfma_f32_16x16x32_bf16 v[84:87], a[84:87], v[152:155], v[84:87]
    ds_read_b64_tr_b16 a[162:163], v20 offset:59392
    v_mul_f32 v116, v52, v116
    v_mfma_f32_16x16x32_bf16 v[68:71], a[84:87], v[144:147], v[68:71]
    ds_read_b64_tr_b16 a[164:165], v21 offset:57344
    v_mul_f32 v117, v52, v117
    v_mfma_f32_16x16x32_bf16 v[72:75], a[88:91], v[144:147], v[72:75]
    ds_read_b64_tr_b16 a[166:167], v21 offset:59392
    v_mul_f32 v118, v52, v118
    v_mfma_f32_16x16x32_bf16 v[88:91], a[88:91], v[152:155], v[88:91]
    ds_read_b64_tr_b16 a[176:177], v20 offset:61440
    v_mul_f32 v119, v52, v119
    v_mfma_f32_16x16x32_bf16 v[92:95], a[92:95], v[152:155], v[92:95]
    ds_read_b64_tr_b16 a[178:179], v20 offset:63488
    v_cvt_pk_bf16_f32 v112, v112, v113
    v_mfma_f32_16x16x32_bf16 v[76:79], a[92:95], v[144:147], v[76:79]
    ds_read_b64_tr_b16 a[180:181], v21 offset:61440
    v_cvt_pk_bf16_f32 v113, v114, v115
    v_mfma_f32_16x16x32_bf16 v[64:67], a[96:99], v[160:163], v[64:67]
    ds_read_b64_tr_b16 a[182:183], v21 offset:63488
    v_cvt_pk_bf16_f32 v114, v116, v117
    v_mfma_f32_16x16x32_bf16 v[80:83], a[96:99], v[168:171], v[80:83]
    ds_read_b64_tr_b16 a[136:137], v22 offset:49152
    v_cvt_pk_bf16_f32 v115, v118, v119
    v_mfma_f32_16x16x32_bf16 v[84:87], a[100:103], v[168:171], v[84:87]
    ds_read_b64_tr_b16 a[138:139], v22 offset:51200
    v_mfma_f32_16x16x32_bf16 v[68:71], a[100:103], v[160:163], v[68:71]
    ds_read_b64_tr_b16 a[140:141], v23 offset:49152
    buffer_store_dwordx4 v[112:115], v19, s[28:31], s46 offen sc1
    v_mfma_f32_16x16x32_bf16 v[72:75], a[104:107], v[160:163], v[72:75]
    ds_read_b64_tr_b16 a[142:143], v23 offset:51200
    v_mul_f32 v120, v52, v120
    v_mfma_f32_16x16x32_bf16 v[88:91], a[104:107], v[168:171], v[88:91]
    ds_read_b64_tr_b16 a[152:153], v22 offset:53248
    v_mul_f32 v121, v52, v121
    v_mfma_f32_16x16x32_bf16 v[92:95], a[108:111], v[168:171], v[92:95]
    ds_read_b64_tr_b16 a[154:155], v22 offset:55296
    v_mul_f32 v122, v52, v122
    v_mfma_f32_16x16x32_bf16 v[76:79], a[108:111], v[160:163], v[76:79]
    ds_read_b64_tr_b16 a[156:157], v23 offset:53248
    v_mul_f32 v123, v52, v123
    v_mfma_f32_16x16x32_bf16 v[64:67], a[112:115], v[176:179], v[64:67]
    ds_read_b64_tr_b16 a[158:159], v23 offset:55296
    v_mul_f32 v124, v52, v124
    v_mfma_f32_16x16x32_bf16 v[80:83], a[112:115], v[184:187], v[80:83]
    ds_read_b64_tr_b16 a[168:169], v22 offset:57344
    v_mul_f32 v125, v52, v125
    v_mfma_f32_16x16x32_bf16 v[84:87], a[116:119], v[184:187], v[84:87]
    ds_read_b64_tr_b16 a[170:171], v22 offset:59392
    v_mul_f32 v126, v52, v126
    v_mfma_f32_16x16x32_bf16 v[68:71], a[116:119], v[176:179], v[68:71]
    ds_read_b64_tr_b16 a[172:173], v23 offset:57344
    v_mul_f32 v127, v52, v127
    v_mfma_f32_16x16x32_bf16 v[72:75], a[120:123], v[176:179], v[72:75]
    ds_read_b64_tr_b16 a[174:175], v23 offset:59392
    v_cvt_pk_bf16_f32 v120, v120, v121
    v_mfma_f32_16x16x32_bf16 v[88:91], a[120:123], v[184:187], v[88:91]
    ds_read_b64_tr_b16 a[184:185], v22 offset:61440
    v_cvt_pk_bf16_f32 v121, v122, v123
    v_mfma_f32_16x16x32_bf16 v[92:95], a[124:127], v[184:187], v[92:95]
    ds_read_b64_tr_b16 a[186:187], v22 offset:63488
    v_cvt_pk_bf16_f32 v122, v124, v125
    v_mfma_f32_16x16x32_bf16 v[76:79], a[124:127], v[176:179], v[76:79]
    ds_read_b64_tr_b16 a[188:189], v23 offset:61440
    ds_read_b64_tr_b16 a[190:191], v23 offset:63488
    v_cvt_pk_bf16_f32 v123, v126, v127
    buffer_store_dwordx4 v[120:123], v19, s[28:31], s87 offen sc1
    s_add_u32 s46, s46, 0x8000
    s_add_u32 s87, s87, 0x8000
    s_waitcnt vmcnt(8) lgkmcnt(6)
    v_mfma_f32_16x16x32_bf16 v[64:67], a[128:131], v[192:195], v[64:67]
    v_readfirstlane_b32 s54, v5
    v_mov_b32 v5, 0x100000
    v_mfma_f32_16x16x32_bf16 v[68:71], a[132:135], v[192:195], v[68:71]
    buffer_atomic_add v5, v2, s[64:67], 0 offen sc0
    v_mfma_f32_16x16x32_bf16 v[64:67], a[144:147], v[208:211], v[64:67]
    s_lshl_b32 s53, s52, 15
    s_cmp_lt_u32 s52, 2
    s_cselect_b32 s47, 8, -2
    v_mfma_f32_16x16x32_bf16 v[68:71], a[148:151], v[208:211], v[68:71]
    s_waitcnt lgkmcnt(0)
    v_mfma_f32_16x16x32_bf16 v[64:67], a[160:163], v[224:227], v[64:67]
    s_add_u32 s47, s47, s52
    s_lshl_b32 s47, s47, 14
    s_add_u32 m0, s47, s32
    v_mfma_f32_16x16x32_bf16 v[68:71], a[164:167], v[224:227], v[68:71]
    s_add_u32 s54, s54, 0x8000
    s_min_u32 s55, s52, 5
    s_mul_i32 s55, s55, 5
    v_mfma_f32_16x16x32_bf16 v[64:67], a[176:179], v[240:243], v[64:67]
    s_add_u32 s55, s55, 4
    s_bitcmp1_b32 s54, s55
    s_cselect_b32 s50, 0x200000, 0
    s_addc_u32 s52, s52, 0
    v_mfma_f32_16x16x32_bf16 v[68:71], a[180:183], v[240:243], v[68:71]
    v_mfma_f32_16x16x32_bf16 v[72:75], a[136:139], v[192:195], v[72:75]
    buffer_load_dwordx4 v3, s[48:51], s53 offen offset:0 sc1 lds
    v_mfma_f32_16x16x32_bf16 v[76:79], a[140:143], v[192:195], v[76:79]
    v_mfma_f32_16x16x32_bf16 v[72:75], a[152:155], v[208:211], v[72:75]
    buffer_load_dwordx4 v3, s[48:51], s53 offen offset:1024 sc1 lds
    v_mfma_f32_16x16x32_bf16 v[76:79], a[156:159], v[208:211], v[76:79]
    s_nop 3
    v_mfma_f32_16x16x32_bf16 v[72:75], a[168:171], v[224:227], v[72:75]
    v_mul_f32 v64, v51, v64
    v_mul_f32 v65, v51, v65
    v_mfma_f32_16x16x32_bf16 v[76:79], a[172:175], v[224:227], v[76:79]
    buffer_load_dwordx4 v3, s[48:51], s53 offen offset:2048 sc1 lds
    v_mfma_f32_16x16x32_bf16 v[72:75], a[184:187], v[240:243], v[72:75]
    v_mul_f32 v66, v51, v66
    v_mul_f32 v67, v51, v67
    v_mfma_f32_16x16x32_bf16 v[76:79], a[188:191], v[240:243], v[76:79]
    v_mul_f32 v68, v51, v68
    v_mul_f32 v69, v51, v69
    v_mfma_f32_16x16x32_bf16 v[80:83], a[128:131], v[200:203], v[80:83]
    buffer_load_dwordx4 v3, s[48:51], s53 offen offset:3072 sc1 lds
    v_mfma_f32_16x16x32_bf16 v[84:87], a[132:135], v[200:203], v[84:87]
    v_mul_f32 v70, v51, v70
    v_mul_f32 v71, v51, v71
    v_mfma_f32_16x16x32_bf16 v[80:83], a[144:147], v[216:219], v[80:83]
    v_cvt_pk_bf16_f32 v64, v64, v65
    v_cvt_pk_bf16_f32 v65, v66, v67
    v_cvt_pk_bf16_f32 v66, v68, v69
    v_cvt_pk_bf16_f32 v67, v70, v71
    buffer_store_dwordx4 v[64:67], v53, s[28:31], s46 offen sc1
    v_mfma_f32_16x16x32_bf16 v[84:87], a[148:151], v[216:219], v[84:87]
    s_nop 3
    v_mfma_f32_16x16x32_bf16 v[80:83], a[160:163], v[232:235], v[80:83]
    v_mul_f32 v72, v51, v72
    v_mul_f32 v73, v51, v73
    v_mfma_f32_16x16x32_bf16 v[84:87], a[164:167], v[232:235], v[84:87]
    v_mul_f32 v74, v51, v74
    v_mul_f32 v75, v51, v75
    v_mfma_f32_16x16x32_bf16 v[80:83], a[176:179], v[248:251], v[80:83]
    v_mul_f32 v76, v51, v76
    v_mul_f32 v77, v51, v77
    v_mfma_f32_16x16x32_bf16 v[84:87], a[180:183], v[248:251], v[84:87]
    v_mul_f32 v78, v51, v78
    v_mul_f32 v79, v51, v79
    v_mfma_f32_16x16x32_bf16 v[88:91], a[136:139], v[200:203], v[88:91]
    v_cvt_pk_bf16_f32 v72, v72, v73
    v_cvt_pk_bf16_f32 v73, v74, v75
    v_mfma_f32_16x16x32_bf16 v[92:95], a[140:143], v[200:203], v[92:95]
    v_cvt_pk_bf16_f32 v74, v76, v77
    v_cvt_pk_bf16_f32 v75, v78, v79
    v_mfma_f32_16x16x32_bf16 v[88:91], a[152:155], v[216:219], v[88:91]
    buffer_store_dwordx4 v[72:75], v53, s[28:31], s87 offen sc1
    v_mfma_f32_16x16x32_bf16 v[92:95], a[156:159], v[216:219], v[92:95]
    s_nop 3
    v_mfma_f32_16x16x32_bf16 v[88:91], a[168:171], v[232:235], v[88:91]
    v_mul_f32 v80, v52, v80
    v_mul_f32 v81, v52, v81
    v_mfma_f32_16x16x32_bf16 v[92:95], a[172:175], v[232:235], v[92:95]
    v_mul_f32 v82, v52, v82
    v_mul_f32 v83, v52, v83
    v_mfma_f32_16x16x32_bf16 v[88:91], a[184:187], v[248:251], v[88:91]
    v_mul_f32 v84, v52, v84
    v_mul_f32 v85, v52, v85
    v_mfma_f32_16x16x32_bf16 v[92:95], a[188:191], v[248:251], v[92:95]
    v_mul_f32 v86, v52, v86
    v_mul_f32 v87, v52, v87
    v_cvt_pk_bf16_f32 v80, v80, v81
    v_cvt_pk_bf16_f32 v81, v82, v83
    v_cvt_pk_bf16_f32 v82, v84, v85
    v_cvt_pk_bf16_f32 v83, v86, v87
    buffer_store_dwordx4 v[80:83], v19, s[28:31], s46 offen sc1
    s_nop 7
    v_mul_f32 v88, v52, v88
    v_mul_f32 v89, v52, v89
    v_mul_f32 v90, v52, v90
    v_mul_f32 v91, v52, v91
    v_mul_f32 v92, v52, v92
    v_mul_f32 v93, v52, v93
    v_mul_f32 v94, v52, v94
    v_mul_f32 v95, v52, v95
    v_cvt_pk_bf16_f32 v88, v88, v89
    v_cvt_pk_bf16_f32 v89, v90, v91
    v_cvt_pk_bf16_f32 v90, v92, v93
    v_cvt_pk_bf16_f32 v91, v94, v95
    buffer_store_dwordx4 v[88:91], v19, s[28:31], s87 offen sc1
    s_add_u32 s46, s46, 0x8000
    s_add_u32 s87, s87, 0x8000
    v_mov_b32 v49, s76
    v_mov_b32 v50, s77
    v_cndmask_b32 v49, v49, v50, s[88:89]
    v_add_u32 v104, v49, v4
    v_mov_b32 v49, s78
    v_mov_b32 v50, s79
    v_cndmask_b32 v49, v49, v50, s[88:89]
    v_add_u32 v105, v49, v4
    v_mov_b32 v49, s80
    v_mov_b32 v50, s81
    v_cndmask_b32 v49, v49, v50, s[88:89]
    v_add_u32 v106, v49, v4
    v_mov_b32 v49, s82
    v_mov_b32 v50, 0x40000000
    v_cndmask_b32 v49, v49, v50, s[88:89]
    v_add_u32 v107, v49, v4
    v_and_b32 v49, 48, v0
    v_and_b32 v50, 3, v0
    v_lshl_add_u32 v49, v50, 2, v49
    v_bfe_u32 v50, v0, 2, 2
    v_add_lshl_u32 v108, v49, v50, 4
    v_add_u32 v108, s32, v108
    v_add_u32 v109, 0x10000, v108
    v_add_u32 v110, 0x20000, v108
    s_waitcnt vmcnt(0)
    v_mov_b32 v7, 0x2000000
    buffer_atomic_add v7, v2, s[64:67], 0 offen
    v_add_u32 v5, 0x100000, v5
    s_barrier
L_rdA:
    v_readfirstlane_b32 s54, v5
L_chkA:
    s_min_u32 s55, s52, 5
    s_mul_i32 s55, s55, 5
    s_add_u32 s55, s55, 4
    s_bitcmp1_b32 s54, s55
    s_cbranch_scc1 L_goA
    s_sub_u32 s86, s86, 1
    s_cbranch_scc1 L_end
    v_mov_b32 v5, 0
    buffer_atomic_add v5, v2, s[64:67], 0 offen sc0
    s_waitcnt vmcnt(0)
    s_branch L_rdA
L_goA:
    s_lshl_b32 s53, s52, 15
    s_cmp_lt_u32 s52, 2
    s_cselect_b32 s47, 8, -2
    s_add_u32 s47, s47, s52
    s_lshl_b32 s47, s47, 14
    s_add_u32 m0, s47, s32
    s_add_u32 s52, s52, 1
    buffer_load_dwordx4 v3, s[28:31], s53 offen offset:0 sc1 lds
    buffer_load_dwordx4 v3, s[28:31], s53 offen offset:1024 sc1 lds
    buffer_load_dwordx4 v3, s[28:31], s53 offen offset:2048 sc1 lds
    buffer_load_dwordx4 v3, s[28:31], s53 offen offset:3072 sc1 lds
    s_cmp_lt_u32 s52, 7
    s_cbranch_scc1 L_chkA
    s_waitcnt vmcnt(24)
    ds_read_b128 v[128:131], v110 offset:0
    ds_read_b128 v[132:135], v110 offset:1024
    ds_read_b128 v[136:139], v110 offset:2048
    ds_read_b128 v[140:143], v110 offset:3072
    s_waitcnt vmcnt(20)
    ds_read_b128 v[144:147], v110 offset:16384
    ds_read_b128 v[148:151], v110 offset:17408
    ds_read_b128 v[152:155], v110 offset:18432
    ds_read_b128 v[156:159], v110 offset:19456
    s_waitcnt lgkmcnt(7)
    v_mfma_f32_16x16x32_bf16 v[240:243], v[56:59], v[128:131], 0
    s_waitcnt lgkmcnt(6)
    v_mfma_f32_16x16x32_bf16 v[240:243], v[56:59], v[132:135], v[240:243]
    s_waitcnt lgkmcnt(5)
    v_mfma_f32_16x16x32_bf16 v[240:243], v[56:59], v[136:139], v[240:243]
    s_waitcnt lgkmcnt(4)
    v_mfma_f32_16x16x32_bf16 v[240:243], v[56:59], v[140:143], v[240:243]
    s_waitcnt vmcnt(16)
    ds_read_b128 v[160:163], v108 offset:0
    ds_read_b128 v[164:167], v108 offset:1024
    ds_read_b128 v[168:171], v108 offset:2048
    ds_read_b128 v[172:175], v108 offset:3072
    s_waitcnt lgkmcnt(7)
    v_mfma_f32_16x16x32_bf16 v[240:243], v[60:63], v[144:147], v[240:243]
    s_waitcnt lgkmcnt(6)
    v_mfma_f32_16x16x32_bf16 v[240:243], v[60:63], v[148:151], v[240:243]
    s_waitcnt lgkmcnt(5)
    v_mfma_f32_16x16x32_bf16 v[240:243], v[60:63], v[152:155], v[240:243]
    s_waitcnt lgkmcnt(4)
    v_mfma_f32_16x16x32_bf16 v[240:243], v[60:63], v[156:159], v[240:243]
    s_waitcnt vmcnt(12)
    ds_read_b128 v[176:179], v108 offset:16384
    ds_read_b128 v[180:183], v108 offset:17408
    ds_read_b128 v[184:187], v108 offset:18432
    ds_read_b128 v[188:191], v108 offset:19456
    s_waitcnt lgkmcnt(7)
    v_mfma_f32_16x16x32_bf16 v[244:247], v[56:59], v[160:163], 0
    s_waitcnt lgkmcnt(6)
    v_mfma_f32_16x16x32_bf16 v[244:247], v[56:59], v[164:167], v[244:247]
    s_waitcnt lgkmcnt(5)
    v_mfma_f32_16x16x32_bf16 v[244:247], v[56:59], v[168:171], v[244:247]
    s_waitcnt lgkmcnt(4)
    v_mfma_f32_16x16x32_bf16 v[244:247], v[56:59], v[172:175], v[244:247]
    s_waitcnt vmcnt(8)
    ds_read_b128 v[192:195], v108 offset:32768
    ds_read_b128 v[196:199], v108 offset:33792
    ds_read_b128 v[200:203], v108 offset:34816
    ds_read_b128 v[204:207], v108 offset:35840
    s_waitcnt lgkmcnt(7)
    v_mfma_f32_16x16x32_bf16 v[244:247], v[60:63], v[176:179], v[244:247]
    s_waitcnt lgkmcnt(6)
    v_mfma_f32_16x16x32_bf16 v[244:247], v[60:63], v[180:183], v[244:247]
    s_waitcnt lgkmcnt(5)
    v_mfma_f32_16x16x32_bf16 v[244:247], v[60:63], v[184:187], v[244:247]
    s_waitcnt lgkmcnt(4)
    v_mfma_f32_16x16x32_bf16 v[244:247], v[60:63], v[188:191], v[244:247]
    s_waitcnt vmcnt(4)
    ds_read_b128 v[208:211], v108 offset:49152
    ds_read_b128 v[212:215], v108 offset:50176
    ds_read_b128 v[216:219], v108 offset:51200
    ds_read_b128 v[220:223], v108 offset:52224
    s_waitcnt lgkmcnt(7)
    v_mfma_f32_16x16x32_bf16 v[248:251], v[56:59], v[192:195], 0
    s_waitcnt lgkmcnt(6)
    v_mfma_f32_16x16x32_bf16 v[248:251], v[56:59], v[196:199], v[248:251]
    s_waitcnt lgkmcnt(5)
    v_mfma_f32_16x16x32_bf16 v[248:251], v[56:59], v[200:203], v[248:251]
    s_waitcnt lgkmcnt(4)
    v_mfma_f32_16x16x32_bf16 v[248:251], v[56:59], v[204:207], v[248:251]
    s_waitcnt lgkmcnt(3)
    v_mfma_f32_16x16x32_bf16 v[248:251], v[60:63], v[208:211], v[248:251]
    s_waitcnt lgkmcnt(2)
    v_mfma_f32_16x16x32_bf16 v[248:251], v[60:63], v[212:215], v[248:251]
    s_waitcnt lgkmcnt(1)
    v_mfma_f32_16x16x32_bf16 v[248:251], v[60:63], v[216:219], v[248:251]
    s_waitcnt lgkmcnt(0)
    v_mfma_f32_16x16x32_bf16 v[248:251], v[60:63], v[220:223], v[248:251]
    v_cvt_pk_bf16_f32 v240, v240, v241
    v_cvt_pk_bf16_f32 v241, v242, v243
    v_cvt_pk_bf16_f32 v244, v244, v245
    v_cvt_pk_bf16_f32 v245, v246, v247
    s_nop 3
    v_cvt_pk_bf16_f32 v248, v248, v249
    v_cvt_pk_bf16_f32 v249, v250, v251
    s_waitcnt vmcnt(0)
    ds_read_b128 v[224:227], v109 offset:0
    ds_read_b128 v[228:231], v109 offset:1024
    ds_read_b128 v[232:235], v109 offset:2048
    ds_read_b128 v[236:239], v109 offset:3072
    buffer_store_dwordx2 v[240:241], v104, s[72:75], 0 offen
    buffer_store_dwordx2 v[244:245], v105, s[72:75], 0 offen
    buffer_store_dwordx2 v[248:249], v106, s[72:75], 0 offen
    s_waitcnt lgkmcnt(3)
    v_mfma_f32_16x16x32_bf16 v[252:255], v[56:59], v[224:227], 0
    s_waitcnt lgkmcnt(2)
    v_mfma_f32_16x16x32_bf16 v[252:255], v[56:59], v[228:231], v[252:255]
    s_waitcnt lgkmcnt(1)
    v_mfma_f32_16x16x32_bf16 v[252:255], v[56:59], v[232:235], v[252:255]
    s_waitcnt lgkmcnt(0)
    v_mfma_f32_16x16x32_bf16 v[252:255], v[56:59], v[236:239], v[252:255]
    s_nop 7
    v_cvt_pk_bf16_f32 v252, v252, v253
    v_cvt_pk_bf16_f32 v253, v254, v255
    buffer_store_dwordx2 v[252:253], v107, s[72:75], 0 offen
    s_endpgm
.p2align 6
L_bodyB:
    s_waitcnt vmcnt(9) lgkmcnt(0)
    s_barrier
    s_add_u32 m0, s32, 32768
    s_nop 0
    buffer_load_dwordx4 v16, s[16:19], s36 offen offset:0  lds
    buffer_load_dwordx4 v17, s[16:19], s36 offen offset:1024  lds
    ds_read_b128 a[192:195], v40 offset:0
    ds_read_b128 a[196:199], v40 offset:2048
    ds_read_b128 a[200:203], v41 offset:0
    ds_read_b128 a[204:207], v41 offset:2048
    ds_read_b64_tr_b16 a[64:65], v32 offset:0
    ds_read_b64_tr_b16 a[66:67], v32 offset:8192
    ds_read_b64_tr_b16 a[68:69], v33 offset:0
    ds_read_b64_tr_b16 a[70:71], v33 offset:8192
    ds_read_b64_tr_b16 a[72:73], v34 offset:0
    ds_read_b64_tr_b16 a[74:75], v34 offset:8192
    ds_read_b64_tr_b16 a[76:77], v35 offset:0
    ds_read_b64_tr_b16 a[78:79], v35 offset:8192
    ds_read_b64_tr_b16 a[80:81], v36 offset:0
    ds_read_b64_tr_b16 a[82:83], v36 offset:8192
    ds_read_b64_tr_b16 a[84:85], v37 offset:0
    ds_read_b64_tr_b16 a[86:87], v37 offset:8192
    ds_read_b64_tr_b16 a[88:89], v38 offset:0
    ds_read_b64_tr_b16 a[90:91], v38 offset:8192
    ds_read_b64_tr_b16 a[92:93], v39 offset:0
    ds_read_b64_tr_b16 a[94:95], v39 offset:8192
    buffer_load_dwordx4 v18, s[16:19], s36 offen offset:2048  lds
    ds_read_b64_tr_b16 a[96:97], v32 offset:256
    ds_read_b64_tr_b16 a[98:99], v32 offset:8448
    ds_read_b64_tr_b16 a[100:101], v33 offset:256
    ds_read_b64_tr_b16 a[102:103], v33 offset:8448
    ds_read_b64_tr_b16 a[104:105], v34 offset:256
    ds_read_b64_tr_b16 a[106:107], v34 offset:8448
    ds_read_b64_tr_b16 a[108:109], v35 offset:256
    ds_read_b64_tr_b16 a[110:111], v35 offset:8448
    ds_read_b64_tr_b16 a[112:113], v36 offset:256
    ds_read_b64_tr_b16 a[114:115], v36 offset:8448
    ds_read_b64_tr_b16 a[116:117], v37 offset:256
    ds_read_b64_tr_b16 a[118:119], v37 offset:8448
    ds_read_b64_tr_b16 a[120:121], v38 offset:256
    ds_read_b64_tr_b16 a[122:123], v38 offset:8448
    ds_read_b64_tr_b16 a[124:125], v39 offset:256
    ds_read_b64_tr_b16 a[126:127], v39 offset:8448
    buffer_load_dwordx4 v19, s[16:19], s36 offen offset:3072  lds
    s_add_u32 s36, s36, 262144
    s_add_u32 m0, s32, 49152
    s_nop 0
    buffer_load_dwordx4 v16, s[16:19], s36 offen offset:0  lds
    buffer_load_dwordx4 v17, s[16:19], s36 offen offset:1024  lds
    buffer_load_dwordx4 v18, s[16:19], s36 offen offset:2048  lds
    buffer_load_dwordx4 v19, s[16:19], s36 offen offset:3072  lds
    s_add_u32 s36, s36, 262144
    s_waitcnt vmcnt(12) lgkmcnt(0)
    s_barrier
    v_mfma_f32_16x16x32_bf16 v[128:131], a[64:67], a[192:195], 0
    s_add_u32 m0, s32, 65536
    ds_read_b64_tr_b16 a[128:129], v32 offset:16384
    s_nop 0
    v_mfma_f32_16x16x32_bf16 v[136:139], a[64:67], a[196:199], 0
    ds_read_b64_tr_b16 a[130:131], v32 offset:24576
    v_mfma_f32_16x16x32_bf16 v[140:143], a[68:71], a[196:199], 0
    ds_read_b64_tr_b16 a[132:133], v33 offset:16384
    v_mfma_f32_16x16x32_bf16 v[132:135], a[68:71], a[192:195], 0
    buffer_load_dwordx4 v20, s[20:23], s37 offen offset:0  lds
    v_mfma_f32_16x16x32_bf16 v[144:147], a[72:75], a[192:195], 0
    ds_read_b64_tr_b16 a[134:135], v33 offset:24576
    v_mfma_f32_16x16x32_bf16 v[152:155], a[72:75], a[196:199], 0
    ds_read_b64_tr_b16 a[136:137], v34 offset:16384
    v_mfma_f32_16x16x32_bf16 v[156:159], a[76:79], a[196:199], 0
    ds_read_b64_tr_b16 a[138:139], v34 offset:24576
    ds_read_b64_tr_b16 a[140:141], v35 offset:16384
    v_mfma_f32_16x16x32_bf16 v[148:151], a[76:79], a[192:195], 0
    ds_read_b64_tr_b16 a[142:143], v35 offset:24576
    buffer_load_dwordx4 v21, s[20:23], s37 offen offset:1024  lds
    v_mfma_f32_16x16x32_bf16 v[160:163], a[80:83], a[192:195], 0
    ds_read_b64_tr_b16 a[144:145], v36 offset:16384
    v_mfma_f32_16x16x32_bf16 v[168:171], a[80:83], a[196:199], 0
    ds_read_b64_tr_b16 a[146:147], v36 offset:24576
    v_mfma_f32_16x16x32_bf16 v[172:175], a[84:87], a[196:199], 0
    ds_read_b64_tr_b16 a[148:149], v37 offset:16384
    buffer_load_dwordx4 v22, s[20:23], s37 offen offset:2048  lds
    v_mfma_f32_16x16x32_bf16 v[164:167], a[84:87], a[192:195], 0
    ds_read_b64_tr_b16 a[150:151], v37 offset:24576
    v_mfma_f32_16x16x32_bf16 v[176:179], a[88:91], a[192:195], 0
    ds_read_b64_tr_b16 a[152:153], v38 offset:16384
    v_mfma_f32_16x16x32_bf16 v[184:187], a[88:91], a[196:199], 0
    ds_read_b64_tr_b16 a[154:155], v38 offset:24576
    buffer_load_dwordx4 v23, s[20:23], s37 offen offset:3072  lds
    v_mfma_f32_16x16x32_bf16 v[188:191], a[92:95], a[196:199], 0
    s_add_u32 s37, s37, 128
    ds_read_b64_tr_b16 a[156:157], v39 offset:16384
    s_add_u32 m0, s32, 0
    v_mfma_f32_16x16x32_bf16 v[180:183], a[92:95], a[192:195], 0
    s_nop 0
    ds_read_b64_tr_b16 a[158:159], v39 offset:24576
    ds_read_b64_tr_b16 a[160:161], v32 offset:16640
    v_mfma_f32_16x16x32_bf16 v[192:195], a[96:99], a[192:195], 0
    ds_read_b64_tr_b16 a[162:163], v32 offset:24832
    v_mfma_f32_16x16x32_bf16 v[200:203], a[96:99], a[196:199], 0
    ds_read_b64_tr_b16 a[164:165], v33 offset:16640
    v_mfma_f32_16x16x32_bf16 v[204:207], a[100:103], a[196:199], 0
    ds_read_b64_tr_b16 a[166:167], v33 offset:24832
    buffer_load_dwordx4 v16, s[16:19], s36 offen offset:0  lds
    v_mfma_f32_16x16x32_bf16 v[196:199], a[100:103], a[192:195], 0
    ds_read_b64_tr_b16 a[168:169], v34 offset:16640
    v_mfma_f32_16x16x32_bf16 v[208:211], a[104:107], a[192:195], 0
    ds_read_b64_tr_b16 a[170:171], v34 offset:24832
    v_mfma_f32_16x16x32_bf16 v[216:219], a[104:107], a[196:199], 0
    ds_read_b64_tr_b16 a[172:173], v35 offset:16640
    v_mfma_f32_16x16x32_bf16 v[220:223], a[108:111], a[196:199], 0
    ds_read_b64_tr_b16 a[174:175], v35 offset:24832
    buffer_load_dwordx4 v17, s[16:19], s36 offen offset:1024  lds
    v_mfma_f32_16x16x32_bf16 v[212:215], a[108:111], a[192:195], 0
    ds_read_b64_tr_b16 a[176:177], v36 offset:16640
    v_mfma_f32_16x16x32_bf16 v[224:227], a[112:115], a[192:195], 0
    ds_read_b64_tr_b16 a[178:179], v36 offset:24832
    v_mfma_f32_16x16x32_bf16 v[232:235], a[112:115], a[196:199], 0
    ds_read_b64_tr_b16 a[180:181], v37 offset:16640
    buffer_load_dwordx4 v18, s[16:19], s36 offen offset:2048  lds
    v_mfma_f32_16x16x32_bf16 v[236:239], a[116:119], a[196:199], 0
    ds_read_b64_tr_b16 a[182:183], v37 offset:24832
    ds_read_b64_tr_b16 a[184:185], v38 offset:16640
    v_mfma_f32_16x16x32_bf16 v[228:231], a[116:119], a[192:195], 0
    ds_read_b64_tr_b16 a[186:187], v38 offset:24832
    v_mfma_f32_16x16x32_bf16 v[240:243], a[120:123], a[192:195], 0
    ds_read_b64_tr_b16 a[188:189], v39 offset:16640
    buffer_load_dwordx4 v19, s[16:19], s36 offen offset:3072  lds
    ds_read_b64_tr_b16 a[190:191], v39 offset:24832
    v_mfma_f32_16x16x32_bf16 v[248:251], a[120:123], a[196:199], 0
    s_add_u32 s36, s36, 262144
    v_mfma_f32_16x16x32_bf16 v[252:255], a[124:127], a[196:199], 0
    v_mfma_f32_16x16x32_bf16 v[244:247], a[124:127], a[192:195], 0
    s_lshl_b32 s5, s3, 3
    s_add_u32 s5, s5, s6
    s_lshl_b32 s7, s5, 21
    s_add_u32 s28, s58, s7
    s_addc_u32 s29, s59, 0
    s_mov_b32 s30, 0x200000
    s_mov_b32 s31, 0x20000
    s_and_b32 s7, s4, 7
    s_lshl_b32 s7, s7, 18
    s_lshr_b32 s47, s4, 3
    s_lshl_b32 s47, s47, 9
    s_add_u32 s7, s7, s47
    s_add_u32 s7, s7, 229376
    v_lshlrev_b32 v49, 4, v115
    v_lshl_add_u32 v49, v114, 13, v49
    v_lshl_add_u32 v49, v113, 21, v49
    v_add_u32 v49, s7, v49
    v_mov_b32 v96, 1
    v_mov_b32 v97, 1
    v_mov_b32 v98, 1
    v_mov_b32 v99, 1
    s_mov_b32 s95, 0
    buffer_store_dwordx4 v[96:99], v49, s[28:31], 0 offen sc1
    s_add_u32 s92, s28, s7
    s_addc_u32 s93, s29, 0
    s_lshl_b32 s7, s5, 2
    s_add_u32 s7, s7, s33
    s_mul_i32 s7, s7, 4352
    s_add_u32 s7, s7, 33554432
    s_add_u32 s64, s58, s7
    s_addc_u32 s65, s59, 0
    s_waitcnt vmcnt(13) lgkmcnt(0)
    s_barrier
    v_mfma_f32_16x16x32_bf16 v[128:131], a[128:131], a[200:203], v[128:131]
    s_add_u32 m0, s32, 16384
    ds_read_b128 a[208:211], v40 offset:16384
    s_nop 0
    v_mfma_f32_16x16x32_bf16 v[136:139], a[128:131], a[204:207], v[136:139]
    ds_read_b128 a[212:215], v40 offset:18432
    v_mfma_f32_16x16x32_bf16 v[140:143], a[132:135], a[204:207], v[140:143]
    ds_read_b128 a[216:219], v41 offset:16384
    v_mfma_f32_16x16x32_bf16 v[132:135], a[132:135], a[200:203], v[132:135]
    ds_read_b128 a[220:223], v41 offset:18432
    v_mfma_f32_16x16x32_bf16 v[144:147], a[136:139], a[200:203], v[144:147]
    ds_read_b64_tr_b16 a[64:65], v32 offset:32768
    v_mfma_f32_16x16x32_bf16 v[152:155], a[136:139], a[204:207], v[152:155]
    ds_read_b64_tr_b16 a[66:67], v32 offset:40960
    v_mfma_f32_16x16x32_bf16 v[156:159], a[140:143], a[204:207], v[156:159]
    ds_read_b64_tr_b16 a[68:69], v33 offset:32768
    buffer_load_dwordx4 v16, s[16:19], s36 offen offset:0  lds
    v_mfma_f32_16x16x32_bf16 v[148:151], a[140:143], a[200:203], v[148:151]
    ds_read_b64_tr_b16 a[70:71], v33 offset:40960
    ds_read_b64_tr_b16 a[72:73], v34 offset:32768
    v_mfma_f32_16x16x32_bf16 v[160:163], a[144:147], a[200:203], v[160:163]
    ds_read_b64_tr_b16 a[74:75], v34 offset:40960
    v_mfma_f32_16x16x32_bf16 v[168:171], a[144:147], a[204:207], v[168:171]
    ds_read_b64_tr_b16 a[76:77], v35 offset:32768
    v_mfma_f32_16x16x32_bf16 v[172:175], a[148:151], a[204:207], v[172:175]
    ds_read_b64_tr_b16 a[78:79], v35 offset:40960
    v_mfma_f32_16x16x32_bf16 v[164:167], a[148:151], a[200:203], v[164:167]
    ds_read_b64_tr_b16 a[80:81], v36 offset:32768
    ds_read_b64_tr_b16 a[82:83], v36 offset:40960
    v_mfma_f32_16x16x32_bf16 v[176:179], a[152:155], a[200:203], v[176:179]
    ds_read_b64_tr_b16 a[84:85], v37 offset:32768
    buffer_load_dwordx4 v17, s[16:19], s36 offen offset:1024  lds
    v_mfma_f32_16x16x32_bf16 v[184:187], a[152:155], a[204:207], v[184:187]
    ds_read_b64_tr_b16 a[86:87], v37 offset:40960
    v_mfma_f32_16x16x32_bf16 v[188:191], a[156:159], a[204:207], v[188:191]
    ds_read_b64_tr_b16 a[88:89], v38 offset:32768
    v_mfma_f32_16x16x32_bf16 v[180:183], a[156:159], a[200:203], v[180:183]
    ds_read_b64_tr_b16 a[90:91], v38 offset:40960
    ds_read_b64_tr_b16 a[92:93], v39 offset:32768
    v_mfma_f32_16x16x32_bf16 v[192:195], a[160:163], a[200:203], v[192:195]
    ds_read_b64_tr_b16 a[94:95], v39 offset:40960
    v_mfma_f32_16x16x32_bf16 v[200:203], a[160:163], a[204:207], v[200:203]
    ds_read_b64_tr_b16 a[96:97], v32 offset:33024
    v_mfma_f32_16x16x32_bf16 v[204:207], a[164:167], a[204:207], v[204:207]
    ds_read_b64_tr_b16 a[98:99], v32 offset:41216
    buffer_load_dwordx4 v18, s[16:19], s36 offen offset:2048  lds
    v_mfma_f32_16x16x32_bf16 v[196:199], a[164:167], a[200:203], v[196:199]
    ds_read_b64_tr_b16 a[100:101], v33 offset:33024
    v_mfma_f32_16x16x32_bf16 v[208:211], a[168:171], a[200:203], v[208:211]
    ds_read_b64_tr_b16 a[102:103], v33 offset:41216
    ds_read_b64_tr_b16 a[104:105], v34 offset:33024
    v_mfma_f32_16x16x32_bf16 v[216:219], a[168:171], a[204:207], v[216:219]
    ds_read_b64_tr_b16 a[106:107], v34 offset:41216
    v_mfma_f32_16x16x32_bf16 v[220:223], a[172:175], a[204:207], v[220:223]
    ds_read_b64_tr_b16 a[108:109], v35 offset:33024
    v_mfma_f32_16x16x32_bf16 v[212:215], a[172:175], a[200:203], v[212:215]
    ds_read_b64_tr_b16 a[110:111], v35 offset:41216
    v_mfma_f32_16x16x32_bf16 v[224:227], a[176:179], a[200:203], v[224:227]
    ds_read_b64_tr_b16 a[112:113], v36 offset:33024
    ds_read_b64_tr_b16 a[114:115], v36 offset:41216
    v_mfma_f32_16x16x32_bf16 v[232:235], a[176:179], a[204:207], v[232:235]
    ds_read_b64_tr_b16 a[116:117], v37 offset:33024
    buffer_load_dwordx4 v19, s[16:19], s36 offen offset:3072  lds
    v_mfma_f32_16x16x32_bf16 v[236:239], a[180:183], a[204:207], v[236:239]
    s_add_u32 s36, s36, 262144
    ds_read_b64_tr_b16 a[118:119], v37 offset:41216
    v_mfma_f32_16x16x32_bf16 v[228:231], a[180:183], a[200:203], v[228:231]
    ds_read_b64_tr_b16 a[120:121], v38 offset:33024
    v_mfma_f32_16x16x32_bf16 v[240:243], a[184:187], a[200:203], v[240:243]
    ds_read_b64_tr_b16 a[122:123], v38 offset:41216
    ds_read_b64_tr_b16 a[124:125], v39 offset:33024
    ds_read_b64_tr_b16 a[126:127], v39 offset:41216
    v_mfma_f32_16x16x32_bf16 v[248:251], a[184:187], a[204:207], v[248:251]
    v_mfma_f32_16x16x32_bf16 v[252:255], a[188:191], a[204:207], v[252:255]
    v_mfma_f32_16x16x32_bf16 v[244:247], a[188:191], a[200:203], v[244:247]
    s_mov_b32 s66, 128
    s_mov_b32 s67, 0x20000
    s_lshl_b32 s7, s4, 7
    v_lshl_add_u32 v1, v0, 2, s7
    v_mov_b32 v7, 0
    buffer_store_dword v7, v1, s[64:67], 0 offen sc1
    v_lshlrev_b32 v2, 7, v0
    v_add_u32 v55, v113, v0
    v_lshlrev_b32 v55, 2, v55
    s_lshl_b32 s7, s6, 4
    s_add_u32 s7, s7, s4
    s_xor_b32 s47, s3, 1
    s_lshr_b32 s7, s7, s47
    s_mul_i32 s34, s7, 16
    s_add_u32 s34, s34, -1
    s_lshl_b32 s34, s34, 14
    s_mov_b32 s35, s34
    s_lshl_b32 s7, s7, 19
    s_add_u32 s8, s50, s7
    s_addc_u32 s9, s51, 0
    s_mov_b32 s10, 0x80000
    s_mov_b32 s11, 0x20000
    s_add_u32 s12, s52, s7
    s_addc_u32 s13, s53, 0
    s_mov_b32 s14, 0x80000
    s_mov_b32 s15, 0x20000
    s_mul_i32 s7, s4, 229376
    s_add_u32 s24, s56, s7
    s_addc_u32 s25, s57, 0
    s_mov_b32 s26, 229376
    s_mov_b32 s27, 0x20000
    s_waitcnt vmcnt(14) lgkmcnt(0)
    s_barrier
    v_mfma_f32_16x16x32_bf16 v[128:131], a[64:67], a[208:211], v[128:131]
    s_add_u32 m0, s32, 81920
    ds_read_b64_tr_b16 a[128:129], v32 offset:49152
    s_nop 0
    v_mfma_f32_16x16x32_bf16 v[136:139], a[64:67], a[212:215], v[136:139]
    ds_read_b64_tr_b16 a[130:131], v32 offset:57344
    v_mfma_f32_16x16x32_bf16 v[140:143], a[68:71], a[212:215], v[140:143]
    ds_read_b64_tr_b16 a[132:133], v33 offset:49152
    v_mfma_f32_16x16x32_bf16 v[132:135], a[68:71], a[208:211], v[132:135]
    buffer_load_dwordx4 v20, s[20:23], s37 offen offset:0  lds
    v_mfma_f32_16x16x32_bf16 v[144:147], a[72:75], a[208:211], v[144:147]
    ds_read_b64_tr_b16 a[134:135], v33 offset:57344
    v_mfma_f32_16x16x32_bf16 v[152:155], a[72:75], a[212:215], v[152:155]
    ds_read_b64_tr_b16 a[136:137], v34 offset:49152
    v_mfma_f32_16x16x32_bf16 v[156:159], a[76:79], a[212:215], v[156:159]
    ds_read_b64_tr_b16 a[138:139], v34 offset:57344
    ds_read_b64_tr_b16 a[140:141], v35 offset:49152
    v_mfma_f32_16x16x32_bf16 v[148:151], a[76:79], a[208:211], v[148:151]
    ds_read_b64_tr_b16 a[142:143], v35 offset:57344
    buffer_load_dwordx4 v21, s[20:23], s37 offen offset:1024  lds
    v_mfma_f32_16x16x32_bf16 v[160:163], a[80:83], a[208:211], v[160:163]
    ds_read_b64_tr_b16 a[144:145], v36 offset:49152
    v_mfma_f32_16x16x32_bf16 v[168:171], a[80:83], a[212:215], v[168:171]
    ds_read_b64_tr_b16 a[146:147], v36 offset:57344
    v_mfma_f32_16x16x32_bf16 v[172:175], a[84:87], a[212:215], v[172:175]
    ds_read_b64_tr_b16 a[148:149], v37 offset:49152
    buffer_load_dwordx4 v22, s[20:23], s37 offen offset:2048  lds
    v_mfma_f32_16x16x32_bf16 v[164:167], a[84:87], a[208:211], v[164:167]
    ds_read_b64_tr_b16 a[150:151], v37 offset:57344
    v_mfma_f32_16x16x32_bf16 v[176:179], a[88:91], a[208:211], v[176:179]
    ds_read_b64_tr_b16 a[152:153], v38 offset:49152
    v_mfma_f32_16x16x32_bf16 v[184:187], a[88:91], a[212:215], v[184:187]
    ds_read_b64_tr_b16 a[154:155], v38 offset:57344
    buffer_load_dwordx4 v23, s[20:23], s37 offen offset:3072  lds
    v_mfma_f32_16x16x32_bf16 v[188:191], a[92:95], a[212:215], v[188:191]
    s_add_u32 s37, s37, 128
    ds_read_b64_tr_b16 a[156:157], v39 offset:49152
    s_add_u32 m0, s32, 32768
    v_mfma_f32_16x16x32_bf16 v[180:183], a[92:95], a[208:211], v[180:183]
    s_nop 0
    ds_read_b64_tr_b16 a[158:159], v39 offset:57344
    ds_read_b64_tr_b16 a[160:161], v32 offset:49408
    v_mfma_f32_16x16x32_bf16 v[192:195], a[96:99], a[208:211], v[192:195]
    ds_read_b64_tr_b16 a[162:163], v32 offset:57600
    v_mfma_f32_16x16x32_bf16 v[200:203], a[96:99], a[212:215], v[200:203]
    ds_read_b64_tr_b16 a[164:165], v33 offset:49408
    v_mfma_f32_16x16x32_bf16 v[204:207], a[100:103], a[212:215], v[204:207]
    ds_read_b64_tr_b16 a[166:167], v33 offset:57600
    buffer_load_dwordx4 v16, s[16:19], s36 offen offset:0  lds
    v_mfma_f32_16x16x32_bf16 v[196:199], a[100:103], a[208:211], v[196:199]
    ds_read_b64_tr_b16 a[168:169], v34 offset:49408
    v_mfma_f32_16x16x32_bf16 v[208:211], a[104:107], a[208:211], v[208:211]
    ds_read_b64_tr_b16 a[170:171], v34 offset:57600
    v_mfma_f32_16x16x32_bf16 v[216:219], a[104:107], a[212:215], v[216:219]
    ds_read_b64_tr_b16 a[172:173], v35 offset:49408
    v_mfma_f32_16x16x32_bf16 v[220:223], a[108:111], a[212:215], v[220:223]
    ds_read_b64_tr_b16 a[174:175], v35 offset:57600
    buffer_load_dwordx4 v17, s[16:19], s36 offen offset:1024  lds
    v_mfma_f32_16x16x32_bf16 v[212:215], a[108:111], a[208:211], v[212:215]
    ds_read_b64_tr_b16 a[176:177], v36 offset:49408
    v_mfma_f32_16x16x32_bf16 v[224:227], a[112:115], a[208:211], v[224:227]
    ds_read_b64_tr_b16 a[178:179], v36 offset:57600
    v_mfma_f32_16x16x32_bf16 v[232:235], a[112:115], a[212:215], v[232:235]
    ds_read_b64_tr_b16 a[180:181], v37 offset:49408
    buffer_load_dwordx4 v18, s[16:19], s36 offen offset:2048  lds
    v_mfma_f32_16x16x32_bf16 v[236:239], a[116:119], a[212:215], v[236:239]
    ds_read_b64_tr_b16 a[182:183], v37 offset:57600
    ds_read_b64_tr_b16 a[184:185], v38 offset:49408
    v_mfma_f32_16x16x32_bf16 v[228:231], a[116:119], a[208:211], v[228:231]
    ds_read_b64_tr_b16 a[186:187], v38 offset:57600
    v_mfma_f32_16x16x32_bf16 v[240:243], a[120:123], a[208:211], v[240:243]
    ds_read_b64_tr_b16 a[188:189], v39 offset:49408
    buffer_load_dwordx4 v19, s[16:19], s36 offen offset:3072  lds
    ds_read_b64_tr_b16 a[190:191], v39 offset:57600
    v_mfma_f32_16x16x32_bf16 v[248:251], a[120:123], a[212:215], v[248:251]
    s_add_u32 s36, s36, 262144
    v_mfma_f32_16x16x32_bf16 v[252:255], a[124:127], a[212:215], v[252:255]
    v_mfma_f32_16x16x32_bf16 v[244:247], a[124:127], a[208:211], v[244:247]
    s_lshl_b32 s7, s5, 4
    s_add_u32 s68, s62, s7
    s_addc_u32 s69, s63, 0
    s_mov_b32 s70, 4
    s_mov_b32 s71, 0x20000
    s_mov_b32 s72, s60
    s_mov_b32 s73, s61
    s_mov_b32 s74, 1835008
    s_mov_b32 s75, 0x20000
    s_mov_b32 s48, s28
    s_mov_b32 s49, s29
    s_mov_b32 s50, 0
    s_mov_b32 s51, 0x20000
    s_mov_b32 s52, 0
    s_mov_b32 s46, 0
    s_mov_b32 s87, 0x40000
    s_mov_b32 s86, 0x40000
    s_mov_b32 s88, 0
    s_mov_b32 s89, -1
    s_mov_b32 s40, 0x41000000
    s_mov_b32 s41, 0x3db8aa3b
    s_lshl_b32 s7, s6, 7
    s_cmp_ge_u32 s7, 896
    s_cselect_b32 s76, 0, s7
    s_add_u32 s7, s76, 128
    s_cmp_ge_u32 s7, 896
    s_cselect_b32 s77, 0, s7
    s_add_u32 s7, s77, 128
    s_cmp_ge_u32 s7, 896
    s_cselect_b32 s78, 0, s7
    s_add_u32 s7, s78, 128
    s_cmp_ge_u32 s7, 896
    s_cselect_b32 s79, 0, s7
    s_waitcnt vmcnt(14) lgkmcnt(0)
    s_barrier
    v_mfma_f32_16x16x32_bf16 v[128:131], a[128:131], a[216:219], v[128:131]
    s_add_u32 m0, s32, 49152
    ds_read_b128 a[192:195], v40 offset:0
    s_nop 0
    v_mfma_f32_16x16x32_bf16 v[136:139], a[128:131], a[220:223], v[136:139]
    ds_read_b128 a[196:199], v40 offset:2048
    v_mfma_f32_16x16x32_bf16 v[140:143], a[132:135], a[220:223], v[140:143]
    ds_read_b128 a[200:203], v41 offset:0
    v_mfma_f32_16x16x32_bf16 v[132:135], a[132:135], a[216:219], v[132:135]
    ds_read_b128 a[204:207], v41 offset:2048
    v_mfma_f32_16x16x32_bf16 v[144:147], a[136:139], a[216:219], v[144:147]
    ds_read_b64_tr_b16 a[64:65], v32 offset:0
    v_mfma_f32_16x16x32_bf16 v[152:155], a[136:139], a[220:223], v[152:155]
    ds_read_b64_tr_b16 a[66:67], v32 offset:8192
    v_mfma_f32_16x16x32_bf16 v[156:159], a[140:143], a[220:223], v[156:159]
    ds_read_b64_tr_b16 a[68:69], v33 offset:0
    buffer_load_dwordx4 v16, s[16:19], s36 offen offset:0  lds
    v_mfma_f32_16x16x32_bf16 v[148:151], a[140:143], a[216:219], v[148:151]
    ds_read_b64_tr_b16 a[70:71], v33 offset:8192
    ds_read_b64_tr_b16 a[72:73], v34 offset:0
    v_mfma_f32_16x16x32_bf16 v[160:163], a[144:147], a[216:219], v[160:163]
    ds_read_b64_tr_b16 a[74:75], v34 offset:8192
    v_mfma_f32_16x16x32_bf16 v[168:171], a[144:147], a[220:223], v[168:171]
    ds_read_b64_tr_b16 a[76:77], v35 offset:0
    v_mfma_f32_16x16x32_bf16 v[172:175], a[148:151], a[220:223], v[172:175]
    ds_read_b64_tr_b16 a[78:79], v35 offset:8192
    v_mfma_f32_16x16x32_bf16 v[164:167], a[148:151], a[216:219], v[164:167]
    ds_read_b64_tr_b16 a[80:81], v36 offset:0
    ds_read_b64_tr_b16 a[82:83], v36 offset:8192
    v_mfma_f32_16x16x32_bf16 v[176:179], a[152:155], a[216:219], v[176:179]
    ds_read_b64_tr_b16 a[84:85], v37 offset:0
    buffer_load_dwordx4 v17, s[16:19], s36 offen offset:1024  lds
    v_mfma_f32_16x16x32_bf16 v[184:187], a[152:155], a[220:223], v[184:187]
    ds_read_b64_tr_b16 a[86:87], v37 offset:8192
    v_mfma_f32_16x16x32_bf16 v[188:191], a[156:159], a[220:223], v[188:191]
    ds_read_b64_tr_b16 a[88:89], v38 offset:0
    v_mfma_f32_16x16x32_bf16 v[180:183], a[156:159], a[216:219], v[180:183]
    ds_read_b64_tr_b16 a[90:91], v38 offset:8192
    ds_read_b64_tr_b16 a[92:93], v39 offset:0
    v_mfma_f32_16x16x32_bf16 v[192:195], a[160:163], a[216:219], v[192:195]
    ds_read_b64_tr_b16 a[94:95], v39 offset:8192
    v_mfma_f32_16x16x32_bf16 v[200:203], a[160:163], a[220:223], v[200:203]
    ds_read_b64_tr_b16 a[96:97], v32 offset:256
    v_mfma_f32_16x16x32_bf16 v[204:207], a[164:167], a[220:223], v[204:207]
    ds_read_b64_tr_b16 a[98:99], v32 offset:8448
    buffer_load_dwordx4 v18, s[16:19], s36 offen offset:2048  lds
    v_mfma_f32_16x16x32_bf16 v[196:199], a[164:167], a[216:219], v[196:199]
    ds_read_b64_tr_b16 a[100:101], v33 offset:256
    v_mfma_f32_16x16x32_bf16 v[208:211], a[168:171], a[216:219], v[208:211]
    ds_read_b64_tr_b16 a[102:103], v33 offset:8448
    ds_read_b64_tr_b16 a[104:105], v34 offset:256
    v_mfma_f32_16x16x32_bf16 v[216:219], a[168:171], a[220:223], v[216:219]
    ds_read_b64_tr_b16 a[106:107], v34 offset:8448
    v_mfma_f32_16x16x32_bf16 v[220:223], a[172:175], a[220:223], v[220:223]
    ds_read_b64_tr_b16 a[108:109], v35 offset:256
    v_mfma_f32_16x16x32_bf16 v[212:215], a[172:175], a[216:219], v[212:215]
    ds_read_b64_tr_b16 a[110:111], v35 offset:8448
    v_mfma_f32_16x16x32_bf16 v[224:227], a[176:179], a[216:219], v[224:227]
    ds_read_b64_tr_b16 a[112:113], v36 offset:256
    ds_read_b64_tr_b16 a[114:115], v36 offset:8448
    v_mfma_f32_16x16x32_bf16 v[232:235], a[176:179], a[220:223], v[232:235]
    ds_read_b64_tr_b16 a[116:117], v37 offset:256
    buffer_load_dwordx4 v19, s[16:19], s36 offen offset:3072  lds
    v_mfma_f32_16x16x32_bf16 v[236:239], a[180:183], a[220:223], v[236:239]
    s_add_u32 s36, s36, 262144
    ds_read_b64_tr_b16 a[118:119], v37 offset:8448
    v_mfma_f32_16x16x32_bf16 v[228:231], a[180:183], a[216:219], v[228:231]
    ds_read_b64_tr_b16 a[120:121], v38 offset:256
    v_mfma_f32_16x16x32_bf16 v[240:243], a[184:187], a[216:219], v[240:243]
    ds_read_b64_tr_b16 a[122:123], v38 offset:8448
    ds_read_b64_tr_b16 a[124:125], v39 offset:256
    ds_read_b64_tr_b16 a[126:127], v39 offset:8448
    v_mfma_f32_16x16x32_bf16 v[248:251], a[184:187], a[220:223], v[248:251]
    v_mfma_f32_16x16x32_bf16 v[252:255], a[188:191], a[220:223], v[252:255]
    v_mfma_f32_16x16x32_bf16 v[244:247], a[188:191], a[216:219], v[244:247]
    s_add_u32 s7, s79, 128
    s_cmp_ge_u32 s7, 896
    s_cselect_b32 s80, 0, s7
    s_add_u32 s7, s80, 128
    s_cmp_ge_u32 s7, 896
    s_cselect_b32 s81, 0, s7
    s_add_u32 s7, s81, 128
    s_cmp_ge_u32 s7, 896
    s_cselect_b32 s82, 0, s7
    s_add_u32 s7, s82, 128
    s_lshl_b32 s83, s33, 11
    s_add_u32 s83, s83, 65536
    s_mov_b32 s84, s76
    s_mov_b32 s85, s77
    v_lshl_add_u32 v50, v113, 3, v114
    v_lshl_add_u32 v12, v50, 9, v12
    v_and_b32 v49, 15, v50
    v_xor_b32 v49, v49, v115
    v_lshlrev_b32 v49, 4, v49
    v_lshl_add_u32 v8, v50, 9, v49
    v_xor_b32 v9, 32, v8
    v_xor_b32 v10, 64, v8
    v_xor_b32 v11, 96, v8
    v_xor_b32 v13, 64, v12
    v_xor_b32 v14, 128, v12
    v_xor_b32 v15, 192, v12
    v_lshlrev_b32 v49, 1, v117
    v_xor_b32 v49, v49, v118
    v_lshl_add_u32 v24, v49, 4, v119
    v_add_u32 v25, 6144, v24
    v_add_u32 v26, 12288, v24
    s_waitcnt vmcnt(13) lgkmcnt(0)
    s_barrier
    s_mov_b64 s[90:91], 0
    s_mov_b32 s98, 0
    s_cmp_lg_u32 s33, 0
    s_cbranch_scc1 L_noprobe0B
    s_load_dword s90, s[92:93], 0 glc
    s_load_dword s91, s[92:93], 8192 glc
L_noprobe0B:
    v_mfma_f32_16x16x32_bf16 v[128:131], a[64:67], a[192:195], v[128:131]
    s_add_u32 m0, s32, 65536
    ds_read_b64_tr_b16 a[128:129], v32 offset:16384
    s_nop 0
    v_mfma_f32_16x16x32_bf16 v[136:139], a[64:67], a[196:199], v[136:139]
    ds_read_b64_tr_b16 a[130:131], v32 offset:24576
    v_mfma_f32_16x16x32_bf16 v[140:143], a[68:71], a[196:199], v[140:143]
    ds_read_b64_tr_b16 a[132:133], v33 offset:16384
    v_mfma_f32_16x16x32_bf16 v[132:135], a[68:71], a[192:195], v[132:135]
    buffer_load_dwordx4 v20, s[20:23], s37 offen offset:0  lds
    v_mfma_f32_16x16x32_bf16 v[144:147], a[72:75], a[192:195], v[144:147]
    ds_read_b64_tr_b16 a[134:135], v33 offset:24576
    v_mfma_f32_16x16x32_bf16 v[152:155], a[72:75], a[196:199], v[152:155]
    ds_read_b64_tr_b16 a[136:137], v34 offset:16384
    v_mfma_f32_16x16x32_bf16 v[156:159], a[76:79], a[196:199], v[156:159]
    ds_read_b64_tr_b16 a[138:139], v34 offset:24576
    ds_read_b64_tr_b16 a[140:141], v35 offset:16384
    v_mfma_f32_16x16x32_bf16 v[148:151], a[76:79], a[192:195], v[148:151]
    ds_read_b64_tr_b16 a[142:143], v35 offset:24576
    buffer_load_dwordx4 v21, s[20:23], s37 offen offset:1024  lds
    v_mfma_f32_16x16x32_bf16 v[160:163], a[80:83], a[192:195], v[160:163]
    ds_read_b64_tr_b16 a[144:145], v36 offset:16384
    v_mfma_f32_16x16x32_bf16 v[168:171], a[80:83], a[196:199], v[168:171]
    ds_read_b64_tr_b16 a[146:147], v36 offset:24576
    v_mfma_f32_16x16x32_bf16 v[172:175], a[84:87], a[196:199], v[172:175]
    ds_read_b64_tr_b16 a[148:149], v37 offset:16384
    buffer_load_dwordx4 v22, s[20:23], s37 offen offset:2048  lds
    v_mfma_f32_16x16x32_bf16 v[164:167], a[84:87], a[192:195], v[164:167]
    ds_read_b64_tr_b16 a[150:151], v37 offset:24576
    v_mfma_f32_16x16x32_bf16 v[176:179], a[88:91], a[192:195], v[176:179]
    ds_read_b64_tr_b16 a[152:153], v38 offset:16384
    v_mfma_f32_16x16x32_bf16 v[184:187], a[88:91], a[196:199], v[184:187]
    ds_read_b64_tr_b16 a[154:155], v38 offset:24576
    buffer_load_dwordx4 v23, s[20:23], s37 offen offset:3072  lds
    v_mfma_f32_16x16x32_bf16 v[188:191], a[92:95], a[196:199], v[188:191]
    s_add_u32 s37, s37, 128
    ds_read_b64_tr_b16 a[156:157], v39 offset:16384
    s_add_u32 m0, s32, 0
    v_mfma_f32_16x16x32_bf16 v[180:183], a[92:95], a[192:195], v[180:183]
    s_nop 0
    ds_read_b64_tr_b16 a[158:159], v39 offset:24576
    ds_read_b64_tr_b16 a[160:161], v32 offset:16640
    v_mfma_f32_16x16x32_bf16 v[192:195], a[96:99], a[192:195], v[192:195]
    s_andn2_b32 s94, s90, s91
    ds_read_b64_tr_b16 a[162:163], v32 offset:24832
    s_or_b32 s98, s98, s94
    v_mfma_f32_16x16x32_bf16 v[200:203], a[96:99], a[196:199], v[200:203]
    s_andn2_b32 s94, s90, s91
    ds_read_b64_tr_b16 a[164:165], v33 offset:16640
    s_or_b32 s98, s98, s94
    v_mfma_f32_16x16x32_bf16 v[204:207], a[100:103], a[196:199], v[204:207]
    s_andn2_b32 s94, s90, s91
    ds_read_b64_tr_b16 a[166:167], v33 offset:24832
    buffer_load_dwordx4 v16, s[16:19], s36 offen offset:0  lds
    v_mfma_f32_16x16x32_bf16 v[196:199], a[100:103], a[192:195], v[196:199]
    s_or_b32 s98, s98, s94
    ds_read_b64_tr_b16 a[168:169], v34 offset:16640
    s_andn2_b32 s94, s90, s91
    v_mfma_f32_16x16x32_bf16 v[208:211], a[104:107], a[192:195], v[208:211]
    s_or_b32 s98, s98, s94
    ds_read_b64_tr_b16 a[170:171], v34 offset:24832
    v_mfma_f32_16x16x32_bf16 v[216:219], a[104:107], a[196:199], v[216:219]
    s_andn2_b32 s94, s90, s91
    ds_read_b64_tr_b16 a[172:173], v35 offset:16640
    v_mfma_f32_16x16x32_bf16 v[220:223], a[108:111], a[196:199], v[220:223]
    s_or_b32 s98, s98, s94
    ds_read_b64_tr_b16 a[174:175], v35 offset:24832
    buffer_load_dwordx4 v17, s[16:19], s36 offen offset:1024  lds
    v_mfma_f32_16x16x32_bf16 v[212:215], a[108:111], a[192:195], v[212:215]
    s_andn2_b32 s94, s90, s91
    ds_read_b64_tr_b16 a[176:177], v36 offset:16640
    v_mfma_f32_16x16x32_bf16 v[224:227], a[112:115], a[192:195], v[224:227]
    s_or_b32 s98, s98, s94
    ds_read_b64_tr_b16 a[178:179], v36 offset:24832
    v_mfma_f32_16x16x32_bf16 v[232:235], a[112:115], a[196:199], v[232:235]
    s_andn2_b32 s94, s90, s91
    ds_read_b64_tr_b16 a[180:181], v37 offset:16640
    buffer_load_dwordx4 v18, s[16:19], s36 offen offset:2048  lds
    v_mfma_f32_16x16x32_bf16 v[236:239], a[116:119], a[196:199], v[236:239]
    s_or_b32 s98, s98, s94
    ds_read_b64_tr_b16 a[182:183], v37 offset:24832
    ds_read_b64_tr_b16 a[184:185], v38 offset:16640
    v_mfma_f32_16x16x32_bf16 v[228:231], a[116:119], a[192:195], v[228:231]
    s_andn2_b32 s94, s90, s91
    ds_read_b64_tr_b16 a[186:187], v38 offset:24832
    s_or_b32 s98, s98, s94
    v_mfma_f32_16x16x32_bf16 v[240:243], a[120:123], a[192:195], v[240:243]
    s_andn2_b32 s94, s90, s91
    ds_read_b64_tr_b16 a[188:189], v39 offset:16640
    buffer_load_dwordx4 v19, s[16:19], s36 offen offset:3072  lds
    ds_read_b64_tr_b16 a[190:191], v39 offset:24832
    v_mfma_f32_16x16x32_bf16 v[248:251], a[120:123], a[196:199], v[248:251]
    s_add_u32 s36, s36, 262144
    s_or_b32 s98, s98, s94
    v_mfma_f32_16x16x32_bf16 v[252:255], a[124:127], a[196:199], v[252:255]
    v_mfma_f32_16x16x32_bf16 v[244:247], a[124:127], a[192:195], v[244:247]
    s_andn2_b32 s94, s90, s91
    s_or_b32 s98, s98, s94
    v_add_u32 v27, 18432, v24
    v_xor_b32 v49, v112, v117
    v_lshlrev_b32 v49, 4, v49
    v_lshl_add_u32 v28, v112, 9, v49
    v_xor_b32 v29, 64, v28
    v_xor_b32 v30, 128, v28
    v_xor_b32 v31, 192, v28
    s_and_b32 s7, s33, 1
    s_andn2_b32 s94, s90, s91
    s_or_b32 s98, s98, s94
    s_lshl_b32 s7, s7, 12
    s_lshr_b32 s47, s33, 1
    s_lshl_b32 s47, s47, 14
    s_or_b32 s7, s7, s47
    v_and_b32 v49, 12, v112
    v_xor_b32 v53, s4, v49
    v_lshlrev_b32 v53, 8, v53
    v_lshl_add_u32 v53, v49, 17, v53
    s_andn2_b32 s94, s90, s91
    s_or_b32 s98, s98, s94
    v_lshl_add_u32 v53, v117, 6, v53
    v_lshl_add_u32 v53, v120, 4, v53
    s_lshl_b32 s47, s7, 1
    s_and_b32 s47, s47, 0x2000
    s_or_b32 s47, s47, s7
    v_add_u32 v53, s47, v53
    s_and_b32 s47, s4, 7
    s_lshl_b32 s47, s47, 18
    s_andn2_b32 s94, s90, s91
    s_or_b32 s98, s98, s94
    s_or_b32 s7, s7, s47
    s_lshr_b32 s47, s4, 3
    s_lshl_b32 s47, s47, 13
    s_or_b32 s7, s7, s47
    s_andn2_b32 s94, s90, s91
    s_or_b32 s98, s98, s94
    s_add_u32 s95, s95, s98
    s_waitcnt vmcnt(12) lgkmcnt(0)
    s_barrier
    v_mfma_f32_16x16x32_bf16 v[128:131], a[128:131], a[200:203], v[128:131]
    s_add_u32 m0, s32, 16384
    ds_read_b128 a[208:211], v40 offset:16384
    s_nop 0
    v_mfma_f32_16x16x32_bf16 v[136:139], a[128:131], a[204:207], v[136:139]
    ds_read_b128 a[212:215], v40 offset:18432
    v_mfma_f32_16x16x32_bf16 v[140:143], a[132:135], a[204:207], v[140:143]
    ds_read_b128 a[216:219], v41 offset:16384
    v_mfma_f32_16x16x32_bf16 v[132:135], a[132:135], a[200:203], v[132:135]
    ds_read_b128 a[220:223], v41 offset:18432
    v_mfma_f32_16x16x32_bf16 v[144:147], a[136:139], a[200:203], v[144:147]
    ds_read_b64_tr_b16 a[64:65], v32 offset:32768
    v_mfma_f32_16x16x32_bf16 v[152:155], a[136:139], a[204:207], v[152:155]
    ds_read_b64_tr_b16 a[66:67], v32 offset:40960
    v_mfma_f32_16x16x32_bf16 v[156:159], a[140:143], a[204:207], v[156:159]
    ds_read_b64_tr_b16 a[68:69], v33 offset:32768
    buffer_load_dwordx4 v16, s[16:19], s36 offen offset:0  lds
    v_mfma_f32_16x16x32_bf16 v[148:151], a[140:143], a[200:203], v[148:151]
    ds_read_b64_tr_b16 a[70:71], v33 offset:40960
    ds_read_b64_tr_b16 a[72:73], v34 offset:32768
    v_mfma_f32_16x16x32_bf16 v[160:163], a[144:147], a[200:203], v[160:163]
    ds_read_b64_tr_b16 a[74:75], v34 offset:40960
    v_mfma_f32_16x16x32_bf16 v[168:171], a[144:147], a[204:207], v[168:171]
    ds_read_b64_tr_b16 a[76:77], v35 offset:32768
    v_mfma_f32_16x16x32_bf16 v[172:175], a[148:151], a[204:207], v[172:175]
    ds_read_b64_tr_b16 a[78:79], v35 offset:40960
    v_mfma_f32_16x16x32_bf16 v[164:167], a[148:151], a[200:203], v[164:167]
    ds_read_b64_tr_b16 a[80:81], v36 offset:32768
    ds_read_b64_tr_b16 a[82:83], v36 offset:40960
    v_mfma_f32_16x16x32_bf16 v[176:179], a[152:155], a[200:203], v[176:179]
    ds_read_b64_tr_b16 a[84:85], v37 offset:32768
    buffer_load_dwordx4 v17, s[16:19], s36 offen offset:1024  lds
    v_mfma_f32_16x16x32_bf16 v[184:187], a[152:155], a[204:207], v[184:187]
    ds_read_b64_tr_b16 a[86:87], v37 offset:40960
    v_mfma_f32_16x16x32_bf16 v[188:191], a[156:159], a[204:207], v[188:191]
    ds_read_b64_tr_b16 a[88:89], v38 offset:32768
    v_mfma_f32_16x16x32_bf16 v[180:183], a[156:159], a[200:203], v[180:183]
    ds_read_b64_tr_b16 a[90:91], v38 offset:40960
    ds_read_b64_tr_b16 a[92:93], v39 offset:32768
    v_mfma_f32_16x16x32_bf16 v[192:195], a[160:163], a[200:203], v[192:195]
    ds_read_b64_tr_b16 a[94:95], v39 offset:40960
    v_mfma_f32_16x16x32_bf16 v[200:203], a[160:163], a[204:207], v[200:203]
    ds_read_b64_tr_b16 a[96:97], v32 offset:33024
    v_mfma_f32_16x16x32_bf16 v[204:207], a[164:167], a[204:207], v[204:207]
    ds_read_b64_tr_b16 a[98:99], v32 offset:41216
    buffer_load_dwordx4 v18, s[16:19], s36 offen offset:2048  lds
    v_mfma_f32_16x16x32_bf16 v[196:199], a[164:167], a[200:203], v[196:199]
    ds_read_b64_tr_b16 a[100:101], v33 offset:33024
    v_mfma_f32_16x16x32_bf16 v[208:211], a[168:171], a[200:203], v[208:211]
    ds_read_b64_tr_b16 a[102:103], v33 offset:41216
    ds_read_b64_tr_b16 a[104:105], v34 offset:33024
    v_mfma_f32_16x16x32_bf16 v[216:219], a[168:171], a[204:207], v[216:219]
    ds_read_b64_tr_b16 a[106:107], v34 offset:41216
    v_mfma_f32_16x16x32_bf16 v[220:223], a[172:175], a[204:207], v[220:223]
    ds_read_b64_tr_b16 a[108:109], v35 offset:33024
    v_mfma_f32_16x16x32_bf16 v[212:215], a[172:175], a[200:203], v[212:215]
    ds_read_b64_tr_b16 a[110:111], v35 offset:41216
    v_mfma_f32_16x16x32_bf16 v[224:227], a[176:179], a[200:203], v[224:227]
    ds_read_b64_tr_b16 a[112:113], v36 offset:33024
    ds_read_b64_tr_b16 a[114:115], v36 offset:41216
    v_mfma_f32_16x16x32_bf16 v[232:235], a[176:179], a[204:207], v[232:235]
    ds_read_b64_tr_b16 a[116:117], v37 offset:33024
    buffer_load_dwordx4 v19, s[16:19], s36 offen offset:3072  lds
    v_mfma_f32_16x16x32_bf16 v[236:239], a[180:183], a[204:207], v[236:239]
    s_add_u32 s36, s36, 262144
    ds_read_b64_tr_b16 a[118:119], v37 offset:41216
    v_mfma_f32_16x16x32_bf16 v[228:231], a[180:183], a[200:203], v[228:231]
    ds_read_b64_tr_b16 a[120:121], v38 offset:33024
    v_mfma_f32_16x16x32_bf16 v[240:243], a[184:187], a[200:203], v[240:243]
    ds_read_b64_tr_b16 a[122:123], v38 offset:41216
    ds_read_b64_tr_b16 a[124:125], v39 offset:33024
    ds_read_b64_tr_b16 a[126:127], v39 offset:41216
    v_mfma_f32_16x16x32_bf16 v[248:251], a[184:187], a[204:207], v[248:251]
    v_mfma_f32_16x16x32_bf16 v[252:255], a[188:191], a[204:207], v[252:255]
    v_mfma_f32_16x16x32_bf16 v[244:247], a[188:191], a[200:203], v[244:247]
    v_lshl_add_u32 v3, v0, 4, s7
    s_lshl_b32 s7, s6, 6
    s_lshl_b32 s47, s33, 3
    s_xor_b32 s47, s47, s4
    s_and_b32 s47, s47, 14
    s_add_u32 s7, s7, s47
    s_mul_i32 s7, s7, 3584
    s_mul_i32 s47, s3, 896
    s_add_u32 s7, s7, s47
    s_and_b32 s47, s4, 1
    s_lshl_b32 s47, s47, 6
    s_add_u32 s7, s7, s47
    v_and_b32 v4, 3, v121
    v_lshl_add_u32 v4, v113, 5, v4
    v_mul_u32_u24 v4, 1792, v4
    v_and_b32 v49, 1, v117
    v_lshl_add_u32 v4, v49, 5, v4
    v_lshl_add_u32 v4, v120, 3, v4
    v_add_u32 v4, s7, v4
    v_bfe_u32 v49, v121, 1, 2
    v_lshlrev_b32 v49, 5, v49
    v_lshl_add_u32 v49, v120, 3, v49
    v_lshl_add_u32 v42, v121, 7, v49
    v_xor_b32 v43, 32, v42
    v_xor_b32 v44, 64, v42
    v_xor_b32 v45, 96, v42
    v_mov_b32 v46, 0
    v_mov_b32 v47, 0
    s_waitcnt vmcnt(12) lgkmcnt(0)
    s_barrier
    s_mov_b64 s[90:91], 0
    s_mov_b32 s98, 0
    s_cmp_lg_u32 s33, 0
    s_cbranch_scc1 L_noprobe1B
    s_load_dword s90, s[92:93], 128 glc
    s_load_dword s91, s[92:93], 8320 glc
L_noprobe1B:
    v_mfma_f32_16x16x32_bf16 v[128:131], a[64:67], a[208:211], v[128:131]
    s_add_u32 m0, s32, 81920
    ds_read_b64_tr_b16 a[128:129], v32 offset:49152
    s_nop 0
    v_mfma_f32_16x16x32_bf16 v[136:139], a[64:67], a[212:215], v[136:139]
    ds_read_b64_tr_b16 a[130:131], v32 offset:57344
    v_mfma_f32_16x16x32_bf16 v[140:143], a[68:71], a[212:215], v[140:143]
    ds_read_b64_tr_b16 a[132:133], v33 offset:49152
    v_mfma_f32_16x16x32_bf16 v[132:135], a[68:71], a[208:211], v[132:135]
    buffer_load_dwordx4 v20, s[20:23], s37 offen offset:0  lds
    v_mfma_f32_16x16x32_bf16 v[144:147], a[72:75], a[208:211], v[144:147]
    ds_read_b64_tr_b16 a[134:135], v33 offset:57344
    v_mfma_f32_16x16x32_bf16 v[152:155], a[72:75], a[212:215], v[152:155]
    ds_read_b64_tr_b16 a[136:137], v34 offset:49152
    v_mfma_f32_16x16x32_bf16 v[156:159], a[76:79], a[212:215], v[156:159]
    ds_read_b64_tr_b16 a[138:139], v34 offset:57344
    ds_read_b64_tr_b16 a[140:141], v35 offset:49152
    v_mfma_f32_16x16x32_bf16 v[148:151], a[76:79], a[208:211], v[148:151]
    ds_read_b64_tr_b16 a[142:143], v35 offset:57344
    buffer_load_dwordx4 v21, s[20:23], s37 offen offset:1024  lds
    v_mfma_f32_16x16x32_bf16 v[160:163], a[80:83], a[208:211], v[160:163]
    ds_read_b64_tr_b16 a[144:145], v36 offset:49152
    v_mfma_f32_16x16x32_bf16 v[168:171], a[80:83], a[212:215], v[168:171]
    ds_read_b64_tr_b16 a[146:147], v36 offset:57344
    v_mfma_f32_16x16x32_bf16 v[172:175], a[84:87], a[212:215], v[172:175]
    ds_read_b64_tr_b16 a[148:149], v37 offset:49152
    buffer_load_dwordx4 v22, s[20:23], s37 offen offset:2048  lds
    v_mfma_f32_16x16x32_bf16 v[164:167], a[84:87], a[208:211], v[164:167]
    ds_read_b64_tr_b16 a[150:151], v37 offset:57344
    v_mfma_f32_16x16x32_bf16 v[176:179], a[88:91], a[208:211], v[176:179]
    ds_read_b64_tr_b16 a[152:153], v38 offset:49152
    v_mfma_f32_16x16x32_bf16 v[184:187], a[88:91], a[212:215], v[184:187]
    ds_read_b64_tr_b16 a[154:155], v38 offset:57344
    buffer_load_dwordx4 v23, s[20:23], s37 offen offset:3072  lds
    v_mfma_f32_16x16x32_bf16 v[188:191], a[92:95], a[212:215], v[188:191]
    s_add_u32 s37, s37, 128
    ds_read_b64_tr_b16 a[156:157], v39 offset:49152
    s_add_u32 m0, s32, 32768
    v_mfma_f32_16x16x32_bf16 v[180:183], a[92:95], a[208:211], v[180:183]
    s_nop 0
    ds_read_b64_tr_b16 a[158:159], v39 offset:57344
    ds_read_b64_tr_b16 a[160:161], v32 offset:49408
    v_mfma_f32_16x16x32_bf16 v[192:195], a[96:99], a[208:211], v[192:195]
    s_andn2_b32 s94, s90, s91
    ds_read_b64_tr_b16 a[162:163], v32 offset:57600
    s_or_b32 s98, s98, s94
    v_mfma_f32_16x16x32_bf16 v[200:203], a[96:99], a[212:215], v[200:203]
    s_andn2_b32 s94, s90, s91
    ds_read_b64_tr_b16 a[164:165], v33 offset:49408
    s_or_b32 s98, s98, s94
    v_mfma_f32_16x16x32_bf16 v[204:207], a[100:103], a[212:215], v[204:207]
    s_andn2_b32 s94, s90, s91
    ds_read_b64_tr_b16 a[166:167], v33 offset:57600
    buffer_load_dwordx4 v16, s[16:19], s36 offen offset:0  lds
    v_mfma_f32_16x16x32_bf16 v[196:199], a[100:103], a[208:211], v[196:199]
    s_or_b32 s98, s98, s94
    ds_read_b64_tr_b16 a[168:169], v34 offset:49408
    s_andn2_b32 s94, s90, s91
    v_mfma_f32_16x16x32_bf16 v[208:211], a[104:107], a[208:211], v[208:211]
    s_or_b32 s98, s98, s94
    ds_read_b64_tr_b16 a[170:171], v34 offset:57600
    v_mfma_f32_16x16x32_bf16 v[216:219], a[104:107], a[212:215], v[216:219]
    s_andn2_b32 s94, s90, s91
    ds_read_b64_tr_b16 a[172:173], v35 offset:49408
    v_mfma_f32_16x16x32_bf16 v[220:223], a[108:111], a[212:215], v[220:223]
    s_or_b32 s98, s98, s94
    ds_read_b64_tr_b16 a[174:175], v35 offset:57600
    buffer_load_dwordx4 v17, s[16:19], s36 offen offset:1024  lds
    v_mfma_f32_16x16x32_bf16 v[212:215], a[108:111], a[208:211], v[212:215]
    s_andn2_b32 s94, s90, s91
    ds_read_b64_tr_b16 a[176:177], v36 offset:49408
    v_mfma_f32_16x16x32_bf16 v[224:227], a[112:115], a[208:211], v[224:227]
    s_or_b32 s98, s98, s94
    ds_read_b64_tr_b16 a[178:179], v36 offset:57600
    v_mfma_f32_16x16x32_bf16 v[232:235], a[112:115], a[212:215], v[232:235]
    s_andn2_b32 s94, s90, s91
    ds_read_b64_tr_b16 a[180:181], v37 offset:49408
    buffer_load_dwordx4 v18, s[16:19], s36 offen offset:2048  lds
    v_mfma_f32_16x16x32_bf16 v[236:239], a[116:119], a[212:215], v[236:239]
    s_or_b32 s98, s98, s94
    ds_read_b64_tr_b16 a[182:183], v37 offset:57600
    ds_read_b64_tr_b16 a[184:185], v38 offset:49408
    v_mfma_f32_16x16x32_bf16 v[228:231], a[116:119], a[208:211], v[228:231]
    s_andn2_b32 s94, s90, s91
    ds_read_b64_tr_b16 a[186:187], v38 offset:57600
    s_or_b32 s98, s98, s94
    v_mfma_f32_16x16x32_bf16 v[240:243], a[120:123], a[208:211], v[240:243]
    s_andn2_b32 s94, s90, s91
    ds_read_b64_tr_b16 a[188:189], v39 offset:49408
    buffer_load_dwordx4 v19, s[16:19], s36 offen offset:3072  lds
    ds_read_b64_tr_b16 a[190:191], v39 offset:57600
    v_mfma_f32_16x16x32_bf16 v[248:251], a[120:123], a[212:215], v[248:251]
    s_add_u32 s36, s36, 262144
    s_or_b32 s98, s98, s94
    v_mfma_f32_16x16x32_bf16 v[252:255], a[124:127], a[212:215], v[252:255]
    v_mfma_f32_16x16x32_bf16 v[244:247], a[124:127], a[208:211], v[244:247]
    s_andn2_b32 s94, s90, s91
    s_or_b32 s98, s98, s94
    v_and_b32 v49, 1, v0
    v_lshlrev_b32 v49, 4, v49
    v_mov_b32 v50, 0x3f80
    v_lshlrev_b32 v50, v49, v50
    v_bfe_u32 v49, v0, 1, 3
    v_cmp_eq_u32 vcc, 0, v49
    s_nop 1
    v_cndmask_b32 v56, 0, v50, vcc
    s_andn2_b32 s94, s90, s91
    s_or_b32 s98, s98, s94
    v_cmp_eq_u32 vcc, 1, v49
    s_nop 1
    v_cndmask_b32 v57, 0, v50, vcc
    v_cmp_eq_u32 vcc, 2, v49
    s_nop 1
    v_cndmask_b32 v58, 0, v50, vcc
    v_cmp_eq_u32 vcc, 3, v49
    s_nop 1
    s_andn2_b32 s94, s90, s91
    s_or_b32 s98, s98, s94
    v_cndmask_b32 v59, 0, v50, vcc
    v_cmp_eq_u32 vcc, 4, v49
    s_nop 1
    v_cndmask_b32 v60, 0, v50, vcc
    v_cmp_eq_u32 vcc, 5, v49
    s_nop 1
    v_cndmask_b32 v61, 0, v50, vcc
    v_cmp_eq_u32 vcc, 6, v49
    s_andn2_b32 s94, s90, s91
    s_or_b32 s98, s98, s94
    s_nop 1
    v_cndmask_b32 v62, 0, v50, vcc
    v_cmp_eq_u32 vcc, 7, v49
    s_nop 1
    v_cndmask_b32 v63, 0, v50, vcc
    s_andn2_b32 s94, s90, s91
    s_or_b32 s98, s98, s94
    s_add_u32 s95, s95, s98
    s_waitcnt vmcnt(12) lgkmcnt(0)
    s_barrier
    v_mfma_f32_16x16x32_bf16 v[128:131], a[128:131], a[216:219], v[128:131]
    s_add_u32 m0, s32, 49152
    ds_read_b128 a[192:195], v40 offset:0
    s_nop 0
    v_mfma_f32_16x16x32_bf16 v[136:139], a[128:131], a[220:223], v[136:139]
    ds_read_b128 a[196:199], v40 offset:2048
    v_mfma_f32_16x16x32_bf16 v[140:143], a[132:135], a[220:223], v[140:143]
    ds_read_b128 a[200:203], v41 offset:0
    v_mfma_f32_16x16x32_bf16 v[132:135], a[132:135], a[216:219], v[132:135]
    ds_read_b128 a[204:207], v41 offset:2048
    v_mfma_f32_16x16x32_bf16 v[144:147], a[136:139], a[216:219], v[144:147]
    ds_read_b64_tr_b16 a[64:65], v32 offset:0
    v_mfma_f32_16x16x32_bf16 v[152:155], a[136:139], a[220:223], v[152:155]
    ds_read_b64_tr_b16 a[66:67], v32 offset:8192
    v_mfma_f32_16x16x32_bf16 v[156:159], a[140:143], a[220:223], v[156:159]
    ds_read_b64_tr_b16 a[68:69], v33 offset:0
    buffer_load_dwordx4 v16, s[16:19], s36 offen offset:0  lds
    v_mfma_f32_16x16x32_bf16 v[148:151], a[140:143], a[216:219], v[148:151]
    ds_read_b64_tr_b16 a[70:71], v33 offset:8192
    ds_read_b64_tr_b16 a[72:73], v34 offset:0
    v_mfma_f32_16x16x32_bf16 v[160:163], a[144:147], a[216:219], v[160:163]
    ds_read_b64_tr_b16 a[74:75], v34 offset:8192
    v_mfma_f32_16x16x32_bf16 v[168:171], a[144:147], a[220:223], v[168:171]
    ds_read_b64_tr_b16 a[76:77], v35 offset:0
    v_mfma_f32_16x16x32_bf16 v[172:175], a[148:151], a[220:223], v[172:175]
    ds_read_b64_tr_b16 a[78:79], v35 offset:8192
    v_mfma_f32_16x16x32_bf16 v[164:167], a[148:151], a[216:219], v[164:167]
    ds_read_b64_tr_b16 a[80:81], v36 offset:0
    ds_read_b64_tr_b16 a[82:83], v36 offset:8192
    v_mfma_f32_16x16x32_bf16 v[176:179], a[152:155], a[216:219], v[176:179]
    ds_read_b64_tr_b16 a[84:85], v37 offset:0
    buffer_load_dwordx4 v17, s[16:19], s36 offen offset:1024  lds
    v_mfma_f32_16x16x32_bf16 v[184:187], a[152:155], a[220:223], v[184:187]
    ds_read_b64_tr_b16 a[86:87], v37 offset:8192
    v_mfma_f32_16x16x32_bf16 v[188:191], a[156:159], a[220:223], v[188:191]
    ds_read_b64_tr_b16 a[88:89], v38 offset:0
    v_mfma_f32_16x16x32_bf16 v[180:183], a[156:159], a[216:219], v[180:183]
    ds_read_b64_tr_b16 a[90:91], v38 offset:8192
    ds_read_b64_tr_b16 a[92:93], v39 offset:0
    v_mfma_f32_16x16x32_bf16 v[192:195], a[160:163], a[216:219], v[192:195]
    ds_read_b64_tr_b16 a[94:95], v39 offset:8192
    v_mfma_f32_16x16x32_bf16 v[200:203], a[160:163], a[220:223], v[200:203]
    ds_read_b64_tr_b16 a[96:97], v32 offset:256
    v_mfma_f32_16x16x32_bf16 v[204:207], a[164:167], a[220:223], v[204:207]
    ds_read_b64_tr_b16 a[98:99], v32 offset:8448
    buffer_load_dwordx4 v18, s[16:19], s36 offen offset:2048  lds
    v_mfma_f32_16x16x32_bf16 v[196:199], a[164:167], a[216:219], v[196:199]
    ds_read_b64_tr_b16 a[100:101], v33 offset:256
    v_mfma_f32_16x16x32_bf16 v[208:211], a[168:171], a[216:219], v[208:211]
    ds_read_b64_tr_b16 a[102:103], v33 offset:8448
    ds_read_b64_tr_b16 a[104:105], v34 offset:256
    v_mfma_f32_16x16x32_bf16 v[216:219], a[168:171], a[220:223], v[216:219]
    ds_read_b64_tr_b16 a[106:107], v34 offset:8448
    v_mfma_f32_16x16x32_bf16 v[220:223], a[172:175], a[220:223], v[220:223]
    ds_read_b64_tr_b16 a[108:109], v35 offset:256
    v_mfma_f32_16x16x32_bf16 v[212:215], a[172:175], a[216:219], v[212:215]
    ds_read_b64_tr_b16 a[110:111], v35 offset:8448
    v_mfma_f32_16x16x32_bf16 v[224:227], a[176:179], a[216:219], v[224:227]
    ds_read_b64_tr_b16 a[112:113], v36 offset:256
    ds_read_b64_tr_b16 a[114:115], v36 offset:8448
    v_mfma_f32_16x16x32_bf16 v[232:235], a[176:179], a[220:223], v[232:235]
    ds_read_b64_tr_b16 a[116:117], v37 offset:256
    buffer_load_dwordx4 v19, s[16:19], s36 offen offset:3072  lds
    v_mfma_f32_16x16x32_bf16 v[236:239], a[180:183], a[220:223], v[236:239]
    s_add_u32 s36, s36, 262144
    ds_read_b64_tr_b16 a[118:119], v37 offset:8448
    v_mfma_f32_16x16x32_bf16 v[228:231], a[180:183], a[216:219], v[228:231]
    ds_read_b64_tr_b16 a[120:121], v38 offset:256
    v_mfma_f32_16x16x32_bf16 v[240:243], a[184:187], a[216:219], v[240:243]
    ds_read_b64_tr_b16 a[122:123], v38 offset:8448
    ds_read_b64_tr_b16 a[124:125], v39 offset:256
    ds_read_b64_tr_b16 a[126:127], v39 offset:8448
    v_mfma_f32_16x16x32_bf16 v[248:251], a[184:187], a[220:223], v[248:251]
    v_mfma_f32_16x16x32_bf16 v[252:255], a[188:191], a[220:223], v[252:255]
    v_mfma_f32_16x16x32_bf16 v[244:247], a[188:191], a[216:219], v[244:247]
    s_waitcnt vmcnt(12) lgkmcnt(0)
    s_barrier
    v_mfma_f32_16x16x32_bf16 v[128:131], a[64:67], a[192:195], v[128:131]
    s_add_u32 m0, s32, 65536
    ds_read_b64_tr_b16 a[128:129], v32 offset:16384
    s_nop 0
    v_mfma_f32_16x16x32_bf16 v[136:139], a[64:67], a[196:199], v[136:139]
    ds_read_b64_tr_b16 a[130:131], v32 offset:24576
    v_mfma_f32_16x16x32_bf16 v[140:143], a[68:71], a[196:199], v[140:143]
    ds_read_b64_tr_b16 a[132:133], v33 offset:16384
    v_mfma_f32_16x16x32_bf16 v[132:135], a[68:71], a[192:195], v[132:135]
    buffer_load_dwordx4 v20, s[20:23], s37 offen offset:0  lds
    v_mfma_f32_16x16x32_bf16 v[144:147], a[72:75], a[192:195], v[144:147]
    ds_read_b64_tr_b16 a[134:135], v33 offset:24576
    v_mfma_f32_16x16x32_bf16 v[152:155], a[72:75], a[196:199], v[152:155]
    ds_read_b64_tr_b16 a[136:137], v34 offset:16384
    v_mfma_f32_16x16x32_bf16 v[156:159], a[76:79], a[196:199], v[156:159]
    ds_read_b64_tr_b16 a[138:139], v34 offset:24576
    ds_read_b64_tr_b16 a[140:141], v35 offset:16384
    v_mfma_f32_16x16x32_bf16 v[148:151], a[76:79], a[192:195], v[148:151]
    ds_read_b64_tr_b16 a[142:143], v35 offset:24576
    buffer_load_dwordx4 v21, s[20:23], s37 offen offset:1024  lds
    v_mfma_f32_16x16x32_bf16 v[160:163], a[80:83], a[192:195], v[160:163]
    ds_read_b64_tr_b16 a[144:145], v36 offset:16384
    v_mfma_f32_16x16x32_bf16 v[168:171], a[80:83], a[196:199], v[168:171]
    ds_read_b64_tr_b16 a[146:147], v36 offset:24576
    v_mfma_f32_16x16x32_bf16 v[172:175], a[84:87], a[196:199], v[172:175]
    ds_read_b64_tr_b16 a[148:149], v37 offset:16384
    buffer_load_dwordx4 v22, s[20:23], s37 offen offset:2048  lds
    v_mfma_f32_16x16x32_bf16 v[164:167], a[84:87], a[192:195], v[164:167]
    ds_read_b64_tr_b16 a[150:151], v37 offset:24576
    v_mfma_f32_16x16x32_bf16 v[176:179], a[88:91], a[192:195], v[176:179]
    ds_read_b64_tr_b16 a[152:153], v38 offset:16384
    v_mfma_f32_16x16x32_bf16 v[184:187], a[88:91], a[196:199], v[184:187]
    ds_read_b64_tr_b16 a[154:155], v38 offset:24576
    buffer_load_dwordx4 v23, s[20:23], s37 offen offset:3072  lds
    v_mfma_f32_16x16x32_bf16 v[188:191], a[92:95], a[196:199], v[188:191]
    s_add_u32 s37, s37, 128
    ds_read_b64_tr_b16 a[156:157], v39 offset:16384
    s_add_u32 m0, s32, 0
    v_mfma_f32_16x16x32_bf16 v[180:183], a[92:95], a[192:195], v[180:183]
    s_nop 0
    ds_read_b64_tr_b16 a[158:159], v39 offset:24576
    ds_read_b64_tr_b16 a[160:161], v32 offset:16640
    v_mfma_f32_16x16x32_bf16 v[192:195], a[96:99], a[192:195], v[192:195]
    ds_read_b64_tr_b16 a[162:163], v32 offset:24832
    v_mfma_f32_16x16x32_bf16 v[200:203], a[96:99], a[196:199], v[200:203]
    ds_read_b64_tr_b16 a[164:165], v33 offset:16640
    v_mfma_f32_16x16x32_bf16 v[204:207], a[100:103], a[196:199], v[204:207]
    ds_read_b64_tr_b16 a[166:167], v33 offset:24832
    buffer_load_dwordx4 v16, s[16:19], s36 offen offset:0  lds
    v_mfma_f32_16x16x32_bf16 v[196:199], a[100:103], a[192:195], v[196:199]
    ds_read_b64_tr_b16 a[168:169], v34 offset:16640
    v_mfma_f32_16x16x32_bf16 v[208:211], a[104:107], a[192:195], v[208:211]
    ds_read_b64_tr_b16 a[170:171], v34 offset:24832
    v_mfma_f32_16x16x32_bf16 v[216:219], a[104:107], a[196:199], v[216:219]
    ds_read_b64_tr_b16 a[172:173], v35 offset:16640
    v_mfma_f32_16x16x32_bf16 v[220:223], a[108:111], a[196:199], v[220:223]
    ds_read_b64_tr_b16 a[174:175], v35 offset:24832
    buffer_load_dwordx4 v17, s[16:19], s36 offen offset:1024  lds
    v_mfma_f32_16x16x32_bf16 v[212:215], a[108:111], a[192:195], v[212:215]
    ds_read_b64_tr_b16 a[176:177], v36 offset:16640
    v_mfma_f32_16x16x32_bf16 v[224:227], a[112:115], a[192:195], v[224:227]
    ds_read_b64_tr_b16 a[178:179], v36 offset:24832
    v_mfma_f32_16x16x32_bf16 v[232:235], a[112:115], a[196:199], v[232:235]
    ds_read_b64_tr_b16 a[180:181], v37 offset:16640
    buffer_load_dwordx4 v18, s[16:19], s36 offen offset:2048  lds
    v_mfma_f32_16x16x32_bf16 v[236:239], a[116:119], a[196:199], v[236:239]
    ds_read_b64_tr_b16 a[182:183], v37 offset:24832
    ds_read_b64_tr_b16 a[184:185], v38 offset:16640
    v_mfma_f32_16x16x32_bf16 v[228:231], a[116:119], a[192:195], v[228:231]
    ds_read_b64_tr_b16 a[186:187], v38 offset:24832
    v_mfma_f32_16x16x32_bf16 v[240:243], a[120:123], a[192:195], v[240:243]
    ds_read_b64_tr_b16 a[188:189], v39 offset:16640
    buffer_load_dwordx4 v19, s[16:19], s36 offen offset:3072  lds
    ds_read_b64_tr_b16 a[190:191], v39 offset:24832
    v_mfma_f32_16x16x32_bf16 v[248:251], a[120:123], a[196:199], v[248:251]
    s_add_u32 s36, s36, 262144
    v_mfma_f32_16x16x32_bf16 v[252:255], a[124:127], a[196:199], v[252:255]
    v_mfma_f32_16x16x32_bf16 v[244:247], a[124:127], a[192:195], v[244:247]
    s_waitcnt vmcnt(12) lgkmcnt(0)
    s_barrier
    v_mfma_f32_16x16x32_bf16 v[128:131], a[128:131], a[200:203], v[128:131]
    s_add_u32 m0, s32, 16384
    ds_read_b128 a[208:211], v40 offset:16384
    s_nop 0
    v_mfma_f32_16x16x32_bf16 v[136:139], a[128:131], a[204:207], v[136:139]
    ds_read_b128 a[212:215], v40 offset:18432
    v_mfma_f32_16x16x32_bf16 v[140:143], a[132:135], a[204:207], v[140:143]
    ds_read_b128 a[216:219], v41 offset:16384
    v_mfma_f32_16x16x32_bf16 v[132:135], a[132:135], a[200:203], v[132:135]
    ds_read_b128 a[220:223], v41 offset:18432
    v_mfma_f32_16x16x32_bf16 v[144:147], a[136:139], a[200:203], v[144:147]
    ds_read_b64_tr_b16 a[64:65], v32 offset:32768
    v_mfma_f32_16x16x32_bf16 v[152:155], a[136:139], a[204:207], v[152:155]
    ds_read_b64_tr_b16 a[66:67], v32 offset:40960
    v_mfma_f32_16x16x32_bf16 v[156:159], a[140:143], a[204:207], v[156:159]
    ds_read_b64_tr_b16 a[68:69], v33 offset:32768
    buffer_load_dwordx4 v16, s[16:19], s36 offen offset:0  lds
    v_mfma_f32_16x16x32_bf16 v[148:151], a[140:143], a[200:203], v[148:151]
    ds_read_b64_tr_b16 a[70:71], v33 offset:40960
    ds_read_b64_tr_b16 a[72:73], v34 offset:32768
    v_mfma_f32_16x16x32_bf16 v[160:163], a[144:147], a[200:203], v[160:163]
    ds_read_b64_tr_b16 a[74:75], v34 offset:40960
    v_mfma_f32_16x16x32_bf16 v[168:171], a[144:147], a[204:207], v[168:171]
    ds_read_b64_tr_b16 a[76:77], v35 offset:32768
    v_mfma_f32_16x16x32_bf16 v[172:175], a[148:151], a[204:207], v[172:175]
    ds_read_b64_tr_b16 a[78:79], v35 offset:40960
    v_mfma_f32_16x16x32_bf16 v[164:167], a[148:151], a[200:203], v[164:167]
    ds_read_b64_tr_b16 a[80:81], v36 offset:32768
    ds_read_b64_tr_b16 a[82:83], v36 offset:40960
    v_mfma_f32_16x16x32_bf16 v[176:179], a[152:155], a[200:203], v[176:179]
    ds_read_b64_tr_b16 a[84:85], v37 offset:32768
    buffer_load_dwordx4 v17, s[16:19], s36 offen offset:1024  lds
    v_mfma_f32_16x16x32_bf16 v[184:187], a[152:155], a[204:207], v[184:187]
    ds_read_b64_tr_b16 a[86:87], v37 offset:40960
    v_mfma_f32_16x16x32_bf16 v[188:191], a[156:159], a[204:207], v[188:191]
    ds_read_b64_tr_b16 a[88:89], v38 offset:32768
    v_mfma_f32_16x16x32_bf16 v[180:183], a[156:159], a[200:203], v[180:183]
    ds_read_b64_tr_b16 a[90:91], v38 offset:40960
    ds_read_b64_tr_b16 a[92:93], v39 offset:32768
    v_mfma_f32_16x16x32_bf16 v[192:195], a[160:163], a[200:203], v[192:195]
    ds_read_b64_tr_b16 a[94:95], v39 offset:40960
    v_mfma_f32_16x16x32_bf16 v[200:203], a[160:163], a[204:207], v[200:203]
    ds_read_b64_tr_b16 a[96:97], v32 offset:33024
    v_mfma_f32_16x16x32_bf16 v[204:207], a[164:167], a[204:207], v[204:207]
    ds_read_b64_tr_b16 a[98:99], v32 offset:41216
    buffer_load_dwordx4 v18, s[16:19], s36 offen offset:2048  lds
    v_mfma_f32_16x16x32_bf16 v[196:199], a[164:167], a[200:203], v[196:199]
    ds_read_b64_tr_b16 a[100:101], v33 offset:33024
    v_mfma_f32_16x16x32_bf16 v[208:211], a[168:171], a[200:203], v[208:211]
    ds_read_b64_tr_b16 a[102:103], v33 offset:41216
    ds_read_b64_tr_b16 a[104:105], v34 offset:33024
    v_mfma_f32_16x16x32_bf16 v[216:219], a[168:171], a[204:207], v[216:219]
    ds_read_b64_tr_b16 a[106:107], v34 offset:41216
    v_mfma_f32_16x16x32_bf16 v[220:223], a[172:175], a[204:207], v[220:223]
    ds_read_b64_tr_b16 a[108:109], v35 offset:33024
    v_mfma_f32_16x16x32_bf16 v[212:215], a[172:175], a[200:203], v[212:215]
    ds_read_b64_tr_b16 a[110:111], v35 offset:41216
    v_mfma_f32_16x16x32_bf16 v[224:227], a[176:179], a[200:203], v[224:227]
    ds_read_b64_tr_b16 a[112:113], v36 offset:33024
    ds_read_b64_tr_b16 a[114:115], v36 offset:41216
    v_mfma_f32_16x16x32_bf16 v[232:235], a[176:179], a[204:207], v[232:235]
    ds_read_b64_tr_b16 a[116:117], v37 offset:33024
    buffer_load_dwordx4 v19, s[16:19], s36 offen offset:3072  lds
    v_mfma_f32_16x16x32_bf16 v[236:239], a[180:183], a[204:207], v[236:239]
    s_add_u32 s36, s36, 262144
    ds_read_b64_tr_b16 a[118:119], v37 offset:41216
    v_mfma_f32_16x16x32_bf16 v[228:231], a[180:183], a[200:203], v[228:231]
    ds_read_b64_tr_b16 a[120:121], v38 offset:33024
    v_mfma_f32_16x16x32_bf16 v[240:243], a[184:187], a[200:203], v[240:243]
    ds_read_b64_tr_b16 a[122:123], v38 offset:41216
    ds_read_b64_tr_b16 a[124:125], v39 offset:33024
    ds_read_b64_tr_b16 a[126:127], v39 offset:41216
    v_mfma_f32_16x16x32_bf16 v[248:251], a[184:187], a[204:207], v[248:251]
    v_mfma_f32_16x16x32_bf16 v[252:255], a[188:191], a[204:207], v[252:255]
    v_mfma_f32_16x16x32_bf16 v[244:247], a[188:191], a[200:203], v[244:247]
    s_waitcnt vmcnt(12) lgkmcnt(0)
    s_barrier
    v_mfma_f32_16x16x32_bf16 v[128:131], a[64:67], a[208:211], v[128:131]
    s_add_u32 m0, s32, 32768
    ds_read_b64_tr_b16 a[128:129], v32 offset:49152
    s_add_u32 s34, s34, 16384
    v_mfma_f32_16x16x32_bf16 v[136:139], a[64:67], a[212:215], v[136:139]
    s_and_b32 s34, s34, 0x7ffff
    ds_read_b64_tr_b16 a[130:131], v32 offset:57344
    v_mfma_f32_16x16x32_bf16 v[140:143], a[68:71], a[212:215], v[140:143]
    ds_read_b64_tr_b16 a[132:133], v33 offset:49152
    v_mfma_f32_16x16x32_bf16 v[132:135], a[68:71], a[208:211], v[132:135]
    ds_read_b64_tr_b16 a[134:135], v33 offset:57344
    v_mfma_f32_16x16x32_bf16 v[144:147], a[72:75], a[208:211], v[144:147]
    buffer_load_dwordx4 v8, s[8:11], s34 offen offset:0 nt lds
    v_mfma_f32_16x16x32_bf16 v[152:155], a[72:75], a[212:215], v[152:155]
    ds_read_b64_tr_b16 a[136:137], v34 offset:49152
    v_mfma_f32_16x16x32_bf16 v[156:159], a[76:79], a[212:215], v[156:159]
    ds_read_b64_tr_b16 a[138:139], v34 offset:57344
    ds_read_b64_tr_b16 a[140:141], v35 offset:49152
    v_mfma_f32_16x16x32_bf16 v[148:151], a[76:79], a[208:211], v[148:151]
    ds_read_b64_tr_b16 a[142:143], v35 offset:57344
    v_mfma_f32_16x16x32_bf16 v[160:163], a[80:83], a[208:211], v[160:163]
    ds_read_b64_tr_b16 a[144:145], v36 offset:49152
    v_mfma_f32_16x16x32_bf16 v[168:171], a[80:83], a[212:215], v[168:171]
    ds_read_b64_tr_b16 a[146:147], v36 offset:57344
    v_mfma_f32_16x16x32_bf16 v[172:175], a[84:87], a[212:215], v[172:175]
    ds_read_b64_tr_b16 a[148:149], v37 offset:49152
    v_mfma_f32_16x16x32_bf16 v[164:167], a[84:87], a[208:211], v[164:167]
    ds_read_b64_tr_b16 a[150:151], v37 offset:57344
    buffer_load_dwordx4 v9, s[8:11], s34 offen offset:1024 nt lds
    v_mfma_f32_16x16x32_bf16 v[176:179], a[88:91], a[208:211], v[176:179]
    ds_read_b64_tr_b16 a[152:153], v38 offset:49152
    v_mfma_f32_16x16x32_bf16 v[184:187], a[88:91], a[212:215], v[184:187]
    ds_read_b64_tr_b16 a[154:155], v38 offset:57344
    v_mfma_f32_16x16x32_bf16 v[188:191], a[92:95], a[212:215], v[188:191]
    ds_read_b64_tr_b16 a[156:157], v39 offset:49152
    v_mfma_f32_16x16x32_bf16 v[180:183], a[92:95], a[208:211], v[180:183]
    ds_read_b64_tr_b16 a[158:159], v39 offset:57344
    ds_read_b64_tr_b16 a[160:161], v32 offset:49408
    v_mfma_f32_16x16x32_bf16 v[192:195], a[96:99], a[208:211], v[192:195]
    ds_read_b64_tr_b16 a[162:163], v32 offset:57600
    v_mfma_f32_16x16x32_bf16 v[200:203], a[96:99], a[212:215], v[200:203]
    ds_read_b64_tr_b16 a[164:165], v33 offset:49408
    v_mfma_f32_16x16x32_bf16 v[204:207], a[100:103], a[212:215], v[204:207]
    ds_read_b64_tr_b16 a[166:167], v33 offset:57600
    buffer_load_dwordx4 v10, s[8:11], s34 offen offset:2048 nt lds
    v_mfma_f32_16x16x32_bf16 v[196:199], a[100:103], a[208:211], v[196:199]
    ds_read_b64_tr_b16 a[168:169], v34 offset:49408
    v_mfma_f32_16x16x32_bf16 v[208:211], a[104:107], a[208:211], v[208:211]
    ds_read_b64_tr_b16 a[170:171], v34 offset:57600
    v_mfma_f32_16x16x32_bf16 v[216:219], a[104:107], a[212:215], v[216:219]
    ds_read_b64_tr_b16 a[172:173], v35 offset:49408
    v_mfma_f32_16x16x32_bf16 v[220:223], a[108:111], a[212:215], v[220:223]
    ds_read_b64_tr_b16 a[174:175], v35 offset:57600
    v_mfma_f32_16x16x32_bf16 v[212:215], a[108:111], a[208:211], v[212:215]
    ds_read_b64_tr_b16 a[176:177], v36 offset:49408
    v_mfma_f32_16x16x32_bf16 v[224:227], a[112:115], a[208:211], v[224:227]
    ds_read_b64_tr_b16 a[178:179], v36 offset:57600
    v_mfma_f32_16x16x32_bf16 v[232:235], a[112:115], a[212:215], v[232:235]
    ds_read_b64_tr_b16 a[180:181], v37 offset:49408
    buffer_load_dwordx4 v11, s[8:11], s34 offen offset:3072 nt lds
    v_mfma_f32_16x16x32_bf16 v[236:239], a[116:119], a[212:215], v[236:239]
    ds_read_b64_tr_b16 a[182:183], v37 offset:57600
    ds_read_b64_tr_b16 a[184:185], v38 offset:49408
    v_mfma_f32_16x16x32_bf16 v[228:231], a[116:119], a[208:211], v[228:231]
    ds_read_b64_tr_b16 a[186:187], v38 offset:57600
    v_mfma_f32_16x16x32_bf16 v[240:243], a[120:123], a[208:211], v[240:243]
    ds_read_b64_tr_b16 a[188:189], v39 offset:49408
    ds_read_b64_tr_b16 a[190:191], v39 offset:57600
    v_mfma_f32_16x16x32_bf16 v[248:251], a[120:123], a[212:215], v[248:251]
    v_mfma_f32_16x16x32_bf16 v[252:255], a[124:127], a[212:215], v[252:255]
    v_mfma_f32_16x16x32_bf16 v[244:247], a[124:127], a[208:211], v[244:247]
    s_waitcnt vmcnt(8) lgkmcnt(0)
    s_barrier
    v_mfma_f32_16x16x32_bf16 v[128:131], a[128:131], a[216:219], v[128:131]
    s_add_u32 m0, s32, 49152
    ds_read_b128 a[192:195], v40 offset:0
    s_add_u32 s34, s34, 16384
    v_mfma_f32_16x16x32_bf16 v[136:139], a[128:131], a[220:223], v[136:139]
    s_and_b32 s34, s34, 0x7ffff
    ds_read_b128 a[196:199], v40 offset:2048
    v_mfma_f32_16x16x32_bf16 v[140:143], a[132:135], a[220:223], v[140:143]
    ds_read_b128 a[200:203], v41 offset:0
    v_mfma_f32_16x16x32_bf16 v[132:135], a[132:135], a[216:219], v[132:135]
    ds_read_b128 a[204:207], v41 offset:2048
    v_mfma_f32_16x16x32_bf16 v[144:147], a[136:139], a[216:219], v[144:147]
    ds_read_b64_tr_b16 a[64:65], v32 offset:0
    buffer_load_dwordx4 v8, s[8:11], s34 offen offset:0 nt lds
    v_mfma_f32_16x16x32_bf16 v[152:155], a[136:139], a[220:223], v[152:155]
    ds_read_b64_tr_b16 a[66:67], v32 offset:8192
    v_mfma_f32_16x16x32_bf16 v[156:159], a[140:143], a[220:223], v[156:159]
    ds_read_b64_tr_b16 a[68:69], v33 offset:0
    v_mfma_f32_16x16x32_bf16 v[148:151], a[140:143], a[216:219], v[148:151]
    ds_read_b64_tr_b16 a[70:71], v33 offset:8192
    ds_read_b64_tr_b16 a[72:73], v34 offset:0
    v_mfma_f32_16x16x32_bf16 v[160:163], a[144:147], a[216:219], v[160:163]
    ds_read_b64_tr_b16 a[74:75], v34 offset:8192
    v_mfma_f32_16x16x32_bf16 v[168:171], a[144:147], a[220:223], v[168:171]
    ds_read_b64_tr_b16 a[76:77], v35 offset:0
    v_mfma_f32_16x16x32_bf16 v[172:175], a[148:151], a[220:223], v[172:175]
    ds_read_b64_tr_b16 a[78:79], v35 offset:8192
    v_mfma_f32_16x16x32_bf16 v[164:167], a[148:151], a[216:219], v[164:167]
    ds_read_b64_tr_b16 a[80:81], v36 offset:0
    ds_read_b64_tr_b16 a[82:83], v36 offset:8192
    v_mfma_f32_16x16x32_bf16 v[176:179], a[152:155], a[216:219], v[176:179]
    ds_read_b64_tr_b16 a[84:85], v37 offset:0
    buffer_load_dwordx4 v9, s[8:11], s34 offen offset:1024 nt lds
    v_mfma_f32_16x16x32_bf16 v[184:187], a[152:155], a[220:223], v[184:187]
    ds_read_b64_tr_b16 a[86:87], v37 offset:8192
    v_mfma_f32_16x16x32_bf16 v[188:191], a[156:159], a[220:223], v[188:191]
    ds_read_b64_tr_b16 a[88:89], v38 offset:0
    v_mfma_f32_16x16x32_bf16 v[180:183], a[156:159], a[216:219], v[180:183]
    ds_read_b64_tr_b16 a[90:91], v38 offset:8192
    ds_read_b64_tr_b16 a[92:93], v39 offset:0
    v_mfma_f32_16x16x32_bf16 v[192:195], a[160:163], a[216:219], v[192:195]
    ds_read_b64_tr_b16 a[94:95], v39 offset:8192
    v_mfma_f32_16x16x32_bf16 v[200:203], a[160:163], a[220:223], v[200:203]
    ds_read_b64_tr_b16 a[96:97], v32 offset:256
    v_mfma_f32_16x16x32_bf16 v[204:207], a[164:167], a[220:223], v[204:207]
    ds_read_b64_tr_b16 a[98:99], v32 offset:8448
    buffer_load_dwordx4 v10, s[8:11], s34 offen offset:2048 nt lds
    v_mfma_f32_16x16x32_bf16 v[196:199], a[164:167], a[216:219], v[196:199]
    ds_read_b64_tr_b16 a[100:101], v33 offset:256
    v_mfma_f32_16x16x32_bf16 v[208:211], a[168:171], a[216:219], v[208:211]
    ds_read_b64_tr_b16 a[102:103], v33 offset:8448
    ds_read_b64_tr_b16 a[104:105], v34 offset:256
    v_mfma_f32_16x16x32_bf16 v[216:219], a[168:171], a[220:223], v[216:219]
    ds_read_b64_tr_b16 a[106:107], v34 offset:8448
    v_mfma_f32_16x16x32_bf16 v[220:223], a[172:175], a[220:223], v[220:223]
    ds_read_b64_tr_b16 a[108:109], v35 offset:256
    v_mfma_f32_16x16x32_bf16 v[212:215], a[172:175], a[216:219], v[212:215]
    ds_read_b64_tr_b16 a[110:111], v35 offset:8448
    v_mfma_f32_16x16x32_bf16 v[224:227], a[176:179], a[216:219], v[224:227]
    ds_read_b64_tr_b16 a[112:113], v36 offset:256
    ds_read_b64_tr_b16 a[114:115], v36 offset:8448
    v_mfma_f32_16x16x32_bf16 v[232:235], a[176:179], a[220:223], v[232:235]
    ds_read_b64_tr_b16 a[116:117], v37 offset:256
    buffer_load_dwordx4 v11, s[8:11], s34 offen offset:3072 nt lds
    v_mfma_f32_16x16x32_bf16 v[236:239], a[180:183], a[220:223], v[236:239]
    ds_read_b64_tr_b16 a[118:119], v37 offset:8448
    v_mfma_f32_16x16x32_bf16 v[228:231], a[180:183], a[216:219], v[228:231]
    ds_read_b64_tr_b16 a[120:121], v38 offset:256
    v_mfma_f32_16x16x32_bf16 v[240:243], a[184:187], a[216:219], v[240:243]
    ds_read_b64_tr_b16 a[122:123], v38 offset:8448
    ds_read_b64_tr_b16 a[124:125], v39 offset:256
    ds_read_b64_tr_b16 a[126:127], v39 offset:8448
    v_mfma_f32_16x16x32_bf16 v[248:251], a[184:187], a[220:223], v[248:251]
    s_mul_i32 s47, s33, 14336
    v_subrev_u32 v16, s47, v24
    v_subrev_u32 v17, s47, v25
    v_mfma_f32_16x16x32_bf16 v[252:255], a[188:191], a[220:223], v[252:255]
    v_mfma_f32_16x16x32_bf16 v[244:247], a[188:191], a[216:219], v[244:247]
    s_waitcnt vmcnt(8) lgkmcnt(0)
    s_barrier
    v_mfma_f32_16x16x32_bf16 v[128:131], a[64:67], a[192:195], v[128:131]
    s_add_u32 m0, s32, 0
    ds_read_b64_tr_b16 a[128:129], v32 offset:16384
    s_add_u32 s35, s35, 16384
    v_mfma_f32_16x16x32_bf16 v[136:139], a[64:67], a[196:199], v[136:139]
    s_and_b32 s35, s35, 0x7ffff
    ds_read_b64_tr_b16 a[130:131], v32 offset:24576
    v_mfma_f32_16x16x32_bf16 v[140:143], a[68:71], a[196:199], v[140:143]
    ds_read_b64_tr_b16 a[132:133], v33 offset:16384
    v_mfma_f32_16x16x32_bf16 v[132:135], a[68:71], a[192:195], v[132:135]
    ds_read_b64_tr_b16 a[134:135], v33 offset:24576
    v_mfma_f32_16x16x32_bf16 v[144:147], a[72:75], a[192:195], v[144:147]
    buffer_load_dwordx4 v12, s[12:15], s35 offen offset:0 nt lds
    v_mfma_f32_16x16x32_bf16 v[152:155], a[72:75], a[196:199], v[152:155]
    ds_read_b64_tr_b16 a[136:137], v34 offset:16384
    v_mfma_f32_16x16x32_bf16 v[156:159], a[76:79], a[196:199], v[156:159]
    ds_read_b64_tr_b16 a[138:139], v34 offset:24576
    ds_read_b64_tr_b16 a[140:141], v35 offset:16384
    v_mfma_f32_16x16x32_bf16 v[148:151], a[76:79], a[192:195], v[148:151]
    ds_read_b64_tr_b16 a[142:143], v35 offset:24576
    v_mfma_f32_16x16x32_bf16 v[160:163], a[80:83], a[192:195], v[160:163]
    ds_read_b64_tr_b16 a[144:145], v36 offset:16384
    v_mfma_f32_16x16x32_bf16 v[168:171], a[80:83], a[196:199], v[168:171]
    ds_read_b64_tr_b16 a[146:147], v36 offset:24576
    v_mfma_f32_16x16x32_bf16 v[172:175], a[84:87], a[196:199], v[172:175]
    ds_read_b64_tr_b16 a[148:149], v37 offset:16384
    v_mfma_f32_16x16x32_bf16 v[164:167], a[84:87], a[192:195], v[164:167]
    ds_read_b64_tr_b16 a[150:151], v37 offset:24576
    buffer_load_dwordx4 v13, s[12:15], s35 offen offset:1024 nt lds
    v_mfma_f32_16x16x32_bf16 v[176:179], a[88:91], a[192:195], v[176:179]
    ds_read_b64_tr_b16 a[152:153], v38 offset:16384
    v_mfma_f32_16x16x32_bf16 v[184:187], a[88:91], a[196:199], v[184:187]
    ds_read_b64_tr_b16 a[154:155], v38 offset:24576
    v_mfma_f32_16x16x32_bf16 v[188:191], a[92:95], a[196:199], v[188:191]
    ds_read_b64_tr_b16 a[156:157], v39 offset:16384
    v_mfma_f32_16x16x32_bf16 v[180:183], a[92:95], a[192:195], v[180:183]
    ds_read_b64_tr_b16 a[158:159], v39 offset:24576
    ds_read_b64_tr_b16 a[160:161], v32 offset:16640
    v_mfma_f32_16x16x32_bf16 v[192:195], a[96:99], a[192:195], v[192:195]
    ds_read_b64_tr_b16 a[162:163], v32 offset:24832
    v_mfma_f32_16x16x32_bf16 v[200:203], a[96:99], a[196:199], v[200:203]
    ds_read_b64_tr_b16 a[164:165], v33 offset:16640
    v_mfma_f32_16x16x32_bf16 v[204:207], a[100:103], a[196:199], v[204:207]
    ds_read_b64_tr_b16 a[166:167], v33 offset:24832
    buffer_load_dwordx4 v14, s[12:15], s35 offen offset:2048 nt lds
    v_mfma_f32_16x16x32_bf16 v[196:199], a[100:103], a[192:195], v[196:199]
    ds_read_b64_tr_b16 a[168:169], v34 offset:16640
    v_mfma_f32_16x16x32_bf16 v[208:211], a[104:107], a[192:195], v[208:211]
    ds_read_b64_tr_b16 a[170:171], v34 offset:24832
    v_mfma_f32_16x16x32_bf16 v[216:219], a[104:107], a[196:199], v[216:219]
    ds_read_b64_tr_b16 a[172:173], v35 offset:16640
    v_mfma_f32_16x16x32_bf16 v[220:223], a[108:111], a[196:199], v[220:223]
    ds_read_b64_tr_b16 a[174:175], v35 offset:24832
    v_mfma_f32_16x16x32_bf16 v[212:215], a[108:111], a[192:195], v[212:215]
    ds_read_b64_tr_b16 a[176:177], v36 offset:16640
    v_mfma_f32_16x16x32_bf16 v[224:227], a[112:115], a[192:195], v[224:227]
    ds_read_b64_tr_b16 a[178:179], v36 offset:24832
    v_mfma_f32_16x16x32_bf16 v[232:235], a[112:115], a[196:199], v[232:235]
    ds_read_b64_tr_b16 a[180:181], v37 offset:16640
    buffer_load_dwordx4 v15, s[12:15], s35 offen offset:3072 nt lds
    v_mfma_f32_16x16x32_bf16 v[236:239], a[116:119], a[196:199], v[236:239]
    ds_read_b64_tr_b16 a[182:183], v37 offset:24832
    ds_read_b64_tr_b16 a[184:185], v38 offset:16640
    v_mfma_f32_16x16x32_bf16 v[228:231], a[116:119], a[192:195], v[228:231]
    ds_read_b64_tr_b16 a[186:187], v38 offset:24832
    v_mfma_f32_16x16x32_bf16 v[240:243], a[120:123], a[192:195], v[240:243]
    ds_read_b64_tr_b16 a[188:189], v39 offset:16640
    ds_read_b64_tr_b16 a[190:191], v39 offset:24832
    v_mfma_f32_16x16x32_bf16 v[248:251], a[120:123], a[196:199], v[248:251]
    v_mfma_f32_16x16x32_bf16 v[252:255], a[124:127], a[196:199], v[252:255]
    v_mfma_f32_16x16x32_bf16 v[244:247], a[124:127], a[192:195], v[244:247]
    s_waitcnt vmcnt(8) lgkmcnt(0)
    s_barrier
    v_mfma_f32_16x16x32_bf16 v[128:131], a[128:131], a[200:203], v[128:131]
    s_add_u32 m0, s32, 16384
    ds_read_b128 a[64:67], v28 offset:32768
    s_add_u32 s34, s34, 16384
    v_mfma_f32_16x16x32_bf16 v[136:139], a[128:131], a[204:207], v[136:139]
    s_and_b32 s34, s34, 0x7ffff
    ds_read_b128 a[68:71], v28 offset:40960
    v_mfma_f32_16x16x32_bf16 v[140:143], a[132:135], a[204:207], v[140:143]
    buffer_load_dwordx4 v8, s[8:11], s34 offen offset:0 nt lds
    v_mfma_f32_16x16x32_bf16 v[132:135], a[132:135], a[200:203], v[132:135]
    ds_read_b128 a[72:75], v29 offset:32768
    v_mfma_f32_16x16x32_bf16 v[144:147], a[136:139], a[200:203], v[144:147]
    ds_read_b128 a[76:79], v29 offset:40960
    v_mfma_f32_16x16x32_bf16 v[152:155], a[136:139], a[204:207], v[152:155]
    ds_read_b128 a[80:83], v30 offset:32768
    v_mfma_f32_16x16x32_bf16 v[156:159], a[140:143], a[204:207], v[156:159]
    v_mfma_f32_16x16x32_bf16 v[148:151], a[140:143], a[200:203], v[148:151]
    ds_read_b128 a[84:87], v30 offset:40960
    v_mfma_f32_16x16x32_bf16 v[160:163], a[144:147], a[200:203], v[160:163]
    v_mul_f32 v128, s41, v128
    v_mul_f32 v129, s41, v129
    v_mfma_f32_16x16x32_bf16 v[168:171], a[144:147], a[204:207], v[168:171]
    ds_read_b128 a[88:91], v31 offset:32768
    v_mul_f32 v130, s41, v130
    v_mfma_f32_16x16x32_bf16 v[172:175], a[148:151], a[204:207], v[172:175]
    v_mul_f32 v131, s41, v131
    v_mul_f32 v132, s41, v132
    v_mfma_f32_16x16x32_bf16 v[164:167], a[148:151], a[200:203], v[164:167]
    ds_read_b128 a[92:95], v31 offset:40960
    v_mul_f32 v133, s41, v133
    v_mfma_f32_16x16x32_bf16 v[176:179], a[152:155], a[200:203], v[176:179]
    buffer_load_dwordx4 v9, s[8:11], s34 offen offset:1024 nt lds
    v_mul_f32 v134, s41, v134
    v_mul_f32 v135, s41, v135
    v_cvt_pk_bf16_f32 v112, v128, v129
    v_mfma_f32_16x16x32_bf16 v[184:187], a[152:155], a[204:207], v[184:187]
    ds_read_b128 a[96:99], v28 offset:33024
    v_cvt_pk_bf16_f32 v114, v132, v133
    v_cvt_pk_bf16_f32 v113, v130, v131
    v_cvt_pk_bf16_f32 v115, v134, v135
    v_mfma_f32_16x16x32_bf16 v[188:191], a[156:159], a[204:207], v[188:191]
    ds_read_b128 a[100:103], v28 offset:41216
    v_mul_f32 v136, s41, v136
    v_mul_f32 v137, s41, v137
    v_mul_f32 v138, s41, v138
    v_mul_f32 v139, s41, v139
    v_mfma_f32_16x16x32_bf16 v[180:183], a[156:159], a[200:203], v[180:183]
    v_mul_f32 v140, s41, v140
    v_mul_f32 v141, s41, v141
    v_mul_f32 v142, s41, v142
    v_mfma_f32_16x16x32_bf16 v[192:195], a[160:163], a[200:203], v[192:195]
    ds_read_b128 a[104:107], v29 offset:33024
    v_mul_f32 v143, s41, v143
    v_cvt_pk_bf16_f32 v116, v136, v137
    v_cvt_pk_bf16_f32 v118, v140, v141
    v_mfma_f32_16x16x32_bf16 v[200:203], a[160:163], a[204:207], v[200:203]
    v_cvt_pk_bf16_f32 v117, v138, v139
    v_cvt_pk_bf16_f32 v119, v142, v143
    v_permlane32_swap_b32 v112, v114
    v_permlane32_swap_b32 v113, v115
    v_mfma_f32_16x16x32_bf16 v[204:207], a[164:167], a[204:207], v[204:207]
    ds_read_b128 a[108:111], v29 offset:41216
    v_permlane32_swap_b32 v116, v118
    v_permlane32_swap_b32 v117, v119
    v_permlane16_swap_b32 v112, v114
    v_mfma_f32_16x16x32_bf16 v[196:199], a[164:167], a[200:203], v[196:199]
    buffer_load_dwordx4 v10, s[8:11], s34 offen offset:2048 nt lds
    v_permlane16_swap_b32 v113, v115
    v_permlane16_swap_b32 v116, v118
    v_permlane16_swap_b32 v117, v119
    v_mfma_f32_16x16x32_bf16 v[208:211], a[168:171], a[200:203], v[208:211]
    ds_read_b128 a[112:115], v30 offset:33024
    v_accvgpr_write_b32 a0, v112
    v_accvgpr_write_b32 a2, v114
    v_accvgpr_write_b32 a1, v113
    v_accvgpr_write_b32 a3, v115
    v_mfma_f32_16x16x32_bf16 v[216:219], a[168:171], a[204:207], v[216:219]
    v_accvgpr_write_b32 a4, v116
    v_accvgpr_write_b32 a6, v118
    v_accvgpr_write_b32 a5, v117
    v_mfma_f32_16x16x32_bf16 v[220:223], a[172:175], a[204:207], v[220:223]
    ds_read_b128 a[116:119], v30 offset:41216
    v_accvgpr_write_b32 a7, v119
    v_mul_f32 v144, s41, v144
    v_mul_f32 v145, s41, v145
    v_mfma_f32_16x16x32_bf16 v[212:215], a[172:175], a[200:203], v[212:215]
    ds_read_b128 a[120:123], v31 offset:33024
    v_mul_f32 v146, s41, v146
    v_mul_f32 v147, s41, v147
    v_mul_f32 v148, s41, v148
    v_mul_f32 v149, s41, v149
    v_mfma_f32_16x16x32_bf16 v[224:227], a[176:179], a[200:203], v[224:227]
    v_mul_f32 v150, s41, v150
    v_mul_f32 v151, s41, v151
    v_cvt_pk_bf16_f32 v112, v144, v145
    v_mfma_f32_16x16x32_bf16 v[232:235], a[176:179], a[204:207], v[232:235]
    ds_read_b128 a[124:127], v31 offset:41216
    v_cvt_pk_bf16_f32 v114, v148, v149
    v_cvt_pk_bf16_f32 v113, v146, v147
    v_cvt_pk_bf16_f32 v115, v150, v151
    v_mfma_f32_16x16x32_bf16 v[236:239], a[180:183], a[204:207], v[236:239]
    buffer_load_dwordx4 v11, s[8:11], s34 offen offset:3072 nt lds
    v_mul_f32 v152, s41, v152
    v_mul_f32 v153, s41, v153
    v_mul_f32 v154, s41, v154
    v_mul_f32 v155, s41, v155
    v_mfma_f32_16x16x32_bf16 v[228:231], a[180:183], a[200:203], v[228:231]
    v_mul_f32 v156, s41, v156
    v_mul_f32 v157, s41, v157
    v_mul_f32 v158, s41, v158
    v_mfma_f32_16x16x32_bf16 v[240:243], a[184:187], a[200:203], v[240:243]
    v_mul_f32 v159, s41, v159
    v_cvt_pk_bf16_f32 v116, v152, v153
    v_cvt_pk_bf16_f32 v118, v156, v157
    v_mfma_f32_16x16x32_bf16 v[248:251], a[184:187], a[204:207], v[248:251]
    v_cvt_pk_bf16_f32 v117, v154, v155
    v_cvt_pk_bf16_f32 v119, v158, v159
    v_permlane32_swap_b32 v112, v114
    v_permlane32_swap_b32 v113, v115
    v_mfma_f32_16x16x32_bf16 v[252:255], a[188:191], a[204:207], v[252:255]
    v_permlane32_swap_b32 v116, v118
    v_permlane32_swap_b32 v117, v119
    v_permlane16_swap_b32 v112, v114
    v_mfma_f32_16x16x32_bf16 v[244:247], a[188:191], a[200:203], v[244:247]
    v_permlane16_swap_b32 v113, v115
    v_permlane16_swap_b32 v116, v118
    v_permlane16_swap_b32 v117, v119
    v_accvgpr_write_b32 a8, v112
    v_accvgpr_write_b32 a10, v114
    v_accvgpr_write_b32 a9, v113
    v_accvgpr_write_b32 a11, v115
    v_accvgpr_write_b32 a12, v116
    v_accvgpr_write_b32 a14, v118
    v_accvgpr_write_b32 a13, v117
    v_accvgpr_write_b32 a15, v119
    s_nop 3
    s_waitcnt vmcnt(8) lgkmcnt(0)
    s_barrier
    v_mfma_f32_16x16x32_bf16 v[64:67], a[64:67], a[0:3], 0
    s_add_u32 m0, s32, 32768
    ds_read_b128 a[128:131], v28 offset:49152
    v_mul_f32 v160, s41, v160
    v_mfma_f32_16x16x32_bf16 v[68:71], a[68:71], a[0:3], 0
    s_add_u32 s35, s35, 16384
    ds_read_b128 a[132:135], v28 offset:57344
    v_mul_f32 v161, s41, v161
    v_mfma_f32_16x16x32_bf16 v[76:79], a[68:71], a[4:7], 0
    s_and_b32 s35, s35, 0x7ffff
    ds_read_b128 a[136:139], v29 offset:49152
    v_mul_f32 v162, s41, v162
    v_mul_f32 v163, s41, v163
    v_mul_f32 v164, s41, v164
    v_mul_f32 v165, s41, v165
    v_mfma_f32_16x16x32_bf16 v[72:75], a[64:67], a[4:7], 0
    ds_read_b128 a[140:143], v29 offset:57344
    v_mul_f32 v166, s41, v166
    v_mul_f32 v167, s41, v167
    v_cvt_pk_bf16_f32 v112, v160, v161
    v_cvt_pk_bf16_f32 v114, v164, v165
    v_cvt_pk_bf16_f32 v113, v162, v163
    v_cvt_pk_bf16_f32 v115, v166, v167
    v_mul_f32 v168, s41, v168
    v_mul_f32 v169, s41, v169
    v_mul_f32 v170, s41, v170
    v_mul_f32 v171, s41, v171
    v_mfma_f32_16x16x32_bf16 v[64:67], a[72:75], a[8:11], v[64:67]
    buffer_load_dwordx4 v12, s[12:15], s35 offen offset:0 nt lds
    v_mul_f32 v172, s41, v172
    v_mul_f32 v173, s41, v173
    v_mul_f32 v174, s41, v174
    v_mul_f32 v175, s41, v175
    v_cvt_pk_bf16_f32 v116, v168, v169
    v_cvt_pk_bf16_f32 v118, v172, v173
    v_cvt_pk_bf16_f32 v117, v170, v171
    v_cvt_pk_bf16_f32 v119, v174, v175
    v_permlane32_swap_b32 v112, v114
    v_permlane32_swap_b32 v113, v115
    v_permlane32_swap_b32 v116, v118
    v_mfma_f32_16x16x32_bf16 v[68:71], a[76:79], a[8:11], v[68:71]
    ds_read_b128 a[144:147], v30 offset:49152
    v_permlane32_swap_b32 v117, v119
    v_permlane16_swap_b32 v112, v114
    v_permlane16_swap_b32 v113, v115
    v_permlane16_swap_b32 v116, v118
    v_permlane16_swap_b32 v117, v119
    v_accvgpr_write_b32 a16, v112
    v_accvgpr_write_b32 a18, v114
    v_accvgpr_write_b32 a17, v113
    v_accvgpr_write_b32 a19, v115
    v_accvgpr_write_b32 a20, v116
    v_mfma_f32_16x16x32_bf16 v[76:79], a[76:79], a[12:15], v[76:79]
    buffer_load_dwordx4 v13, s[12:15], s35 offen offset:1024 nt lds
    v_accvgpr_write_b32 a22, v118
    v_accvgpr_write_b32 a21, v117
    v_accvgpr_write_b32 a23, v119
    v_mul_f32 v176, s41, v176
    v_mul_f32 v177, s41, v177
    v_mul_f32 v178, s41, v178
    v_mul_f32 v179, s41, v179
    v_mul_f32 v180, s41, v180
    v_mul_f32 v181, s41, v181
    v_mul_f32 v182, s41, v182
    v_mfma_f32_16x16x32_bf16 v[72:75], a[72:75], a[12:15], v[72:75]
    ds_read_b128 a[148:151], v30 offset:57344
    v_mul_f32 v183, s41, v183
    v_cvt_pk_bf16_f32 v112, v176, v177
    v_cvt_pk_bf16_f32 v114, v180, v181
    v_cvt_pk_bf16_f32 v113, v178, v179
    v_cvt_pk_bf16_f32 v115, v182, v183
    v_mul_f32 v184, s41, v184
    v_mul_f32 v185, s41, v185
    v_mul_f32 v186, s41, v186
    v_mul_f32 v187, s41, v187
    v_mul_f32 v188, s41, v188
    v_mul_f32 v189, s41, v189
    v_mfma_f32_16x16x32_bf16 v[64:67], a[80:83], a[16:19], v[64:67]
    v_mul_f32 v190, s41, v190
    v_mul_f32 v191, s41, v191
    v_cvt_pk_bf16_f32 v116, v184, v185
    v_cvt_pk_bf16_f32 v118, v188, v189
    v_cvt_pk_bf16_f32 v117, v186, v187
    v_cvt_pk_bf16_f32 v119, v190, v191
    v_permlane32_swap_b32 v112, v114
    v_permlane32_swap_b32 v113, v115
    v_permlane32_swap_b32 v116, v118
    v_permlane32_swap_b32 v117, v119
    v_mfma_f32_16x16x32_bf16 v[68:71], a[84:87], a[16:19], v[68:71]
    buffer_load_dwordx4 v14, s[12:15], s35 offen offset:2048 nt lds
    v_permlane16_swap_b32 v112, v114
    v_permlane16_swap_b32 v113, v115
    v_permlane16_swap_b32 v116, v118
    v_permlane16_swap_b32 v117, v119
    v_accvgpr_write_b32 a24, v112
    v_accvgpr_write_b32 a26, v114
    v_accvgpr_write_b32 a25, v113
    v_accvgpr_write_b32 a27, v115
    v_accvgpr_write_b32 a28, v116
    v_accvgpr_write_b32 a30, v118
    v_accvgpr_write_b32 a29, v117
    v_mfma_f32_16x16x32_bf16 v[76:79], a[84:87], a[20:23], v[76:79]
    ds_read_b128 a[152:155], v31 offset:49152
    v_accvgpr_write_b32 a31, v119
    v_mul_f32 v192, s41, v192
    v_mul_f32 v193, s41, v193
    v_mul_f32 v194, s41, v194
    v_mul_f32 v195, s41, v195
    v_mul_f32 v196, s41, v196
    v_mul_f32 v197, s41, v197
    v_mul_f32 v198, s41, v198
    v_mul_f32 v199, s41, v199
    v_cvt_pk_bf16_f32 v112, v192, v193
    v_mfma_f32_16x16x32_bf16 v[72:75], a[80:83], a[20:23], v[72:75]
    buffer_load_dwordx4 v15, s[12:15], s35 offen offset:3072 nt lds
    v_cvt_pk_bf16_f32 v114, v196, v197
    v_cvt_pk_bf16_f32 v113, v194, v195
    v_cvt_pk_bf16_f32 v115, v198, v199
    v_mul_f32 v200, s41, v200
    v_mul_f32 v201, s41, v201
    v_mul_f32 v202, s41, v202
    v_mul_f32 v203, s41, v203
    v_mul_f32 v204, s41, v204
    v_mul_f32 v205, s41, v205
    v_mul_f32 v206, s41, v206
    v_mul_f32 v207, s41, v207
    v_mfma_f32_16x16x32_bf16 v[64:67], a[88:91], a[24:27], v[64:67]
    s_mov_b32 m0, s83
    ds_read_b128 a[156:159], v31 offset:57344
    v_cvt_pk_bf16_f32 v116, v200, v201
    v_cvt_pk_bf16_f32 v118, v204, v205
    v_cvt_pk_bf16_f32 v117, v202, v203
    v_cvt_pk_bf16_f32 v119, v206, v207
    v_permlane32_swap_b32 v112, v114
    v_permlane32_swap_b32 v113, v115
    v_permlane32_swap_b32 v116, v118
    v_permlane32_swap_b32 v117, v119
    v_permlane16_swap_b32 v112, v114
    v_permlane16_swap_b32 v113, v115
    v_mfma_f32_16x16x32_bf16 v[68:71], a[92:95], a[24:27], v[68:71]
    s_add_u32 s83, s83, 8192
    ds_read_b128 a[160:163], v28 offset:49408
    v_permlane16_swap_b32 v116, v118
    v_permlane16_swap_b32 v117, v119
    v_accvgpr_write_b32 a32, v112
    v_accvgpr_write_b32 a34, v114
    v_accvgpr_write_b32 a33, v113
    v_accvgpr_write_b32 a35, v115
    v_accvgpr_write_b32 a36, v116
    v_accvgpr_write_b32 a38, v118
    v_accvgpr_write_b32 a37, v117
    v_accvgpr_write_b32 a39, v119
    v_mul_f32 v208, s41, v208
    v_mfma_f32_16x16x32_bf16 v[76:79], a[92:95], a[28:31], v[76:79]
    buffer_load_dwordx4 v16, s[24:27], s84 offen offset:0  lds
    v_mul_f32 v209, s41, v209
    v_mul_f32 v210, s41, v210
    v_mul_f32 v211, s41, v211
    v_mul_f32 v212, s41, v212
    v_mul_f32 v213, s41, v213
    v_mul_f32 v214, s41, v214
    v_mul_f32 v215, s41, v215
    v_cvt_pk_bf16_f32 v112, v208, v209
    v_cvt_pk_bf16_f32 v114, v212, v213
    v_cvt_pk_bf16_f32 v113, v210, v211
    v_mfma_f32_16x16x32_bf16 v[72:75], a[88:91], a[28:31], v[72:75]
    ds_read_b128 a[164:167], v28 offset:57600
    v_cvt_pk_bf16_f32 v115, v214, v215
    v_mul_f32 v216, s41, v216
    v_mul_f32 v217, s41, v217
    v_mul_f32 v218, s41, v218
    v_mul_f32 v219, s41, v219
    v_mul_f32 v220, s41, v220
    v_mul_f32 v221, s41, v221
    v_mul_f32 v222, s41, v222
    v_mul_f32 v223, s41, v223
    v_cvt_pk_bf16_f32 v116, v216, v217
    v_mfma_f32_16x16x32_bf16 v[64:67], a[96:99], a[32:35], v[64:67]
    ds_read_b128 a[168:171], v29 offset:49408
    v_cvt_pk_bf16_f32 v118, v220, v221
    v_cvt_pk_bf16_f32 v117, v218, v219
    v_cvt_pk_bf16_f32 v119, v222, v223
    v_permlane32_swap_b32 v112, v114
    v_permlane32_swap_b32 v113, v115
    v_permlane32_swap_b32 v116, v118
    v_permlane32_swap_b32 v117, v119
    v_permlane16_swap_b32 v112, v114
    v_permlane16_swap_b32 v113, v115
    v_permlane16_swap_b32 v116, v118
    v_permlane16_swap_b32 v117, v119
    v_mfma_f32_16x16x32_bf16 v[68:71], a[100:103], a[32:35], v[68:71]
    buffer_load_dwordx4 v17, s[24:27], s84 offen offset:1024  lds
    v_accvgpr_write_b32 a40, v112
    v_accvgpr_write_b32 a42, v114
    v_accvgpr_write_b32 a41, v113
    v_accvgpr_write_b32 a43, v115
    v_accvgpr_write_b32 a44, v116
    v_accvgpr_write_b32 a46, v118
    v_accvgpr_write_b32 a45, v117
    v_accvgpr_write_b32 a47, v119
    v_mul_f32 v224, s41, v224
    v_mul_f32 v225, s41, v225
    v_mfma_f32_16x16x32_bf16 v[76:79], a[100:103], a[36:39], v[76:79]
    s_add_u32 s84, s84, 57344
    ds_read_b128 a[172:175], v29 offset:57600
    v_mul_f32 v226, s41, v226
    v_mul_f32 v227, s41, v227
    v_mul_f32 v228, s41, v228
    v_mul_f32 v229, s41, v229
    v_mul_f32 v230, s41, v230
    v_mul_f32 v231, s41, v231
    v_cvt_pk_bf16_f32 v112, v224, v225
    v_cvt_pk_bf16_f32 v114, v228, v229
    v_cvt_pk_bf16_f32 v113, v226, v227
    v_cvt_pk_bf16_f32 v115, v230, v231
    v_mul_f32 v232, s41, v232
    v_mfma_f32_16x16x32_bf16 v[72:75], a[96:99], a[36:39], v[72:75]
    s_cmp_ge_u32 s84, 229376
    s_cselect_b32 s84, s85, s84
    s_cselect_b32 s85, s78, s85
    v_mul_f32 v233, s41, v233
    v_mul_f32 v234, s41, v234
    v_mul_f32 v235, s41, v235
    v_mul_f32 v236, s41, v236
    v_mul_f32 v237, s41, v237
    v_mul_f32 v238, s41, v238
    v_mul_f32 v239, s41, v239
    v_cvt_pk_bf16_f32 v116, v232, v233
    v_cvt_pk_bf16_f32 v118, v236, v237
    v_cvt_pk_bf16_f32 v117, v234, v235
    v_mfma_f32_16x16x32_bf16 v[64:67], a[104:107], a[40:43], v[64:67]
    s_mov_b32 m0, s83
    ds_read_b128 a[176:179], v30 offset:49408
    v_cvt_pk_bf16_f32 v119, v238, v239
    v_permlane32_swap_b32 v112, v114
    v_permlane32_swap_b32 v113, v115
    v_permlane32_swap_b32 v116, v118
    v_permlane32_swap_b32 v117, v119
    v_permlane16_swap_b32 v112, v114
    v_permlane16_swap_b32 v113, v115
    v_permlane16_swap_b32 v116, v118
    v_permlane16_swap_b32 v117, v119
    v_accvgpr_write_b32 a48, v112
    v_accvgpr_write_b32 a50, v114
    v_mfma_f32_16x16x32_bf16 v[68:71], a[108:111], a[40:43], v[68:71]
    s_add_u32 s83, s83, 8192
    v_accvgpr_write_b32 a49, v113
    v_accvgpr_write_b32 a51, v115
    v_accvgpr_write_b32 a52, v116
    v_accvgpr_write_b32 a54, v118
    v_accvgpr_write_b32 a53, v117
    v_accvgpr_write_b32 a55, v119
    v_mul_f32 v240, s41, v240
    v_mul_f32 v241, s41, v241
    v_mul_f32 v242, s41, v242
    v_mul_f32 v243, s41, v243
    v_mfma_f32_16x16x32_bf16 v[76:79], a[108:111], a[44:47], v[76:79]
    ds_read_b128 a[180:183], v30 offset:57600
    v_mul_f32 v244, s41, v244
    v_mul_f32 v245, s41, v245
    v_mul_f32 v246, s41, v246
    v_mul_f32 v247, s41, v247
    v_cvt_pk_bf16_f32 v112, v240, v241
    v_cvt_pk_bf16_f32 v114, v244, v245
    v_cvt_pk_bf16_f32 v113, v242, v243
    v_cvt_pk_bf16_f32 v115, v246, v247
    v_mul_f32 v248, s41, v248
    v_mul_f32 v249, s41, v249
    v_mul_f32 v250, s41, v250
    v_mul_f32 v251, s41, v251
    v_mul_f32 v252, s41, v252
    v_mul_f32 v253, s41, v253
    v_mul_f32 v254, s41, v254
    v_mul_f32 v255, s41, v255
    v_cvt_pk_bf16_f32 v116, v248, v249
    v_cvt_pk_bf16_f32 v118, v252, v253
    v_cvt_pk_bf16_f32 v117, v250, v251
    v_cvt_pk_bf16_f32 v119, v254, v255
    v_permlane32_swap_b32 v112, v114
    v_permlane32_swap_b32 v113, v115
    v_permlane32_swap_b32 v116, v118
    v_permlane32_swap_b32 v117, v119
    v_permlane16_swap_b32 v112, v114
    v_permlane16_swap_b32 v113, v115
    v_permlane16_swap_b32 v116, v118
    v_permlane16_swap_b32 v117, v119
    v_accvgpr_write_b32 a56, v112
    v_accvgpr_write_b32 a58, v114
    v_accvgpr_write_b32 a57, v113
    v_accvgpr_write_b32 a59, v115
    v_accvgpr_write_b32 a60, v116
    v_accvgpr_write_b32 a62, v118
    v_accvgpr_write_b32 a61, v117
    v_accvgpr_write_b32 a63, v119
    v_mfma_f32_16x16x32_bf16 v[72:75], a[104:107], a[44:47], v[72:75]
    buffer_load_dwordx4 v16, s[24:27], s84 offen offset:0  lds
    v_mfma_f32_16x16x32_bf16 v[64:67], a[112:115], a[48:51], v[64:67]
    buffer_load_dwordx4 v17, s[24:27], s84 offen offset:1024  lds
    v_mfma_f32_16x16x32_bf16 v[68:71], a[116:119], a[48:51], v[68:71]
    s_add_u32 s84, s84, 57344
    ds_read_b128 a[184:187], v31 offset:49408
    s_cmp_ge_u32 s84, 229376
    s_cselect_b32 s84, s85, s84
    s_cselect_b32 s85, s78, s85
    v_mfma_f32_16x16x32_bf16 v[76:79], a[116:119], a[52:55], v[76:79]
    ds_read_b128 a[188:191], v31 offset:57600
    v_mfma_f32_16x16x32_bf16 v[72:75], a[112:115], a[52:55], v[72:75]
    v_mfma_f32_16x16x32_bf16 v[64:67], a[120:123], a[56:59], v[64:67]
    v_mfma_f32_16x16x32_bf16 v[68:71], a[124:127], a[56:59], v[68:71]
    v_mfma_f32_16x16x32_bf16 v[76:79], a[124:127], a[60:63], v[76:79]
    v_mfma_f32_16x16x32_bf16 v[72:75], a[120:123], a[60:63], v[72:75]
    v_add_u32 v20, 0x10000, v42
    v_add_u32 v21, 0x10000, v43
    v_add_u32 v22, 0x10000, v44
    v_add_u32 v23, 0x10000, v45
    s_nop 3
    v_max3_f32 v48, v64, v65, v66
    v_max3_f32 v48, v48, v67, v68
    v_max3_f32 v48, v48, v69, v70
    v_max_f32 v48, v48, v71
    v_mov_b32 v49, v48
    s_nop 1
    v_permlane32_swap_b32 v49, v48
    v_max_f32 v48, v49, v48
    v_mov_b32 v49, v48
    s_nop 1
    v_permlane16_swap_b32 v49, v48
    v_max_f32 v48, v49, v48
    v_sub_f32 v104, 0, v48
    v_sub_f32 v105, 0, v48
    v_sub_f32 v106, 0, v48
    v_sub_f32 v107, 0, v48
    v_sub_f32 v64, v64, v48
    v_sub_f32 v65, v65, v48
    v_sub_f32 v66, v66, v48
    v_sub_f32 v67, v67, v48
    v_sub_f32 v68, v68, v48
    v_sub_f32 v69, v69, v48
    v_sub_f32 v70, v70, v48
    v_sub_f32 v71, v71, v48
    v_max3_f32 v48, v72, v73, v74
    v_max3_f32 v48, v48, v75, v76
    v_max3_f32 v48, v48, v77, v78
    v_max_f32 v48, v48, v79
    v_mov_b32 v49, v48
    s_nop 1
    v_permlane32_swap_b32 v49, v48
    v_max_f32 v48, v49, v48
    v_mov_b32 v49, v48
    s_nop 1
    v_permlane16_swap_b32 v49, v48
    v_max_f32 v48, v49, v48
    v_sub_f32 v108, 0, v48
    v_sub_f32 v109, 0, v48
    v_sub_f32 v110, 0, v48
    v_sub_f32 v111, 0, v48
    v_sub_f32 v72, v72, v48
    v_sub_f32 v73, v73, v48
    v_sub_f32 v74, v74, v48
    v_sub_f32 v75, v75, v48
    v_sub_f32 v76, v76, v48
    v_sub_f32 v77, v77, v48
    v_sub_f32 v78, v78, v48
    v_sub_f32 v79, v79, v48
    s_waitcnt vmcnt(12) lgkmcnt(0)
    s_barrier
    v_mfma_f32_16x16x32_bf16 v[80:83], a[128:131], a[0:3], v[104:107]
    s_add_u32 m0, s32, 49152
    ds_read_b64_tr_b16 a[64:65], v32 offset:0
    s_add_u32 s34, s34, 16384
    v_mfma_f32_16x16x32_bf16 v[84:87], a[132:135], a[0:3], v[104:107]
    s_and_b32 s34, s34, 0x7ffff
    v_exp_f32 v64, v64
    v_mfma_f32_16x16x32_bf16 v[92:95], a[132:135], a[4:7], v[108:111]
    ds_read_b64_tr_b16 a[66:67], v32 offset:8192
    ds_read_b64_tr_b16 a[68:69], v33 offset:0
    v_mfma_f32_16x16x32_bf16 v[88:91], a[128:131], a[4:7], v[108:111]
    v_exp_f32 v65, v65
    v_mfma_f32_16x16x32_bf16 v[80:83], a[136:139], a[8:11], v[80:83]
    ds_read_b64_tr_b16 a[70:71], v33 offset:8192
    buffer_load_dwordx4 v8, s[8:11], s34 offen offset:0 nt lds
    v_mfma_f32_16x16x32_bf16 v[84:87], a[140:143], a[8:11], v[84:87]
    ds_read_b64_tr_b16 a[72:73], v34 offset:0
    v_exp_f32 v66, v66
    v_mfma_f32_16x16x32_bf16 v[92:95], a[140:143], a[12:15], v[92:95]
    ds_read_b64_tr_b16 a[74:75], v34 offset:8192
    ds_read_b64_tr_b16 a[76:77], v35 offset:0
    v_mfma_f32_16x16x32_bf16 v[88:91], a[136:139], a[12:15], v[88:91]
    ds_read_b64_tr_b16 a[78:79], v35 offset:8192
    v_cvt_pk_bf16_f32 v96, v64, v65
    v_exp_f32 v67, v67
    v_mfma_f32_16x16x32_bf16 v[80:83], a[144:147], a[16:19], v[80:83]
    ds_read_b64_tr_b16 a[80:81], v36 offset:0
    buffer_load_dwordx4 v9, s[8:11], s34 offen offset:1024 nt lds
    v_mfma_f32_16x16x32_bf16 v[84:87], a[148:151], a[16:19], v[84:87]
    s_mov_b32 m0, s83
    ds_read_b64_tr_b16 a[82:83], v36 offset:8192
    v_exp_f32 v68, v68
    v_mfma_f32_16x16x32_bf16 v[92:95], a[148:151], a[20:23], v[92:95]
    s_add_u32 s83, s83, 8192
    ds_read_b64_tr_b16 a[84:85], v37 offset:0
    v_cvt_pk_bf16_f32 v97, v66, v67
    v_mfma_f32_16x16x32_bf16 v[88:91], a[144:147], a[20:23], v[88:91]
    ds_read_b64_tr_b16 a[86:87], v37 offset:8192
    v_exp_f32 v69, v69
    v_mfma_f32_16x16x32_bf16 v[80:83], a[152:155], a[24:27], v[80:83]
    ds_read_b64_tr_b16 a[88:89], v38 offset:0
    v_exp_f32 v70, v70
    v_mfma_f32_16x16x32_bf16 v[84:87], a[156:159], a[24:27], v[84:87]
    ds_read_b64_tr_b16 a[90:91], v38 offset:8192
    v_cvt_pk_bf16_f32 v98, v68, v69
    v_mfma_f32_16x16x32_bf16 v[92:95], a[156:159], a[28:31], v[92:95]
    ds_read_b64_tr_b16 a[92:93], v39 offset:0
    v_exp_f32 v71, v71
    v_mfma_f32_16x16x32_bf16 v[88:91], a[152:155], a[28:31], v[88:91]
    ds_read_b64_tr_b16 a[94:95], v39 offset:8192
    buffer_load_dwordx4 v16, s[24:27], s84 offen offset:0  lds
    v_mfma_f32_16x16x32_bf16 v[80:83], a[160:163], a[32:35], v[80:83]
    ds_read_b64_tr_b16 a[96:97], v32 offset:256
    ds_read_b64_tr_b16 a[98:99], v32 offset:8448
    v_mfma_f32_16x16x32_bf16 v[84:87], a[164:167], a[32:35], v[84:87]
    ds_read_b64_tr_b16 a[100:101], v33 offset:256
    v_exp_f32 v72, v72
    v_mfma_f32_16x16x32_bf16 v[92:95], a[164:167], a[36:39], v[92:95]
    ds_read_b64_tr_b16 a[102:103], v33 offset:8448
    v_cvt_pk_bf16_f32 v99, v70, v71
    v_mfma_f32_16x16x32_bf16 v[88:91], a[160:163], a[36:39], v[88:91]
    ds_read_b64_tr_b16 a[104:105], v34 offset:256
    v_exp_f32 v73, v73
    v_mfma_f32_16x16x32_bf16 v[80:83], a[168:171], a[40:43], v[80:83]
    ds_read_b64_tr_b16 a[106:107], v34 offset:8448
    buffer_load_dwordx4 v17, s[24:27], s84 offen offset:1024  lds
    v_exp_f32 v74, v74
    v_mfma_f32_16x16x32_bf16 v[84:87], a[172:175], a[40:43], v[84:87]
    s_add_u32 s84, s84, 57344
    ds_read_b64_tr_b16 a[108:109], v35 offset:256
    v_cvt_pk_bf16_f32 v100, v72, v73
    v_mfma_f32_16x16x32_bf16 v[92:95], a[172:175], a[44:47], v[92:95]
    s_cmp_ge_u32 s84, 229376
    s_cselect_b32 s84, s85, s84
    s_cselect_b32 s85, s78, s85
    ds_read_b64_tr_b16 a[110:111], v35 offset:8448
    v_exp_f32 v75, v75
    v_mfma_f32_16x16x32_bf16 v[88:91], a[168:171], a[44:47], v[88:91]
    ds_read_b64_tr_b16 a[112:113], v36 offset:256
    v_exp_f32 v76, v76
    v_mfma_f32_16x16x32_bf16 v[80:83], a[176:179], a[48:51], v[80:83]
    ds_read_b64_tr_b16 a[114:115], v36 offset:8448
    v_cvt_pk_bf16_f32 v101, v74, v75
    v_mfma_f32_16x16x32_bf16 v[84:87], a[180:183], a[48:51], v[84:87]
    ds_read_b64_tr_b16 a[116:117], v37 offset:256
    ds_read_b64_tr_b16 a[118:119], v37 offset:8448
    v_mfma_f32_16x16x32_bf16 v[92:95], a[180:183], a[52:55], v[92:95]
    ds_read_b64_tr_b16 a[120:121], v38 offset:256
    v_exp_f32 v77, v77
    v_mfma_f32_16x16x32_bf16 v[88:91], a[176:179], a[52:55], v[88:91]
    ds_read_b64_tr_b16 a[122:123], v38 offset:8448
    v_exp_f32 v78, v78
    v_mfma_f32_16x16x32_bf16 v[80:83], a[184:187], a[56:59], v[80:83]
    ds_read_b64_tr_b16 a[124:125], v39 offset:256
    ds_read_b64_tr_b16 a[126:127], v39 offset:8448
    v_mfma_f32_16x16x32_bf16 v[84:87], a[188:191], a[56:59], v[84:87]
    v_cvt_pk_bf16_f32 v102, v76, v77
    v_exp_f32 v79, v79
    v_mfma_f32_16x16x32_bf16 v[92:95], a[188:191], a[60:63], v[92:95]
    v_cvt_pk_bf16_f32 v103, v78, v79
    v_mfma_f32_16x16x32_bf16 v[88:91], a[184:187], a[60:63], v[88:91]
    s_waitcnt vmcnt(12) lgkmcnt(0)
    s_barrier
    v_mfma_f32_16x16x32_bf16 v[128:131], a[64:67], v[96:99], 0
    s_add_u32 m0, s32, 49152
    ds_read_b128 a[128:131], v28 offset:16384
    v_add_f32 v46, v46, v64
    v_mfma_f32_16x16x32_bf16 v[136:139], a[64:67], v[100:103], 0
    s_nop 0
    ds_read_b128 a[132:135], v28 offset:24576
    v_add_f32 v47, v47, v72
    v_mfma_f32_16x16x32_bf16 v[140:143], a[68:71], v[100:103], 0
    buffer_load_dwordx4 v10, s[8:11], s34 offen offset:2048 nt lds
    v_mfma_f32_16x16x32_bf16 v[132:135], a[68:71], v[96:99], 0
    ds_read_b128 a[136:139], v29 offset:16384
    v_add_f32 v46, v46, v65
    v_mfma_f32_16x16x32_bf16 v[144:147], a[72:75], v[96:99], 0
    ds_read_b128 a[140:143], v29 offset:24576
    v_add_f32 v47, v47, v73
    v_mfma_f32_16x16x32_bf16 v[152:155], a[72:75], v[100:103], 0
    ds_read_b128 a[144:147], v30 offset:16384
    v_add_f32 v46, v46, v66
    v_mfma_f32_16x16x32_bf16 v[156:159], a[76:79], v[100:103], 0
    buffer_load_dwordx4 v11, s[8:11], s34 offen offset:3072 nt lds
    v_mfma_f32_16x16x32_bf16 v[148:151], a[76:79], v[96:99], 0
    s_add_u32 m0, s32, 0
    ds_read_b128 a[148:151], v30 offset:24576
    v_add_f32 v47, v47, v74
    v_mfma_f32_16x16x32_bf16 v[160:163], a[80:83], v[96:99], 0
    s_add_u32 s35, s35, 16384
    v_add_f32 v46, v46, v67
    v_add_f32 v47, v47, v75
    v_mfma_f32_16x16x32_bf16 v[168:171], a[80:83], v[100:103], 0
    s_and_b32 s35, s35, 0x7ffff
    ds_read_b128 a[152:155], v31 offset:16384
    v_add_f32 v46, v46, v68
    v_mfma_f32_16x16x32_bf16 v[172:175], a[84:87], v[100:103], 0
    buffer_load_dwordx4 v12, s[12:15], s35 offen offset:0 nt lds
    v_mfma_f32_16x16x32_bf16 v[164:167], a[84:87], v[96:99], 0
    ds_read_b128 a[156:159], v31 offset:24576
    v_add_f32 v47, v47, v76
    v_mfma_f32_16x16x32_bf16 v[176:179], a[88:91], v[96:99], 0
    ds_read_b128 a[160:163], v28 offset:16640
    v_add_f32 v46, v46, v69
    v_mfma_f32_16x16x32_bf16 v[184:187], a[88:91], v[100:103], 0
    v_add_f32 v47, v47, v77
    v_add_f32 v46, v46, v70
    v_mfma_f32_16x16x32_bf16 v[188:191], a[92:95], v[100:103], 0
    buffer_load_dwordx4 v13, s[12:15], s35 offen offset:1024 nt lds
    v_mfma_f32_16x16x32_bf16 v[180:183], a[92:95], v[96:99], 0
    s_mov_b32 m0, s83
    ds_read_b128 a[164:167], v28 offset:24832
    v_add_f32 v47, v47, v78
    v_add_f32 v46, v46, v71
    v_add_f32 v47, v47, v79
    v_mfma_f32_16x16x32_bf16 v[192:195], a[96:99], v[96:99], 0
    s_add_u32 s83, s83, 8192
    buffer_load_dwordx4 v16, s[24:27], s84 offen offset:0  lds
    v_mfma_f32_16x16x32_bf16 v[200:203], a[96:99], v[100:103], 0
    ds_read_b128 a[168:171], v29 offset:16640
    v_max3_f32 v48, v80, v81, v82
    v_mfma_f32_16x16x32_bf16 v[204:207], a[100:103], v[100:103], 0
    buffer_load_dwordx4 v17, s[24:27], s84 offen offset:1024  lds
    v_mfma_f32_16x16x32_bf16 v[196:199], a[100:103], v[96:99], 0
    s_add_u32 s84, s84, 57344
    ds_read_b128 a[172:175], v29 offset:24832
    v_max3_f32 v48, v48, v83, v84
    v_mfma_f32_16x16x32_bf16 v[208:211], a[104:107], v[96:99], 0
    s_cmp_ge_u32 s84, 229376
    s_cselect_b32 s84, s85, s84
    s_cselect_b32 s85, s78, s85
    ds_read_b128 a[176:179], v30 offset:16640
    v_mfma_f32_16x16x32_bf16 v[216:219], a[104:107], v[100:103], 0
    s_and_b32 s7, s4, 12
    v_max3_f32 v48, v48, v85, v86
    v_max3_f32 v48, v48, v87, v88
    v_mfma_f32_16x16x32_bf16 v[220:223], a[108:111], v[100:103], 0
    s_add_u32 s7, s7, 8
    ds_read_b128 a[180:183], v30 offset:24832
    v_max3_f32 v48, v48, v89, v90
    v_mfma_f32_16x16x32_bf16 v[212:215], a[108:111], v[96:99], 0
    s_lshl_b32 s95, s95, s7
    ds_read_b128 a[184:187], v31 offset:16640
    v_max3_f32 v48, v48, v91, v92
    v_mfma_f32_16x16x32_bf16 v[224:227], a[112:115], v[96:99], 0
    s_add_u32 s95, s95, 1
    v_max3_f32 v48, v48, v93, v94
    v_mov_b32 v7, s95
    v_mfma_f32_16x16x32_bf16 v[232:235], a[112:115], v[100:103], 0
    ds_read_b128 a[188:191], v31 offset:24832
    v_max_f32 v48, v48, v95
    v_mfma_f32_16x16x32_bf16 v[236:239], a[116:119], v[100:103], 0
    buffer_atomic_add v7, v55, s[68:71], 0 offen
    v_mfma_f32_16x16x32_bf16 v[228:231], a[116:119], v[96:99], 0
    v_cmp_lt_f32 vcc, s40, v48
    v_mfma_f32_16x16x32_bf16 v[240:243], a[120:123], v[96:99], 0
    v_mfma_f32_16x16x32_bf16 v[248:251], a[120:123], v[100:103], 0
    v_mfma_f32_16x16x32_bf16 v[252:255], a[124:127], v[100:103], 0
    v_mfma_f32_16x16x32_bf16 v[244:247], a[124:127], v[96:99], 0
    s_cbranch_vccnz L_rs7
L_rb7:
    s_mov_b32 s39, 6
L_loopaB:
    s_waitcnt vmcnt(6) lgkmcnt(0)
    s_barrier
    v_mfma_f32_16x16x32_bf16 v[64:67], a[128:131], a[0:3], v[104:107]
    s_add_u32 m0, s32, 0
    ds_read_b64_tr_b16 a[64:65], v32 offset:32768
    s_nop 0
    v_mfma_f32_16x16x32_bf16 v[68:71], a[132:135], a[0:3], v[104:107]
    v_exp_f32 v80, v80
    v_mfma_f32_16x16x32_bf16 v[76:79], a[132:135], a[4:7], v[108:111]
    ds_read_b64_tr_b16 a[66:67], v32 offset:40960
    ds_read_b64_tr_b16 a[68:69], v33 offset:32768
    v_mfma_f32_16x16x32_bf16 v[72:75], a[128:131], a[4:7], v[108:111]
    v_exp_f32 v81, v81
    v_mfma_f32_16x16x32_bf16 v[64:67], a[136:139], a[8:11], v[64:67]
    ds_read_b64_tr_b16 a[70:71], v33 offset:40960
    ds_read_b64_tr_b16 a[72:73], v34 offset:32768
    v_mfma_f32_16x16x32_bf16 v[68:71], a[140:143], a[8:11], v[68:71]
    v_exp_f32 v82, v82
    v_mfma_f32_16x16x32_bf16 v[76:79], a[140:143], a[12:15], v[76:79]
    ds_read_b64_tr_b16 a[74:75], v34 offset:40960
    buffer_load_dwordx4 v14, s[12:15], s35 offen offset:2048 nt lds
    v_mfma_f32_16x16x32_bf16 v[72:75], a[136:139], a[12:15], v[72:75]
    ds_read_b64_tr_b16 a[76:77], v35 offset:32768
    ds_read_b64_tr_b16 a[78:79], v35 offset:40960
    v_cvt_pk_bf16_f32 v96, v80, v81
    v_exp_f32 v83, v83
    v_mfma_f32_16x16x32_bf16 v[64:67], a[144:147], a[16:19], v[64:67]
    ds_read_b64_tr_b16 a[80:81], v36 offset:32768
    v_exp_f32 v84, v84
    v_mfma_f32_16x16x32_bf16 v[68:71], a[148:151], a[16:19], v[68:71]
    ds_read_b64_tr_b16 a[82:83], v36 offset:40960
    v_cvt_pk_bf16_f32 v97, v82, v83
    v_mfma_f32_16x16x32_bf16 v[76:79], a[148:151], a[20:23], v[76:79]
    ds_read_b64_tr_b16 a[84:85], v37 offset:32768
    v_exp_f32 v85, v85
    v_mfma_f32_16x16x32_bf16 v[72:75], a[144:147], a[20:23], v[72:75]
    ds_read_b64_tr_b16 a[86:87], v37 offset:40960
    buffer_load_dwordx4 v15, s[12:15], s35 offen offset:3072 nt lds
    v_mfma_f32_16x16x32_bf16 v[64:67], a[152:155], a[24:27], v[64:67]
    s_add_u32 m0, s32, 16384
    ds_read_b64_tr_b16 a[88:89], v38 offset:32768
    v_exp_f32 v86, v86
    v_mfma_f32_16x16x32_bf16 v[68:71], a[156:159], a[24:27], v[68:71]
    s_add_u32 s34, s34, 16384
    ds_read_b64_tr_b16 a[90:91], v38 offset:40960
    v_cvt_pk_bf16_f32 v98, v84, v85
    v_mfma_f32_16x16x32_bf16 v[76:79], a[156:159], a[28:31], v[76:79]
    s_and_b32 s34, s34, 0x7ffff
    ds_read_b64_tr_b16 a[92:93], v39 offset:32768
    v_exp_f32 v87, v87
    v_mfma_f32_16x16x32_bf16 v[72:75], a[152:155], a[28:31], v[72:75]
    ds_read_b64_tr_b16 a[94:95], v39 offset:40960
    ds_read_b64_tr_b16 a[96:97], v32 offset:33024
    v_mfma_f32_16x16x32_bf16 v[64:67], a[160:163], a[32:35], v[64:67]
    ds_read_b64_tr_b16 a[98:99], v32 offset:41216
    v_exp_f32 v88, v88
    v_mfma_f32_16x16x32_bf16 v[68:71], a[164:167], a[32:35], v[68:71]
    ds_read_b64_tr_b16 a[100:101], v33 offset:33024
    v_cvt_pk_bf16_f32 v99, v86, v87
    v_mfma_f32_16x16x32_bf16 v[76:79], a[164:167], a[36:39], v[76:79]
    ds_read_b64_tr_b16 a[102:103], v33 offset:41216
    v_exp_f32 v89, v89
    v_mfma_f32_16x16x32_bf16 v[72:75], a[160:163], a[36:39], v[72:75]
    ds_read_b64_tr_b16 a[104:105], v34 offset:33024
    v_exp_f32 v90, v90
    v_mfma_f32_16x16x32_bf16 v[64:67], a[168:171], a[40:43], v[64:67]
    ds_read_b64_tr_b16 a[106:107], v34 offset:41216
    buffer_load_dwordx4 v8, s[8:11], s34 offen offset:0 nt lds
    v_mfma_f32_16x16x32_bf16 v[68:71], a[172:175], a[40:43], v[68:71]
    ds_read_b64_tr_b16 a[108:109], v35 offset:33024
    v_cvt_pk_bf16_f32 v100, v88, v89
    v_mfma_f32_16x16x32_bf16 v[76:79], a[172:175], a[44:47], v[76:79]
    ds_read_b64_tr_b16 a[110:111], v35 offset:41216
    v_exp_f32 v91, v91
    v_mfma_f32_16x16x32_bf16 v[72:75], a[168:171], a[44:47], v[72:75]
    ds_read_b64_tr_b16 a[112:113], v36 offset:33024
    v_exp_f32 v92, v92
    v_mfma_f32_16x16x32_bf16 v[64:67], a[176:179], a[48:51], v[64:67]
    ds_read_b64_tr_b16 a[114:115], v36 offset:41216
    v_cvt_pk_bf16_f32 v101, v90, v91
    v_mfma_f32_16x16x32_bf16 v[68:71], a[180:183], a[48:51], v[68:71]
    ds_read_b64_tr_b16 a[116:117], v37 offset:33024
    ds_read_b64_tr_b16 a[118:119], v37 offset:41216
    v_mfma_f32_16x16x32_bf16 v[76:79], a[180:183], a[52:55], v[76:79]
    ds_read_b64_tr_b16 a[120:121], v38 offset:33024
    buffer_load_dwordx4 v9, s[8:11], s34 offen offset:1024 nt lds
    v_mfma_f32_16x16x32_bf16 v[72:75], a[176:179], a[52:55], v[72:75]
    ds_read_b64_tr_b16 a[122:123], v38 offset:41216
    v_exp_f32 v93, v93
    v_mfma_f32_16x16x32_bf16 v[64:67], a[184:187], a[56:59], v[64:67]
    ds_read_b64_tr_b16 a[124:125], v39 offset:33024
    v_exp_f32 v94, v94
    ds_read_b64_tr_b16 a[126:127], v39 offset:41216
    v_mfma_f32_16x16x32_bf16 v[68:71], a[188:191], a[56:59], v[68:71]
    v_cvt_pk_bf16_f32 v102, v92, v93
    v_exp_f32 v95, v95
    v_mfma_f32_16x16x32_bf16 v[76:79], a[188:191], a[60:63], v[76:79]
    v_cvt_pk_bf16_f32 v103, v94, v95
    v_mfma_f32_16x16x32_bf16 v[72:75], a[184:187], a[60:63], v[72:75]
    s_waitcnt vmcnt(6) lgkmcnt(0)
    s_barrier
    v_mfma_f32_16x16x32_bf16 v[128:131], a[64:67], v[96:99], v[128:131]
    s_add_u32 m0, s32, 16384
    ds_read_b128 a[128:131], v28 offset:49152
    v_add_f32 v46, v46, v80
    v_mfma_f32_16x16x32_bf16 v[136:139], a[64:67], v[100:103], v[136:139]
    s_nop 0
    ds_read_b128 a[132:135], v28 offset:57344
    v_add_f32 v47, v47, v88
    v_mfma_f32_16x16x32_bf16 v[140:143], a[68:71], v[100:103], v[140:143]
    ds_read_b128 a[136:139], v29 offset:49152
    v_add_f32 v46, v46, v81
    v_mfma_f32_16x16x32_bf16 v[132:135], a[68:71], v[96:99], v[132:135]
    ds_read_b128 a[140:143], v29 offset:57344
    v_add_f32 v47, v47, v89
    v_mfma_f32_16x16x32_bf16 v[144:147], a[72:75], v[96:99], v[144:147]
    buffer_load_dwordx4 v10, s[8:11], s34 offen offset:2048 nt lds
    v_mfma_f32_16x16x32_bf16 v[152:155], a[72:75], v[100:103], v[152:155]
    ds_read_b128 a[144:147], v30 offset:49152
    v_add_f32 v46, v46, v82
    v_mfma_f32_16x16x32_bf16 v[156:159], a[76:79], v[100:103], v[156:159]
    v_add_f32 v47, v47, v90
    v_add_f32 v46, v46, v83
    v_mfma_f32_16x16x32_bf16 v[148:151], a[76:79], v[96:99], v[148:151]
    ds_read_b128 a[148:151], v30 offset:57344
    v_add_f32 v47, v47, v91
    v_mfma_f32_16x16x32_bf16 v[160:163], a[80:83], v[96:99], v[160:163]
    v_add_f32 v46, v46, v84
    v_add_f32 v47, v47, v92
    v_mfma_f32_16x16x32_bf16 v[168:171], a[80:83], v[100:103], v[168:171]
    buffer_load_dwordx4 v11, s[8:11], s34 offen offset:3072 nt lds
    v_mfma_f32_16x16x32_bf16 v[172:175], a[84:87], v[100:103], v[172:175]
    ds_read_b128 a[152:155], v31 offset:49152
    v_add_f32 v46, v46, v85
    v_mfma_f32_16x16x32_bf16 v[164:167], a[84:87], v[96:99], v[164:167]
    ds_read_b128 a[156:159], v31 offset:57344
    v_add_f32 v47, v47, v93
    v_mfma_f32_16x16x32_bf16 v[176:179], a[88:91], v[96:99], v[176:179]
    s_add_u32 m0, s32, 32768
    ds_read_b128 a[160:163], v28 offset:49408
    v_add_f32 v46, v46, v86
    v_mfma_f32_16x16x32_bf16 v[184:187], a[88:91], v[100:103], v[184:187]
    s_add_u32 s35, s35, 16384
    v_add_f32 v47, v47, v94
    v_add_f32 v46, v46, v87
    v_mfma_f32_16x16x32_bf16 v[188:191], a[92:95], v[100:103], v[188:191]
    s_and_b32 s35, s35, 0x7ffff
    ds_read_b128 a[164:167], v28 offset:57600
    v_add_f32 v47, v47, v95
    v_mfma_f32_16x16x32_bf16 v[180:183], a[92:95], v[96:99], v[180:183]
    v_mfma_f32_16x16x32_bf16 v[192:195], a[96:99], v[96:99], v[192:195]
    ds_read_b128 a[168:171], v29 offset:49408
    v_max3_f32 v48, v64, v65, v66
    v_mfma_f32_16x16x32_bf16 v[200:203], a[96:99], v[100:103], v[200:203]
    v_max3_f32 v48, v48, v67, v68
    v_max3_f32 v48, v48, v69, v70
    v_mfma_f32_16x16x32_bf16 v[204:207], a[100:103], v[100:103], v[204:207]
    buffer_load_dwordx4 v12, s[12:15], s35 offen offset:0 nt lds
    v_mfma_f32_16x16x32_bf16 v[196:199], a[100:103], v[96:99], v[196:199]
    ds_read_b128 a[172:175], v29 offset:57600
    v_max3_f32 v48, v48, v71, v72
    v_mfma_f32_16x16x32_bf16 v[208:211], a[104:107], v[96:99], v[208:211]
    ds_read_b128 a[176:179], v30 offset:49408
    v_max3_f32 v48, v48, v73, v74
    v_mfma_f32_16x16x32_bf16 v[216:219], a[104:107], v[100:103], v[216:219]
    v_mfma_f32_16x16x32_bf16 v[220:223], a[108:111], v[100:103], v[220:223]
    ds_read_b128 a[180:183], v30 offset:57600
    v_max3_f32 v48, v48, v75, v76
    v_mfma_f32_16x16x32_bf16 v[212:215], a[108:111], v[96:99], v[212:215]
    buffer_load_dwordx4 v13, s[12:15], s35 offen offset:1024 nt lds
    v_mfma_f32_16x16x32_bf16 v[224:227], a[112:115], v[96:99], v[224:227]
    ds_read_b128 a[184:187], v31 offset:49408
    v_max3_f32 v48, v48, v77, v78
    v_mfma_f32_16x16x32_bf16 v[232:235], a[112:115], v[100:103], v[232:235]
    ds_read_b128 a[188:191], v31 offset:57600
    v_max_f32 v48, v48, v79
    v_mfma_f32_16x16x32_bf16 v[236:239], a[116:119], v[100:103], v[236:239]
    v_cmp_lt_f32 vcc, s40, v48
    v_mfma_f32_16x16x32_bf16 v[228:231], a[116:119], v[96:99], v[228:231]
    v_mfma_f32_16x16x32_bf16 v[240:243], a[120:123], v[96:99], v[240:243]
    v_mfma_f32_16x16x32_bf16 v[248:251], a[120:123], v[100:103], v[248:251]
    v_mfma_f32_16x16x32_bf16 v[252:255], a[124:127], v[100:103], v[252:255]
    v_mfma_f32_16x16x32_bf16 v[244:247], a[124:127], v[96:99], v[244:247]
    s_cbranch_vccnz L_rs8
L_rb8:
    s_waitcnt vmcnt(6) lgkmcnt(0)
    s_barrier
    v_mfma_f32_16x16x32_bf16 v[80:83], a[128:131], a[0:3], v[104:107]
    s_add_u32 m0, s32, 32768
    ds_read_b64_tr_b16 a[64:65], v32 offset:0
    s_nop 0
    v_mfma_f32_16x16x32_bf16 v[84:87], a[132:135], a[0:3], v[104:107]
    v_exp_f32 v64, v64
    v_mfma_f32_16x16x32_bf16 v[92:95], a[132:135], a[4:7], v[108:111]
    ds_read_b64_tr_b16 a[66:67], v32 offset:8192
    ds_read_b64_tr_b16 a[68:69], v33 offset:0
    v_mfma_f32_16x16x32_bf16 v[88:91], a[128:131], a[4:7], v[108:111]
    v_exp_f32 v65, v65
    v_mfma_f32_16x16x32_bf16 v[80:83], a[136:139], a[8:11], v[80:83]
    ds_read_b64_tr_b16 a[70:71], v33 offset:8192
    ds_read_b64_tr_b16 a[72:73], v34 offset:0
    v_mfma_f32_16x16x32_bf16 v[84:87], a[140:143], a[8:11], v[84:87]
    v_exp_f32 v66, v66
    v_mfma_f32_16x16x32_bf16 v[92:95], a[140:143], a[12:15], v[92:95]
    ds_read_b64_tr_b16 a[74:75], v34 offset:8192
    buffer_load_dwordx4 v14, s[12:15], s35 offen offset:2048 nt lds
    v_mfma_f32_16x16x32_bf16 v[88:91], a[136:139], a[12:15], v[88:91]
    ds_read_b64_tr_b16 a[76:77], v35 offset:0
    ds_read_b64_tr_b16 a[78:79], v35 offset:8192
    v_cvt_pk_bf16_f32 v96, v64, v65
    v_exp_f32 v67, v67
    v_mfma_f32_16x16x32_bf16 v[80:83], a[144:147], a[16:19], v[80:83]
    ds_read_b64_tr_b16 a[80:81], v36 offset:0
    v_exp_f32 v68, v68
    v_mfma_f32_16x16x32_bf16 v[84:87], a[148:151], a[16:19], v[84:87]
    ds_read_b64_tr_b16 a[82:83], v36 offset:8192
    v_cvt_pk_bf16_f32 v97, v66, v67
    v_mfma_f32_16x16x32_bf16 v[92:95], a[148:151], a[20:23], v[92:95]
    ds_read_b64_tr_b16 a[84:85], v37 offset:0
    v_exp_f32 v69, v69
    v_mfma_f32_16x16x32_bf16 v[88:91], a[144:147], a[20:23], v[88:91]
    ds_read_b64_tr_b16 a[86:87], v37 offset:8192
    buffer_load_dwordx4 v15, s[12:15], s35 offen offset:3072 nt lds
    v_mfma_f32_16x16x32_bf16 v[80:83], a[152:155], a[24:27], v[80:83]
    s_add_u32 m0, s32, 49152
    ds_read_b64_tr_b16 a[88:89], v38 offset:0
    v_exp_f32 v70, v70
    v_mfma_f32_16x16x32_bf16 v[84:87], a[156:159], a[24:27], v[84:87]
    s_add_u32 s34, s34, 16384
    ds_read_b64_tr_b16 a[90:91], v38 offset:8192
    v_cvt_pk_bf16_f32 v98, v68, v69
    v_mfma_f32_16x16x32_bf16 v[92:95], a[156:159], a[28:31], v[92:95]
    s_and_b32 s34, s34, 0x7ffff
    ds_read_b64_tr_b16 a[92:93], v39 offset:0
    v_exp_f32 v71, v71
    v_mfma_f32_16x16x32_bf16 v[88:91], a[152:155], a[28:31], v[88:91]
    ds_read_b64_tr_b16 a[94:95], v39 offset:8192
    ds_read_b64_tr_b16 a[96:97], v32 offset:256
    v_mfma_f32_16x16x32_bf16 v[80:83], a[160:163], a[32:35], v[80:83]
    ds_read_b64_tr_b16 a[98:99], v32 offset:8448
    v_exp_f32 v72, v72
    v_mfma_f32_16x16x32_bf16 v[84:87], a[164:167], a[32:35], v[84:87]
    ds_read_b64_tr_b16 a[100:101], v33 offset:256
    v_cvt_pk_bf16_f32 v99, v70, v71
    v_mfma_f32_16x16x32_bf16 v[92:95], a[164:167], a[36:39], v[92:95]
    ds_read_b64_tr_b16 a[102:103], v33 offset:8448
    v_exp_f32 v73, v73
    v_mfma_f32_16x16x32_bf16 v[88:91], a[160:163], a[36:39], v[88:91]
    ds_read_b64_tr_b16 a[104:105], v34 offset:256
    v_exp_f32 v74, v74
    v_mfma_f32_16x16x32_bf16 v[80:83], a[168:171], a[40:43], v[80:83]
    ds_read_b64_tr_b16 a[106:107], v34 offset:8448
    buffer_load_dwordx4 v8, s[8:11], s34 offen offset:0 nt lds
    v_mfma_f32_16x16x32_bf16 v[84:87], a[172:175], a[40:43], v[84:87]
    ds_read_b64_tr_b16 a[108:109], v35 offset:256
    v_cvt_pk_bf16_f32 v100, v72, v73
    v_mfma_f32_16x16x32_bf16 v[92:95], a[172:175], a[44:47], v[92:95]
    ds_read_b64_tr_b16 a[110:111], v35 offset:8448
    v_exp_f32 v75, v75
    v_mfma_f32_16x16x32_bf16 v[88:91], a[168:171], a[44:47], v[88:91]
    ds_read_b64_tr_b16 a[112:113], v36 offset:256
    v_exp_f32 v76, v76
    v_mfma_f32_16x16x32_bf16 v[80:83], a[176:179], a[48:51], v[80:83]
    ds_read_b64_tr_b16 a[114:115], v36 offset:8448
    v_cvt_pk_bf16_f32 v101, v74, v75
    v_mfma_f32_16x16x32_bf16 v[84:87], a[180:183], a[48:51], v[84:87]
    ds_read_b64_tr_b16 a[116:117], v37 offset:256
    ds_read_b64_tr_b16 a[118:119], v37 offset:8448
    v_mfma_f32_16x16x32_bf16 v[92:95], a[180:183], a[52:55], v[92:95]
    ds_read_b64_tr_b16 a[120:121], v38 offset:256
    buffer_load_dwordx4 v9, s[8:11], s34 offen offset:1024 nt lds
    v_mfma_f32_16x16x32_bf16 v[88:91], a[176:179], a[52:55], v[88:91]
    ds_read_b64_tr_b16 a[122:123], v38 offset:8448
    v_exp_f32 v77, v77
    v_mfma_f32_16x16x32_bf16 v[80:83], a[184:187], a[56:59], v[80:83]
    ds_read_b64_tr_b16 a[124:125], v39 offset:256
    v_exp_f32 v78, v78
    ds_read_b64_tr_b16 a[126:127], v39 offset:8448
    v_mfma_f32_16x16x32_bf16 v[84:87], a[188:191], a[56:59], v[84:87]
    v_cvt_pk_bf16_f32 v102, v76, v77
    v_exp_f32 v79, v79
    v_mfma_f32_16x16x32_bf16 v[92:95], a[188:191], a[60:63], v[92:95]
    v_cvt_pk_bf16_f32 v103, v78, v79
    v_mfma_f32_16x16x32_bf16 v[88:91], a[184:187], a[60:63], v[88:91]
    s_waitcnt vmcnt(6) lgkmcnt(0)
    s_barrier
    v_mfma_f32_16x16x32_bf16 v[128:131], a[64:67], v[96:99], v[128:131]
    s_add_u32 m0, s32, 49152
    ds_read_b128 a[128:131], v28 offset:16384
    v_add_f32 v46, v46, v64
    v_mfma_f32_16x16x32_bf16 v[136:139], a[64:67], v[100:103], v[136:139]
    s_nop 0
    ds_read_b128 a[132:135], v28 offset:24576
    v_add_f32 v47, v47, v72
    v_mfma_f32_16x16x32_bf16 v[140:143], a[68:71], v[100:103], v[140:143]
    ds_read_b128 a[136:139], v29 offset:16384
    v_add_f32 v46, v46, v65
    v_mfma_f32_16x16x32_bf16 v[132:135], a[68:71], v[96:99], v[132:135]
    ds_read_b128 a[140:143], v29 offset:24576
    v_add_f32 v47, v47, v73
    v_mfma_f32_16x16x32_bf16 v[144:147], a[72:75], v[96:99], v[144:147]
    buffer_load_dwordx4 v10, s[8:11], s34 offen offset:2048 nt lds
    v_mfma_f32_16x16x32_bf16 v[152:155], a[72:75], v[100:103], v[152:155]
    ds_read_b128 a[144:147], v30 offset:16384
    v_add_f32 v46, v46, v66
    v_mfma_f32_16x16x32_bf16 v[156:159], a[76:79], v[100:103], v[156:159]
    v_add_f32 v47, v47, v74
    v_add_f32 v46, v46, v67
    v_mfma_f32_16x16x32_bf16 v[148:151], a[76:79], v[96:99], v[148:151]
    ds_read_b128 a[148:151], v30 offset:24576
    v_add_f32 v47, v47, v75
    v_mfma_f32_16x16x32_bf16 v[160:163], a[80:83], v[96:99], v[160:163]
    v_add_f32 v46, v46, v68
    v_add_f32 v47, v47, v76
    v_mfma_f32_16x16x32_bf16 v[168:171], a[80:83], v[100:103], v[168:171]
    buffer_load_dwordx4 v11, s[8:11], s34 offen offset:3072 nt lds
    v_mfma_f32_16x16x32_bf16 v[172:175], a[84:87], v[100:103], v[172:175]
    ds_read_b128 a[152:155], v31 offset:16384
    v_add_f32 v46, v46, v69
    v_mfma_f32_16x16x32_bf16 v[164:167], a[84:87], v[96:99], v[164:167]
    ds_read_b128 a[156:159], v31 offset:24576
    v_add_f32 v47, v47, v77
    v_mfma_f32_16x16x32_bf16 v[176:179], a[88:91], v[96:99], v[176:179]
    s_add_u32 m0, s32, 0
    ds_read_b128 a[160:163], v28 offset:16640
    v_add_f32 v46, v46, v70
    v_mfma_f32_16x16x32_bf16 v[184:187], a[88:91], v[100:103], v[184:187]
    s_add_u32 s35, s35, 16384
    v_add_f32 v47, v47, v78
    v_add_f32 v46, v46, v71
    v_mfma_f32_16x16x32_bf16 v[188:191], a[92:95], v[100:103], v[188:191]
    s_and_b32 s35, s35, 0x7ffff
    ds_read_b128 a[164:167], v28 offset:24832
    v_add_f32 v47, v47, v79
    v_mfma_f32_16x16x32_bf16 v[180:183], a[92:95], v[96:99], v[180:183]
    v_mfma_f32_16x16x32_bf16 v[192:195], a[96:99], v[96:99], v[192:195]
    ds_read_b128 a[168:171], v29 offset:16640
    v_max3_f32 v48, v80, v81, v82
    v_mfma_f32_16x16x32_bf16 v[200:203], a[96:99], v[100:103], v[200:203]
    v_max3_f32 v48, v48, v83, v84
    v_max3_f32 v48, v48, v85, v86
    v_mfma_f32_16x16x32_bf16 v[204:207], a[100:103], v[100:103], v[204:207]
    buffer_load_dwordx4 v12, s[12:15], s35 offen offset:0 nt lds
    v_mfma_f32_16x16x32_bf16 v[196:199], a[100:103], v[96:99], v[196:199]
    ds_read_b128 a[172:175], v29 offset:24832
    v_max3_f32 v48, v48, v87, v88
    v_mfma_f32_16x16x32_bf16 v[208:211], a[104:107], v[96:99], v[208:211]
    ds_read_b128 a[176:179], v30 offset:16640
    v_max3_f32 v48, v48, v89, v90
    v_mfma_f32_16x16x32_bf16 v[216:219], a[104:107], v[100:103], v[216:219]
    v_mfma_f32_16x16x32_bf16 v[220:223], a[108:111], v[100:103], v[220:223]
    ds_read_b128 a[180:183], v30 offset:24832
    v_max3_f32 v48, v48, v91, v92
    v_mfma_f32_16x16x32_bf16 v[212:215], a[108:111], v[96:99], v[212:215]
    buffer_load_dwordx4 v13, s[12:15], s35 offen offset:1024 nt lds
    v_mfma_f32_16x16x32_bf16 v[224:227], a[112:115], v[96:99], v[224:227]
    ds_read_b128 a[184:187], v31 offset:16640
    v_max3_f32 v48, v48, v93, v94
    v_mfma_f32_16x16x32_bf16 v[232:235], a[112:115], v[100:103], v[232:235]
    ds_read_b128 a[188:191], v31 offset:24832
    v_max_f32 v48, v48, v95
    v_mfma_f32_16x16x32_bf16 v[236:239], a[116:119], v[100:103], v[236:239]
    v_cmp_lt_f32 vcc, s40, v48
    v_mfma_f32_16x16x32_bf16 v[228:231], a[116:119], v[96:99], v[228:231]
    v_mfma_f32_16x16x32_bf16 v[240:243], a[120:123], v[96:99], v[240:243]
    v_mfma_f32_16x16x32_bf16 v[248:251], a[120:123], v[100:103], v[248:251]
    v_mfma_f32_16x16x32_bf16 v[252:255], a[124:127], v[100:103], v[252:255]
    s_sub_u32 s39, s39, 1
    s_cmp_lg_u32 s39, 0
    v_mfma_f32_16x16x32_bf16 v[244:247], a[124:127], v[96:99], v[244:247]
    s_cbranch_vccnz L_rs9
L_rb9:
    s_cbranch_scc1 L_loopaB
    buffer_load_dword v6, off, s[68:71], 0 sc1
    s_mov_b32 s39, 8
L_loopbB:
    s_waitcnt vmcnt(6) lgkmcnt(0)
    s_barrier
    v_mfma_f32_16x16x32_bf16 v[64:67], a[128:131], a[0:3], v[104:107]
    s_add_u32 m0, s32, 0
    ds_read_b64_tr_b16 a[64:65], v32 offset:32768
    s_nop 0
    v_mfma_f32_16x16x32_bf16 v[68:71], a[132:135], a[0:3], v[104:107]
    v_exp_f32 v80, v80
    v_mfma_f32_16x16x32_bf16 v[76:79], a[132:135], a[4:7], v[108:111]
    ds_read_b64_tr_b16 a[66:67], v32 offset:40960
    ds_read_b64_tr_b16 a[68:69], v33 offset:32768
    v_mfma_f32_16x16x32_bf16 v[72:75], a[128:131], a[4:7], v[108:111]
    v_exp_f32 v81, v81
    v_mfma_f32_16x16x32_bf16 v[64:67], a[136:139], a[8:11], v[64:67]
    ds_read_b64_tr_b16 a[70:71], v33 offset:40960
    ds_read_b64_tr_b16 a[72:73], v34 offset:32768
    v_mfma_f32_16x16x32_bf16 v[68:71], a[140:143], a[8:11], v[68:71]
    v_exp_f32 v82, v82
    v_mfma_f32_16x16x32_bf16 v[76:79], a[140:143], a[12:15], v[76:79]
    ds_read_b64_tr_b16 a[74:75], v34 offset:40960
    buffer_load_dwordx4 v14, s[12:15], s35 offen offset:2048 nt lds
    v_mfma_f32_16x16x32_bf16 v[72:75], a[136:139], a[12:15], v[72:75]
    ds_read_b64_tr_b16 a[76:77], v35 offset:32768
    ds_read_b64_tr_b16 a[78:79], v35 offset:40960
    v_cvt_pk_bf16_f32 v96, v80, v81
    v_exp_f32 v83, v83
    v_mfma_f32_16x16x32_bf16 v[64:67], a[144:147], a[16:19], v[64:67]
    ds_read_b64_tr_b16 a[80:81], v36 offset:32768
    v_exp_f32 v84, v84
    v_mfma_f32_16x16x32_bf16 v[68:71], a[148:151], a[16:19], v[68:71]
    ds_read_b64_tr_b16 a[82:83], v36 offset:40960
    v_cvt_pk_bf16_f32 v97, v82, v83
    v_mfma_f32_16x16x32_bf16 v[76:79], a[148:151], a[20:23], v[76:79]
    ds_read_b64_tr_b16 a[84:85], v37 offset:32768
    v_exp_f32 v85, v85
    v_mfma_f32_16x16x32_bf16 v[72:75], a[144:147], a[20:23], v[72:75]
    ds_read_b64_tr_b16 a[86:87], v37 offset:40960
    buffer_load_dwordx4 v15, s[12:15], s35 offen offset:3072 nt lds
    v_mfma_f32_16x16x32_bf16 v[64:67], a[152:155], a[24:27], v[64:67]
    s_add_u32 m0, s32, 16384
    ds_read_b64_tr_b16 a[88:89], v38 offset:32768
    v_exp_f32 v86, v86
    v_mfma_f32_16x16x32_bf16 v[68:71], a[156:159], a[24:27], v[68:71]
    s_add_u32 s34, s34, 16384
    ds_read_b64_tr_b16 a[90:91], v38 offset:40960
    v_cvt_pk_bf16_f32 v98, v84, v85
    v_mfma_f32_16x16x32_bf16 v[76:79], a[156:159], a[28:31], v[76:79]
    s_and_b32 s34, s34, 0x7ffff
    ds_read_b64_tr_b16 a[92:93], v39 offset:32768
    v_exp_f32 v87, v87
    v_mfma_f32_16x16x32_bf16 v[72:75], a[152:155], a[28:31], v[72:75]
    ds_read_b64_tr_b16 a[94:95], v39 offset:40960
    ds_read_b64_tr_b16 a[96:97], v32 offset:33024
    v_mfma_f32_16x16x32_bf16 v[64:67], a[160:163], a[32:35], v[64:67]
    ds_read_b64_tr_b16 a[98:99], v32 offset:41216
    v_exp_f32 v88, v88
    v_mfma_f32_16x16x32_bf16 v[68:71], a[164:167], a[32:35], v[68:71]
    ds_read_b64_tr_b16 a[100:101], v33 offset:33024
    v_cvt_pk_bf16_f32 v99, v86, v87
    v_mfma_f32_16x16x32_bf16 v[76:79], a[164:167], a[36:39], v[76:79]
    ds_read_b64_tr_b16 a[102:103], v33 offset:41216
    v_exp_f32 v89, v89
    v_mfma_f32_16x16x32_bf16 v[72:75], a[160:163], a[36:39], v[72:75]
    ds_read_b64_tr_b16 a[104:105], v34 offset:33024
    v_exp_f32 v90, v90
    v_mfma_f32_16x16x32_bf16 v[64:67], a[168:171], a[40:43], v[64:67]
    ds_read_b64_tr_b16 a[106:107], v34 offset:41216
    buffer_load_dwordx4 v8, s[8:11], s34 offen offset:0 nt lds
    v_mfma_f32_16x16x32_bf16 v[68:71], a[172:175], a[40:43], v[68:71]
    ds_read_b64_tr_b16 a[108:109], v35 offset:33024
    v_cvt_pk_bf16_f32 v100, v88, v89
    v_mfma_f32_16x16x32_bf16 v[76:79], a[172:175], a[44:47], v[76:79]
    ds_read_b64_tr_b16 a[110:111], v35 offset:41216
    v_exp_f32 v91, v91
    v_mfma_f32_16x16x32_bf16 v[72:75], a[168:171], a[44:47], v[72:75]
    ds_read_b64_tr_b16 a[112:113], v36 offset:33024
    v_exp_f32 v92, v92
    v_mfma_f32_16x16x32_bf16 v[64:67], a[176:179], a[48:51], v[64:67]
    ds_read_b64_tr_b16 a[114:115], v36 offset:41216
    v_cvt_pk_bf16_f32 v101, v90, v91
    v_mfma_f32_16x16x32_bf16 v[68:71], a[180:183], a[48:51], v[68:71]
    ds_read_b64_tr_b16 a[116:117], v37 offset:33024
    ds_read_b64_tr_b16 a[118:119], v37 offset:41216
    v_mfma_f32_16x16x32_bf16 v[76:79], a[180:183], a[52:55], v[76:79]
    ds_read_b64_tr_b16 a[120:121], v38 offset:33024
    buffer_load_dwordx4 v9, s[8:11], s34 offen offset:1024 nt lds
    v_mfma_f32_16x16x32_bf16 v[72:75], a[176:179], a[52:55], v[72:75]
    ds_read_b64_tr_b16 a[122:123], v38 offset:41216
    v_exp_f32 v93, v93
    v_mfma_f32_16x16x32_bf16 v[64:67], a[184:187], a[56:59], v[64:67]
    ds_read_b64_tr_b16 a[124:125], v39 offset:33024
    v_exp_f32 v94, v94
    ds_read_b64_tr_b16 a[126:127], v39 offset:41216
    v_mfma_f32_16x16x32_bf16 v[68:71], a[188:191], a[56:59], v[68:71]
    v_cvt_pk_bf16_f32 v102, v92, v93
    v_exp_f32 v95, v95
    v_mfma_f32_16x16x32_bf16 v[76:79], a[188:191], a[60:63], v[76:79]
    v_cvt_pk_bf16_f32 v103, v94, v95
    v_mfma_f32_16x16x32_bf16 v[72:75], a[184:187], a[60:63], v[72:75]
    s_waitcnt vmcnt(6) lgkmcnt(0)
    s_barrier
    v_mfma_f32_16x16x32_bf16 v[128:131], a[64:67], v[96:99], v[128:131]
    s_add_u32 m0, s32, 16384
    ds_read_b128 a[128:131], v28 offset:49152
    v_add_f32 v46, v46, v80
    v_mfma_f32_16x16x32_bf16 v[136:139], a[64:67], v[100:103], v[136:139]
    s_nop 0
    ds_read_b128 a[132:135], v28 offset:57344
    v_add_f32 v47, v47, v88
    v_mfma_f32_16x16x32_bf16 v[140:143], a[68:71], v[100:103], v[140:143]
    ds_read_b128 a[136:139], v29 offset:49152
    v_add_f32 v46, v46, v81
    v_mfma_f32_16x16x32_bf16 v[132:135], a[68:71], v[96:99], v[132:135]
    buffer_load_dwordx4 v10, s[8:11], s34 offen offset:2048 nt lds
    v_mfma_f32_16x16x32_bf16 v[144:147], a[72:75], v[96:99], v[144:147]
    ds_read_b128 a[140:143], v29 offset:57344
    v_add_f32 v47, v47, v89
    v_mfma_f32_16x16x32_bf16 v[152:155], a[72:75], v[100:103], v[152:155]
    ds_read_b128 a[144:147], v30 offset:49152
    v_add_f32 v46, v46, v82
    v_mfma_f32_16x16x32_bf16 v[156:159], a[76:79], v[100:103], v[156:159]
    v_add_f32 v47, v47, v90
    v_add_f32 v46, v46, v83
    v_mfma_f32_16x16x32_bf16 v[148:151], a[76:79], v[96:99], v[148:151]
    buffer_load_dwordx4 v11, s[8:11], s34 offen offset:3072 nt lds
    v_mfma_f32_16x16x32_bf16 v[160:163], a[80:83], v[96:99], v[160:163]
    s_add_u32 m0, s32, 32768
    ds_read_b128 a[148:151], v30 offset:57344
    v_add_f32 v47, v47, v91
    v_mfma_f32_16x16x32_bf16 v[168:171], a[80:83], v[100:103], v[168:171]
    s_add_u32 s35, s35, 16384
    ds_read_b128 a[152:155], v31 offset:49152
    v_add_f32 v46, v46, v84
    v_mfma_f32_16x16x32_bf16 v[172:175], a[84:87], v[100:103], v[172:175]
    s_and_b32 s35, s35, 0x7ffff
    v_add_f32 v47, v47, v92
    v_add_f32 v46, v46, v85
    v_mfma_f32_16x16x32_bf16 v[164:167], a[84:87], v[96:99], v[164:167]
    buffer_load_dwordx4 v12, s[12:15], s35 offen offset:0 nt lds
    v_mfma_f32_16x16x32_bf16 v[176:179], a[88:91], v[96:99], v[176:179]
    ds_read_b128 a[156:159], v31 offset:57344
    v_add_f32 v47, v47, v93
    v_mfma_f32_16x16x32_bf16 v[184:187], a[88:91], v[100:103], v[184:187]
    ds_read_b128 a[160:163], v28 offset:49408
    v_add_f32 v46, v46, v86
    v_mfma_f32_16x16x32_bf16 v[188:191], a[92:95], v[100:103], v[188:191]
    ds_read_b128 a[164:167], v28 offset:57600
    v_add_f32 v47, v47, v94
    v_mfma_f32_16x16x32_bf16 v[180:183], a[92:95], v[96:99], v[180:183]
    buffer_load_dwordx4 v13, s[12:15], s35 offen offset:1024 nt lds
    v_add_f32 v46, v46, v87
    v_add_f32 v47, v47, v95
    v_mfma_f32_16x16x32_bf16 v[192:195], a[96:99], v[96:99], v[192:195]
    s_mov_b32 m0, s83
    ds_read_b128 a[168:171], v29 offset:49408
    v_max3_f32 v48, v64, v65, v66
    v_mfma_f32_16x16x32_bf16 v[200:203], a[96:99], v[100:103], v[200:203]
    s_add_u32 s83, s83, 8192
    v_max3_f32 v48, v48, v67, v68
    v_max3_f32 v48, v48, v69, v70
    v_mfma_f32_16x16x32_bf16 v[204:207], a[100:103], v[100:103], v[204:207]
    buffer_load_dwordx4 v16, s[24:27], s84 offen offset:0  lds
    v_mfma_f32_16x16x32_bf16 v[196:199], a[100:103], v[96:99], v[196:199]
    ds_read_b128 a[172:175], v29 offset:57600
    v_max3_f32 v48, v48, v71, v72
    v_mfma_f32_16x16x32_bf16 v[208:211], a[104:107], v[96:99], v[208:211]
    buffer_load_dwordx4 v17, s[24:27], s84 offen offset:1024  lds
    v_mfma_f32_16x16x32_bf16 v[216:219], a[104:107], v[100:103], v[216:219]
    s_add_u32 s84, s84, 57344
    ds_read_b128 a[176:179], v30 offset:49408
    v_max3_f32 v48, v48, v73, v74
    v_mfma_f32_16x16x32_bf16 v[220:223], a[108:111], v[100:103], v[220:223]
    s_cmp_ge_u32 s84, 229376
    s_cselect_b32 s84, s85, s84
    s_cselect_b32 s85, s78, s85
    ds_read_b128 a[180:183], v30 offset:57600
    v_mfma_f32_16x16x32_bf16 v[212:215], a[108:111], v[96:99], v[212:215]
    ds_read_b128 a[184:187], v31 offset:49408
    v_max3_f32 v48, v48, v75, v76
    v_mfma_f32_16x16x32_bf16 v[224:227], a[112:115], v[96:99], v[224:227]
    v_max3_f32 v48, v48, v77, v78
    v_mfma_f32_16x16x32_bf16 v[232:235], a[112:115], v[100:103], v[232:235]
    ds_read_b128 a[188:191], v31 offset:57600
    v_max_f32 v48, v48, v79
    v_mfma_f32_16x16x32_bf16 v[236:239], a[116:119], v[100:103], v[236:239]
    v_cmp_lt_f32 vcc, s40, v48
    v_mfma_f32_16x16x32_bf16 v[228:231], a[116:119], v[96:99], v[228:231]
    v_mfma_f32_16x16x32_bf16 v[240:243], a[120:123], v[96:99], v[240:243]
    v_mfma_f32_16x16x32_bf16 v[248:251], a[120:123], v[100:103], v[248:251]
    v_mfma_f32_16x16x32_bf16 v[252:255], a[124:127], v[100:103], v[252:255]
    v_mfma_f32_16x16x32_bf16 v[244:247], a[124:127], v[96:99], v[244:247]
    s_cbranch_vccnz L_rs10
L_rb10:
    s_waitcnt vmcnt(8) lgkmcnt(0)
    s_barrier
    v_mfma_f32_16x16x32_bf16 v[80:83], a[128:131], a[0:3], v[104:107]
    s_add_u32 m0, s32, 32768
    ds_read_b64_tr_b16 a[64:65], v32 offset:0
    s_nop 0
    v_mfma_f32_16x16x32_bf16 v[84:87], a[132:135], a[0:3], v[104:107]
    v_exp_f32 v64, v64
    v_mfma_f32_16x16x32_bf16 v[92:95], a[132:135], a[4:7], v[108:111]
    ds_read_b64_tr_b16 a[66:67], v32 offset:8192
    ds_read_b64_tr_b16 a[68:69], v33 offset:0
    v_mfma_f32_16x16x32_bf16 v[88:91], a[128:131], a[4:7], v[108:111]
    v_exp_f32 v65, v65
    v_mfma_f32_16x16x32_bf16 v[80:83], a[136:139], a[8:11], v[80:83]
    ds_read_b64_tr_b16 a[70:71], v33 offset:8192
    ds_read_b64_tr_b16 a[72:73], v34 offset:0
    v_mfma_f32_16x16x32_bf16 v[84:87], a[140:143], a[8:11], v[84:87]
    v_exp_f32 v66, v66
    v_mfma_f32_16x16x32_bf16 v[92:95], a[140:143], a[12:15], v[92:95]
    ds_read_b64_tr_b16 a[74:75], v34 offset:8192
    buffer_load_dwordx4 v14, s[12:15], s35 offen offset:2048 nt lds
    v_mfma_f32_16x16x32_bf16 v[88:91], a[136:139], a[12:15], v[88:91]
    ds_read_b64_tr_b16 a[76:77], v35 offset:0
    ds_read_b64_tr_b16 a[78:79], v35 offset:8192
    v_cvt_pk_bf16_f32 v96, v64, v65
    v_exp_f32 v67, v67
    v_mfma_f32_16x16x32_bf16 v[80:83], a[144:147], a[16:19], v[80:83]
    ds_read_b64_tr_b16 a[80:81], v36 offset:0
    v_exp_f32 v68, v68
    v_mfma_f32_16x16x32_bf16 v[84:87], a[148:151], a[16:19], v[84:87]
    ds_read_b64_tr_b16 a[82:83], v36 offset:8192
    v_cvt_pk_bf16_f32 v97, v66, v67
    v_mfma_f32_16x16x32_bf16 v[92:95], a[148:151], a[20:23], v[92:95]
    ds_read_b64_tr_b16 a[84:85], v37 offset:0
    v_exp_f32 v69, v69
    v_mfma_f32_16x16x32_bf16 v[88:91], a[144:147], a[20:23], v[88:91]
    ds_read_b64_tr_b16 a[86:87], v37 offset:8192
    buffer_load_dwordx4 v15, s[12:15], s35 offen offset:3072 nt lds
    v_mfma_f32_16x16x32_bf16 v[80:83], a[152:155], a[24:27], v[80:83]
    s_add_u32 m0, s32, 49152
    ds_read_b64_tr_b16 a[88:89], v38 offset:0
    v_exp_f32 v70, v70
    v_mfma_f32_16x16x32_bf16 v[84:87], a[156:159], a[24:27], v[84:87]
    s_add_u32 s34, s34, 16384
    ds_read_b64_tr_b16 a[90:91], v38 offset:8192
    v_cvt_pk_bf16_f32 v98, v68, v69
    v_mfma_f32_16x16x32_bf16 v[92:95], a[156:159], a[28:31], v[92:95]
    s_and_b32 s34, s34, 0x7ffff
    ds_read_b64_tr_b16 a[92:93], v39 offset:0
    v_exp_f32 v71, v71
    v_mfma_f32_16x16x32_bf16 v[88:91], a[152:155], a[28:31], v[88:91]
    ds_read_b64_tr_b16 a[94:95], v39 offset:8192
    ds_read_b64_tr_b16 a[96:97], v32 offset:256
    v_mfma_f32_16x16x32_bf16 v[80:83], a[160:163], a[32:35], v[80:83]
    ds_read_b64_tr_b16 a[98:99], v32 offset:8448
    v_exp_f32 v72, v72
    v_mfma_f32_16x16x32_bf16 v[84:87], a[164:167], a[32:35], v[84:87]
    ds_read_b64_tr_b16 a[100:101], v33 offset:256
    v_cvt_pk_bf16_f32 v99, v70, v71
    v_mfma_f32_16x16x32_bf16 v[92:95], a[164:167], a[36:39], v[92:95]
    ds_read_b64_tr_b16 a[102:103], v33 offset:8448
    v_exp_f32 v73, v73
    v_mfma_f32_16x16x32_bf16 v[88:91], a[160:163], a[36:39], v[88:91]
    ds_read_b64_tr_b16 a[104:105], v34 offset:256
    v_exp_f32 v74, v74
    v_mfma_f32_16x16x32_bf16 v[80:83], a[168:171], a[40:43], v[80:83]
    ds_read_b64_tr_b16 a[106:107], v34 offset:8448
    buffer_load_dwordx4 v8, s[8:11], s34 offen offset:0 nt lds
    v_mfma_f32_16x16x32_bf16 v[84:87], a[172:175], a[40:43], v[84:87]
    ds_read_b64_tr_b16 a[108:109], v35 offset:256
    v_cvt_pk_bf16_f32 v100, v72, v73
    v_mfma_f32_16x16x32_bf16 v[92:95], a[172:175], a[44:47], v[92:95]
    ds_read_b64_tr_b16 a[110:111], v35 offset:8448
    v_exp_f32 v75, v75
    v_mfma_f32_16x16x32_bf16 v[88:91], a[168:171], a[44:47], v[88:91]
    ds_read_b64_tr_b16 a[112:113], v36 offset:256
    v_exp_f32 v76, v76
    v_mfma_f32_16x16x32_bf16 v[80:83], a[176:179], a[48:51], v[80:83]
    ds_read_b64_tr_b16 a[114:115], v36 offset:8448
    v_cvt_pk_bf16_f32 v101, v74, v75
    v_mfma_f32_16x16x32_bf16 v[84:87], a[180:183], a[48:51], v[84:87]
    ds_read_b64_tr_b16 a[116:117], v37 offset:256
    ds_read_b64_tr_b16 a[118:119], v37 offset:8448
    v_mfma_f32_16x16x32_bf16 v[92:95], a[180:183], a[52:55], v[92:95]
    ds_read_b64_tr_b16 a[120:121], v38 offset:256
    buffer_load_dwordx4 v9, s[8:11], s34 offen offset:1024 nt lds
    v_mfma_f32_16x16x32_bf16 v[88:91], a[176:179], a[52:55], v[88:91]
    ds_read_b64_tr_b16 a[122:123], v38 offset:8448
    v_exp_f32 v77, v77
    v_mfma_f32_16x16x32_bf16 v[80:83], a[184:187], a[56:59], v[80:83]
    ds_read_b64_tr_b16 a[124:125], v39 offset:256
    v_exp_f32 v78, v78
    ds_read_b64_tr_b16 a[126:127], v39 offset:8448
    v_mfma_f32_16x16x32_bf16 v[84:87], a[188:191], a[56:59], v[84:87]
    v_cvt_pk_bf16_f32 v102, v76, v77
    v_exp_f32 v79, v79
    v_mfma_f32_16x16x32_bf16 v[92:95], a[188:191], a[60:63], v[92:95]
    v_cvt_pk_bf16_f32 v103, v78, v79
    v_mfma_f32_16x16x32_bf16 v[88:91], a[184:187], a[60:63], v[88:91]
    s_waitcnt vmcnt(8) lgkmcnt(0)
    s_barrier
    v_mfma_f32_16x16x32_bf16 v[128:131], a[64:67], v[96:99], v[128:131]
    s_add_u32 m0, s32, 49152
    ds_read_b128 a[128:131], v28 offset:16384
    v_add_f32 v46, v46, v64
    v_mfma_f32_16x16x32_bf16 v[136:139], a[64:67], v[100:103], v[136:139]
    s_nop 0
    ds_read_b128 a[132:135], v28 offset:24576
    v_add_f32 v47, v47, v72
    v_mfma_f32_16x16x32_bf16 v[140:143], a[68:71], v[100:103], v[140:143]
    ds_read_b128 a[136:139], v29 offset:16384
    v_add_f32 v46, v46, v65
    v_mfma_f32_16x16x32_bf16 v[132:135], a[68:71], v[96:99], v[132:135]
    ds_read_b128 a[140:143], v29 offset:24576
    v_add_f32 v47, v47, v73
    v_mfma_f32_16x16x32_bf16 v[144:147], a[72:75], v[96:99], v[144:147]
    buffer_load_dwordx4 v10, s[8:11], s34 offen offset:2048 nt lds
    v_mfma_f32_16x16x32_bf16 v[152:155], a[72:75], v[100:103], v[152:155]
    ds_read_b128 a[144:147], v30 offset:16384
    v_add_f32 v46, v46, v66
    v_mfma_f32_16x16x32_bf16 v[156:159], a[76:79], v[100:103], v[156:159]
    v_add_f32 v47, v47, v74
    v_add_f32 v46, v46, v67
    v_mfma_f32_16x16x32_bf16 v[148:151], a[76:79], v[96:99], v[148:151]
    ds_read_b128 a[148:151], v30 offset:24576
    v_add_f32 v47, v47, v75
    v_mfma_f32_16x16x32_bf16 v[160:163], a[80:83], v[96:99], v[160:163]
    v_add_f32 v46, v46, v68
    v_add_f32 v47, v47, v76
    v_mfma_f32_16x16x32_bf16 v[168:171], a[80:83], v[100:103], v[168:171]
    buffer_load_dwordx4 v11, s[8:11], s34 offen offset:3072 nt lds
    v_mfma_f32_16x16x32_bf16 v[172:175], a[84:87], v[100:103], v[172:175]
    ds_read_b128 a[152:155], v31 offset:16384
    v_add_f32 v46, v46, v69
    v_mfma_f32_16x16x32_bf16 v[164:167], a[84:87], v[96:99], v[164:167]
    ds_read_b128 a[156:159], v31 offset:24576
    v_add_f32 v47, v47, v77
    v_mfma_f32_16x16x32_bf16 v[176:179], a[88:91], v[96:99], v[176:179]
    s_add_u32 m0, s32, 0
    ds_read_b128 a[160:163], v28 offset:16640
    v_add_f32 v46, v46, v70
    v_mfma_f32_16x16x32_bf16 v[184:187], a[88:91], v[100:103], v[184:187]
    s_add_u32 s35, s35, 16384
    v_add_f32 v47, v47, v78
    v_add_f32 v46, v46, v71
    v_mfma_f32_16x16x32_bf16 v[188:191], a[92:95], v[100:103], v[188:191]
    s_and_b32 s35, s35, 0x7ffff
    ds_read_b128 a[164:167], v28 offset:24832
    v_add_f32 v47, v47, v79
    v_mfma_f32_16x16x32_bf16 v[180:183], a[92:95], v[96:99], v[180:183]
    v_mfma_f32_16x16x32_bf16 v[192:195], a[96:99], v[96:99], v[192:195]
    ds_read_b128 a[168:171], v29 offset:16640
    v_max3_f32 v48, v80, v81, v82
    v_mfma_f32_16x16x32_bf16 v[200:203], a[96:99], v[100:103], v[200:203]
    v_max3_f32 v48, v48, v83, v84
    v_max3_f32 v48, v48, v85, v86
    v_mfma_f32_16x16x32_bf16 v[204:207], a[100:103], v[100:103], v[204:207]
    buffer_load_dwordx4 v12, s[12:15], s35 offen offset:0 nt lds
    v_mfma_f32_16x16x32_bf16 v[196:199], a[100:103], v[96:99], v[196:199]
    ds_read_b128 a[172:175], v29 offset:24832
    v_max3_f32 v48, v48, v87, v88
    v_mfma_f32_16x16x32_bf16 v[208:211], a[104:107], v[96:99], v[208:211]
    ds_read_b128 a[176:179], v30 offset:16640
    v_max3_f32 v48, v48, v89, v90
    v_mfma_f32_16x16x32_bf16 v[216:219], a[104:107], v[100:103], v[216:219]
    v_mfma_f32_16x16x32_bf16 v[220:223], a[108:111], v[100:103], v[220:223]
    ds_read_b128 a[180:183], v30 offset:24832
    v_max3_f32 v48, v48, v91, v92
    v_mfma_f32_16x16x32_bf16 v[212:215], a[108:111], v[96:99], v[212:215]
    buffer_load_dwordx4 v13, s[12:15], s35 offen offset:1024 nt lds
    v_mfma_f32_16x16x32_bf16 v[224:227], a[112:115], v[96:99], v[224:227]
    ds_read_b128 a[184:187], v31 offset:16640
    v_max3_f32 v48, v48, v93, v94
    v_mfma_f32_16x16x32_bf16 v[232:235], a[112:115], v[100:103], v[232:235]
    ds_read_b128 a[188:191], v31 offset:24832
    v_max_f32 v48, v48, v95
    v_mfma_f32_16x16x32_bf16 v[236:239], a[116:119], v[100:103], v[236:239]
    v_cmp_lt_f32 vcc, s40, v48
    v_mfma_f32_16x16x32_bf16 v[228:231], a[116:119], v[96:99], v[228:231]
    v_mfma_f32_16x16x32_bf16 v[240:243], a[120:123], v[96:99], v[240:243]
    v_mfma_f32_16x16x32_bf16 v[248:251], a[120:123], v[100:103], v[248:251]
    v_mfma_f32_16x16x32_bf16 v[252:255], a[124:127], v[100:103], v[252:255]
    s_sub_u32 s39, s39, 1
    s_cmp_lg_u32 s39, 0
    v_mfma_f32_16x16x32_bf16 v[244:247], a[124:127], v[96:99], v[244:247]
    s_cbranch_vccnz L_rs11
L_rb11:
    s_cbranch_scc1 L_loopbB
    v_and_b32 v49, 0xff, v6
    v_cmp_gt_u32 vcc, 16, v49
    s_cbranch_vccnz L_hsB
L_hsbB:
    v_and_b32 v49, 8, v0
    v_lshrrev_b32 v49, 1, v49
    v_lshrrev_b32 v50, v49, v6
    v_bfe_u32 v49, v50, 8, 4
    v_bfe_u32 v50, v50, 16, 4
    v_sub_u32 v49, v49, v50
    v_and_b32 v49, 0x2000, v49
    v_xor_b32 v53, v49, v53
    v_mov_b32 v49, s4
    v_and_b32 v49, 4, v49
    v_lshrrev_b32 v50, v49, v6
    v_bfe_u32 v49, v50, 8, 4
    v_bfe_u32 v50, v50, 16, 4
    v_sub_u32 v49, v49, v50
    v_and_b32 v49, 0x2000, v49
    v_xor_b32 v3, v49, v3
    v_xor_b32 v19, 0x2000, v53
    s_waitcnt vmcnt(6) lgkmcnt(0)
    s_barrier
    v_mfma_f32_16x16x32_bf16 v[64:67], a[128:131], a[0:3], v[104:107]
    s_add_u32 m0, s32, 0
    ds_read_b64_tr_b16 a[64:65], v32 offset:32768
    s_nop 0
    v_mfma_f32_16x16x32_bf16 v[68:71], a[132:135], a[0:3], v[104:107]
    v_exp_f32 v80, v80
    v_mfma_f32_16x16x32_bf16 v[76:79], a[132:135], a[4:7], v[108:111]
    ds_read_b64_tr_b16 a[66:67], v32 offset:40960
    ds_read_b64_tr_b16 a[68:69], v33 offset:32768
    v_mfma_f32_16x16x32_bf16 v[72:75], a[128:131], a[4:7], v[108:111]
    v_exp_f32 v81, v81
    v_mfma_f32_16x16x32_bf16 v[64:67], a[136:139], a[8:11], v[64:67]
    ds_read_b64_tr_b16 a[70:71], v33 offset:40960
    ds_read_b64_tr_b16 a[72:73], v34 offset:32768
    v_mfma_f32_16x16x32_bf16 v[68:71], a[140:143], a[8:11], v[68:71]
    buffer_load_dwordx4 v14, s[12:15], s35 offen offset:2048 nt lds
    v_exp_f32 v82, v82
    v_mfma_f32_16x16x32_bf16 v[76:79], a[140:143], a[12:15], v[76:79]
    ds_read_b64_tr_b16 a[74:75], v34 offset:40960
    ds_read_b64_tr_b16 a[76:77], v35 offset:32768
    v_mfma_f32_16x16x32_bf16 v[72:75], a[136:139], a[12:15], v[72:75]
    ds_read_b64_tr_b16 a[78:79], v35 offset:40960
    v_cvt_pk_bf16_f32 v96, v80, v81
    v_exp_f32 v83, v83
    v_mfma_f32_16x16x32_bf16 v[64:67], a[144:147], a[16:19], v[64:67]
    ds_read_b64_tr_b16 a[80:81], v36 offset:32768
    v_exp_f32 v84, v84
    v_mfma_f32_16x16x32_bf16 v[68:71], a[148:151], a[16:19], v[68:71]
    ds_read_b64_tr_b16 a[82:83], v36 offset:40960
    buffer_load_dwordx4 v15, s[12:15], s35 offen offset:3072 nt lds
    v_mfma_f32_16x16x32_bf16 v[76:79], a[148:151], a[20:23], v[76:79]
    s_add_u32 m0, s32, 16384
    ds_read_b64_tr_b16 a[84:85], v37 offset:32768
    v_cvt_pk_bf16_f32 v97, v82, v83
    v_mfma_f32_16x16x32_bf16 v[72:75], a[144:147], a[20:23], v[72:75]
    s_add_u32 s35, s35, 16384
    ds_read_b64_tr_b16 a[86:87], v37 offset:40960
    v_exp_f32 v85, v85
    v_mfma_f32_16x16x32_bf16 v[64:67], a[152:155], a[24:27], v[64:67]
    s_and_b32 s35, s35, 0x7ffff
    ds_read_b64_tr_b16 a[88:89], v38 offset:32768
    v_exp_f32 v86, v86
    v_mfma_f32_16x16x32_bf16 v[68:71], a[156:159], a[24:27], v[68:71]
    ds_read_b64_tr_b16 a[90:91], v38 offset:40960
    v_cvt_pk_bf16_f32 v98, v84, v85
    v_mfma_f32_16x16x32_bf16 v[76:79], a[156:159], a[28:31], v[76:79]
    ds_read_b64_tr_b16 a[92:93], v39 offset:32768
    v_exp_f32 v87, v87
    v_mfma_f32_16x16x32_bf16 v[72:75], a[152:155], a[28:31], v[72:75]
    ds_read_b64_tr_b16 a[94:95], v39 offset:40960
    buffer_load_dwordx4 v12, s[12:15], s35 offen offset:0 nt lds
    v_mfma_f32_16x16x32_bf16 v[64:67], a[160:163], a[32:35], v[64:67]
    ds_read_b64_tr_b16 a[96:97], v32 offset:33024
    ds_read_b64_tr_b16 a[98:99], v32 offset:41216
    v_mfma_f32_16x16x32_bf16 v[68:71], a[164:167], a[32:35], v[68:71]
    ds_read_b64_tr_b16 a[100:101], v33 offset:33024
    v_exp_f32 v88, v88
    v_mfma_f32_16x16x32_bf16 v[76:79], a[164:167], a[36:39], v[76:79]
    ds_read_b64_tr_b16 a[102:103], v33 offset:41216
    v_cvt_pk_bf16_f32 v99, v86, v87
    v_mfma_f32_16x16x32_bf16 v[72:75], a[160:163], a[36:39], v[72:75]
    ds_read_b64_tr_b16 a[104:105], v34 offset:33024
    v_exp_f32 v89, v89
    v_mfma_f32_16x16x32_bf16 v[64:67], a[168:171], a[40:43], v[64:67]
    ds_read_b64_tr_b16 a[106:107], v34 offset:41216
    buffer_load_dwordx4 v13, s[12:15], s35 offen offset:1024 nt lds
    v_exp_f32 v90, v90
    v_mfma_f32_16x16x32_bf16 v[68:71], a[172:175], a[40:43], v[68:71]
    ds_read_b64_tr_b16 a[108:109], v35 offset:33024
    v_cvt_pk_bf16_f32 v100, v88, v89
    v_mfma_f32_16x16x32_bf16 v[76:79], a[172:175], a[44:47], v[76:79]
    ds_read_b64_tr_b16 a[110:111], v35 offset:41216
    v_exp_f32 v91, v91
    v_mfma_f32_16x16x32_bf16 v[72:75], a[168:171], a[44:47], v[72:75]
    ds_read_b64_tr_b16 a[112:113], v36 offset:33024
    buffer_load_dwordx4 v14, s[12:15], s35 offen offset:2048 nt lds
    v_mfma_f32_16x16x32_bf16 v[64:67], a[176:179], a[48:51], v[64:67]
    ds_read_b64_tr_b16 a[114:115], v36 offset:41216
    v_exp_f32 v92, v92
    v_mfma_f32_16x16x32_bf16 v[68:71], a[180:183], a[48:51], v[68:71]
    ds_read_b64_tr_b16 a[116:117], v37 offset:33024
    ds_read_b64_tr_b16 a[118:119], v37 offset:41216
    v_mfma_f32_16x16x32_bf16 v[76:79], a[180:183], a[52:55], v[76:79]
    ds_read_b64_tr_b16 a[120:121], v38 offset:33024
    v_cvt_pk_bf16_f32 v101, v90, v91
    v_mfma_f32_16x16x32_bf16 v[72:75], a[176:179], a[52:55], v[72:75]
    ds_read_b64_tr_b16 a[122:123], v38 offset:41216
    v_exp_f32 v93, v93
    v_mfma_f32_16x16x32_bf16 v[64:67], a[184:187], a[56:59], v[64:67]
    ds_read_b64_tr_b16 a[124:125], v39 offset:33024
    buffer_load_dwordx4 v15, s[12:15], s35 offen offset:3072 nt lds
    ds_read_b64_tr_b16 a[126:127], v39 offset:41216
    v_exp_f32 v94, v94
    v_mfma_f32_16x16x32_bf16 v[68:71], a[188:191], a[56:59], v[68:71]
    v_cvt_pk_bf16_f32 v102, v92, v93
    v_exp_f32 v95, v95
    v_mfma_f32_16x16x32_bf16 v[76:79], a[188:191], a[60:63], v[76:79]
    v_cvt_pk_bf16_f32 v103, v94, v95
    v_mfma_f32_16x16x32_bf16 v[72:75], a[184:187], a[60:63], v[72:75]
    s_waitcnt vmcnt(8) lgkmcnt(0)
    s_barrier
    v_mfma_f32_16x16x32_bf16 v[128:131], a[64:67], v[96:99], v[128:131]
    s_add_u32 m0, s32, 32768
    ds_read_b128 a[128:131], v28 offset:49152
    v_add_f32 v46, v46, v80
    v_mfma_f32_16x16x32_bf16 v[136:139], a[64:67], v[100:103], v[136:139]
    s_add_u32 s38, s79, 0
    ds_read_b128 a[132:135], v28 offset:57344
    v_add_f32 v47, v47, v88
    v_mfma_f32_16x16x32_bf16 v[140:143], a[68:71], v[100:103], v[140:143]
    ds_read_b128 a[136:139], v29 offset:49152
    v_add_f32 v46, v46, v81
    v_mfma_f32_16x16x32_bf16 v[132:135], a[68:71], v[96:99], v[132:135]
    buffer_load_dwordx4 v24, s[24:27], s38 offen offset:0  lds
    v_mfma_f32_16x16x32_bf16 v[144:147], a[72:75], v[96:99], v[144:147]
    ds_read_b128 a[140:143], v29 offset:57344
    v_add_f32 v47, v47, v89
    v_mfma_f32_16x16x32_bf16 v[152:155], a[72:75], v[100:103], v[152:155]
    ds_read_b128 a[144:147], v30 offset:49152
    v_add_f32 v46, v46, v82
    v_mfma_f32_16x16x32_bf16 v[156:159], a[76:79], v[100:103], v[156:159]
    v_add_f32 v47, v47, v90
    v_add_f32 v46, v46, v83
    v_mfma_f32_16x16x32_bf16 v[148:151], a[76:79], v[96:99], v[148:151]
    ds_read_b128 a[148:151], v30 offset:57344
    v_add_f32 v47, v47, v91
    v_mfma_f32_16x16x32_bf16 v[160:163], a[80:83], v[96:99], v[160:163]
    v_add_f32 v46, v46, v84
    v_add_f32 v47, v47, v92
    v_mfma_f32_16x16x32_bf16 v[168:171], a[80:83], v[100:103], v[168:171]
    buffer_load_dwordx4 v25, s[24:27], s38 offen offset:1024  lds
    v_mfma_f32_16x16x32_bf16 v[172:175], a[84:87], v[100:103], v[172:175]
    ds_read_b128 a[152:155], v31 offset:49152
    v_add_f32 v46, v46, v85
    v_mfma_f32_16x16x32_bf16 v[164:167], a[84:87], v[96:99], v[164:167]
    ds_read_b128 a[156:159], v31 offset:57344
    v_add_f32 v47, v47, v93
    v_mfma_f32_16x16x32_bf16 v[176:179], a[88:91], v[96:99], v[176:179]
    ds_read_b128 a[160:163], v28 offset:49408
    v_add_f32 v46, v46, v86
    v_mfma_f32_16x16x32_bf16 v[184:187], a[88:91], v[100:103], v[184:187]
    v_add_f32 v47, v47, v94
    v_add_f32 v46, v46, v87
    v_mfma_f32_16x16x32_bf16 v[188:191], a[92:95], v[100:103], v[188:191]
    ds_read_b128 a[164:167], v28 offset:57600
    v_add_f32 v47, v47, v95
    v_mfma_f32_16x16x32_bf16 v[180:183], a[92:95], v[96:99], v[180:183]
    buffer_load_dwordx4 v26, s[24:27], s38 offen offset:2048  lds
    v_mfma_f32_16x16x32_bf16 v[192:195], a[96:99], v[96:99], v[192:195]
    ds_read_b128 a[168:171], v29 offset:49408
    v_max3_f32 v48, v64, v65, v66
    v_mfma_f32_16x16x32_bf16 v[200:203], a[96:99], v[100:103], v[200:203]
    v_max3_f32 v48, v48, v67, v68
    v_max3_f32 v48, v48, v69, v70
    v_mfma_f32_16x16x32_bf16 v[204:207], a[100:103], v[100:103], v[204:207]
    ds_read_b128 a[172:175], v29 offset:57600
    v_mfma_f32_16x16x32_bf16 v[196:199], a[100:103], v[96:99], v[196:199]
    v_max3_f32 v48, v48, v71, v72
    v_mfma_f32_16x16x32_bf16 v[208:211], a[104:107], v[96:99], v[208:211]
    ds_read_b128 a[176:179], v30 offset:49408
    v_max3_f32 v48, v48, v73, v74
    v_mfma_f32_16x16x32_bf16 v[216:219], a[104:107], v[100:103], v[216:219]
    buffer_load_dwordx4 v27, s[24:27], s38 offen offset:3072  lds
    v_mfma_f32_16x16x32_bf16 v[220:223], a[108:111], v[100:103], v[220:223]
    ds_read_b128 a[180:183], v30 offset:57600
    v_max3_f32 v48, v48, v75, v76
    v_mfma_f32_16x16x32_bf16 v[212:215], a[108:111], v[96:99], v[212:215]
    ds_read_b128 a[184:187], v31 offset:49408
    v_max3_f32 v48, v48, v77, v78
    v_mfma_f32_16x16x32_bf16 v[224:227], a[112:115], v[96:99], v[224:227]
    v_mfma_f32_16x16x32_bf16 v[232:235], a[112:115], v[100:103], v[232:235]
    ds_read_b128 a[188:191], v31 offset:57600
    v_max_f32 v48, v48, v79
    v_mfma_f32_16x16x32_bf16 v[236:239], a[116:119], v[100:103], v[236:239]
    v_cmp_lt_f32 vcc, s40, v48
    v_mfma_f32_16x16x32_bf16 v[228:231], a[116:119], v[96:99], v[228:231]
    v_mfma_f32_16x16x32_bf16 v[240:243], a[120:123], v[96:99], v[240:243]
    v_mfma_f32_16x16x32_bf16 v[248:251], a[120:123], v[100:103], v[248:251]
    v_mfma_f32_16x16x32_bf16 v[252:255], a[124:127], v[100:103], v[252:255]
    v_mfma_f32_16x16x32_bf16 v[244:247], a[124:127], v[96:99], v[244:247]
    s_cbranch_vccnz L_rs12
L_rb12:
    s_waitcnt vmcnt(8) lgkmcnt(0)
    s_barrier
    v_mfma_f32_16x16x32_bf16 v[80:83], a[128:131], a[0:3], v[104:107]
    s_add_u32 m0, s32, 49152
    ds_read_b64_tr_b16 a[64:65], v32 offset:0
    s_add_u32 s38, s79, 114688
    v_mfma_f32_16x16x32_bf16 v[84:87], a[132:135], a[0:3], v[104:107]
    v_exp_f32 v64, v64
    v_mfma_f32_16x16x32_bf16 v[92:95], a[132:135], a[4:7], v[108:111]
    ds_read_b64_tr_b16 a[66:67], v32 offset:8192
    ds_read_b64_tr_b16 a[68:69], v33 offset:0
    v_mfma_f32_16x16x32_bf16 v[88:91], a[128:131], a[4:7], v[108:111]
    v_exp_f32 v65, v65
    v_mfma_f32_16x16x32_bf16 v[80:83], a[136:139], a[8:11], v[80:83]
    ds_read_b64_tr_b16 a[70:71], v33 offset:8192
    buffer_load_dwordx4 v24, s[24:27], s38 offen offset:0  lds
    v_mfma_f32_16x16x32_bf16 v[84:87], a[140:143], a[8:11], v[84:87]
    ds_read_b64_tr_b16 a[72:73], v34 offset:0
    v_exp_f32 v66, v66
    v_mfma_f32_16x16x32_bf16 v[92:95], a[140:143], a[12:15], v[92:95]
    ds_read_b64_tr_b16 a[74:75], v34 offset:8192
    ds_read_b64_tr_b16 a[76:77], v35 offset:0
    v_mfma_f32_16x16x32_bf16 v[88:91], a[136:139], a[12:15], v[88:91]
    ds_read_b64_tr_b16 a[78:79], v35 offset:8192
    v_cvt_pk_bf16_f32 v96, v64, v65
    v_exp_f32 v67, v67
    v_mfma_f32_16x16x32_bf16 v[80:83], a[144:147], a[16:19], v[80:83]
    ds_read_b64_tr_b16 a[80:81], v36 offset:0
    v_exp_f32 v68, v68
    v_mfma_f32_16x16x32_bf16 v[84:87], a[148:151], a[16:19], v[84:87]
    ds_read_b64_tr_b16 a[82:83], v36 offset:8192
    v_cvt_pk_bf16_f32 v97, v66, v67
    v_mfma_f32_16x16x32_bf16 v[92:95], a[148:151], a[20:23], v[92:95]
    ds_read_b64_tr_b16 a[84:85], v37 offset:0
    v_exp_f32 v69, v69
    v_mfma_f32_16x16x32_bf16 v[88:91], a[144:147], a[20:23], v[88:91]
    ds_read_b64_tr_b16 a[86:87], v37 offset:8192
    buffer_load_dwordx4 v25, s[24:27], s38 offen offset:1024  lds
    v_mfma_f32_16x16x32_bf16 v[80:83], a[152:155], a[24:27], v[80:83]
    ds_read_b64_tr_b16 a[88:89], v38 offset:0
    v_exp_f32 v70, v70
    v_mfma_f32_16x16x32_bf16 v[84:87], a[156:159], a[24:27], v[84:87]
    ds_read_b64_tr_b16 a[90:91], v38 offset:8192
    v_cvt_pk_bf16_f32 v98, v68, v69
    v_mfma_f32_16x16x32_bf16 v[92:95], a[156:159], a[28:31], v[92:95]
    ds_read_b64_tr_b16 a[92:93], v39 offset:0
    v_exp_f32 v71, v71
    v_mfma_f32_16x16x32_bf16 v[88:91], a[152:155], a[28:31], v[88:91]
    ds_read_b64_tr_b16 a[94:95], v39 offset:8192
    ds_read_b64_tr_b16 a[96:97], v32 offset:256
    v_mfma_f32_16x16x32_bf16 v[80:83], a[160:163], a[32:35], v[80:83]
    ds_read_b64_tr_b16 a[98:99], v32 offset:8448
    v_exp_f32 v72, v72
    v_mfma_f32_16x16x32_bf16 v[84:87], a[164:167], a[32:35], v[84:87]
    ds_read_b64_tr_b16 a[100:101], v33 offset:256
    buffer_load_dwordx4 v26, s[24:27], s38 offen offset:2048  lds
    v_mfma_f32_16x16x32_bf16 v[92:95], a[164:167], a[36:39], v[92:95]
    ds_read_b64_tr_b16 a[102:103], v33 offset:8448
    v_cvt_pk_bf16_f32 v99, v70, v71
    v_mfma_f32_16x16x32_bf16 v[88:91], a[160:163], a[36:39], v[88:91]
    ds_read_b64_tr_b16 a[104:105], v34 offset:256
    v_exp_f32 v73, v73
    v_mfma_f32_16x16x32_bf16 v[80:83], a[168:171], a[40:43], v[80:83]
    ds_read_b64_tr_b16 a[106:107], v34 offset:8448
    v_exp_f32 v74, v74
    v_mfma_f32_16x16x32_bf16 v[84:87], a[172:175], a[40:43], v[84:87]
    ds_read_b64_tr_b16 a[108:109], v35 offset:256
    v_cvt_pk_bf16_f32 v100, v72, v73
    v_mfma_f32_16x16x32_bf16 v[92:95], a[172:175], a[44:47], v[92:95]
    ds_read_b64_tr_b16 a[110:111], v35 offset:8448
    v_exp_f32 v75, v75
    v_mfma_f32_16x16x32_bf16 v[88:91], a[168:171], a[44:47], v[88:91]
    ds_read_b64_tr_b16 a[112:113], v36 offset:256
    v_exp_f32 v76, v76
    v_mfma_f32_16x16x32_bf16 v[80:83], a[176:179], a[48:51], v[80:83]
    ds_read_b64_tr_b16 a[114:115], v36 offset:8448
    v_cvt_pk_bf16_f32 v101, v74, v75
    v_mfma_f32_16x16x32_bf16 v[84:87], a[180:183], a[48:51], v[84:87]
    ds_read_b64_tr_b16 a[116:117], v37 offset:256
    buffer_load_dwordx4 v27, s[24:27], s38 offen offset:3072  lds
    v_mfma_f32_16x16x32_bf16 v[92:95], a[180:183], a[52:55], v[92:95]
    ds_read_b64_tr_b16 a[118:119], v37 offset:8448
    ds_read_b64_tr_b16 a[120:121], v38 offset:256
    v_mfma_f32_16x16x32_bf16 v[88:91], a[176:179], a[52:55], v[88:91]
    ds_read_b64_tr_b16 a[122:123], v38 offset:8448
    v_exp_f32 v77, v77
    v_mfma_f32_16x16x32_bf16 v[80:83], a[184:187], a[56:59], v[80:83]
    ds_read_b64_tr_b16 a[124:125], v39 offset:256
    v_exp_f32 v78, v78
    ds_read_b64_tr_b16 a[126:127], v39 offset:8448
    v_mfma_f32_16x16x32_bf16 v[84:87], a[188:191], a[56:59], v[84:87]
    v_cvt_pk_bf16_f32 v102, v76, v77
    v_exp_f32 v79, v79
    v_mfma_f32_16x16x32_bf16 v[92:95], a[188:191], a[60:63], v[92:95]
    v_cvt_pk_bf16_f32 v103, v78, v79
    v_mfma_f32_16x16x32_bf16 v[88:91], a[184:187], a[60:63], v[88:91]
    s_waitcnt vmcnt(8) lgkmcnt(0)
    s_barrier
    v_mfma_f32_16x16x32_bf16 v[128:131], a[64:67], v[96:99], v[128:131]
    s_add_u32 m0, s32, 0
    ds_read_b64_tr_b16 a[128:129], v32 offset:16384
    v_add_f32 v46, v46, v64
    v_mfma_f32_16x16x32_bf16 v[136:139], a[64:67], v[100:103], v[136:139]
    s_add_u32 s38, s80, 0
    ds_read_b64_tr_b16 a[130:131], v32 offset:24576
    v_add_f32 v47, v47, v72
    v_mfma_f32_16x16x32_bf16 v[140:143], a[68:71], v[100:103], v[140:143]
    ds_read_b64_tr_b16 a[132:133], v33 offset:16384
    v_add_f32 v46, v46, v65
    v_mfma_f32_16x16x32_bf16 v[132:135], a[68:71], v[96:99], v[132:135]
    buffer_load_dwordx4 v24, s[24:27], s38 offen offset:0  lds
    v_mfma_f32_16x16x32_bf16 v[144:147], a[72:75], v[96:99], v[144:147]
    ds_read_b64_tr_b16 a[134:135], v33 offset:24576
    v_add_f32 v47, v47, v73
    v_mfma_f32_16x16x32_bf16 v[152:155], a[72:75], v[100:103], v[152:155]
    ds_read_b64_tr_b16 a[136:137], v34 offset:16384
    v_add_f32 v46, v46, v66
    v_mfma_f32_16x16x32_bf16 v[156:159], a[76:79], v[100:103], v[156:159]
    ds_read_b64_tr_b16 a[138:139], v34 offset:24576
    ds_read_b64_tr_b16 a[140:141], v35 offset:16384
    v_add_f32 v47, v47, v74
    v_mfma_f32_16x16x32_bf16 v[148:151], a[76:79], v[96:99], v[148:151]
    ds_read_b64_tr_b16 a[142:143], v35 offset:24576
    v_add_f32 v46, v46, v67
    v_mfma_f32_16x16x32_bf16 v[160:163], a[80:83], v[96:99], v[160:163]
    ds_read_b64_tr_b16 a[144:145], v36 offset:16384
    v_add_f32 v47, v47, v75
    v_add_f32 v46, v46, v68
    v_mfma_f32_16x16x32_bf16 v[168:171], a[80:83], v[100:103], v[168:171]
    ds_read_b64_tr_b16 a[146:147], v36 offset:24576
    v_add_f32 v47, v47, v76
    v_mfma_f32_16x16x32_bf16 v[172:175], a[84:87], v[100:103], v[172:175]
    ds_read_b64_tr_b16 a[148:149], v37 offset:16384
    v_add_f32 v46, v46, v69
    v_mfma_f32_16x16x32_bf16 v[164:167], a[84:87], v[96:99], v[164:167]
    ds_read_b64_tr_b16 a[150:151], v37 offset:24576
    v_add_f32 v47, v47, v77
    v_mfma_f32_16x16x32_bf16 v[176:179], a[88:91], v[96:99], v[176:179]
    ds_read_b64_tr_b16 a[152:153], v38 offset:16384
    buffer_load_dwordx4 v25, s[24:27], s38 offen offset:1024  lds
    v_add_f32 v46, v46, v70
    v_add_f32 v47, v47, v78
    v_mfma_f32_16x16x32_bf16 v[184:187], a[88:91], v[100:103], v[184:187]
    ds_read_b64_tr_b16 a[154:155], v38 offset:24576
    v_add_f32 v46, v46, v71
    v_mfma_f32_16x16x32_bf16 v[188:191], a[92:95], v[100:103], v[188:191]
    ds_read_b64_tr_b16 a[156:157], v39 offset:16384
    v_add_f32 v47, v47, v79
    v_mfma_f32_16x16x32_bf16 v[180:183], a[92:95], v[96:99], v[180:183]
    ds_read_b64_tr_b16 a[158:159], v39 offset:24576
    ds_read_b64_tr_b16 a[160:161], v32 offset:16640
    v_add_u32 v28, 0x20000, v42
    v_add_u32 v29, 0x20000, v43
    v_add_u32 v30, 0x20000, v44
    v_add_u32 v31, 0x20000, v45
    v_mfma_f32_16x16x32_bf16 v[192:195], a[96:99], v[96:99], v[192:195]
    ds_read_b64_tr_b16 a[162:163], v32 offset:24832
    v_max3_f32 v48, v80, v81, v82
    v_mfma_f32_16x16x32_bf16 v[200:203], a[96:99], v[100:103], v[200:203]
    ds_read_b64_tr_b16 a[164:165], v33 offset:16640
    buffer_load_dwordx4 v26, s[24:27], s38 offen offset:2048  lds
    v_mfma_f32_16x16x32_bf16 v[204:207], a[100:103], v[100:103], v[204:207]
    ds_read_b64_tr_b16 a[166:167], v33 offset:24832
    v_max3_f32 v48, v48, v83, v84
    v_mfma_f32_16x16x32_bf16 v[196:199], a[100:103], v[96:99], v[196:199]
    ds_read_b64_tr_b16 a[168:169], v34 offset:16640
    v_max3_f32 v48, v48, v85, v86
    v_mfma_f32_16x16x32_bf16 v[208:211], a[104:107], v[96:99], v[208:211]
    ds_read_b64_tr_b16 a[170:171], v34 offset:24832
    v_max3_f32 v48, v48, v87, v88
    v_mfma_f32_16x16x32_bf16 v[216:219], a[104:107], v[100:103], v[216:219]
    ds_read_b64_tr_b16 a[172:173], v35 offset:16640
    v_max3_f32 v48, v48, v89, v90
    v_mfma_f32_16x16x32_bf16 v[220:223], a[108:111], v[100:103], v[220:223]
    ds_read_b64_tr_b16 a[174:175], v35 offset:24832
    v_max3_f32 v48, v48, v91, v92
    v_mfma_f32_16x16x32_bf16 v[212:215], a[108:111], v[96:99], v[212:215]
    ds_read_b64_tr_b16 a[176:177], v36 offset:16640
    v_max3_f32 v48, v48, v93, v94
    v_mfma_f32_16x16x32_bf16 v[224:227], a[112:115], v[96:99], v[224:227]
    ds_read_b64_tr_b16 a[178:179], v36 offset:24832
    v_mfma_f32_16x16x32_bf16 v[232:235], a[112:115], v[100:103], v[232:235]
    ds_read_b64_tr_b16 a[180:181], v37 offset:16640
    buffer_load_dwordx4 v27, s[24:27], s38 offen offset:3072  lds
    v_mfma_f32_16x16x32_bf16 v[236:239], a[116:119], v[100:103], v[236:239]
    ds_read_b64_tr_b16 a[182:183], v37 offset:24832
    ds_read_b64_tr_b16 a[184:185], v38 offset:16640
    v_mfma_f32_16x16x32_bf16 v[228:231], a[116:119], v[96:99], v[228:231]
    ds_read_b64_tr_b16 a[186:187], v38 offset:24832
    v_max_f32 v48, v48, v95
    v_mfma_f32_16x16x32_bf16 v[240:243], a[120:123], v[96:99], v[240:243]
    ds_read_b64_tr_b16 a[188:189], v39 offset:16640
    ds_read_b64_tr_b16 a[190:191], v39 offset:24832
    v_mfma_f32_16x16x32_bf16 v[248:251], a[120:123], v[100:103], v[248:251]
    v_cmp_lt_f32 vcc, s40, v48
    v_mfma_f32_16x16x32_bf16 v[252:255], a[124:127], v[100:103], v[252:255]
    v_mfma_f32_16x16x32_bf16 v[244:247], a[124:127], v[96:99], v[244:247]
    s_cbranch_vccnz L_rs13
L_rb13:
    v_exp_f32 v80, v80
    v_exp_f32 v81, v81
    v_exp_f32 v82, v82
    v_exp_f32 v83, v83
    v_exp_f32 v84, v84
    v_exp_f32 v85, v85
    v_exp_f32 v86, v86
    v_exp_f32 v87, v87
    v_exp_f32 v88, v88
    v_exp_f32 v89, v89
    v_exp_f32 v90, v90
    v_exp_f32 v91, v91
    v_exp_f32 v92, v92
    v_exp_f32 v93, v93
    v_exp_f32 v94, v94
    v_exp_f32 v95, v95
    v_cvt_pk_bf16_f32 v96, v80, v81
    v_cvt_pk_bf16_f32 v97, v82, v83
    v_cvt_pk_bf16_f32 v98, v84, v85
    v_cvt_pk_bf16_f32 v99, v86, v87
    v_cvt_pk_bf16_f32 v100, v88, v89
    v_cvt_pk_bf16_f32 v101, v90, v91
    v_cvt_pk_bf16_f32 v102, v92, v93
    v_cvt_pk_bf16_f32 v103, v94, v95
    s_waitcnt lgkmcnt(0)
    s_barrier
    v_mfma_f32_16x16x32_bf16 v[128:131], a[128:131], v[96:99], v[128:131]
    s_add_u32 m0, s32, 16384
    ds_read_b64_tr_b16 a[64:65], v20 offset:0
    v_add_f32 v46, v46, v80
    v_mfma_f32_16x16x32_bf16 v[136:139], a[128:131], v[100:103], v[136:139]
    s_add_u32 s38, s80, 114688
    ds_read_b64_tr_b16 a[66:67], v20 offset:2048
    v_add_f32 v47, v47, v88
    v_mfma_f32_16x16x32_bf16 v[140:143], a[132:135], v[100:103], v[140:143]
    ds_read_b64_tr_b16 a[68:69], v21 offset:0
    v_add_f32 v46, v46, v81
    v_mfma_f32_16x16x32_bf16 v[132:135], a[132:135], v[96:99], v[132:135]
    ds_read_b64_tr_b16 a[70:71], v21 offset:2048
    v_add_f32 v47, v47, v89
    v_mfma_f32_16x16x32_bf16 v[144:147], a[136:139], v[96:99], v[144:147]
    ds_read_b64_tr_b16 a[72:73], v22 offset:0
    v_add_f32 v46, v46, v82
    v_add_f32 v47, v47, v90
    v_mfma_f32_16x16x32_bf16 v[152:155], a[136:139], v[100:103], v[152:155]
    buffer_load_dwordx4 v24, s[24:27], s38 offen offset:0  lds
    v_add_f32 v46, v46, v83
    v_add_f32 v47, v47, v91
    v_add_f32 v46, v46, v84
    v_mfma_f32_16x16x32_bf16 v[156:159], a[140:143], v[100:103], v[156:159]
    ds_read_b64_tr_b16 a[74:75], v22 offset:2048
    ds_read_b64_tr_b16 a[76:77], v23 offset:0
    v_add_f32 v47, v47, v92
    v_add_f32 v46, v46, v85
    v_mfma_f32_16x16x32_bf16 v[148:151], a[140:143], v[96:99], v[148:151]
    ds_read_b64_tr_b16 a[78:79], v23 offset:2048
    v_add_f32 v47, v47, v93
    v_add_f32 v46, v46, v86
    v_mfma_f32_16x16x32_bf16 v[160:163], a[144:147], v[96:99], v[160:163]
    ds_read_b64_tr_b16 a[80:81], v20 offset:4096
    v_add_f32 v47, v47, v94
    v_add_f32 v46, v46, v87
    v_add_f32 v47, v47, v95
    v_mfma_f32_16x16x32_bf16 v[168:171], a[144:147], v[100:103], v[168:171]
    ds_read_b64_tr_b16 a[82:83], v20 offset:6144
    v_mov_b32 v49, v46
    s_nop 1
    v_mfma_f32_16x16x32_bf16 v[172:175], a[148:151], v[100:103], v[172:175]
    ds_read_b64_tr_b16 a[84:85], v21 offset:4096
    v_permlane32_swap_b32 v49, v46
    v_add_f32 v46, v49, v46
    v_mfma_f32_16x16x32_bf16 v[164:167], a[148:151], v[96:99], v[164:167]
    ds_read_b64_tr_b16 a[86:87], v21 offset:6144
    v_mov_b32 v49, v46
    s_nop 1
    v_mfma_f32_16x16x32_bf16 v[176:179], a[152:155], v[96:99], v[176:179]
    ds_read_b64_tr_b16 a[88:89], v22 offset:4096
    buffer_load_dwordx4 v25, s[24:27], s38 offen offset:1024  lds
    v_permlane16_swap_b32 v49, v46
    v_mfma_f32_16x16x32_bf16 v[184:187], a[152:155], v[100:103], v[184:187]
    ds_read_b64_tr_b16 a[90:91], v22 offset:6144
    v_add_f32 v46, v49, v46
    v_rcp_f32 v51, v46
    v_mfma_f32_16x16x32_bf16 v[188:191], a[156:159], v[100:103], v[188:191]
    ds_read_b64_tr_b16 a[92:93], v23 offset:4096
    v_mov_b32 v49, v47
    s_nop 1
    v_mfma_f32_16x16x32_bf16 v[180:183], a[156:159], v[96:99], v[180:183]
    ds_read_b64_tr_b16 a[94:95], v23 offset:6144
    ds_read_b64_tr_b16 a[96:97], v20 offset:8192
    v_permlane32_swap_b32 v49, v47
    v_mfma_f32_16x16x32_bf16 v[192:195], a[160:163], v[96:99], v[192:195]
    ds_read_b64_tr_b16 a[98:99], v20 offset:10240
    v_add_f32 v47, v49, v47
    v_mov_b32 v49, v47
    s_nop 1
    v_permlane16_swap_b32 v49, v47
    v_add_f32 v47, v49, v47
    v_rcp_f32 v52, v47
    v_mfma_f32_16x16x32_bf16 v[200:203], a[160:163], v[100:103], v[200:203]
    ds_read_b64_tr_b16 a[100:101], v21 offset:8192
    buffer_load_dwordx4 v26, s[24:27], s38 offen offset:2048  lds
    v_mfma_f32_16x16x32_bf16 v[204:207], a[164:167], v[100:103], v[204:207]
    ds_read_b64_tr_b16 a[102:103], v21 offset:10240
    v_cvt_pk_bf16_f32 v128, v128, v129
    v_mfma_f32_16x16x32_bf16 v[196:199], a[164:167], v[96:99], v[196:199]
    ds_read_b64_tr_b16 a[104:105], v22 offset:8192
    v_cvt_pk_bf16_f32 v129, v130, v131
    v_mfma_f32_16x16x32_bf16 v[208:211], a[168:171], v[96:99], v[208:211]
    ds_read_b64_tr_b16 a[106:107], v22 offset:10240
    v_cvt_pk_bf16_f32 v130, v132, v133
    v_cvt_pk_bf16_f32 v131, v134, v135
    v_mfma_f32_16x16x32_bf16 v[216:219], a[168:171], v[100:103], v[216:219]
    ds_read_b64_tr_b16 a[108:109], v23 offset:8192
    v_cvt_pk_bf16_f32 v136, v136, v137
    v_cvt_pk_bf16_f32 v137, v138, v139
    v_mfma_f32_16x16x32_bf16 v[220:223], a[172:175], v[100:103], v[220:223]
    ds_read_b64_tr_b16 a[110:111], v23 offset:10240
    v_cvt_pk_bf16_f32 v138, v140, v141
    v_cvt_pk_bf16_f32 v139, v142, v143
    v_mfma_f32_16x16x32_bf16 v[212:215], a[172:175], v[96:99], v[212:215]
    ds_read_b64_tr_b16 a[112:113], v20 offset:12288
    v_cvt_pk_bf16_f32 v144, v144, v145
    v_cvt_pk_bf16_f32 v145, v146, v147
    v_mfma_f32_16x16x32_bf16 v[224:227], a[176:179], v[96:99], v[224:227]
    ds_read_b64_tr_b16 a[114:115], v20 offset:14336
    v_cvt_pk_bf16_f32 v146, v148, v149
    v_cvt_pk_bf16_f32 v147, v150, v151
    v_mfma_f32_16x16x32_bf16 v[232:235], a[176:179], v[100:103], v[232:235]
    ds_read_b64_tr_b16 a[116:117], v21 offset:12288
    ds_read_b64_tr_b16 a[118:119], v21 offset:14336
    v_cvt_pk_bf16_f32 v152, v152, v153
    v_cvt_pk_bf16_f32 v153, v154, v155
    v_mfma_f32_16x16x32_bf16 v[236:239], a[180:183], v[100:103], v[236:239]
    ds_read_b64_tr_b16 a[120:121], v22 offset:12288
    buffer_load_dwordx4 v27, s[24:27], s38 offen offset:3072  lds
    v_cvt_pk_bf16_f32 v154, v156, v157
    v_cvt_pk_bf16_f32 v155, v158, v159
    v_cvt_pk_bf16_f32 v160, v160, v161
    v_mfma_f32_16x16x32_bf16 v[228:231], a[180:183], v[96:99], v[228:231]
    ds_read_b64_tr_b16 a[122:123], v22 offset:14336
    v_cvt_pk_bf16_f32 v161, v162, v163
    v_cvt_pk_bf16_f32 v162, v164, v165
    v_mfma_f32_16x16x32_bf16 v[240:243], a[184:187], v[96:99], v[240:243]
    ds_read_b64_tr_b16 a[124:125], v23 offset:12288
    ds_read_b64_tr_b16 a[126:127], v23 offset:14336
    v_cvt_pk_bf16_f32 v163, v166, v167
    v_cvt_pk_bf16_f32 v168, v168, v169
    v_mfma_f32_16x16x32_bf16 v[248:251], a[184:187], v[100:103], v[248:251]
    v_cvt_pk_bf16_f32 v169, v170, v171
    v_cvt_pk_bf16_f32 v170, v172, v173
    v_mfma_f32_16x16x32_bf16 v[252:255], a[188:191], v[100:103], v[252:255]
    v_cvt_pk_bf16_f32 v171, v174, v175
    v_cvt_pk_bf16_f32 v176, v176, v177
    v_mfma_f32_16x16x32_bf16 v[244:247], a[188:191], v[96:99], v[244:247]
    v_cvt_pk_bf16_f32 v177, v178, v179
    v_cvt_pk_bf16_f32 v178, v180, v181
    v_cvt_pk_bf16_f32 v179, v182, v183
    v_cvt_pk_bf16_f32 v184, v184, v185
    v_cvt_pk_bf16_f32 v185, v186, v187
    v_cvt_pk_bf16_f32 v186, v188, v189
    v_cvt_pk_bf16_f32 v187, v190, v191
    s_waitcnt lgkmcnt(0)
    s_barrier
    v_mfma_f32_16x16x32_bf16 v[64:67], a[64:67], v[128:131], 0
    ds_read_b64_tr_b16 a[128:129], v20 offset:16384
    v_mfma_f32_16x16x32_bf16 v[80:83], a[64:67], v[136:139], 0
    ds_read_b64_tr_b16 a[130:131], v20 offset:18432
    v_mfma_f32_16x16x32_bf16 v[84:87], a[68:71], v[136:139], 0
    s_add_u32 m0, s32, 65536
    ds_read_b64_tr_b16 a[132:133], v21 offset:16384
    s_add_u32 s38, s81, 0
    v_mfma_f32_16x16x32_bf16 v[68:71], a[68:71], v[128:131], 0
    ds_read_b64_tr_b16 a[134:135], v21 offset:18432
    v_mfma_f32_16x16x32_bf16 v[72:75], a[72:75], v[128:131], 0
    ds_read_b64_tr_b16 a[144:145], v20 offset:20480
    v_cvt_pk_bf16_f32 v192, v192, v193
    v_mfma_f32_16x16x32_bf16 v[88:91], a[72:75], v[136:139], 0
    buffer_load_dwordx4 v24, s[24:27], s38 offen offset:0  lds
    v_mfma_f32_16x16x32_bf16 v[92:95], a[76:79], v[136:139], 0
    ds_read_b64_tr_b16 a[146:147], v20 offset:22528
    ds_read_b64_tr_b16 a[148:149], v21 offset:20480
    v_mfma_f32_16x16x32_bf16 v[76:79], a[76:79], v[128:131], 0
    ds_read_b64_tr_b16 a[150:151], v21 offset:22528
    v_cvt_pk_bf16_f32 v193, v194, v195
    v_mfma_f32_16x16x32_bf16 v[64:67], a[80:83], v[144:147], v[64:67]
    ds_read_b64_tr_b16 a[160:161], v20 offset:24576
    v_cvt_pk_bf16_f32 v194, v196, v197
    v_cvt_pk_bf16_f32 v195, v198, v199
    v_mfma_f32_16x16x32_bf16 v[80:83], a[80:83], v[152:155], v[80:83]
    ds_read_b64_tr_b16 a[162:163], v20 offset:26624
    v_cvt_pk_bf16_f32 v200, v200, v201
    v_mfma_f32_16x16x32_bf16 v[84:87], a[84:87], v[152:155], v[84:87]
    ds_read_b64_tr_b16 a[164:165], v21 offset:24576
    v_cvt_pk_bf16_f32 v201, v202, v203
    v_mfma_f32_16x16x32_bf16 v[68:71], a[84:87], v[144:147], v[68:71]
    ds_read_b64_tr_b16 a[166:167], v21 offset:26624
    v_cvt_pk_bf16_f32 v202, v204, v205
    v_mfma_f32_16x16x32_bf16 v[72:75], a[88:91], v[144:147], v[72:75]
    ds_read_b64_tr_b16 a[176:177], v20 offset:28672
    v_cvt_pk_bf16_f32 v203, v206, v207
    v_cvt_pk_bf16_f32 v208, v208, v209
    v_mfma_f32_16x16x32_bf16 v[88:91], a[88:91], v[152:155], v[88:91]
    ds_read_b64_tr_b16 a[178:179], v20 offset:30720
    buffer_load_dwordx4 v25, s[24:27], s38 offen offset:1024  lds
    v_cvt_pk_bf16_f32 v209, v210, v211
    v_mfma_f32_16x16x32_bf16 v[92:95], a[92:95], v[152:155], v[92:95]
    ds_read_b64_tr_b16 a[180:181], v21 offset:28672
    v_cvt_pk_bf16_f32 v210, v212, v213
    v_mfma_f32_16x16x32_bf16 v[76:79], a[92:95], v[144:147], v[76:79]
    ds_read_b64_tr_b16 a[182:183], v21 offset:30720
    ds_read_b64_tr_b16 a[136:137], v22 offset:16384
    v_cvt_pk_bf16_f32 v211, v214, v215
    v_mfma_f32_16x16x32_bf16 v[64:67], a[96:99], v[160:163], v[64:67]
    ds_read_b64_tr_b16 a[138:139], v22 offset:18432
    v_cvt_pk_bf16_f32 v216, v216, v217
    v_mfma_f32_16x16x32_bf16 v[80:83], a[96:99], v[168:171], v[80:83]
    ds_read_b64_tr_b16 a[140:141], v23 offset:16384
    v_cvt_pk_bf16_f32 v217, v218, v219
    v_cvt_pk_bf16_f32 v218, v220, v221
    v_mfma_f32_16x16x32_bf16 v[84:87], a[100:103], v[168:171], v[84:87]
    ds_read_b64_tr_b16 a[142:143], v23 offset:18432
    v_cvt_pk_bf16_f32 v219, v222, v223
    v_mfma_f32_16x16x32_bf16 v[68:71], a[100:103], v[160:163], v[68:71]
    ds_read_b64_tr_b16 a[152:153], v22 offset:20480
    buffer_load_dwordx4 v26, s[24:27], s38 offen offset:2048  lds
    v_cvt_pk_bf16_f32 v224, v224, v225
    v_mfma_f32_16x16x32_bf16 v[72:75], a[104:107], v[160:163], v[72:75]
    ds_read_b64_tr_b16 a[154:155], v22 offset:22528
    v_cvt_pk_bf16_f32 v225, v226, v227
    v_mfma_f32_16x16x32_bf16 v[88:91], a[104:107], v[168:171], v[88:91]
    ds_read_b64_tr_b16 a[156:157], v23 offset:20480
    v_cvt_pk_bf16_f32 v226, v228, v229
    v_cvt_pk_bf16_f32 v227, v230, v231
    v_mfma_f32_16x16x32_bf16 v[92:95], a[108:111], v[168:171], v[92:95]
    ds_read_b64_tr_b16 a[158:159], v23 offset:22528
    v_cvt_pk_bf16_f32 v232, v232, v233
    v_mfma_f32_16x16x32_bf16 v[76:79], a[108:111], v[160:163], v[76:79]
    ds_read_b64_tr_b16 a[168:169], v22 offset:24576
    v_cvt_pk_bf16_f32 v233, v234, v235
    v_mfma_f32_16x16x32_bf16 v[64:67], a[112:115], v[176:179], v[64:67]
    ds_read_b64_tr_b16 a[170:171], v22 offset:26624
    v_cvt_pk_bf16_f32 v234, v236, v237
    v_mfma_f32_16x16x32_bf16 v[80:83], a[112:115], v[184:187], v[80:83]
    ds_read_b64_tr_b16 a[172:173], v23 offset:24576
    ds_read_b64_tr_b16 a[174:175], v23 offset:26624
    v_cvt_pk_bf16_f32 v235, v238, v239
    v_cvt_pk_bf16_f32 v240, v240, v241
    v_mfma_f32_16x16x32_bf16 v[84:87], a[116:119], v[184:187], v[84:87]
    ds_read_b64_tr_b16 a[184:185], v22 offset:28672
    buffer_load_dwordx4 v27, s[24:27], s38 offen offset:3072  lds
    v_cvt_pk_bf16_f32 v241, v242, v243
    v_mfma_f32_16x16x32_bf16 v[68:71], a[116:119], v[176:179], v[68:71]
    ds_read_b64_tr_b16 a[186:187], v22 offset:30720
    v_cvt_pk_bf16_f32 v242, v244, v245
    v_mfma_f32_16x16x32_bf16 v[72:75], a[120:123], v[176:179], v[72:75]
    ds_read_b64_tr_b16 a[188:189], v23 offset:28672
    ds_read_b64_tr_b16 a[190:191], v23 offset:30720
    v_cvt_pk_bf16_f32 v243, v246, v247
    v_mfma_f32_16x16x32_bf16 v[88:91], a[120:123], v[184:187], v[88:91]
    v_cvt_pk_bf16_f32 v248, v248, v249
    v_cvt_pk_bf16_f32 v249, v250, v251
    v_cvt_pk_bf16_f32 v250, v252, v253
    v_cvt_pk_bf16_f32 v251, v254, v255
    v_mfma_f32_16x16x32_bf16 v[92:95], a[124:127], v[184:187], v[92:95]
    v_mfma_f32_16x16x32_bf16 v[76:79], a[124:127], v[176:179], v[76:79]
    s_waitcnt lgkmcnt(0)
    s_barrier
    v_mfma_f32_16x16x32_bf16 v[64:67], a[128:131], v[192:195], v[64:67]
    ds_read_b64_tr_b16 a[64:65], v20 offset:32768
    v_mfma_f32_16x16x32_bf16 v[68:71], a[132:135], v[192:195], v[68:71]
    ds_read_b64_tr_b16 a[66:67], v20 offset:34816
    v_mfma_f32_16x16x32_bf16 v[64:67], a[144:147], v[208:211], v[64:67]
    s_add_u32 m0, s32, 81920
    ds_read_b64_tr_b16 a[68:69], v21 offset:32768
    s_add_u32 s38, s81, 114688
    v_mfma_f32_16x16x32_bf16 v[68:71], a[148:151], v[208:211], v[68:71]
    ds_read_b64_tr_b16 a[70:71], v21 offset:34816
    v_mfma_f32_16x16x32_bf16 v[64:67], a[160:163], v[224:227], v[64:67]
    ds_read_b64_tr_b16 a[72:73], v22 offset:32768
    v_mfma_f32_16x16x32_bf16 v[68:71], a[164:167], v[224:227], v[68:71]
    buffer_load_dwordx4 v24, s[24:27], s38 offen offset:0  lds
    v_mfma_f32_16x16x32_bf16 v[64:67], a[176:179], v[240:243], v[64:67]
    ds_read_b64_tr_b16 a[74:75], v22 offset:34816
    ds_read_b64_tr_b16 a[76:77], v23 offset:32768
    v_mfma_f32_16x16x32_bf16 v[68:71], a[180:183], v[240:243], v[68:71]
    ds_read_b64_tr_b16 a[78:79], v23 offset:34816
    v_mfma_f32_16x16x32_bf16 v[72:75], a[136:139], v[192:195], v[72:75]
    ds_read_b64_tr_b16 a[80:81], v20 offset:36864
    v_mfma_f32_16x16x32_bf16 v[76:79], a[140:143], v[192:195], v[76:79]
    ds_read_b64_tr_b16 a[82:83], v20 offset:38912
    v_mfma_f32_16x16x32_bf16 v[72:75], a[152:155], v[208:211], v[72:75]
    ds_read_b64_tr_b16 a[84:85], v21 offset:36864
    v_mfma_f32_16x16x32_bf16 v[76:79], a[156:159], v[208:211], v[76:79]
    ds_read_b64_tr_b16 a[86:87], v21 offset:38912
    v_mfma_f32_16x16x32_bf16 v[72:75], a[168:171], v[224:227], v[72:75]
    ds_read_b64_tr_b16 a[88:89], v22 offset:36864
    buffer_load_dwordx4 v25, s[24:27], s38 offen offset:1024  lds
    v_mfma_f32_16x16x32_bf16 v[76:79], a[172:175], v[224:227], v[76:79]
    ds_read_b64_tr_b16 a[90:91], v22 offset:38912
    v_mul_f32 v64, v51, v64
    v_mfma_f32_16x16x32_bf16 v[72:75], a[184:187], v[240:243], v[72:75]
    ds_read_b64_tr_b16 a[92:93], v23 offset:36864
    v_mul_f32 v65, v51, v65
    v_mfma_f32_16x16x32_bf16 v[76:79], a[188:191], v[240:243], v[76:79]
    ds_read_b64_tr_b16 a[94:95], v23 offset:38912
    ds_read_b64_tr_b16 a[96:97], v20 offset:40960
    v_mfma_f32_16x16x32_bf16 v[80:83], a[128:131], v[200:203], v[80:83]
    ds_read_b64_tr_b16 a[98:99], v20 offset:43008
    v_mul_f32 v66, v51, v66
    v_mfma_f32_16x16x32_bf16 v[84:87], a[132:135], v[200:203], v[84:87]
    ds_read_b64_tr_b16 a[100:101], v21 offset:40960
    v_mul_f32 v67, v51, v67
    v_mfma_f32_16x16x32_bf16 v[80:83], a[144:147], v[216:219], v[80:83]
    ds_read_b64_tr_b16 a[102:103], v21 offset:43008
    v_mul_f32 v68, v51, v68
    v_mfma_f32_16x16x32_bf16 v[84:87], a[148:151], v[216:219], v[84:87]
    ds_read_b64_tr_b16 a[104:105], v22 offset:40960
    v_mul_f32 v69, v51, v69
    v_mfma_f32_16x16x32_bf16 v[80:83], a[160:163], v[232:235], v[80:83]
    ds_read_b64_tr_b16 a[106:107], v22 offset:43008
    buffer_load_dwordx4 v26, s[24:27], s38 offen offset:2048  lds
    v_mul_f32 v70, v51, v70
    v_mfma_f32_16x16x32_bf16 v[84:87], a[164:167], v[232:235], v[84:87]
    ds_read_b64_tr_b16 a[108:109], v23 offset:40960
    v_mul_f32 v71, v51, v71
    v_mfma_f32_16x16x32_bf16 v[80:83], a[176:179], v[248:251], v[80:83]
    ds_read_b64_tr_b16 a[110:111], v23 offset:43008
    v_cvt_pk_bf16_f32 v64, v64, v65
    v_mfma_f32_16x16x32_bf16 v[84:87], a[180:183], v[248:251], v[84:87]
    ds_read_b64_tr_b16 a[112:113], v20 offset:45056
    v_cvt_pk_bf16_f32 v65, v66, v67
    v_mfma_f32_16x16x32_bf16 v[88:91], a[136:139], v[200:203], v[88:91]
    ds_read_b64_tr_b16 a[114:115], v20 offset:47104
    v_cvt_pk_bf16_f32 v66, v68, v69
    v_cvt_pk_bf16_f32 v67, v70, v71
    v_mfma_f32_16x16x32_bf16 v[92:95], a[140:143], v[200:203], v[92:95]
    ds_read_b64_tr_b16 a[116:117], v21 offset:45056
    buffer_store_dwordx4 v[64:67], v53, s[28:31], s46 offen sc1
    v_mfma_f32_16x16x32_bf16 v[88:91], a[152:155], v[216:219], v[88:91]
    ds_read_b64_tr_b16 a[118:119], v21 offset:47104
    buffer_load_dwordx4 v27, s[24:27], s38 offen offset:3072  lds
    v_mfma_f32_16x16x32_bf16 v[92:95], a[156:159], v[216:219], v[92:95]
    ds_read_b64_tr_b16 a[120:121], v22 offset:45056
    ds_read_b64_tr_b16 a[122:123], v22 offset:47104
    v_mul_f32 v72, v51, v72
    v_mfma_f32_16x16x32_bf16 v[88:91], a[168:171], v[232:235], v[88:91]
    ds_read_b64_tr_b16 a[124:125], v23 offset:45056
    ds_read_b64_tr_b16 a[126:127], v23 offset:47104
    v_mul_f32 v73, v51, v73
    v_mfma_f32_16x16x32_bf16 v[92:95], a[172:175], v[232:235], v[92:95]
    v_mul_f32 v74, v51, v74
    v_mul_f32 v75, v51, v75
    v_mfma_f32_16x16x32_bf16 v[88:91], a[184:187], v[248:251], v[88:91]
    v_mul_f32 v76, v51, v76
    v_mul_f32 v77, v51, v77
    v_mfma_f32_16x16x32_bf16 v[92:95], a[188:191], v[248:251], v[92:95]
    v_mul_f32 v78, v51, v78
    s_waitcnt lgkmcnt(0)
    s_barrier
    v_mfma_f32_16x16x32_bf16 v[96:99], a[64:67], v[128:131], 0
    ds_read_b64_tr_b16 a[128:129], v20 offset:49152
    v_mul_f32 v79, v51, v79
    v_mfma_f32_16x16x32_bf16 v[112:115], a[64:67], v[136:139], 0
    ds_read_b64_tr_b16 a[130:131], v20 offset:51200
    v_cvt_pk_bf16_f32 v72, v72, v73
    v_mfma_f32_16x16x32_bf16 v[116:119], a[68:71], v[136:139], 0
    s_add_u32 m0, s32, 98304
    ds_read_b64_tr_b16 a[132:133], v21 offset:49152
    v_cvt_pk_bf16_f32 v73, v74, v75
    v_mfma_f32_16x16x32_bf16 v[100:103], a[68:71], v[128:131], 0
    s_add_u32 s38, s82, 0
    ds_read_b64_tr_b16 a[134:135], v21 offset:51200
    v_cvt_pk_bf16_f32 v74, v76, v77
    v_mfma_f32_16x16x32_bf16 v[104:107], a[72:75], v[128:131], 0
    ds_read_b64_tr_b16 a[144:145], v20 offset:53248
    v_cvt_pk_bf16_f32 v75, v78, v79
    v_mfma_f32_16x16x32_bf16 v[120:123], a[72:75], v[136:139], 0
    buffer_load_dwordx4 v24, s[24:27], s38 offen offset:0  lds
    v_mfma_f32_16x16x32_bf16 v[124:127], a[76:79], v[136:139], 0
    ds_read_b64_tr_b16 a[146:147], v20 offset:55296
    buffer_store_dwordx4 v[72:75], v53, s[28:31], s87 offen sc1
    v_mfma_f32_16x16x32_bf16 v[108:111], a[76:79], v[128:131], 0
    ds_read_b64_tr_b16 a[148:149], v21 offset:53248
    ds_read_b64_tr_b16 a[150:151], v21 offset:55296
    v_mfma_f32_16x16x32_bf16 v[96:99], a[80:83], v[144:147], v[96:99]
    ds_read_b64_tr_b16 a[160:161], v20 offset:57344
    v_mul_f32 v80, v52, v80
    v_mfma_f32_16x16x32_bf16 v[112:115], a[80:83], v[152:155], v[112:115]
    ds_read_b64_tr_b16 a[162:163], v20 offset:59392
    v_mul_f32 v81, v52, v81
    v_mfma_f32_16x16x32_bf16 v[116:119], a[84:87], v[152:155], v[116:119]
    ds_read_b64_tr_b16 a[164:165], v21 offset:57344
    v_mul_f32 v82, v52, v82
    v_mfma_f32_16x16x32_bf16 v[100:103], a[84:87], v[144:147], v[100:103]
    ds_read_b64_tr_b16 a[166:167], v21 offset:59392
    v_mul_f32 v83, v52, v83
    v_mfma_f32_16x16x32_bf16 v[104:107], a[88:91], v[144:147], v[104:107]
    ds_read_b64_tr_b16 a[176:177], v20 offset:61440
    v_mul_f32 v84, v52, v84
    v_mfma_f32_16x16x32_bf16 v[120:123], a[88:91], v[152:155], v[120:123]
    ds_read_b64_tr_b16 a[178:179], v20 offset:63488
    buffer_load_dwordx4 v25, s[24:27], s38 offen offset:1024  lds
    v_mul_f32 v85, v52, v85
    v_mfma_f32_16x16x32_bf16 v[124:127], a[92:95], v[152:155], v[124:127]
    ds_read_b64_tr_b16 a[180:181], v21 offset:61440
    v_mul_f32 v86, v52, v86
    v_mfma_f32_16x16x32_bf16 v[108:111], a[92:95], v[144:147], v[108:111]
    ds_read_b64_tr_b16 a[182:183], v21 offset:63488
    ds_read_b64_tr_b16 a[136:137], v22 offset:49152
    v_mul_f32 v87, v52, v87
    v_cvt_pk_bf16_f32 v80, v80, v81
    v_mfma_f32_16x16x32_bf16 v[96:99], a[96:99], v[160:163], v[96:99]
    ds_read_b64_tr_b16 a[138:139], v22 offset:51200
    v_cvt_pk_bf16_f32 v81, v82, v83
    v_mfma_f32_16x16x32_bf16 v[112:115], a[96:99], v[168:171], v[112:115]
    ds_read_b64_tr_b16 a[140:141], v23 offset:49152
    v_cvt_pk_bf16_f32 v82, v84, v85
    v_mfma_f32_16x16x32_bf16 v[116:119], a[100:103], v[168:171], v[116:119]
    ds_read_b64_tr_b16 a[142:143], v23 offset:51200
    v_cvt_pk_bf16_f32 v83, v86, v87
    v_mfma_f32_16x16x32_bf16 v[100:103], a[100:103], v[160:163], v[100:103]
    ds_read_b64_tr_b16 a[152:153], v22 offset:53248
    buffer_load_dwordx4 v26, s[24:27], s38 offen offset:2048  lds
    v_mfma_f32_16x16x32_bf16 v[104:107], a[104:107], v[160:163], v[104:107]
    ds_read_b64_tr_b16 a[154:155], v22 offset:55296
    buffer_store_dwordx4 v[80:83], v19, s[28:31], s46 offen sc1
    v_mfma_f32_16x16x32_bf16 v[120:123], a[104:107], v[168:171], v[120:123]
    ds_read_b64_tr_b16 a[156:157], v23 offset:53248
    v_mul_f32 v88, v52, v88
    v_mfma_f32_16x16x32_bf16 v[124:127], a[108:111], v[168:171], v[124:127]
    ds_read_b64_tr_b16 a[158:159], v23 offset:55296
    v_mul_f32 v89, v52, v89
    v_mfma_f32_16x16x32_bf16 v[108:111], a[108:111], v[160:163], v[108:111]
    ds_read_b64_tr_b16 a[168:169], v22 offset:57344
    v_mul_f32 v90, v52, v90
    v_mfma_f32_16x16x32_bf16 v[96:99], a[112:115], v[176:179], v[96:99]
    ds_read_b64_tr_b16 a[170:171], v22 offset:59392
    v_mul_f32 v91, v52, v91
    v_mul_f32 v92, v52, v92
    v_mfma_f32_16x16x32_bf16 v[112:115], a[112:115], v[184:187], v[112:115]
    ds_read_b64_tr_b16 a[172:173], v23 offset:57344
    ds_read_b64_tr_b16 a[174:175], v23 offset:59392
    v_mul_f32 v93, v52, v93
    v_mfma_f32_16x16x32_bf16 v[116:119], a[116:119], v[184:187], v[116:119]
    ds_read_b64_tr_b16 a[184:185], v22 offset:61440
    buffer_load_dwordx4 v27, s[24:27], s38 offen offset:3072  lds
    v_mul_f32 v94, v52, v94
    v_mfma_f32_16x16x32_bf16 v[100:103], a[116:119], v[176:179], v[100:103]
    ds_read_b64_tr_b16 a[186:187], v22 offset:63488
    v_mul_f32 v95, v52, v95
    v_mfma_f32_16x16x32_bf16 v[104:107], a[120:123], v[176:179], v[104:107]
    ds_read_b64_tr_b16 a[188:189], v23 offset:61440
    ds_read_b64_tr_b16 a[190:191], v23 offset:63488
    v_cvt_pk_bf16_f32 v88, v88, v89
    v_mfma_f32_16x16x32_bf16 v[120:123], a[120:123], v[184:187], v[120:123]
    v_cvt_pk_bf16_f32 v89, v90, v91
    v_cvt_pk_bf16_f32 v90, v92, v93
    v_mfma_f32_16x16x32_bf16 v[124:127], a[124:127], v[184:187], v[124:127]
    v_cvt_pk_bf16_f32 v91, v94, v95
    v_mfma_f32_16x16x32_bf16 v[108:111], a[124:127], v[176:179], v[108:111]
    buffer_store_dwordx4 v[88:91], v19, s[28:31], s87 offen sc1
    s_add_u32 s46, s46, 0x8000
    s_add_u32 s87, s87, 0x8000
    s_waitcnt vmcnt(16) lgkmcnt(0)
    s_barrier
    v_mfma_f32_16x16x32_bf16 v[96:99], a[128:131], v[192:195], v[96:99]
    ds_read_b64_tr_b16 a[64:65], v28 offset:0
    v_mfma_f32_16x16x32_bf16 v[100:103], a[132:135], v[192:195], v[100:103]
    ds_read_b64_tr_b16 a[66:67], v28 offset:2048
    v_mfma_f32_16x16x32_bf16 v[96:99], a[144:147], v[208:211], v[96:99]
    s_add_u32 m0, s32, 114688
    ds_read_b64_tr_b16 a[68:69], v29 offset:0
    s_add_u32 s38, s82, 114688
    v_mfma_f32_16x16x32_bf16 v[100:103], a[148:151], v[208:211], v[100:103]
    ds_read_b64_tr_b16 a[70:71], v29 offset:2048
    v_mfma_f32_16x16x32_bf16 v[96:99], a[160:163], v[224:227], v[96:99]
    buffer_load_dwordx4 v24, s[24:27], s38 offen offset:0  lds
    v_mfma_f32_16x16x32_bf16 v[100:103], a[164:167], v[224:227], v[100:103]
    ds_read_b64_tr_b16 a[72:73], v30 offset:0
    v_mfma_f32_16x16x32_bf16 v[96:99], a[176:179], v[240:243], v[96:99]
    ds_read_b64_tr_b16 a[74:75], v30 offset:2048
    v_mfma_f32_16x16x32_bf16 v[100:103], a[180:183], v[240:243], v[100:103]
    ds_read_b64_tr_b16 a[76:77], v31 offset:0
    v_mfma_f32_16x16x32_bf16 v[104:107], a[136:139], v[192:195], v[104:107]
    ds_read_b64_tr_b16 a[78:79], v31 offset:2048
    v_mfma_f32_16x16x32_bf16 v[108:111], a[140:143], v[192:195], v[108:111]
    ds_read_b64_tr_b16 a[80:81], v28 offset:4096
    v_mfma_f32_16x16x32_bf16 v[104:107], a[152:155], v[208:211], v[104:107]
    ds_read_b64_tr_b16 a[82:83], v28 offset:6144
    v_mfma_f32_16x16x32_bf16 v[108:111], a[156:159], v[208:211], v[108:111]
    ds_read_b64_tr_b16 a[84:85], v29 offset:4096
    v_mfma_f32_16x16x32_bf16 v[104:107], a[168:171], v[224:227], v[104:107]
    ds_read_b64_tr_b16 a[86:87], v29 offset:6144
    buffer_load_dwordx4 v25, s[24:27], s38 offen offset:1024  lds
    v_mfma_f32_16x16x32_bf16 v[108:111], a[172:175], v[224:227], v[108:111]
    ds_read_b64_tr_b16 a[88:89], v30 offset:4096
    v_mul_f32 v96, v51, v96
    v_mfma_f32_16x16x32_bf16 v[104:107], a[184:187], v[240:243], v[104:107]
    ds_read_b64_tr_b16 a[90:91], v30 offset:6144
    v_mul_f32 v97, v51, v97
    v_mfma_f32_16x16x32_bf16 v[108:111], a[188:191], v[240:243], v[108:111]
    ds_read_b64_tr_b16 a[92:93], v31 offset:4096
    v_mul_f32 v98, v51, v98
    v_mfma_f32_16x16x32_bf16 v[112:115], a[128:131], v[200:203], v[112:115]
    ds_read_b64_tr_b16 a[94:95], v31 offset:6144
    v_mul_f32 v99, v51, v99
    v_mfma_f32_16x16x32_bf16 v[116:119], a[132:135], v[200:203], v[116:119]
    ds_read_b64_tr_b16 a[96:97], v28 offset:8192
    v_mul_f32 v100, v51, v100
    v_mfma_f32_16x16x32_bf16 v[112:115], a[144:147], v[216:219], v[112:115]
    ds_read_b64_tr_b16 a[98:99], v28 offset:10240
    v_mul_f32 v101, v51, v101
    v_mfma_f32_16x16x32_bf16 v[116:119], a[148:151], v[216:219], v[116:119]
    ds_read_b64_tr_b16 a[100:101], v29 offset:8192
    buffer_load_dwordx4 v26, s[24:27], s38 offen offset:2048  lds
    v_mfma_f32_16x16x32_bf16 v[112:115], a[160:163], v[232:235], v[112:115]
    ds_read_b64_tr_b16 a[102:103], v29 offset:10240
    v_mul_f32 v102, v51, v102
    v_mfma_f32_16x16x32_bf16 v[116:119], a[164:167], v[232:235], v[116:119]
    ds_read_b64_tr_b16 a[104:105], v30 offset:8192
    v_mul_f32 v103, v51, v103
    v_mfma_f32_16x16x32_bf16 v[112:115], a[176:179], v[248:251], v[112:115]
    ds_read_b64_tr_b16 a[106:107], v30 offset:10240
    v_cvt_pk_bf16_f32 v96, v96, v97
    v_mfma_f32_16x16x32_bf16 v[116:119], a[180:183], v[248:251], v[116:119]
    ds_read_b64_tr_b16 a[108:109], v31 offset:8192
    v_cvt_pk_bf16_f32 v97, v98, v99
    v_mfma_f32_16x16x32_bf16 v[120:123], a[136:139], v[200:203], v[120:123]
    ds_read_b64_tr_b16 a[110:111], v31 offset:10240
    v_cvt_pk_bf16_f32 v98, v100, v101
    v_cvt_pk_bf16_f32 v99, v102, v103
    v_mfma_f32_16x16x32_bf16 v[124:127], a[140:143], v[200:203], v[124:127]
    ds_read_b64_tr_b16 a[112:113], v28 offset:12288
    buffer_store_dwordx4 v[96:99], v53, s[28:31], s46 offen sc1
    v_mfma_f32_16x16x32_bf16 v[120:123], a[152:155], v[216:219], v[120:123]
    ds_read_b64_tr_b16 a[114:115], v28 offset:14336
    buffer_load_dwordx4 v27, s[24:27], s38 offen offset:3072  lds
    v_mfma_f32_16x16x32_bf16 v[124:127], a[156:159], v[216:219], v[124:127]
    ds_read_b64_tr_b16 a[116:117], v29 offset:12288
    v_mul_f32 v104, v51, v104
    v_mfma_f32_16x16x32_bf16 v[120:123], a[168:171], v[232:235], v[120:123]
    ds_read_b64_tr_b16 a[118:119], v29 offset:14336
    v_mul_f32 v105, v51, v105
    v_mfma_f32_16x16x32_bf16 v[124:127], a[172:175], v[232:235], v[124:127]
    ds_read_b64_tr_b16 a[120:121], v30 offset:12288
    v_mul_f32 v106, v51, v106
    v_mfma_f32_16x16x32_bf16 v[120:123], a[184:187], v[248:251], v[120:123]
    ds_read_b64_tr_b16 a[122:123], v30 offset:14336
    v_mul_f32 v107, v51, v107
    v_mfma_f32_16x16x32_bf16 v[124:127], a[188:191], v[248:251], v[124:127]
    ds_read_b64_tr_b16 a[124:125], v31 offset:12288
    ds_read_b64_tr_b16 a[126:127], v31 offset:14336
    v_mul_f32 v108, v51, v108
    v_mul_f32 v109, v51, v109
    v_mul_f32 v110, v51, v110
    s_waitcnt lgkmcnt(6)
    v_mfma_f32_16x16x32_bf16 v[64:67], a[64:67], v[128:131], 0
    ds_read_b64_tr_b16 a[128:129], v28 offset:16384
    v_mul_f32 v111, v51, v111
    v_mfma_f32_16x16x32_bf16 v[80:83], a[64:67], v[136:139], 0
    ds_read_b64_tr_b16 a[130:131], v28 offset:18432
    v_cvt_pk_bf16_f32 v104, v104, v105
    v_mfma_f32_16x16x32_bf16 v[84:87], a[68:71], v[136:139], 0
    ds_read_b64_tr_b16 a[132:133], v29 offset:16384
    v_cvt_pk_bf16_f32 v105, v106, v107
    v_mfma_f32_16x16x32_bf16 v[68:71], a[68:71], v[128:131], 0
    s_waitcnt lgkmcnt(3)
    ds_read_b64_tr_b16 a[134:135], v29 offset:18432
    v_cvt_pk_bf16_f32 v106, v108, v109
    v_mfma_f32_16x16x32_bf16 v[72:75], a[72:75], v[128:131], 0
    ds_read_b64_tr_b16 a[144:145], v28 offset:20480
    v_cvt_pk_bf16_f32 v107, v110, v111
    v_mfma_f32_16x16x32_bf16 v[88:91], a[72:75], v[136:139], 0
    buffer_store_dwordx4 v[104:107], v53, s[28:31], s87 offen sc1
    v_mfma_f32_16x16x32_bf16 v[92:95], a[76:79], v[136:139], 0
    ds_read_b64_tr_b16 a[146:147], v28 offset:22528
    v_mul_f32 v112, v52, v112
    v_mfma_f32_16x16x32_bf16 v[76:79], a[76:79], v[128:131], 0
    ds_read_b64_tr_b16 a[148:149], v29 offset:20480
    v_mul_f32 v113, v52, v113
    v_mfma_f32_16x16x32_bf16 v[64:67], a[80:83], v[144:147], v[64:67]
    ds_read_b64_tr_b16 a[150:151], v29 offset:22528
    v_mul_f32 v114, v52, v114
    v_mfma_f32_16x16x32_bf16 v[80:83], a[80:83], v[152:155], v[80:83]
    ds_read_b64_tr_b16 a[160:161], v28 offset:24576
    v_mul_f32 v115, v52, v115
    v_mfma_f32_16x16x32_bf16 v[84:87], a[84:87], v[152:155], v[84:87]
    ds_read_b64_tr_b16 a[162:163], v28 offset:26624
    v_mul_f32 v116, v52, v116
    v_mfma_f32_16x16x32_bf16 v[68:71], a[84:87], v[144:147], v[68:71]
    ds_read_b64_tr_b16 a[164:165], v29 offset:24576
    v_mul_f32 v117, v52, v117
    v_mfma_f32_16x16x32_bf16 v[72:75], a[88:91], v[144:147], v[72:75]
    ds_read_b64_tr_b16 a[166:167], v29 offset:26624
    v_mul_f32 v118, v52, v118
    v_mfma_f32_16x16x32_bf16 v[88:91], a[88:91], v[152:155], v[88:91]
    ds_read_b64_tr_b16 a[176:177], v28 offset:28672
    v_mul_f32 v119, v52, v119
    v_mfma_f32_16x16x32_bf16 v[92:95], a[92:95], v[152:155], v[92:95]
    ds_read_b64_tr_b16 a[178:179], v28 offset:30720
    v_cvt_pk_bf16_f32 v112, v112, v113
    v_mfma_f32_16x16x32_bf16 v[76:79], a[92:95], v[144:147], v[76:79]
    ds_read_b64_tr_b16 a[180:181], v29 offset:28672
    v_cvt_pk_bf16_f32 v113, v114, v115
    v_mfma_f32_16x16x32_bf16 v[64:67], a[96:99], v[160:163], v[64:67]
    ds_read_b64_tr_b16 a[182:183], v29 offset:30720
    v_cvt_pk_bf16_f32 v114, v116, v117
    v_mfma_f32_16x16x32_bf16 v[80:83], a[96:99], v[168:171], v[80:83]
    ds_read_b64_tr_b16 a[136:137], v30 offset:16384
    v_cvt_pk_bf16_f32 v115, v118, v119
    v_mfma_f32_16x16x32_bf16 v[84:87], a[100:103], v[168:171], v[84:87]
    ds_read_b64_tr_b16 a[138:139], v30 offset:18432
    v_mfma_f32_16x16x32_bf16 v[68:71], a[100:103], v[160:163], v[68:71]
    ds_read_b64_tr_b16 a[140:141], v31 offset:16384
    buffer_store_dwordx4 v[112:115], v19, s[28:31], s46 offen sc1
    v_mfma_f32_16x16x32_bf16 v[72:75], a[104:107], v[160:163], v[72:75]
    ds_read_b64_tr_b16 a[142:143], v31 offset:18432
    v_mul_f32 v120, v52, v120
    v_mfma_f32_16x16x32_bf16 v[88:91], a[104:107], v[168:171], v[88:91]
    ds_read_b64_tr_b16 a[152:153], v30 offset:20480
    v_mul_f32 v121, v52, v121
    v_mfma_f32_16x16x32_bf16 v[92:95], a[108:111], v[168:171], v[92:95]
    ds_read_b64_tr_b16 a[154:155], v30 offset:22528
    v_mul_f32 v122, v52, v122
    v_mfma_f32_16x16x32_bf16 v[76:79], a[108:111], v[160:163], v[76:79]
    ds_read_b64_tr_b16 a[156:157], v31 offset:20480
    v_mul_f32 v123, v52, v123
    v_mfma_f32_16x16x32_bf16 v[64:67], a[112:115], v[176:179], v[64:67]
    ds_read_b64_tr_b16 a[158:159], v31 offset:22528
    v_mul_f32 v124, v52, v124
    v_mfma_f32_16x16x32_bf16 v[80:83], a[112:115], v[184:187], v[80:83]
    ds_read_b64_tr_b16 a[168:169], v30 offset:24576
    v_mul_f32 v125, v52, v125
    v_mfma_f32_16x16x32_bf16 v[84:87], a[116:119], v[184:187], v[84:87]
    ds_read_b64_tr_b16 a[170:171], v30 offset:26624
    v_mul_f32 v126, v52, v126
    v_mfma_f32_16x16x32_bf16 v[68:71], a[116:119], v[176:179], v[68:71]
    ds_read_b64_tr_b16 a[172:173], v31 offset:24576
    v_mul_f32 v127, v52, v127
    v_mfma_f32_16x16x32_bf16 v[72:75], a[120:123], v[176:179], v[72:75]
    ds_read_b64_tr_b16 a[174:175], v31 offset:26624
    v_cvt_pk_bf16_f32 v120, v120, v121
    v_mfma_f32_16x16x32_bf16 v[88:91], a[120:123], v[184:187], v[88:91]
    ds_read_b64_tr_b16 a[184:185], v30 offset:28672
    v_cvt_pk_bf16_f32 v121, v122, v123
    v_mfma_f32_16x16x32_bf16 v[92:95], a[124:127], v[184:187], v[92:95]
    ds_read_b64_tr_b16 a[186:187], v30 offset:30720
    v_cvt_pk_bf16_f32 v122, v124, v125
    v_mfma_f32_16x16x32_bf16 v[76:79], a[124:127], v[176:179], v[76:79]
    ds_read_b64_tr_b16 a[188:189], v31 offset:28672
    ds_read_b64_tr_b16 a[190:191], v31 offset:30720
    v_cvt_pk_bf16_f32 v123, v126, v127
    buffer_store_dwordx4 v[120:123], v19, s[28:31], s87 offen sc1
    s_add_u32 s46, s46, 0x8000
    s_add_u32 s87, s87, 0x8000
    s_waitcnt vmcnt(8) lgkmcnt(6)
    v_mfma_f32_16x16x32_bf16 v[64:67], a[128:131], v[192:195], v[64:67]
    ds_read_b64_tr_b16 a[64:65], v42 offset:32768
    v_mov_b32 v5, 0x1
    v_mfma_f32_16x16x32_bf16 v[68:71], a[132:135], v[192:195], v[68:71]
    buffer_atomic_add v5, v2, s[64:67], 0 offen sc0
    v_mfma_f32_16x16x32_bf16 v[64:67], a[144:147], v[208:211], v[64:67]
    ds_read_b64_tr_b16 a[66:67], v42 offset:34816
    v_mfma_f32_16x16x32_bf16 v[68:71], a[148:151], v[208:211], v[68:71]
    s_waitcnt lgkmcnt(2)
    ds_read_b64_tr_b16 a[68:69], v43 offset:32768
    v_mfma_f32_16x16x32_bf16 v[64:67], a[160:163], v[224:227], v[64:67]
    ds_read_b64_tr_b16 a[70:71], v43 offset:34816
    v_mfma_f32_16x16x32_bf16 v[68:71], a[164:167], v[224:227], v[68:71]
    ds_read_b64_tr_b16 a[72:73], v44 offset:32768
    v_mfma_f32_16x16x32_bf16 v[64:67], a[176:179], v[240:243], v[64:67]
    ds_read_b64_tr_b16 a[74:75], v44 offset:34816
    v_mfma_f32_16x16x32_bf16 v[68:71], a[180:183], v[240:243], v[68:71]
    ds_read_b64_tr_b16 a[76:77], v45 offset:32768
    v_mfma_f32_16x16x32_bf16 v[72:75], a[136:139], v[192:195], v[72:75]
    ds_read_b64_tr_b16 a[78:79], v45 offset:34816
    v_mfma_f32_16x16x32_bf16 v[76:79], a[140:143], v[192:195], v[76:79]
    ds_read_b64_tr_b16 a[80:81], v42 offset:36864
    v_mfma_f32_16x16x32_bf16 v[72:75], a[152:155], v[208:211], v[72:75]
    ds_read_b64_tr_b16 a[82:83], v42 offset:38912
    v_mfma_f32_16x16x32_bf16 v[76:79], a[156:159], v[208:211], v[76:79]
    ds_read_b64_tr_b16 a[84:85], v43 offset:36864
    v_mfma_f32_16x16x32_bf16 v[72:75], a[168:171], v[224:227], v[72:75]
    ds_read_b64_tr_b16 a[86:87], v43 offset:38912
    v_mul_f32 v64, v51, v64
    v_mfma_f32_16x16x32_bf16 v[76:79], a[172:175], v[224:227], v[76:79]
    ds_read_b64_tr_b16 a[88:89], v44 offset:36864
    v_mul_f32 v65, v51, v65
    v_mfma_f32_16x16x32_bf16 v[72:75], a[184:187], v[240:243], v[72:75]
    ds_read_b64_tr_b16 a[90:91], v44 offset:38912
    v_mul_f32 v66, v51, v66
    v_mfma_f32_16x16x32_bf16 v[76:79], a[188:191], v[240:243], v[76:79]
    ds_read_b64_tr_b16 a[92:93], v45 offset:36864
    v_mul_f32 v67, v51, v67
    v_mfma_f32_16x16x32_bf16 v[80:83], a[128:131], v[200:203], v[80:83]
    ds_read_b64_tr_b16 a[94:95], v45 offset:38912
    v_mul_f32 v68, v51, v68
    v_mfma_f32_16x16x32_bf16 v[84:87], a[132:135], v[200:203], v[84:87]
    ds_read_b64_tr_b16 a[96:97], v42 offset:40960
    v_mul_f32 v69, v51, v69
    v_mfma_f32_16x16x32_bf16 v[80:83], a[144:147], v[216:219], v[80:83]
    ds_read_b64_tr_b16 a[98:99], v42 offset:43008
    v_mul_f32 v70, v51, v70
    v_mfma_f32_16x16x32_bf16 v[84:87], a[148:151], v[216:219], v[84:87]
    ds_read_b64_tr_b16 a[100:101], v43 offset:40960
    v_mul_f32 v71, v51, v71
    v_mfma_f32_16x16x32_bf16 v[80:83], a[160:163], v[232:235], v[80:83]
    ds_read_b64_tr_b16 a[102:103], v43 offset:43008
    v_cvt_pk_bf16_f32 v64, v64, v65
    v_mfma_f32_16x16x32_bf16 v[84:87], a[164:167], v[232:235], v[84:87]
    ds_read_b64_tr_b16 a[104:105], v44 offset:40960
    v_cvt_pk_bf16_f32 v65, v66, v67
    v_mfma_f32_16x16x32_bf16 v[80:83], a[176:179], v[248:251], v[80:83]
    ds_read_b64_tr_b16 a[106:107], v44 offset:43008
    v_cvt_pk_bf16_f32 v66, v68, v69
    v_mfma_f32_16x16x32_bf16 v[84:87], a[180:183], v[248:251], v[84:87]
    ds_read_b64_tr_b16 a[108:109], v45 offset:40960
    v_cvt_pk_bf16_f32 v67, v70, v71
    v_mfma_f32_16x16x32_bf16 v[88:91], a[136:139], v[200:203], v[88:91]
    ds_read_b64_tr_b16 a[110:111], v45 offset:43008
    v_mfma_f32_16x16x32_bf16 v[92:95], a[140:143], v[200:203], v[92:95]
    ds_read_b64_tr_b16 a[112:113], v42 offset:45056
    buffer_store_dwordx4 v[64:67], v53, s[28:31], s46 offen sc1
    v_mfma_f32_16x16x32_bf16 v[88:91], a[152:155], v[216:219], v[88:91]
    ds_read_b64_tr_b16 a[114:115], v42 offset:47104
    v_mul_f32 v72, v51, v72
    v_mfma_f32_16x16x32_bf16 v[92:95], a[156:159], v[216:219], v[92:95]
    ds_read_b64_tr_b16 a[116:117], v43 offset:45056
    v_mul_f32 v73, v51, v73
    v_mfma_f32_16x16x32_bf16 v[88:91], a[168:171], v[232:235], v[88:91]
    ds_read_b64_tr_b16 a[118:119], v43 offset:47104
    v_mul_f32 v74, v51, v74
    v_mfma_f32_16x16x32_bf16 v[92:95], a[172:175], v[232:235], v[92:95]
    ds_read_b64_tr_b16 a[120:121], v44 offset:45056
    v_mul_f32 v75, v51, v75
    v_mfma_f32_16x16x32_bf16 v[88:91], a[184:187], v[248:251], v[88:91]
    ds_read_b64_tr_b16 a[122:123], v44 offset:47104
    v_mul_f32 v76, v51, v76
    v_mfma_f32_16x16x32_bf16 v[92:95], a[188:191], v[248:251], v[92:95]
    ds_read_b64_tr_b16 a[124:125], v45 offset:45056
    ds_read_b64_tr_b16 a[126:127], v45 offset:47104
    v_mul_f32 v77, v51, v77
    v_mul_f32 v78, v51, v78
    s_waitcnt vmcnt(5) lgkmcnt(6)
    s_barrier
    v_mfma_f32_16x16x32_bf16 v[96:99], a[64:67], v[128:131], 0
    ds_read_b64_tr_b16 a[128:129], v42 offset:49152
    v_mul_f32 v79, v51, v79
    v_mfma_f32_16x16x32_bf16 v[112:115], a[64:67], v[136:139], 0
    ds_read_b64_tr_b16 a[130:131], v42 offset:51200
    v_cvt_pk_bf16_f32 v72, v72, v73
    v_mfma_f32_16x16x32_bf16 v[116:119], a[68:71], v[136:139], 0
    ds_read_b64_tr_b16 a[132:133], v43 offset:49152
    v_cvt_pk_bf16_f32 v73, v74, v75
    v_mfma_f32_16x16x32_bf16 v[100:103], a[68:71], v[128:131], 0
    s_waitcnt lgkmcnt(3)
    ds_read_b64_tr_b16 a[134:135], v43 offset:51200
    v_cvt_pk_bf16_f32 v74, v76, v77
    v_mfma_f32_16x16x32_bf16 v[104:107], a[72:75], v[128:131], 0
    ds_read_b64_tr_b16 a[144:145], v42 offset:53248
    v_cvt_pk_bf16_f32 v75, v78, v79
    v_mfma_f32_16x16x32_bf16 v[120:123], a[72:75], v[136:139], 0
    buffer_store_dwordx4 v[72:75], v53, s[28:31], s87 offen sc1
    v_mfma_f32_16x16x32_bf16 v[124:127], a[76:79], v[136:139], 0
    ds_read_b64_tr_b16 a[146:147], v42 offset:55296
    v_mul_f32 v80, v52, v80
    v_mfma_f32_16x16x32_bf16 v[108:111], a[76:79], v[128:131], 0
    ds_read_b64_tr_b16 a[148:149], v43 offset:53248
    v_mul_f32 v81, v52, v81
    v_mfma_f32_16x16x32_bf16 v[96:99], a[80:83], v[144:147], v[96:99]
    ds_read_b64_tr_b16 a[150:151], v43 offset:55296
    v_mul_f32 v82, v52, v82
    v_mfma_f32_16x16x32_bf16 v[112:115], a[80:83], v[152:155], v[112:115]
    ds_read_b64_tr_b16 a[160:161], v42 offset:57344
    v_mul_f32 v83, v52, v83
    v_mfma_f32_16x16x32_bf16 v[116:119], a[84:87], v[152:155], v[116:119]
    ds_read_b64_tr_b16 a[162:163], v42 offset:59392
    v_mul_f32 v84, v52, v84
    v_mfma_f32_16x16x32_bf16 v[100:103], a[84:87], v[144:147], v[100:103]
    ds_read_b64_tr_b16 a[164:165], v43 offset:57344
    v_mul_f32 v85, v52, v85
    v_mfma_f32_16x16x32_bf16 v[104:107], a[88:91], v[144:147], v[104:107]
    ds_read_b64_tr_b16 a[166:167], v43 offset:59392
    v_mul_f32 v86, v52, v86
    v_mfma_f32_16x16x32_bf16 v[120:123], a[88:91], v[152:155], v[120:123]
    ds_read_b64_tr_b16 a[176:177], v42 offset:61440
    v_mul_f32 v87, v52, v87
    v_mfma_f32_16x16x32_bf16 v[124:127], a[92:95], v[152:155], v[124:127]
    ds_read_b64_tr_b16 a[178:179], v42 offset:63488
    v_cvt_pk_bf16_f32 v80, v80, v81
    v_mfma_f32_16x16x32_bf16 v[108:111], a[92:95], v[144:147], v[108:111]
    ds_read_b64_tr_b16 a[180:181], v43 offset:61440
    v_cvt_pk_bf16_f32 v81, v82, v83
    v_mfma_f32_16x16x32_bf16 v[96:99], a[96:99], v[160:163], v[96:99]
    ds_read_b64_tr_b16 a[182:183], v43 offset:63488
    v_cvt_pk_bf16_f32 v82, v84, v85
    v_mfma_f32_16x16x32_bf16 v[112:115], a[96:99], v[168:171], v[112:115]
    ds_read_b64_tr_b16 a[136:137], v44 offset:49152
    v_cvt_pk_bf16_f32 v83, v86, v87
    v_mfma_f32_16x16x32_bf16 v[116:119], a[100:103], v[168:171], v[116:119]
    ds_read_b64_tr_b16 a[138:139], v44 offset:51200
    v_mfma_f32_16x16x32_bf16 v[100:103], a[100:103], v[160:163], v[100:103]
    ds_read_b64_tr_b16 a[140:141], v45 offset:49152
    buffer_store_dwordx4 v[80:83], v19, s[28:31], s46 offen sc1
    v_mfma_f32_16x16x32_bf16 v[104:107], a[104:107], v[160:163], v[104:107]
    ds_read_b64_tr_b16 a[142:143], v45 offset:51200
    v_mul_f32 v88, v52, v88
    v_mfma_f32_16x16x32_bf16 v[120:123], a[104:107], v[168:171], v[120:123]
    ds_read_b64_tr_b16 a[152:153], v44 offset:53248
    v_mul_f32 v89, v52, v89
    v_mfma_f32_16x16x32_bf16 v[124:127], a[108:111], v[168:171], v[124:127]
    ds_read_b64_tr_b16 a[154:155], v44 offset:55296
    v_mul_f32 v90, v52, v90
    v_mfma_f32_16x16x32_bf16 v[108:111], a[108:111], v[160:163], v[108:111]
    ds_read_b64_tr_b16 a[156:157], v45 offset:53248
    v_mul_f32 v91, v52, v91
    v_mfma_f32_16x16x32_bf16 v[96:99], a[112:115], v[176:179], v[96:99]
    ds_read_b64_tr_b16 a[158:159], v45 offset:55296
    v_mul_f32 v92, v52, v92
    v_mfma_f32_16x16x32_bf16 v[112:115], a[112:115], v[184:187], v[112:115]
    ds_read_b64_tr_b16 a[168:169], v44 offset:57344
    v_mul_f32 v93, v52, v93
    v_mfma_f32_16x16x32_bf16 v[116:119], a[116:119], v[184:187], v[116:119]
    ds_read_b64_tr_b16 a[170:171], v44 offset:59392
    v_mul_f32 v94, v52, v94
    v_mfma_f32_16x16x32_bf16 v[100:103], a[116:119], v[176:179], v[100:103]
    ds_read_b64_tr_b16 a[172:173], v45 offset:57344
    v_mul_f32 v95, v52, v95
    v_mfma_f32_16x16x32_bf16 v[104:107], a[120:123], v[176:179], v[104:107]
    ds_read_b64_tr_b16 a[174:175], v45 offset:59392
    v_cvt_pk_bf16_f32 v88, v88, v89
    v_mfma_f32_16x16x32_bf16 v[120:123], a[120:123], v[184:187], v[120:123]
    ds_read_b64_tr_b16 a[184:185], v44 offset:61440
    v_cvt_pk_bf16_f32 v89, v90, v91
    v_mfma_f32_16x16x32_bf16 v[124:127], a[124:127], v[184:187], v[124:127]
    ds_read_b64_tr_b16 a[186:187], v44 offset:63488
    v_cvt_pk_bf16_f32 v90, v92, v93
    v_mfma_f32_16x16x32_bf16 v[108:111], a[124:127], v[176:179], v[108:111]
    ds_read_b64_tr_b16 a[188:189], v45 offset:61440
    ds_read_b64_tr_b16 a[190:191], v45 offset:63488
    v_cvt_pk_bf16_f32 v91, v94, v95
    buffer_store_dwordx4 v[88:91], v19, s[28:31], s87 offen sc1
    s_add_u32 s46, s46, 0x8000
    s_add_u32 s87, s87, 0x8000
    s_waitcnt vmcnt(4) lgkmcnt(6)
    v_mfma_f32_16x16x32_bf16 v[96:99], a[128:131], v[192:195], v[96:99]
    ds_read_b64_tr_b16 a[64:65], v42 offset:0
    v_readfirstlane_b32 s54, v5
    v_mfma_f32_16x16x32_bf16 v[100:103], a[132:135], v[192:195], v[100:103]
    ds_read_b64_tr_b16 a[66:67], v42 offset:2048
    v_mov_b32 v5, 0x20
    v_mfma_f32_16x16x32_bf16 v[96:99], a[144:147], v[208:211], v[96:99]
    buffer_atomic_add v5, v2, s[64:67], 0 offen sc0
    v_mfma_f32_16x16x32_bf16 v[100:103], a[148:151], v[208:211], v[100:103]
    s_waitcnt lgkmcnt(2)
    ds_read_b64_tr_b16 a[68:69], v43 offset:0
    s_lshl_b32 s53, s52, 15
    v_mfma_f32_16x16x32_bf16 v[96:99], a[160:163], v[224:227], v[96:99]
    s_cmp_lt_u32 s52, 2
    s_cselect_b32 s47, 8, -2
    ds_read_b64_tr_b16 a[70:71], v43 offset:2048
    v_mfma_f32_16x16x32_bf16 v[100:103], a[164:167], v[224:227], v[100:103]
    s_add_u32 s47, s47, s52
    ds_read_b64_tr_b16 a[72:73], v44 offset:0
    s_lshl_b32 s47, s47, 14
    v_mfma_f32_16x16x32_bf16 v[96:99], a[176:179], v[240:243], v[96:99]
    s_add_u32 m0, s47, s32
    ds_read_b64_tr_b16 a[74:75], v44 offset:2048
    s_add_u32 s54, s54, 0x1
    v_mfma_f32_16x16x32_bf16 v[100:103], a[180:183], v[240:243], v[100:103]
    s_min_u32 s55, s52, 5
    ds_read_b64_tr_b16 a[76:77], v45 offset:0
    s_mul_i32 s55, s55, 5
    v_mfma_f32_16x16x32_bf16 v[104:107], a[136:139], v[192:195], v[104:107]
    s_add_u32 s55, s55, 4
    ds_read_b64_tr_b16 a[78:79], v45 offset:2048
    s_bitcmp1_b32 s54, s55
    s_cselect_b32 s50, 0x200000, 0
    s_addc_u32 s52, s52, 0
    v_mfma_f32_16x16x32_bf16 v[108:111], a[140:143], v[192:195], v[108:111]
    ds_read_b64_tr_b16 a[80:81], v42 offset:4096
    v_mfma_f32_16x16x32_bf16 v[104:107], a[152:155], v[208:211], v[104:107]
    ds_read_b64_tr_b16 a[82:83], v42 offset:6144
    v_mfma_f32_16x16x32_bf16 v[108:111], a[156:159], v[208:211], v[108:111]
    ds_read_b64_tr_b16 a[84:85], v43 offset:4096
    buffer_load_dwordx4 v3, s[48:51], s53 offen offset:0 sc1 lds
    v_mfma_f32_16x16x32_bf16 v[104:107], a[168:171], v[224:227], v[104:107]
    ds_read_b64_tr_b16 a[86:87], v43 offset:6144
    v_mul_f32 v96, v51, v96
    v_mfma_f32_16x16x32_bf16 v[108:111], a[172:175], v[224:227], v[108:111]
    ds_read_b64_tr_b16 a[88:89], v44 offset:4096
    buffer_load_dwordx4 v3, s[48:51], s53 offen offset:1024 sc1 lds
    v_mfma_f32_16x16x32_bf16 v[104:107], a[184:187], v[240:243], v[104:107]
    ds_read_b64_tr_b16 a[90:91], v44 offset:6144
    v_mul_f32 v97, v51, v97
    v_mfma_f32_16x16x32_bf16 v[108:111], a[188:191], v[240:243], v[108:111]
    ds_read_b64_tr_b16 a[92:93], v45 offset:4096
    buffer_load_dwordx4 v3, s[48:51], s53 offen offset:2048 sc1 lds
    v_mfma_f32_16x16x32_bf16 v[112:115], a[128:131], v[200:203], v[112:115]
    ds_read_b64_tr_b16 a[94:95], v45 offset:6144
    buffer_load_dwordx4 v3, s[48:51], s53 offen offset:3072 sc1 lds
    v_mul_f32 v98, v51, v98
    v_mfma_f32_16x16x32_bf16 v[116:119], a[132:135], v[200:203], v[116:119]
    ds_read_b64_tr_b16 a[96:97], v42 offset:8192
    v_mul_f32 v99, v51, v99
    v_mfma_f32_16x16x32_bf16 v[112:115], a[144:147], v[216:219], v[112:115]
    ds_read_b64_tr_b16 a[98:99], v42 offset:10240
    v_mul_f32 v100, v51, v100
    v_mfma_f32_16x16x32_bf16 v[116:119], a[148:151], v[216:219], v[116:119]
    ds_read_b64_tr_b16 a[100:101], v43 offset:8192
    v_mul_f32 v101, v51, v101
    v_mfma_f32_16x16x32_bf16 v[112:115], a[160:163], v[232:235], v[112:115]
    ds_read_b64_tr_b16 a[102:103], v43 offset:10240
    v_mul_f32 v102, v51, v102
    v_mfma_f32_16x16x32_bf16 v[116:119], a[164:167], v[232:235], v[116:119]
    ds_read_b64_tr_b16 a[104:105], v44 offset:8192
    v_mul_f32 v103, v51, v103
    v_mfma_f32_16x16x32_bf16 v[112:115], a[176:179], v[248:251], v[112:115]
    ds_read_b64_tr_b16 a[106:107], v44 offset:10240
    v_cvt_pk_bf16_f32 v96, v96, v97
    v_mfma_f32_16x16x32_bf16 v[116:119], a[180:183], v[248:251], v[116:119]
    ds_read_b64_tr_b16 a[108:109], v45 offset:8192
    v_cvt_pk_bf16_f32 v97, v98, v99
    v_mfma_f32_16x16x32_bf16 v[120:123], a[136:139], v[200:203], v[120:123]
    ds_read_b64_tr_b16 a[110:111], v45 offset:10240
    v_cvt_pk_bf16_f32 v98, v100, v101
    v_cvt_pk_bf16_f32 v99, v102, v103
    v_mfma_f32_16x16x32_bf16 v[124:127], a[140:143], v[200:203], v[124:127]
    ds_read_b64_tr_b16 a[112:113], v42 offset:12288
    buffer_store_dwordx4 v[96:99], v53, s[28:31], s46 offen sc1
    v_mfma_f32_16x16x32_bf16 v[120:123], a[152:155], v[216:219], v[120:123]
    ds_read_b64_tr_b16 a[114:115], v42 offset:14336
    v_mul_f32 v104, v51, v104
    v_mfma_f32_16x16x32_bf16 v[124:127], a[156:159], v[216:219], v[124:127]
    ds_read_b64_tr_b16 a[116:117], v43 offset:12288
    v_mul_f32 v105, v51, v105
    v_mfma_f32_16x16x32_bf16 v[120:123], a[168:171], v[232:235], v[120:123]
    ds_read_b64_tr_b16 a[118:119], v43 offset:14336
    v_mul_f32 v106, v51, v106
    v_mfma_f32_16x16x32_bf16 v[124:127], a[172:175], v[232:235], v[124:127]
    ds_read_b64_tr_b16 a[120:121], v44 offset:12288
    v_mul_f32 v107, v51, v107
    v_mfma_f32_16x16x32_bf16 v[120:123], a[184:187], v[248:251], v[120:123]
    ds_read_b64_tr_b16 a[122:123], v44 offset:14336
    v_mul_f32 v108, v51, v108
    v_mfma_f32_16x16x32_bf16 v[124:127], a[188:191], v[248:251], v[124:127]
    ds_read_b64_tr_b16 a[124:125], v45 offset:12288
    ds_read_b64_tr_b16 a[126:127], v45 offset:14336
    v_mul_f32 v109, v51, v109
    v_mul_f32 v110, v51, v110
    s_waitcnt lgkmcnt(6)
    v_mfma_f32_16x16x32_bf16 v[64:67], a[64:67], v[128:131], 0
    ds_read_b64_tr_b16 a[128:129], v42 offset:16384
    v_mul_f32 v111, v51, v111
    v_mfma_f32_16x16x32_bf16 v[80:83], a[64:67], v[136:139], 0
    ds_read_b64_tr_b16 a[130:131], v42 offset:18432
    v_cvt_pk_bf16_f32 v104, v104, v105
    v_mfma_f32_16x16x32_bf16 v[84:87], a[68:71], v[136:139], 0
    ds_read_b64_tr_b16 a[132:133], v43 offset:16384
    v_cvt_pk_bf16_f32 v105, v106, v107
    v_mfma_f32_16x16x32_bf16 v[68:71], a[68:71], v[128:131], 0
    s_waitcnt lgkmcnt(3)
    ds_read_b64_tr_b16 a[134:135], v43 offset:18432
    v_cvt_pk_bf16_f32 v106, v108, v109
    v_mfma_f32_16x16x32_bf16 v[72:75], a[72:75], v[128:131], 0
    ds_read_b64_tr_b16 a[144:145], v42 offset:20480
    v_cvt_pk_bf16_f32 v107, v110, v111
    v_mfma_f32_16x16x32_bf16 v[88:91], a[72:75], v[136:139], 0
    buffer_store_dwordx4 v[104:107], v53, s[28:31], s87 offen sc1
    v_mfma_f32_16x16x32_bf16 v[92:95], a[76:79], v[136:139], 0
    ds_read_b64_tr_b16 a[146:147], v42 offset:22528
    v_mul_f32 v112, v52, v112
    v_mfma_f32_16x16x32_bf16 v[76:79], a[76:79], v[128:131], 0
    ds_read_b64_tr_b16 a[148:149], v43 offset:20480
    v_mul_f32 v113, v52, v113
    v_mfma_f32_16x16x32_bf16 v[64:67], a[80:83], v[144:147], v[64:67]
    ds_read_b64_tr_b16 a[150:151], v43 offset:22528
    v_mul_f32 v114, v52, v114
    v_mfma_f32_16x16x32_bf16 v[80:83], a[80:83], v[152:155], v[80:83]
    ds_read_b64_tr_b16 a[160:161], v42 offset:24576
    v_mul_f32 v115, v52, v115
    v_mfma_f32_16x16x32_bf16 v[84:87], a[84:87], v[152:155], v[84:87]
    ds_read_b64_tr_b16 a[162:163], v42 offset:26624
    v_mul_f32 v116, v52, v116
    v_mfma_f32_16x16x32_bf16 v[68:71], a[84:87], v[144:147], v[68:71]
    ds_read_b64_tr_b16 a[164:165], v43 offset:24576
    v_mul_f32 v117, v52, v117
    v_mfma_f32_16x16x32_bf16 v[72:75], a[88:91], v[144:147], v[72:75]
    ds_read_b64_tr_b16 a[166:167], v43 offset:26624
    v_mul_f32 v118, v52, v118
    v_mfma_f32_16x16x32_bf16 v[88:91], a[88:91], v[152:155], v[88:91]
    ds_read_b64_tr_b16 a[176:177], v42 offset:28672
    v_mul_f32 v119, v52, v119
    v_mfma_f32_16x16x32_bf16 v[92:95], a[92:95], v[152:155], v[92:95]
    ds_read_b64_tr_b16 a[178:179], v42 offset:30720
    v_cvt_pk_bf16_f32 v112, v112, v113
    v_mfma_f32_16x16x32_bf16 v[76:79], a[92:95], v[144:147], v[76:79]
    ds_read_b64_tr_b16 a[180:181], v43 offset:28672
    v_cvt_pk_bf16_f32 v113, v114, v115
    v_mfma_f32_16x16x32_bf16 v[64:67], a[96:99], v[160:163], v[64:67]
    ds_read_b64_tr_b16 a[182:183], v43 offset:30720
    v_cvt_pk_bf16_f32 v114, v116, v117
    v_mfma_f32_16x16x32_bf16 v[80:83], a[96:99], v[168:171], v[80:83]
    ds_read_b64_tr_b16 a[136:137], v44 offset:16384
    v_cvt_pk_bf16_f32 v115, v118, v119
    v_mfma_f32_16x16x32_bf16 v[84:87], a[100:103], v[168:171], v[84:87]
    ds_read_b64_tr_b16 a[138:139], v44 offset:18432
    v_mfma_f32_16x16x32_bf16 v[68:71], a[100:103], v[160:163], v[68:71]
    ds_read_b64_tr_b16 a[140:141], v45 offset:16384
    buffer_store_dwordx4 v[112:115], v19, s[28:31], s46 offen sc1
    v_mfma_f32_16x16x32_bf16 v[72:75], a[104:107], v[160:163], v[72:75]
    ds_read_b64_tr_b16 a[142:143], v45 offset:18432
    v_mul_f32 v120, v52, v120
    v_mfma_f32_16x16x32_bf16 v[88:91], a[104:107], v[168:171], v[88:91]
    ds_read_b64_tr_b16 a[152:153], v44 offset:20480
    v_mul_f32 v121, v52, v121
    v_mfma_f32_16x16x32_bf16 v[92:95], a[108:111], v[168:171], v[92:95]
    ds_read_b64_tr_b16 a[154:155], v44 offset:22528
    v_mul_f32 v122, v52, v122
    v_mfma_f32_16x16x32_bf16 v[76:79], a[108:111], v[160:163], v[76:79]
    ds_read_b64_tr_b16 a[156:157], v45 offset:20480
    v_mul_f32 v123, v52, v123
    v_mfma_f32_16x16x32_bf16 v[64:67], a[112:115], v[176:179], v[64:67]
    ds_read_b64_tr_b16 a[158:159], v45 offset:22528
    v_mul_f32 v124, v52, v124
    v_mfma_f32_16x16x32_bf16 v[80:83], a[112:115], v[184:187], v[80:83]
    ds_read_b64_tr_b16 a[168:169], v44 offset:24576
    v_mul_f32 v125, v52, v125
    v_mfma_f32_16x16x32_bf16 v[84:87], a[116:119], v[184:187], v[84:87]
    ds_read_b64_tr_b16 a[170:171], v44 offset:26624
    v_mul_f32 v126, v52, v126
    v_mfma_f32_16x16x32_bf16 v[68:71], a[116:119], v[176:179], v[68:71]
    ds_read_b64_tr_b16 a[172:173], v45 offset:24576
    v_mul_f32 v127, v52, v127
    v_mfma_f32_16x16x32_bf16 v[72:75], a[120:123], v[176:179], v[72:75]
    ds_read_b64_tr_b16 a[174:175], v45 offset:26624
    v_cvt_pk_bf16_f32 v120, v120, v121
    v_mfma_f32_16x16x32_bf16 v[88:91], a[120:123], v[184:187], v[88:91]
    ds_read_b64_tr_b16 a[184:185], v44 offset:28672
    v_cvt_pk_bf16_f32 v121, v122, v123
    v_mfma_f32_16x16x32_bf16 v[92:95], a[124:127], v[184:187], v[92:95]
    ds_read_b64_tr_b16 a[186:187], v44 offset:30720
    v_cvt_pk_bf16_f32 v122, v124, v125
    v_mfma_f32_16x16x32_bf16 v[76:79], a[124:127], v[176:179], v[76:79]
    ds_read_b64_tr_b16 a[188:189], v45 offset:28672
    ds_read_b64_tr_b16 a[190:191], v45 offset:30720
    v_cvt_pk_bf16_f32 v123, v126, v127
    buffer_store_dwordx4 v[120:123], v19, s[28:31], s87 offen sc1
    s_add_u32 s46, s46, 0x8000
    s_add_u32 s87, s87, 0x8000
    s_waitcnt vmcnt(8) lgkmcnt(6)
    v_mfma_f32_16x16x32_bf16 v[64:67], a[128:131], v[192:195], v[64:67]
    ds_read_b64_tr_b16 a[64:65], v20 offset:0
    v_readfirstlane_b32 s54, v5
    v_mfma_f32_16x16x32_bf16 v[68:71], a[132:135], v[192:195], v[68:71]
    ds_read_b64_tr_b16 a[66:67], v20 offset:2048
    v_mov_b32 v5, 0x400
    v_mfma_f32_16x16x32_bf16 v[64:67], a[144:147], v[208:211], v[64:67]
    buffer_atomic_add v5, v2, s[64:67], 0 offen sc0
    v_mfma_f32_16x16x32_bf16 v[68:71], a[148:151], v[208:211], v[68:71]
    s_waitcnt lgkmcnt(2)
    ds_read_b64_tr_b16 a[68:69], v21 offset:0
    s_lshl_b32 s53, s52, 15
    v_mfma_f32_16x16x32_bf16 v[64:67], a[160:163], v[224:227], v[64:67]
    s_cmp_lt_u32 s52, 2
    s_cselect_b32 s47, 8, -2
    ds_read_b64_tr_b16 a[70:71], v21 offset:2048
    v_mfma_f32_16x16x32_bf16 v[68:71], a[164:167], v[224:227], v[68:71]
    s_add_u32 s47, s47, s52
    ds_read_b64_tr_b16 a[72:73], v22 offset:0
    s_lshl_b32 s47, s47, 14
    v_mfma_f32_16x16x32_bf16 v[64:67], a[176:179], v[240:243], v[64:67]
    s_add_u32 m0, s47, s32
    ds_read_b64_tr_b16 a[74:75], v22 offset:2048
    s_add_u32 s54, s54, 0x20
    v_mfma_f32_16x16x32_bf16 v[68:71], a[180:183], v[240:243], v[68:71]
    s_min_u32 s55, s52, 5
    ds_read_b64_tr_b16 a[76:77], v23 offset:0
    s_mul_i32 s55, s55, 5
    v_mfma_f32_16x16x32_bf16 v[72:75], a[136:139], v[192:195], v[72:75]
    s_add_u32 s55, s55, 4
    ds_read_b64_tr_b16 a[78:79], v23 offset:2048
    s_bitcmp1_b32 s54, s55
    s_cselect_b32 s50, 0x200000, 0
    s_addc_u32 s52, s52, 0
    v_mfma_f32_16x16x32_bf16 v[76:79], a[140:143], v[192:195], v[76:79]
    ds_read_b64_tr_b16 a[80:81], v20 offset:4096
    v_mfma_f32_16x16x32_bf16 v[72:75], a[152:155], v[208:211], v[72:75]
    ds_read_b64_tr_b16 a[82:83], v20 offset:6144
    v_mfma_f32_16x16x32_bf16 v[76:79], a[156:159], v[208:211], v[76:79]
    ds_read_b64_tr_b16 a[84:85], v21 offset:4096
    buffer_load_dwordx4 v3, s[48:51], s53 offen offset:0 sc1 lds
    v_mfma_f32_16x16x32_bf16 v[72:75], a[168:171], v[224:227], v[72:75]
    ds_read_b64_tr_b16 a[86:87], v21 offset:6144
    v_mul_f32 v64, v51, v64
    v_mfma_f32_16x16x32_bf16 v[76:79], a[172:175], v[224:227], v[76:79]
    ds_read_b64_tr_b16 a[88:89], v22 offset:4096
    buffer_load_dwordx4 v3, s[48:51], s53 offen offset:1024 sc1 lds
    v_mfma_f32_16x16x32_bf16 v[72:75], a[184:187], v[240:243], v[72:75]
    ds_read_b64_tr_b16 a[90:91], v22 offset:6144
    v_mul_f32 v65, v51, v65
    v_mfma_f32_16x16x32_bf16 v[76:79], a[188:191], v[240:243], v[76:79]
    ds_read_b64_tr_b16 a[92:93], v23 offset:4096
    buffer_load_dwordx4 v3, s[48:51], s53 offen offset:2048 sc1 lds
    v_mfma_f32_16x16x32_bf16 v[80:83], a[128:131], v[200:203], v[80:83]
    ds_read_b64_tr_b16 a[94:95], v23 offset:6144
    buffer_load_dwordx4 v3, s[48:51], s53 offen offset:3072 sc1 lds
    v_mul_f32 v66, v51, v66
    v_mfma_f32_16x16x32_bf16 v[84:87], a[132:135], v[200:203], v[84:87]
    ds_read_b64_tr_b16 a[96:97], v20 offset:8192
    v_mul_f32 v67, v51, v67
    v_mfma_f32_16x16x32_bf16 v[80:83], a[144:147], v[216:219], v[80:83]
    ds_read_b64_tr_b16 a[98:99], v20 offset:10240
    v_mul_f32 v68, v51, v68
    v_mfma_f32_16x16x32_bf16 v[84:87], a[148:151], v[216:219], v[84:87]
    ds_read_b64_tr_b16 a[100:101], v21 offset:8192
    v_mul_f32 v69, v51, v69
    v_mfma_f32_16x16x32_bf16 v[80:83], a[160:163], v[232:235], v[80:83]
    ds_read_b64_tr_b16 a[102:103], v21 offset:10240
    v_mul_f32 v70, v51, v70
    v_mfma_f32_16x16x32_bf16 v[84:87], a[164:167], v[232:235], v[84:87]
    ds_read_b64_tr_b16 a[104:105], v22 offset:8192
    v_mul_f32 v71, v51, v71
    v_mfma_f32_16x16x32_bf16 v[80:83], a[176:179], v[248:251], v[80:83]
    ds_read_b64_tr_b16 a[106:107], v22 offset:10240
    v_cvt_pk_bf16_f32 v64, v64, v65
    v_mfma_f32_16x16x32_bf16 v[84:87], a[180:183], v[248:251], v[84:87]
    ds_read_b64_tr_b16 a[108:109], v23 offset:8192
    v_cvt_pk_bf16_f32 v65, v66, v67
    v_mfma_f32_16x16x32_bf16 v[88:91], a[136:139], v[200:203], v[88:91]
    ds_read_b64_tr_b16 a[110:111], v23 offset:10240
    v_cvt_pk_bf16_f32 v66, v68, v69
    v_cvt_pk_bf16_f32 v67, v70, v71
    v_mfma_f32_16x16x32_bf16 v[92:95], a[140:143], v[200:203], v[92:95]
    ds_read_b64_tr_b16 a[112:113], v20 offset:12288
    buffer_store_dwordx4 v[64:67], v53, s[28:31], s46 offen sc1
    v_mfma_f32_16x16x32_bf16 v[88:91], a[152:155], v[216:219], v[88:91]
    ds_read_b64_tr_b16 a[114:115], v20 offset:14336
    v_mul_f32 v72, v51, v72
    v_mfma_f32_16x16x32_bf16 v[92:95], a[156:159], v[216:219], v[92:95]
    ds_read_b64_tr_b16 a[116:117], v21 offset:12288
    v_mul_f32 v73, v51, v73
    v_mfma_f32_16x16x32_bf16 v[88:91], a[168:171], v[232:235], v[88:91]
    ds_read_b64_tr_b16 a[118:119], v21 offset:14336
    v_mul_f32 v74, v51, v74
    v_mfma_f32_16x16x32_bf16 v[92:95], a[172:175], v[232:235], v[92:95]
    ds_read_b64_tr_b16 a[120:121], v22 offset:12288
    v_mul_f32 v75, v51, v75
    v_mfma_f32_16x16x32_bf16 v[88:91], a[184:187], v[248:251], v[88:91]
    ds_read_b64_tr_b16 a[122:123], v22 offset:14336
    v_mul_f32 v76, v51, v76
    v_mfma_f32_16x16x32_bf16 v[92:95], a[188:191], v[248:251], v[92:95]
    ds_read_b64_tr_b16 a[124:125], v23 offset:12288
    ds_read_b64_tr_b16 a[126:127], v23 offset:14336
    v_mul_f32 v77, v51, v77
    v_mul_f32 v78, v51, v78
    s_waitcnt lgkmcnt(6)
    s_barrier
    v_mfma_f32_16x16x32_bf16 v[96:99], a[64:67], v[128:131], 0
    ds_read_b64_tr_b16 a[128:129], v20 offset:16384
    v_mul_f32 v79, v51, v79
    v_mfma_f32_16x16x32_bf16 v[112:115], a[64:67], v[136:139], 0
    ds_read_b64_tr_b16 a[130:131], v20 offset:18432
    v_cvt_pk_bf16_f32 v72, v72, v73
    v_mfma_f32_16x16x32_bf16 v[116:119], a[68:71], v[136:139], 0
    ds_read_b64_tr_b16 a[132:133], v21 offset:16384
    v_cvt_pk_bf16_f32 v73, v74, v75
    v_mfma_f32_16x16x32_bf16 v[100:103], a[68:71], v[128:131], 0
    s_waitcnt lgkmcnt(3)
    ds_read_b64_tr_b16 a[134:135], v21 offset:18432
    v_cvt_pk_bf16_f32 v74, v76, v77
    v_mfma_f32_16x16x32_bf16 v[104:107], a[72:75], v[128:131], 0
    ds_read_b64_tr_b16 a[144:145], v20 offset:20480
    v_cvt_pk_bf16_f32 v75, v78, v79
    v_mfma_f32_16x16x32_bf16 v[120:123], a[72:75], v[136:139], 0
    buffer_store_dwordx4 v[72:75], v53, s[28:31], s87 offen sc1
    v_mfma_f32_16x16x32_bf16 v[124:127], a[76:79], v[136:139], 0
    ds_read_b64_tr_b16 a[146:147], v20 offset:22528
    v_mul_f32 v80, v52, v80
    v_mfma_f32_16x16x32_bf16 v[108:111], a[76:79], v[128:131], 0
    ds_read_b64_tr_b16 a[148:149], v21 offset:20480
    v_mul_f32 v81, v52, v81
    v_mfma_f32_16x16x32_bf16 v[96:99], a[80:83], v[144:147], v[96:99]
    ds_read_b64_tr_b16 a[150:151], v21 offset:22528
    v_mul_f32 v82, v52, v82
    v_mfma_f32_16x16x32_bf16 v[112:115], a[80:83], v[152:155], v[112:115]
    ds_read_b64_tr_b16 a[160:161], v20 offset:24576
    v_mul_f32 v83, v52, v83
    v_mfma_f32_16x16x32_bf16 v[116:119], a[84:87], v[152:155], v[116:119]
    ds_read_b64_tr_b16 a[162:163], v20 offset:26624
    v_mul_f32 v84, v52, v84
    v_mfma_f32_16x16x32_bf16 v[100:103], a[84:87], v[144:147], v[100:103]
    ds_read_b64_tr_b16 a[164:165], v21 offset:24576
    v_mul_f32 v85, v52, v85
    v_mfma_f32_16x16x32_bf16 v[104:107], a[88:91], v[144:147], v[104:107]
    ds_read_b64_tr_b16 a[166:167], v21 offset:26624
    v_mul_f32 v86, v52, v86
    v_mfma_f32_16x16x32_bf16 v[120:123], a[88:91], v[152:155], v[120:123]
    ds_read_b64_tr_b16 a[176:177], v20 offset:28672
    v_mul_f32 v87, v52, v87
    v_mfma_f32_16x16x32_bf16 v[124:127], a[92:95], v[152:155], v[124:127]
    ds_read_b64_tr_b16 a[178:179], v20 offset:30720
    v_cvt_pk_bf16_f32 v80, v80, v81
    v_mfma_f32_16x16x32_bf16 v[108:111], a[92:95], v[144:147], v[108:111]
    ds_read_b64_tr_b16 a[180:181], v21 offset:28672
    v_cvt_pk_bf16_f32 v81, v82, v83
    v_mfma_f32_16x16x32_bf16 v[96:99], a[96:99], v[160:163], v[96:99]
    ds_read_b64_tr_b16 a[182:183], v21 offset:30720
    v_cvt_pk_bf16_f32 v82, v84, v85
    v_mfma_f32_16x16x32_bf16 v[112:115], a[96:99], v[168:171], v[112:115]
    ds_read_b64_tr_b16 a[136:137], v22 offset:16384
    v_cvt_pk_bf16_f32 v83, v86, v87
    v_mfma_f32_16x16x32_bf16 v[116:119], a[100:103], v[168:171], v[116:119]
    ds_read_b64_tr_b16 a[138:139], v22 offset:18432
    v_mfma_f32_16x16x32_bf16 v[100:103], a[100:103], v[160:163], v[100:103]
    ds_read_b64_tr_b16 a[140:141], v23 offset:16384
    buffer_store_dwordx4 v[80:83], v19, s[28:31], s46 offen sc1
    v_mfma_f32_16x16x32_bf16 v[104:107], a[104:107], v[160:163], v[104:107]
    ds_read_b64_tr_b16 a[142:143], v23 offset:18432
    v_mul_f32 v88, v52, v88
    v_mfma_f32_16x16x32_bf16 v[120:123], a[104:107], v[168:171], v[120:123]
    ds_read_b64_tr_b16 a[152:153], v22 offset:20480
    v_mul_f32 v89, v52, v89
    v_mfma_f32_16x16x32_bf16 v[124:127], a[108:111], v[168:171], v[124:127]
    ds_read_b64_tr_b16 a[154:155], v22 offset:22528
    v_mul_f32 v90, v52, v90
    v_mfma_f32_16x16x32_bf16 v[108:111], a[108:111], v[160:163], v[108:111]
    ds_read_b64_tr_b16 a[156:157], v23 offset:20480
    v_mul_f32 v91, v52, v91
    v_mfma_f32_16x16x32_bf16 v[96:99], a[112:115], v[176:179], v[96:99]
    ds_read_b64_tr_b16 a[158:159], v23 offset:22528
    v_mul_f32 v92, v52, v92
    v_mfma_f32_16x16x32_bf16 v[112:115], a[112:115], v[184:187], v[112:115]
    ds_read_b64_tr_b16 a[168:169], v22 offset:24576
    v_mul_f32 v93, v52, v93
    v_mfma_f32_16x16x32_bf16 v[116:119], a[116:119], v[184:187], v[116:119]
    ds_read_b64_tr_b16 a[170:171], v22 offset:26624
    v_mul_f32 v94, v52, v94
    v_mfma_f32_16x16x32_bf16 v[100:103], a[116:119], v[176:179], v[100:103]
    ds_read_b64_tr_b16 a[172:173], v23 offset:24576
    v_mul_f32 v95, v52, v95
    v_mfma_f32_16x16x32_bf16 v[104:107], a[120:123], v[176:179], v[104:107]
    ds_read_b64_tr_b16 a[174:175], v23 offset:26624
    v_cvt_pk_bf16_f32 v88, v88, v89
    v_mfma_f32_16x16x32_bf16 v[120:123], a[120:123], v[184:187], v[120:123]
    ds_read_b64_tr_b16 a[184:185], v22 offset:28672
    v_cvt_pk_bf16_f32 v89, v90, v91
    v_mfma_f32_16x16x32_bf16 v[124:127], a[124:127], v[184:187], v[124:127]
    ds_read_b64_tr_b16 a[186:187], v22 offset:30720
    v_cvt_pk_bf16_f32 v90, v92, v93
    v_mfma_f32_16x16x32_bf16 v[108:111], a[124:127], v[176:179], v[108:111]
    ds_read_b64_tr_b16 a[188:189], v23 offset:28672
    ds_read_b64_tr_b16 a[190:191], v23 offset:30720
    v_cvt_pk_bf16_f32 v91, v94, v95
    buffer_store_dwordx4 v[88:91], v19, s[28:31], s87 offen sc1
    s_add_u32 s46, s46, 0x8000
    s_add_u32 s87, s87, 0x8000
    s_waitcnt vmcnt(8) lgkmcnt(6)
    v_mfma_f32_16x16x32_bf16 v[96:99], a[128:131], v[192:195], v[96:99]
    ds_read_b64_tr_b16 a[64:65], v20 offset:32768
    v_readfirstlane_b32 s54, v5
    v_mfma_f32_16x16x32_bf16 v[100:103], a[132:135], v[192:195], v[100:103]
    ds_read_b64_tr_b16 a[66:67], v20 offset:34816
    v_mov_b32 v5, 0x8000
    v_mfma_f32_16x16x32_bf16 v[96:99], a[144:147], v[208:211], v[96:99]
    buffer_atomic_add v5, v2, s[64:67], 0 offen sc0
    v_mfma_f32_16x16x32_bf16 v[100:103], a[148:151], v[208:211], v[100:103]
    s_waitcnt lgkmcnt(2)
    ds_read_b64_tr_b16 a[68:69], v21 offset:32768
    s_lshl_b32 s53, s52, 15
    v_mfma_f32_16x16x32_bf16 v[96:99], a[160:163], v[224:227], v[96:99]
    s_cmp_lt_u32 s52, 2
    s_cselect_b32 s47, 8, -2
    ds_read_b64_tr_b16 a[70:71], v21 offset:34816
    v_mfma_f32_16x16x32_bf16 v[100:103], a[164:167], v[224:227], v[100:103]
    s_add_u32 s47, s47, s52
    ds_read_b64_tr_b16 a[72:73], v22 offset:32768
    s_lshl_b32 s47, s47, 14
    v_mfma_f32_16x16x32_bf16 v[96:99], a[176:179], v[240:243], v[96:99]
    s_add_u32 m0, s47, s32
    ds_read_b64_tr_b16 a[74:75], v22 offset:34816
    s_add_u32 s54, s54, 0x400
    v_mfma_f32_16x16x32_bf16 v[100:103], a[180:183], v[240:243], v[100:103]
    s_min_u32 s55, s52, 5
    ds_read_b64_tr_b16 a[76:77], v23 offset:32768
    s_mul_i32 s55, s55, 5
    v_mfma_f32_16x16x32_bf16 v[104:107], a[136:139], v[192:195], v[104:107]
    s_add_u32 s55, s55, 4
    ds_read_b64_tr_b16 a[78:79], v23 offset:34816
    s_bitcmp1_b32 s54, s55
    s_cselect_b32 s50, 0x200000, 0
    s_addc_u32 s52, s52, 0
    v_mfma_f32_16x16x32_bf16 v[108:111], a[140:143], v[192:195], v[108:111]
    ds_read_b64_tr_b16 a[80:81], v20 offset:36864
    v_mfma_f32_16x16x32_bf16 v[104:107], a[152:155], v[208:211], v[104:107]
    ds_read_b64_tr_b16 a[82:83], v20 offset:38912
    v_mfma_f32_16x16x32_bf16 v[108:111], a[156:159], v[208:211], v[108:111]
    ds_read_b64_tr_b16 a[84:85], v21 offset:36864
    buffer_load_dwordx4 v3, s[48:51], s53 offen offset:0 sc1 lds
    v_mfma_f32_16x16x32_bf16 v[104:107], a[168:171], v[224:227], v[104:107]
    ds_read_b64_tr_b16 a[86:87], v21 offset:38912
    v_mul_f32 v96, v51, v96
    v_mfma_f32_16x16x32_bf16 v[108:111], a[172:175], v[224:227], v[108:111]
    ds_read_b64_tr_b16 a[88:89], v22 offset:36864
    buffer_load_dwordx4 v3, s[48:51], s53 offen offset:1024 sc1 lds
    v_mfma_f32_16x16x32_bf16 v[104:107], a[184:187], v[240:243], v[104:107]
    ds_read_b64_tr_b16 a[90:91], v22 offset:38912
    v_mul_f32 v97, v51, v97
    v_mfma_f32_16x16x32_bf16 v[108:111], a[188:191], v[240:243], v[108:111]
    ds_read_b64_tr_b16 a[92:93], v23 offset:36864
    buffer_load_dwordx4 v3, s[48:51], s53 offen offset:2048 sc1 lds
    v_mfma_f32_16x16x32_bf16 v[112:115], a[128:131], v[200:203], v[112:115]
    ds_read_b64_tr_b16 a[94:95], v23 offset:38912
    buffer_load_dwordx4 v3, s[48:51], s53 offen offset:3072 sc1 lds
    v_mul_f32 v98, v51, v98
    v_mfma_f32_16x16x32_bf16 v[116:119], a[132:135], v[200:203], v[116:119]
    ds_read_b64_tr_b16 a[96:97], v20 offset:40960
    v_mul_f32 v99, v51, v99
    v_mfma_f32_16x16x32_bf16 v[112:115], a[144:147], v[216:219], v[112:115]
    ds_read_b64_tr_b16 a[98:99], v20 offset:43008
    v_mul_f32 v100, v51, v100
    v_mfma_f32_16x16x32_bf16 v[116:119], a[148:151], v[216:219], v[116:119]
    ds_read_b64_tr_b16 a[100:101], v21 offset:40960
    v_mul_f32 v101, v51, v101
    v_mfma_f32_16x16x32_bf16 v[112:115], a[160:163], v[232:235], v[112:115]
    ds_read_b64_tr_b16 a[102:103], v21 offset:43008
    v_mul_f32 v102, v51, v102
    v_mfma_f32_16x16x32_bf16 v[116:119], a[164:167], v[232:235], v[116:119]
    ds_read_b64_tr_b16 a[104:105], v22 offset:40960
    v_mul_f32 v103, v51, v103
    v_mfma_f32_16x16x32_bf16 v[112:115], a[176:179], v[248:251], v[112:115]
    ds_read_b64_tr_b16 a[106:107], v22 offset:43008
    v_cvt_pk_bf16_f32 v96, v96, v97
    v_mfma_f32_16x16x32_bf16 v[116:119], a[180:183], v[248:251], v[116:119]
    ds_read_b64_tr_b16 a[108:109], v23 offset:40960
    v_cvt_pk_bf16_f32 v97, v98, v99
    v_mfma_f32_16x16x32_bf16 v[120:123], a[136:139], v[200:203], v[120:123]
    ds_read_b64_tr_b16 a[110:111], v23 offset:43008
    v_cvt_pk_bf16_f32 v98, v100, v101
    v_cvt_pk_bf16_f32 v99, v102, v103
    v_mfma_f32_16x16x32_bf16 v[124:127], a[140:143], v[200:203], v[124:127]
    ds_read_b64_tr_b16 a[112:113], v20 offset:45056
    buffer_store_dwordx4 v[96:99], v53, s[28:31], s46 offen sc1
    v_mfma_f32_16x16x32_bf16 v[120:123], a[152:155], v[216:219], v[120:123]
    ds_read_b64_tr_b16 a[114:115], v20 offset:47104
    v_mul_f32 v104, v51, v104
    v_mfma_f32_16x16x32_bf16 v[124:127], a[156:159], v[216:219], v[124:127]
    ds_read_b64_tr_b16 a[116:117], v21 offset:45056
    v_mul_f32 v105, v51, v105
    v_mfma_f32_16x16x32_bf16 v[120:123], a[168:171], v[232:235], v[120:123]
    ds_read_b64_tr_b16 a[118:119], v21 offset:47104
    v_mul_f32 v106, v51, v106
    v_mfma_f32_16x16x32_bf16 v[124:127], a[172:175], v[232:235], v[124:127]
    ds_read_b64_tr_b16 a[120:121], v22 offset:45056
    v_mul_f32 v107, v51, v107
    v_mfma_f32_16x16x32_bf16 v[120:123], a[184:187], v[248:251], v[120:123]
    ds_read_b64_tr_b16 a[122:123], v22 offset:47104
    v_mul_f32 v108, v51, v108
    v_mfma_f32_16x16x32_bf16 v[124:127], a[188:191], v[248:251], v[124:127]
    ds_read_b64_tr_b16 a[124:125], v23 offset:45056
    ds_read_b64_tr_b16 a[126:127], v23 offset:47104
    v_mul_f32 v109, v51, v109
    v_mul_f32 v110, v51, v110
    s_waitcnt lgkmcnt(6)
    v_mfma_f32_16x16x32_bf16 v[64:67], a[64:67], v[128:131], 0
    ds_read_b64_tr_b16 a[128:129], v20 offset:49152
    v_mul_f32 v111, v51, v111
    v_mfma_f32_16x16x32_bf16 v[80:83], a[64:67], v[136:139], 0
    ds_read_b64_tr_b16 a[130:131], v20 offset:51200
    v_cvt_pk_bf16_f32 v104, v104, v105
    v_mfma_f32_16x16x32_bf16 v[84:87], a[68:71], v[136:139], 0
    ds_read_b64_tr_b16 a[132:133], v21 offset:49152
    v_cvt_pk_bf16_f32 v105, v106, v107
    v_mfma_f32_16x16x32_bf16 v[68:71], a[68:71], v[128:131], 0
    s_waitcnt lgkmcnt(3)
    ds_read_b64_tr_b16 a[134:135], v21 offset:51200
    v_cvt_pk_bf16_f32 v106, v108, v109
    v_mfma_f32_16x16x32_bf16 v[72:75], a[72:75], v[128:131], 0
    ds_read_b64_tr_b16 a[144:145], v20 offset:53248
    v_cvt_pk_bf16_f32 v107, v110, v111
    v_mfma_f32_16x16x32_bf16 v[88:91], a[72:75], v[136:139], 0
    buffer_store_dwordx4 v[104:107], v53, s[28:31], s87 offen sc1
    v_mfma_f32_16x16x32_bf16 v[92:95], a[76:79], v[136:139], 0
    ds_read_b64_tr_b16 a[146:147], v20 offset:55296
    v_mul_f32 v112, v52, v112
    v_mfma_f32_16x16x32_bf16 v[76:79], a[76:79], v[128:131], 0
    ds_read_b64_tr_b16 a[148:149], v21 offset:53248
    v_mul_f32 v113, v52, v113
    v_mfma_f32_16x16x32_bf16 v[64:67], a[80:83], v[144:147], v[64:67]
    ds_read_b64_tr_b16 a[150:151], v21 offset:55296
    v_mul_f32 v114, v52, v114
    v_mfma_f32_16x16x32_bf16 v[80:83], a[80:83], v[152:155], v[80:83]
    ds_read_b64_tr_b16 a[160:161], v20 offset:57344
    v_mul_f32 v115, v52, v115
    v_mfma_f32_16x16x32_bf16 v[84:87], a[84:87], v[152:155], v[84:87]
    ds_read_b64_tr_b16 a[162:163], v20 offset:59392
    v_mul_f32 v116, v52, v116
    v_mfma_f32_16x16x32_bf16 v[68:71], a[84:87], v[144:147], v[68:71]
    ds_read_b64_tr_b16 a[164:165], v21 offset:57344
    v_mul_f32 v117, v52, v117
    v_mfma_f32_16x16x32_bf16 v[72:75], a[88:91], v[144:147], v[72:75]
    ds_read_b64_tr_b16 a[166:167], v21 offset:59392
    v_mul_f32 v118, v52, v118
    v_mfma_f32_16x16x32_bf16 v[88:91], a[88:91], v[152:155], v[88:91]
    ds_read_b64_tr_b16 a[176:177], v20 offset:61440
    v_mul_f32 v119, v52, v119
    v_mfma_f32_16x16x32_bf16 v[92:95], a[92:95], v[152:155], v[92:95]
    ds_read_b64_tr_b16 a[178:179], v20 offset:63488
    v_cvt_pk_bf16_f32 v112, v112, v113
    v_mfma_f32_16x16x32_bf16 v[76:79], a[92:95], v[144:147], v[76:79]
    ds_read_b64_tr_b16 a[180:181], v21 offset:61440
    v_cvt_pk_bf16_f32 v113, v114, v115
    v_mfma_f32_16x16x32_bf16 v[64:67], a[96:99], v[160:163], v[64:67]
    ds_read_b64_tr_b16 a[182:183], v21 offset:63488
    v_cvt_pk_bf16_f32 v114, v116, v117
    v_mfma_f32_16x16x32_bf16 v[80:83], a[96:99], v[168:171], v[80:83]
    ds_read_b64_tr_b16 a[136:137], v22 offset:49152
    v_cvt_pk_bf16_f32 v115, v118, v119
    v_mfma_f32_16x16x32_bf16 v[84:87], a[100:103], v[168:171], v[84:87]
    ds_read_b64_tr_b16 a[138:139], v22 offset:51200
    v_mfma_f32_16x16x32_bf16 v[68:71], a[100:103], v[160:163], v[68:71]
    ds_read_b64_tr_b16 a[140:141], v23 offset:49152
    buffer_store_dwordx4 v[112:115], v19, s[28:31], s46 offen sc1
    v_mfma_f32_16x16x32_bf16 v[72:75], a[104:107], v[160:163], v[72:75]
    ds_read_b64_tr_b16 a[142:143], v23 offset:51200
    v_mul_f32 v120, v52, v120
    v_mfma_f32_16x16x32_bf16 v[88:91], a[104:107], v[168:171], v[88:91]
    ds_read_b64_tr_b16 a[152:153], v22 offset:53248
    v_mul_f32 v121, v52, v121
    v_mfma_f32_16x16x32_bf16 v[92:95], a[108:111], v[168:171], v[92:95]
    ds_read_b64_tr_b16 a[154:155], v22 offset:55296
    v_mul_f32 v122, v52, v122
    v_mfma_f32_16x16x32_bf16 v[76:79], a[108:111], v[160:163], v[76:79]
    ds_read_b64_tr_b16 a[156:157], v23 offset:53248
    v_mul_f32 v123, v52, v123
    v_mfma_f32_16x16x32_bf16 v[64:67], a[112:115], v[176:179], v[64:67]
    ds_read_b64_tr_b16 a[158:159], v23 offset:55296
    v_mul_f32 v124, v52, v124
    v_mfma_f32_16x16x32_bf16 v[80:83], a[112:115], v[184:187], v[80:83]
    ds_read_b64_tr_b16 a[168:169], v22 offset:57344
    v_mul_f32 v125, v52, v125
    v_mfma_f32_16x16x32_bf16 v[84:87], a[116:119], v[184:187], v[84:87]
    ds_read_b64_tr_b16 a[170:171], v22 offset:59392
    v_mul_f32 v126, v52, v126
    v_mfma_f32_16x16x32_bf16 v[68:71], a[116:119], v[176:179], v[68:71]
    ds_read_b64_tr_b16 a[172:173], v23 offset:57344
    v_mul_f32 v127, v52, v127
    v_mfma_f32_16x16x32_bf16 v[72:75], a[120:123], v[176:179], v[72:75]
    ds_read_b64_tr_b16 a[174:175], v23 offset:59392
    v_cvt_pk_bf16_f32 v120, v120, v121
    v_mfma_f32_16x16x32_bf16 v[88:91], a[120:123], v[184:187], v[88:91]
    ds_read_b64_tr_b16 a[184:185], v22 offset:61440
    v_cvt_pk_bf16_f32 v121, v122, v123
    v_mfma_f32_16x16x32_bf16 v[92:95], a[124:127], v[184:187], v[92:95]
    ds_read_b64_tr_b16 a[186:187], v22 offset:63488
    v_cvt_pk_bf16_f32 v122, v124, v125
    v_mfma_f32_16x16x32_bf16 v[76:79], a[124:127], v[176:179], v[76:79]
    ds_read_b64_tr_b16 a[188:189], v23 offset:61440
    ds_read_b64_tr_b16 a[190:191], v23 offset:63488
    v_cvt_pk_bf16_f32 v123, v126, v127
    buffer_store_dwordx4 v[120:123], v19, s[28:31], s87 offen sc1
    s_add_u32 s46, s46, 0x8000
    s_add_u32 s87, s87, 0x8000
    s_waitcnt vmcnt(8) lgkmcnt(6)
    v_mfma_f32_16x16x32_bf16 v[64:67], a[128:131], v[192:195], v[64:67]
    v_readfirstlane_b32 s54, v5
    v_mov_b32 v5, 0x100000
    v_mfma_f32_16x16x32_bf16 v[68:71], a[132:135], v[192:195], v[68:71]
    buffer_atomic_add v5, v2, s[64:67], 0 offen sc0
    v_mfma_f32_16x16x32_bf16 v[64:67], a[144:147], v[208:211], v[64:67]
    s_lshl_b32 s53, s52, 15
    s_cmp_lt_u32 s52, 2
    s_cselect_b32 s47, 8, -2
    v_mfma_f32_16x16x32_bf16 v[68:71], a[148:151], v[208:211], v[68:71]
    s_waitcnt lgkmcnt(0)
    v_mfma_f32_16x16x32_bf16 v[64:67], a[160:163], v[224:227], v[64:67]
    s_add_u32 s47, s47, s52
    s_lshl_b32 s47, s47, 14
    s_add_u32 m0, s47, s32
    v_mfma_f32_16x16x32_bf16 v[68:71], a[164:167], v[224:227], v[68:71]
    s_add_u32 s54, s54, 0x8000
    s_min_u32 s55, s52, 5
    s_mul_i32 s55, s55, 5
    v_mfma_f32_16x16x32_bf16 v[64:67], a[176:179], v[240:243], v[64:67]
    s_add_u32 s55, s55, 4
    s_bitcmp1_b32 s54, s55
    s_cselect_b32 s50, 0x200000, 0
    s_addc_u32 s52, s52, 0
    v_mfma_f32_16x16x32_bf16 v[68:71], a[180:183], v[240:243], v[68:71]
    v_mfma_f32_16x16x32_bf16 v[72:75], a[136:139], v[192:195], v[72:75]
    buffer_load_dwordx4 v3, s[48:51], s53 offen offset:0 sc1 lds
    v_mfma_f32_16x16x32_bf16 v[76:79], a[140:143], v[192:195], v[76:79]
    v_mfma_f32_16x16x32_bf16 v[72:75], a[152:155], v[208:211], v[72:75]
    buffer_load_dwordx4 v3, s[48:51], s53 offen offset:1024 sc1 lds
    v_mfma_f32_16x16x32_bf16 v[76:79], a[156:159], v[208:211], v[76:79]
    s_nop 3
    v_mfma_f32_16x16x32_bf16 v[72:75], a[168:171], v[224:227], v[72:75]
    v_mul_f32 v64, v51, v64
    v_mul_f32 v65, v51, v65
    v_mfma_f32_16x16x32_bf16 v[76:79], a[172:175], v[224:227], v[76:79]
    buffer_load_dwordx4 v3, s[48:51], s53 offen offset:2048 sc1 lds
    v_mfma_f32_16x16x32_bf16 v[72:75], a[184:187], v[240:243], v[72:75]
    v_mul_f32 v66, v51, v66
    v_mul_f32 v67, v51, v67
    v_mfma_f32_16x16x32_bf16 v[76:79], a[188:191], v[240:243], v[76:79]
    v_mul_f32 v68, v51, v68
    v_mul_f32 v69, v51, v69
    v_mfma_f32_16x16x32_bf16 v[80:83], a[128:131], v[200:203], v[80:83]
    buffer_load_dwordx4 v3, s[48:51], s53 offen offset:3072 sc1 lds
    v_mfma_f32_16x16x32_bf16 v[84:87], a[132:135], v[200:203], v[84:87]
    v_mul_f32 v70, v51, v70
    v_mul_f32 v71, v51, v71
    v_mfma_f32_16x16x32_bf16 v[80:83], a[144:147], v[216:219], v[80:83]
    v_cvt_pk_bf16_f32 v64, v64, v65
    v_cvt_pk_bf16_f32 v65, v66, v67
    v_cvt_pk_bf16_f32 v66, v68, v69
    v_cvt_pk_bf16_f32 v67, v70, v71
    buffer_store_dwordx4 v[64:67], v53, s[28:31], s46 offen sc1
    v_mfma_f32_16x16x32_bf16 v[84:87], a[148:151], v[216:219], v[84:87]
    s_nop 3
    v_mfma_f32_16x16x32_bf16 v[80:83], a[160:163], v[232:235], v[80:83]
    v_mul_f32 v72, v51, v72
    v_mul_f32 v73, v51, v73
    v_mfma_f32_16x16x32_bf16 v[84:87], a[164:167], v[232:235], v[84:87]
    v_mul_f32 v74, v51, v74
    v_mul_f32 v75, v51, v75
    v_mfma_f32_16x16x32_bf16 v[80:83], a[176:179], v[248:251], v[80:83]
    v_mul_f32 v76, v51, v76
    v_mul_f32 v77, v51, v77
    v_mfma_f32_16x16x32_bf16 v[84:87], a[180:183], v[248:251], v[84:87]
    v_mul_f32 v78, v51, v78
    v_mul_f32 v79, v51, v79
    v_mfma_f32_16x16x32_bf16 v[88:91], a[136:139], v[200:203], v[88:91]
    v_cvt_pk_bf16_f32 v72, v72, v73
    v_cvt_pk_bf16_f32 v73, v74, v75
    v_mfma_f32_16x16x32_bf16 v[92:95], a[140:143], v[200:203], v[92:95]
    v_cvt_pk_bf16_f32 v74, v76, v77
    v_cvt_pk_bf16_f32 v75, v78, v79
    v_mfma_f32_16x16x32_bf16 v[88:91], a[152:155], v[216:219], v[88:91]
    buffer_store_dwordx4 v[72:75], v53, s[28:31], s87 offen sc1
    v_mfma_f32_16x16x32_bf16 v[92:95], a[156:159], v[216:219], v[92:95]
    s_nop 3
    v_mfma_f32_16x16x32_bf16 v[88:91], a[168:171], v[232:235], v[88:91]
    v_mul_f32 v80, v52, v80
    v_mul_f32 v81, v52, v81
    v_mfma_f32_16x16x32_bf16 v[92:95], a[172:175], v[232:235], v[92:95]
    v_mul_f32 v82, v52, v82
    v_mul_f32 v83, v52, v83
    v_mfma_f32_16x16x32_bf16 v[88:91], a[184:187], v[248:251], v[88:91]
    v_mul_f32 v84, v52, v84
    v_mul_f32 v85, v52, v85
    v_mfma_f32_16x16x32_bf16 v[92:95], a[188:191], v[248:251], v[92:95]
    v_mul_f32 v86, v52, v86
    v_mul_f32 v87, v52, v87
    v_cvt_pk_bf16_f32 v80, v80, v81
    v_cvt_pk_bf16_f32 v81, v82, v83
    v_cvt_pk_bf16_f32 v82, v84, v85
    v_cvt_pk_bf16_f32 v83, v86, v87
    buffer_store_dwordx4 v[80:83], v19, s[28:31], s46 offen sc1
    s_nop 7
    v_mul_f32 v88, v52, v88
    v_mul_f32 v89, v52, v89
    v_mul_f32 v90, v52, v90
    v_mul_f32 v91, v52, v91
    v_mul_f32 v92, v52, v92
    v_mul_f32 v93, v52, v93
    v_mul_f32 v94, v52, v94
    v_mul_f32 v95, v52, v95
    v_cvt_pk_bf16_f32 v88, v88, v89
    v_cvt_pk_bf16_f32 v89, v90, v91
    v_cvt_pk_bf16_f32 v90, v92, v93
    v_cvt_pk_bf16_f32 v91, v94, v95
    buffer_store_dwordx4 v[88:91], v19, s[28:31], s87 offen sc1
    s_add_u32 s46, s46, 0x8000
    s_add_u32 s87, s87, 0x8000
    v_mov_b32 v49, s76
    v_mov_b32 v50, s77
    v_cndmask_b32 v49, v49, v50, s[88:89]
    v_add_u32 v104, v49, v4
    v_mov_b32 v49, s78
    v_mov_b32 v50, s79
    v_cndmask_b32 v49, v49, v50, s[88:89]
    v_add_u32 v105, v49, v4
    v_mov_b32 v49, s80
    v_mov_b32 v50, s81
    v_cndmask_b32 v49, v49, v50, s[88:89]
    v_add_u32 v106, v49, v4
    v_mov_b32 v49, s82
    v_mov_b32 v50, 0x40000000
    v_cndmask_b32 v49, v49, v50, s[88:89]
    v_add_u32 v107, v49, v4
    v_and_b32 v49, 48, v0
    v_and_b32 v50, 3, v0
    v_lshl_add_u32 v49, v50, 2, v49
    v_bfe_u32 v50, v0, 2, 2
    v_add_lshl_u32 v108, v49, v50, 4
    v_add_u32 v108, s32, v108
    v_add_u32 v109, 0x10000, v108
    v_add_u32 v110, 0x20000, v108
    s_waitcnt vmcnt(0)
    v_mov_b32 v7, 0x2000000
    buffer_atomic_add v7, v2, s[64:67], 0 offen
    v_add_u32 v5, 0x100000, v5
    s_barrier
L_rdB:
    v_readfirstlane_b32 s54, v5
L_chkB:
    s_min_u32 s55, s52, 5
    s_mul_i32 s55, s55, 5
    s_add_u32 s55, s55, 4
    s_bitcmp1_b32 s54, s55
    s_cbranch_scc1 L_goB
    s_sub_u32 s86, s86, 1
    s_cbranch_scc1 L_end
    v_mov_b32 v5, 0
    buffer_atomic_add v5, v2, s[64:67], 0 offen sc0
    s_waitcnt vmcnt(0)
    s_branch L_rdB
L_goB:
    s_lshl_b32 s53, s52, 15
    s_cmp_lt_u32 s52, 2
    s_cselect_b32 s47, 8, -2
    s_add_u32 s47, s47, s52
    s_lshl_b32 s47, s47, 14
    s_add_u32 m0, s47, s32
    s_add_u32 s52, s52, 1
    buffer_load_dwordx4 v3, s[28:31], s53 offen offset:0 sc1 lds
    buffer_load_dwordx4 v3, s[28:31], s53 offen offset:1024 sc1 lds
    buffer_load_dwordx4 v3, s[28:31], s53 offen offset:2048 sc1 lds
    buffer_load_dwordx4 v3, s[28:31], s53 offen offset:3072 sc1 lds
    s_cmp_lt_u32 s52, 7
    s_cbranch_scc1 L_chkB
    s_waitcnt vmcnt(24)
    ds_read_b128 v[128:131], v110 offset:0
    ds_read_b128 v[132:135], v110 offset:1024
    ds_read_b128 v[136:139], v110 offset:2048
    ds_read_b128 v[140:143], v110 offset:3072
    s_waitcnt vmcnt(20)
    ds_read_b128 v[144:147], v110 offset:16384
    ds_read_b128 v[148:151], v110 offset:17408
    ds_read_b128 v[152:155], v110 offset:18432
    ds_read_b128 v[156:159], v110 offset:19456
    s_waitcnt lgkmcnt(7)
    v_mfma_f32_16x16x32_bf16 v[240:243], v[56:59], v[128:131], 0
    s_waitcnt lgkmcnt(6)
    v_mfma_f32_16x16x32_bf16 v[240:243], v[56:59], v[132:135], v[240:243]
    s_waitcnt lgkmcnt(5)
    v_mfma_f32_16x16x32_bf16 v[240:243], v[56:59], v[136:139], v[240:243]
    s_waitcnt lgkmcnt(4)
    v_mfma_f32_16x16x32_bf16 v[240:243], v[56:59], v[140:143], v[240:243]
    s_waitcnt vmcnt(16)
    ds_read_b128 v[160:163], v108 offset:0
    ds_read_b128 v[164:167], v108 offset:1024
    ds_read_b128 v[168:171], v108 offset:2048
    ds_read_b128 v[172:175], v108 offset:3072
    s_waitcnt lgkmcnt(7)
    v_mfma_f32_16x16x32_bf16 v[240:243], v[60:63], v[144:147], v[240:243]
    s_waitcnt lgkmcnt(6)
    v_mfma_f32_16x16x32_bf16 v[240:243], v[60:63], v[148:151], v[240:243]
    s_waitcnt lgkmcnt(5)
    v_mfma_f32_16x16x32_bf16 v[240:243], v[60:63], v[152:155], v[240:243]
    s_waitcnt lgkmcnt(4)
    v_mfma_f32_16x16x32_bf16 v[240:243], v[60:63], v[156:159], v[240:243]
    s_waitcnt vmcnt(12)
    ds_read_b128 v[176:179], v108 offset:16384
    ds_read_b128 v[180:183], v108 offset:17408
    ds_read_b128 v[184:187], v108 offset:18432
    ds_read_b128 v[188:191], v108 offset:19456
    s_waitcnt lgkmcnt(7)
    v_mfma_f32_16x16x32_bf16 v[244:247], v[56:59], v[160:163], 0
    s_waitcnt lgkmcnt(6)
    v_mfma_f32_16x16x32_bf16 v[244:247], v[56:59], v[164:167], v[244:247]
    s_waitcnt lgkmcnt(5)
    v_mfma_f32_16x16x32_bf16 v[244:247], v[56:59], v[168:171], v[244:247]
    s_waitcnt lgkmcnt(4)
    v_mfma_f32_16x16x32_bf16 v[244:247], v[56:59], v[172:175], v[244:247]
    s_waitcnt vmcnt(8)
    ds_read_b128 v[192:195], v108 offset:32768
    ds_read_b128 v[196:199], v108 offset:33792
    ds_read_b128 v[200:203], v108 offset:34816
    ds_read_b128 v[204:207], v108 offset:35840
    s_waitcnt lgkmcnt(7)
    v_mfma_f32_16x16x32_bf16 v[244:247], v[60:63], v[176:179], v[244:247]
    s_waitcnt lgkmcnt(6)
    v_mfma_f32_16x16x32_bf16 v[244:247], v[60:63], v[180:183], v[244:247]
    s_waitcnt lgkmcnt(5)
    v_mfma_f32_16x16x32_bf16 v[244:247], v[60:63], v[184:187], v[244:247]
    s_waitcnt lgkmcnt(4)
    v_mfma_f32_16x16x32_bf16 v[244:247], v[60:63], v[188:191], v[244:247]
    s_waitcnt vmcnt(4)
    ds_read_b128 v[208:211], v108 offset:49152
    ds_read_b128 v[212:215], v108 offset:50176
    ds_read_b128 v[216:219], v108 offset:51200
    ds_read_b128 v[220:223], v108 offset:52224
    s_waitcnt lgkmcnt(7)
    v_mfma_f32_16x16x32_bf16 v[248:251], v[56:59], v[192:195], 0
    s_waitcnt lgkmcnt(6)
    v_mfma_f32_16x16x32_bf16 v[248:251], v[56:59], v[196:199], v[248:251]
    s_waitcnt lgkmcnt(5)
    v_mfma_f32_16x16x32_bf16 v[248:251], v[56:59], v[200:203], v[248:251]
    s_waitcnt lgkmcnt(4)
    v_mfma_f32_16x16x32_bf16 v[248:251], v[56:59], v[204:207], v[248:251]
    s_waitcnt lgkmcnt(3)
    v_mfma_f32_16x16x32_bf16 v[248:251], v[60:63], v[208:211], v[248:251]
    s_waitcnt lgkmcnt(2)
    v_mfma_f32_16x16x32_bf16 v[248:251], v[60:63], v[212:215], v[248:251]
    s_waitcnt lgkmcnt(1)
    v_mfma_f32_16x16x32_bf16 v[248:251], v[60:63], v[216:219], v[248:251]
    s_waitcnt lgkmcnt(0)
    v_mfma_f32_16x16x32_bf16 v[248:251], v[60:63], v[220:223], v[248:251]
    v_cvt_pk_bf16_f32 v240, v240, v241
    v_cvt_pk_bf16_f32 v241, v242, v243
    v_cvt_pk_bf16_f32 v244, v244, v245
    v_cvt_pk_bf16_f32 v245, v246, v247
    s_nop 3
    v_cvt_pk_bf16_f32 v248, v248, v249
    v_cvt_pk_bf16_f32 v249, v250, v251
    s_waitcnt vmcnt(0)
    ds_read_b128 v[224:227], v109 offset:0
    ds_read_b128 v[228:231], v109 offset:1024
    ds_read_b128 v[232:235], v109 offset:2048
    ds_read_b128 v[236:239], v109 offset:3072
    buffer_store_dwordx2 v[240:241], v104, s[72:75], 0 offen
    buffer_store_dwordx2 v[244:245], v105, s[72:75], 0 offen
    buffer_store_dwordx2 v[248:249], v106, s[72:75], 0 offen
    s_waitcnt lgkmcnt(3)
    v_mfma_f32_16x16x32_bf16 v[252:255], v[56:59], v[224:227], 0
    s_waitcnt lgkmcnt(2)
    v_mfma_f32_16x16x32_bf16 v[252:255], v[56:59], v[228:231], v[252:255]
    s_waitcnt lgkmcnt(1)
    v_mfma_f32_16x16x32_bf16 v[252:255], v[56:59], v[232:235], v[252:255]
    s_waitcnt lgkmcnt(0)
    v_mfma_f32_16x16x32_bf16 v[252:255], v[56:59], v[236:239], v[252:255]
    s_nop 7
    v_cvt_pk_bf16_f32 v252, v252, v253
    v_cvt_pk_bf16_f32 v253, v254, v255
    buffer_store_dwordx2 v[252:253], v107, s[72:75], 0 offen
    s_endpgm
L_end:
    s_endpgm
L_rs0:
    s_call_b64 s[42:43], L_rescale1
    s_branch L_rb0
L_rs1:
    s_call_b64 s[42:43], L_rescale0
    s_branch L_rb1
L_rs2:
    s_call_b64 s[42:43], L_rescale1
    s_branch L_rb2
L_rs3:
    s_call_b64 s[42:43], L_rescale0
    s_branch L_rb3
L_rs4:
    s_call_b64 s[42:43], L_rescale1
    s_branch L_rb4
L_hsA:
    s_sub_u32 s86, s86, 1
    s_cbranch_scc1 L_end
    buffer_load_dword v6, off, s[68:71], 0 sc1
    s_waitcnt vmcnt(0)
    v_and_b32 v49, 0xff, v6
    v_cmp_gt_u32 vcc, 16, v49
    s_cbranch_vccnz L_hsA
    s_branch L_hsbA
L_rs5:
    s_call_b64 s[42:43], L_rescale0
    s_branch L_rb5
L_rs6:
    s_call_b64 s[42:43], L_rescale1
    s_branch L_rb6
L_rs7:
    s_call_b64 s[42:43], L_rescale1
    s_branch L_rb7
L_rs8:
    s_call_b64 s[42:43], L_rescale0
    s_branch L_rb8
L_rs9:
    s_call_b64 s[42:43], L_rescale1
    s_branch L_rb9
L_rs10:
    s_call_b64 s[42:43], L_rescale0
    s_branch L_rb10
L_rs11:
    s_call_b64 s[42:43], L_rescale1
    s_branch L_rb11
L_hsB:
    s_sub_u32 s86, s86, 1
    s_cbranch_scc1 L_end
    buffer_load_dword v6, off, s[68:71], 0 sc1
    s_waitcnt vmcnt(0)
    v_and_b32 v49, 0xff, v6
    v_cmp_gt_u32 vcc, 16, v49
    s_cbranch_vccnz L_hsB
    s_branch L_hsbB
L_rs12:
    s_call_b64 s[42:43], L_rescale0
    s_branch L_rb12
L_rs13:
    s_call_b64 s[42:43], L_rescale1
    s_branch L_rb13
L_rescale0:
    s_nop 7
    v_max3_f32 v48, v64, v65, v66
    v_max3_f32 v48, v48, v67, v68
    v_max3_f32 v48, v48, v69, v70
    v_max_f32 v48, v48, v71
    v_mov_b32 v49, v48
    s_nop 1
    v_permlane32_swap_b32 v49, v48
    v_max_f32 v48, v49, v48
    v_mov_b32 v49, v48
    s_nop 1
    v_permlane16_swap_b32 v49, v48
    v_max_f32 v48, v49, v48
    v_max_f32 v48, 0, v48
    v_sub_f32 v49, 0, v48
    v_exp_f32 v49, v49
    v_sub_f32 v104, v104, v48
    v_sub_f32 v105, v105, v48
    v_sub_f32 v106, v106, v48
    v_sub_f32 v107, v107, v48
    v_sub_f32 v64, v64, v48
    v_sub_f32 v65, v65, v48
    v_sub_f32 v66, v66, v48
    v_sub_f32 v67, v67, v48
    v_sub_f32 v68, v68, v48
    v_sub_f32 v69, v69, v48
    v_sub_f32 v70, v70, v48
    v_sub_f32 v71, v71, v48
    v_mul_f32 v46, v46, v49
    v_mul_f32 v128, v128, v49
    v_mul_f32 v129, v129, v49
    v_mul_f32 v130, v130, v49
    v_mul_f32 v131, v131, v49
    v_mul_f32 v132, v132, v49
    v_mul_f32 v133, v133, v49
    v_mul_f32 v134, v134, v49
    v_mul_f32 v135, v135, v49
    v_mul_f32 v144, v144, v49
    v_mul_f32 v145, v145, v49
    v_mul_f32 v146, v146, v49
    v_mul_f32 v147, v147, v49
    v_mul_f32 v148, v148, v49
    v_mul_f32 v149, v149, v49
    v_mul_f32 v150, v150, v49
    v_mul_f32 v151, v151, v49
    v_mul_f32 v160, v160, v49
    v_mul_f32 v161, v161, v49
    v_mul_f32 v162, v162, v49
    v_mul_f32 v163, v163, v49
    v_mul_f32 v164, v164, v49
    v_mul_f32 v165, v165, v49
    v_mul_f32 v166, v166, v49
    v_mul_f32 v167, v167, v49
    v_mul_f32 v176, v176, v49
    v_mul_f32 v177, v177, v49
    v_mul_f32 v178, v178, v49
    v_mul_f32 v179, v179, v49
    v_mul_f32 v180, v180, v49
    v_mul_f32 v181, v181, v49
    v_mul_f32 v182, v182, v49
    v_mul_f32 v183, v183, v49
    v_mul_f32 v192, v192, v49
    v_mul_f32 v193, v193, v49
    v_mul_f32 v194, v194, v49
    v_mul_f32 v195, v195, v49
    v_mul_f32 v196, v196, v49
    v_mul_f32 v197, v197, v49
    v_mul_f32 v198, v198, v49
    v_mul_f32 v199, v199, v49
    v_mul_f32 v208, v208, v49
    v_mul_f32 v209, v209, v49
    v_mul_f32 v210, v210, v49
    v_mul_f32 v211, v211, v49
    v_mul_f32 v212, v212, v49
    v_mul_f32 v213, v213, v49
    v_mul_f32 v214, v214, v49
    v_mul_f32 v215, v215, v49
    v_mul_f32 v224, v224, v49
    v_mul_f32 v225, v225, v49
    v_mul_f32 v226, v226, v49
    v_mul_f32 v227, v227, v49
    v_mul_f32 v228, v228, v49
    v_mul_f32 v229, v229, v49
    v_mul_f32 v230, v230, v49
    v_mul_f32 v231, v231, v49
    v_mul_f32 v240, v240, v49
    v_mul_f32 v241, v241, v49
    v_mul_f32 v242, v242, v49
    v_mul_f32 v243, v243, v49
    v_mul_f32 v244, v244, v49
    v_mul_f32 v245, v245, v49
    v_mul_f32 v246, v246, v49
    v_mul_f32 v247, v247, v49
    v_max3_f32 v48, v72, v73, v74
    v_max3_f32 v48, v48, v75, v76
    v_max3_f32 v48, v48, v77, v78
    v_max_f32 v48, v48, v79
    v_mov_b32 v49, v48
    s_nop 1
    v_permlane32_swap_b32 v49, v48
    v_max_f32 v48, v49, v48
    v_mov_b32 v49, v48
    s_nop 1
    v_permlane16_swap_b32 v49, v48
    v_max_f32 v48, v49, v48
    v_max_f32 v48, 0, v48
    v_sub_f32 v49, 0, v48
    v_exp_f32 v49, v49
    v_sub_f32 v108, v108, v48
    v_sub_f32 v109, v109, v48
    v_sub_f32 v110, v110, v48
    v_sub_f32 v111, v111, v48
    v_sub_f32 v72, v72, v48
    v_sub_f32 v73, v73, v48
    v_sub_f32 v74, v74, v48
    v_sub_f32 v75, v75, v48
    v_sub_f32 v76, v76, v48
    v_sub_f32 v77, v77, v48
    v_sub_f32 v78, v78, v48
    v_sub_f32 v79, v79, v48
    v_mul_f32 v47, v47, v49
    v_mul_f32 v136, v136, v49
    v_mul_f32 v137, v137, v49
    v_mul_f32 v138, v138, v49
    v_mul_f32 v139, v139, v49
    v_mul_f32 v140, v140, v49
    v_mul_f32 v141, v141, v49
    v_mul_f32 v142, v142, v49
    v_mul_f32 v143, v143, v49
    v_mul_f32 v152, v152, v49
    v_mul_f32 v153, v153, v49
    v_mul_f32 v154, v154, v49
    v_mul_f32 v155, v155, v49
    v_mul_f32 v156, v156, v49
    v_mul_f32 v157, v157, v49
    v_mul_f32 v158, v158, v49
    v_mul_f32 v159, v159, v49
    v_mul_f32 v168, v168, v49
    v_mul_f32 v169, v169, v49
    v_mul_f32 v170, v170, v49
    v_mul_f32 v171, v171, v49
    v_mul_f32 v172, v172, v49
    v_mul_f32 v173, v173, v49
    v_mul_f32 v174, v174, v49
    v_mul_f32 v175, v175, v49
    v_mul_f32 v184, v184, v49
    v_mul_f32 v185, v185, v49
    v_mul_f32 v186, v186, v49
    v_mul_f32 v187, v187, v49
    v_mul_f32 v188, v188, v49
    v_mul_f32 v189, v189, v49
    v_mul_f32 v190, v190, v49
    v_mul_f32 v191, v191, v49
    v_mul_f32 v200, v200, v49
    v_mul_f32 v201, v201, v49
    v_mul_f32 v202, v202, v49
    v_mul_f32 v203, v203, v49
    v_mul_f32 v204, v204, v49
    v_mul_f32 v205, v205, v49
    v_mul_f32 v206, v206, v49
    v_mul_f32 v207, v207, v49
    v_mul_f32 v216, v216, v49
    v_mul_f32 v217, v217, v49
    v_mul_f32 v218, v218, v49
    v_mul_f32 v219, v219, v49
    v_mul_f32 v220, v220, v49
    v_mul_f32 v221, v221, v49
    v_mul_f32 v222, v222, v49
    v_mul_f32 v223, v223, v49
    v_mul_f32 v232, v232, v49
    v_mul_f32 v233, v233, v49
    v_mul_f32 v234, v234, v49
    v_mul_f32 v235, v235, v49
    v_mul_f32 v236, v236, v49
    v_mul_f32 v237, v237, v49
    v_mul_f32 v238, v238, v49
    v_mul_f32 v239, v239, v49
    v_mul_f32 v248, v248, v49
    v_mul_f32 v249, v249, v49
    v_mul_f32 v250, v250, v49
    v_mul_f32 v251, v251, v49
    v_mul_f32 v252, v252, v49
    v_mul_f32 v253, v253, v49
    v_mul_f32 v254, v254, v49
    v_mul_f32 v255, v255, v49
    s_nop 1
    s_setpc_b64 s[42:43]
L_rescale1:
    s_nop 7
    v_max3_f32 v48, v80, v81, v82
    v_max3_f32 v48, v48, v83, v84
    v_max3_f32 v48, v48, v85, v86
    v_max_f32 v48, v48, v87
    v_mov_b32 v49, v48
    s_nop 1
    v_permlane32_swap_b32 v49, v48
    v_max_f32 v48, v49, v48
    v_mov_b32 v49, v48
    s_nop 1
    v_permlane16_swap_b32 v49, v48
    v_max_f32 v48, v49, v48
    v_max_f32 v48, 0, v48
    v_sub_f32 v49, 0, v48
    v_exp_f32 v49, v49
    v_sub_f32 v104, v104, v48
    v_sub_f32 v105, v105, v48
    v_sub_f32 v106, v106, v48
    v_sub_f32 v107, v107, v48
    v_sub_f32 v80, v80, v48
    v_sub_f32 v81, v81, v48
    v_sub_f32 v82, v82, v48
    v_sub_f32 v83, v83, v48
    v_sub_f32 v84, v84, v48
    v_sub_f32 v85, v85, v48
    v_sub_f32 v86, v86, v48
    v_sub_f32 v87, v87, v48
    v_mul_f32 v46, v46, v49
    v_mul_f32 v128, v128, v49
    v_mul_f32 v129, v129, v49
    v_mul_f32 v130, v130, v49
    v_mul_f32 v131, v131, v49
    v_mul_f32 v132, v132, v49
    v_mul_f32 v133, v133, v49
    v_mul_f32 v134, v134, v49
    v_mul_f32 v135, v135, v49
    v_mul_f32 v144, v144, v49
    v_mul_f32 v145, v145, v49
    v_mul_f32 v146, v146, v49
    v_mul_f32 v147, v147, v49
    v_mul_f32 v148, v148, v49
    v_mul_f32 v149, v149, v49
    v_mul_f32 v150, v150, v49
    v_mul_f32 v151, v151, v49
    v_mul_f32 v160, v160, v49
    v_mul_f32 v161, v161, v49
    v_mul_f32 v162, v162, v49
    v_mul_f32 v163, v163, v49
    v_mul_f32 v164, v164, v49
    v_mul_f32 v165, v165, v49
    v_mul_f32 v166, v166, v49
    v_mul_f32 v167, v167, v49
    v_mul_f32 v176, v176, v49
    v_mul_f32 v177, v177, v49
    v_mul_f32 v178, v178, v49
    v_mul_f32 v179, v179, v49
    v_mul_f32 v180, v180, v49
    v_mul_f32 v181, v181, v49
    v_mul_f32 v182, v182, v49
    v_mul_f32 v183, v183, v49
    v_mul_f32 v192, v192, v49
    v_mul_f32 v193, v193, v49
    v_mul_f32 v194, v194, v49
    v_mul_f32 v195, v195, v49
    v_mul_f32 v196, v196, v49
    v_mul_f32 v197, v197, v49
    v_mul_f32 v198, v198, v49
    v_mul_f32 v199, v199, v49
    v_mul_f32 v208, v208, v49
    v_mul_f32 v209, v209, v49
    v_mul_f32 v210, v210, v49
    v_mul_f32 v211, v211, v49
    v_mul_f32 v212, v212, v49
    v_mul_f32 v213, v213, v49
    v_mul_f32 v214, v214, v49
    v_mul_f32 v215, v215, v49
    v_mul_f32 v224, v224, v49
    v_mul_f32 v225, v225, v49
    v_mul_f32 v226, v226, v49
    v_mul_f32 v227, v227, v49
    v_mul_f32 v228, v228, v49
    v_mul_f32 v229, v229, v49
    v_mul_f32 v230, v230, v49
    v_mul_f32 v231, v231, v49
    v_mul_f32 v240, v240, v49
    v_mul_f32 v241, v241, v49
    v_mul_f32 v242, v242, v49
    v_mul_f32 v243, v243, v49
    v_mul_f32 v244, v244, v49
    v_mul_f32 v245, v245, v49
    v_mul_f32 v246, v246, v49
    v_mul_f32 v247, v247, v49
    v_max3_f32 v48, v88, v89, v90
    v_max3_f32 v48, v48, v91, v92
    v_max3_f32 v48, v48, v93, v94
    v_max_f32 v48, v48, v95
    v_mov_b32 v49, v48
    s_nop 1
    v_permlane32_swap_b32 v49, v48
    v_max_f32 v48, v49, v48
    v_mov_b32 v49, v48
    s_nop 1
    v_permlane16_swap_b32 v49, v48
    v_max_f32 v48, v49, v48
    v_max_f32 v48, 0, v48
    v_sub_f32 v49, 0, v48
    v_exp_f32 v49, v49
    v_sub_f32 v108, v108, v48
    v_sub_f32 v109, v109, v48
    v_sub_f32 v110, v110, v48
    v_sub_f32 v111, v111, v48
    v_sub_f32 v88, v88, v48
    v_sub_f32 v89, v89, v48
    v_sub_f32 v90, v90, v48
    v_sub_f32 v91, v91, v48
    v_sub_f32 v92, v92, v48
    v_sub_f32 v93, v93, v48
    v_sub_f32 v94, v94, v48
    v_sub_f32 v95, v95, v48
    v_mul_f32 v47, v47, v49
    v_mul_f32 v136, v136, v49
    v_mul_f32 v137, v137, v49
    v_mul_f32 v138, v138, v49
    v_mul_f32 v139, v139, v49
    v_mul_f32 v140, v140, v49
    v_mul_f32 v141, v141, v49
    v_mul_f32 v142, v142, v49
    v_mul_f32 v143, v143, v49
    v_mul_f32 v152, v152, v49
    v_mul_f32 v153, v153, v49
    v_mul_f32 v154, v154, v49
    v_mul_f32 v155, v155, v49
    v_mul_f32 v156, v156, v49
    v_mul_f32 v157, v157, v49
    v_mul_f32 v158, v158, v49
    v_mul_f32 v159, v159, v49
    v_mul_f32 v168, v168, v49
    v_mul_f32 v169, v169, v49
    v_mul_f32 v170, v170, v49
    v_mul_f32 v171, v171, v49
    v_mul_f32 v172, v172, v49
    v_mul_f32 v173, v173, v49
    v_mul_f32 v174, v174, v49
    v_mul_f32 v175, v175, v49
    v_mul_f32 v184, v184, v49
    v_mul_f32 v185, v185, v49
    v_mul_f32 v186, v186, v49
    v_mul_f32 v187, v187, v49
    v_mul_f32 v188, v188, v49
    v_mul_f32 v189, v189, v49
    v_mul_f32 v190, v190, v49
    v_mul_f32 v191, v191, v49
    v_mul_f32 v200, v200, v49
    v_mul_f32 v201, v201, v49
    v_mul_f32 v202, v202, v49
    v_mul_f32 v203, v203, v49
    v_mul_f32 v204, v204, v49
    v_mul_f32 v205, v205, v49
    v_mul_f32 v206, v206, v49
    v_mul_f32 v207, v207, v49
    v_mul_f32 v216, v216, v49
    v_mul_f32 v217, v217, v49
    v_mul_f32 v218, v218, v49
    v_mul_f32 v219, v219, v49
    v_mul_f32 v220, v220, v49
    v_mul_f32 v221, v221, v49
    v_mul_f32 v222, v222, v49
    v_mul_f32 v223, v223, v49
    v_mul_f32 v232, v232, v49
    v_mul_f32 v233, v233, v49
    v_mul_f32 v234, v234, v49
    v_mul_f32 v235, v235, v49
    v_mul_f32 v236, v236, v49
    v_mul_f32 v237, v237, v49
    v_mul_f32 v238, v238, v49
    v_mul_f32 v239, v239, v49
    v_mul_f32 v248, v248, v49
    v_mul_f32 v249, v249, v49
    v_mul_f32 v250, v250, v49
    v_mul_f32 v251, v251, v49
    v_mul_f32 v252, v252, v49
    v_mul_f32 v253, v253, v49
    v_mul_f32 v254, v254, v49
    v_mul_f32 v255, v255, v49
    s_nop 1
    s_setpc_b64 s[42:43]
.section .rodata,"a"
.p2align 6
.amdhsa_kernel concat_heads__gqa_block_cached__mha_block_cached__near_ridge_kernel
  .amdhsa_next_free_vgpr 512
  .amdhsa_next_free_sgpr 100
  .amdhsa_accum_offset 256
  .amdhsa_group_segment_fixed_size 0
  .amdhsa_kernarg_size 104
  .amdhsa_user_sgpr_count 2
  .amdhsa_user_sgpr_kernarg_segment_ptr 1
  .amdhsa_system_sgpr_workgroup_id_x 1
  .amdhsa_float_denorm_mode_32 3
.end_amdhsa_kernel
```
